```python
import torch

def _softmax(x, axis=-1):
    return torch.softmax(x, dim=axis)
def _gelu(x):
    return torch.nn.functional.gelu(x, approximate="tanh")
def _silu(x):
    return torch.nn.functional.silu(x)
def _sigmoid(x):
    return torch.sigmoid(x)
def _layernorm(x, axis=-1, eps=1e-5):
    m = x.mean(dim=axis, keepdim=True)
    v = x.var(dim=axis, keepdim=True, unbiased=False)
    return (x - m) / torch.sqrt(v + eps)
def _scatter_add(tgt, idx, src, axis=0):
    return tgt.clone().index_add_(axis, idx, src)
def _segment_sum(src, seg, n):
    out = torch.zeros((n,) + src.shape[1:], dtype=src.dtype)
    return out.index_add_(0, seg, src)
def _pad(x, pw):
    flat = tuple(v for pair in reversed(pw) for v in pair)
    return torch.nn.functional.pad(x, flat)

kernel_name = 'standalone__window_attn_swin__vision'

def setup_inputs():

    _w = (lambda a: (lambda t: t.to(torch.bfloat16) if t.is_floating_point() else t)(torch.as_tensor(a)))
    H = W = 512
    C = 96
    ws = 8
    nh = 4
    shift = ws // 2
    coords = torch.stack(torch.meshgrid(torch.arange(ws), torch.arange(ws), indexing='ij'), 0).reshape(2, -1)
    rel = coords[:, :, None] - coords[:, None, :]
    rel[0] += ws - 1
    rel[1] += ws - 1
    rel[0] *= 2 * ws - 1
    rp_idx = rel.sum(0).to(torch.int64)
    img_mask = torch.zeros((1, H, W, 1), dtype=float)
    cnt = 0
    for hs in (slice(0, H - ws), slice(H - ws, H - shift), slice(H - shift, H)):
        for vs in (slice(0, W - ws), slice(W - ws, W - shift), slice(W - shift, W)):
            img_mask[:, hs, vs, :] = cnt
            cnt += 1
    mw = img_mask.reshape(1, H // ws, ws, W // ws, ws, 1).permute(0, 1, 3, 2, 4, 5).reshape(-1, ws * ws)
    am = mw[:, :, None] - mw[:, None, :]
    attn_mask = torch.where(am != 0, -100.0, 0.0).to(float)
    return {
        "x": _w((lambda *s: torch.randn(*s, dtype=torch.bfloat16) * 1.6)(1, H, W, C)),
        "wqkv": _w((lambda *s: torch.randn(*s, dtype=torch.bfloat16) * 1.6)(C, 3 * C) * 0.02),
        "wo": _w((lambda *s: torch.randn(*s, dtype=torch.bfloat16) * 0.05)(C, C) * 0.02),
        "rpb": _w((lambda *s: torch.randn(*s, dtype=torch.bfloat16) * 0.4)((2 * ws - 1) * (2 * ws - 1), nh)),
        "rp_idx": _w(rp_idx),
        "attn_mask": _w(attn_mask),
    }

def reference(x, wqkv, wo, rpb, rp_idx, attn_mask):
    B, H, W, C = x.shape
    N = rp_idx.shape[0]
    ws = int(round(N ** 0.5))
    nh = rpb.shape[-1]
    hd = C // nh
    shift = ws // 2
    xs = torch.roll(x, (-shift, -shift), (1, 2))
    nWh = H // ws
    nWw = W // ws
    xw = (lambda x, *d: x.permute(*d))(xs.reshape(B, nWh, ws, nWw, ws, C), 0, 1, 3, 2, 4, 5).reshape(B * nWh * nWw, N, C)
    qkv = (lambda x, *d: x.permute(*d))(torch.einsum('wnc,cd->wnd', xw, wqkv).reshape(-1, N, 3, nh, hd), 2, 0, 3, 1, 4)
    q, k, v = qkv[0], qkv[1], qkv[2]
    attn = torch.einsum('whid,whjd->whij', q, k) * (hd ** -0.5)
    bias = (lambda x, *d: x.permute(*d))(rpb[rp_idx.reshape(-1)].reshape(N, N, nh), 2, 0, 1)
    attn = attn + bias[None, :, :, :]
    attn = (attn.reshape(B, nWh * nWw, nh, N, N) + attn_mask[None, :, None, :, :]).reshape(-1, nh, N, N)
    attn = _softmax(attn, axis=-1)
    out = (lambda x, *d: x.permute(*d))(torch.einsum('whij,whjd->whid', attn, v), 0, 2, 1, 3).reshape(-1, N, C)
    out = torch.einsum('wnc,cd->wnd', out, wo)
    out = (lambda x, *d: x.permute(*d))(out.reshape(B, nWh, nWw, ws, ws, C), 0, 1, 3, 2, 4, 5).reshape(B, H, W, C)
    return torch.roll(out, (shift, shift), (1, 2))
```

```asm
; @launch grid=(256,1,1) block=(256,1,1) lds=163840
.amdgcn_target "amdgcn-amd-amdhsa--gfx950"
.text
.globl standalone__window_attn_swin__vision_kernel
.p2align 8
.type standalone__window_attn_swin__vision_kernel,@function
standalone__window_attn_swin__vision_kernel:
  s_cmp_ge_u32 s2, 256
  s_cbranch_scc1 L_end
  s_load_dwordx4 s[60:63], s[0:1], 0
  s_load_dwordx4 s[64:67], s[0:1], 16
  s_load_dwordx2 s[68:69], s[0:1], 48
  v_and_b32 v13, 63, v0
  s_getpc_b64 s[56:57]
L_pc:
  v_lshlrev_b32 v43, 6, v13
  s_mov_b32 s58, L_end-L_pc
  s_mov_b32 s59, 0x00020000
  v_lshrrev_b32 v12, 6, v0
  v_mov_b32 v14, v0
  v_readfirstlane_b32 s28, v12
  s_nop 1
  s_bfe_u32 s74, s2, 0x50003
  s_lshl_b32 s74, s74, 2
  s_add_u32 s74, s74, s28
  s_lshl_b32 s74, s74, 6
  s_lshl_b32 s29, s2, 2
  s_add_u32 s29, s29, s28
  s_lshr_b32 s30, s29, 6
  s_and_b32 s31, s29, 63
  s_lshl_b32 s55, s30, 3
  s_add_u32 s55, s55, 4
  s_add_u32 s54, s55, 0
  s_mul_i32 s32, s54, 98304
  s_add_u32 s54, s55, 2
  s_mul_i32 s33, s54, 98304
  s_add_u32 s54, s55, 4
  s_mul_i32 s34, s54, 98304
  s_add_u32 s54, s55, 6
  s_mul_i32 s35, s54, 98304
  s_lshl_b32 s53, s31, 3
  s_add_u32 s53, s53, 4
  s_mul_i32 s50, s28, 12288
  s_add_u32 s50, s50, 110592
  s_mov_b32 s48, 43691
  s_mov_b32 s49, 98304
  s_movk_i32 s51, 192
  v_add_u32 v20, 0, v13
  v_mul_u32_u24 v21, s48, v20
  v_lshrrev_b32 v21, 19, v21
  v_mul_u32_u24 v22, 12, v21
  v_sub_u32 v22, v20, v22
  v_lshrrev_b32 v23, 2, v21
  v_and_b32 v24, 2, v21
  v_add_u32 v23, v23, v24
  v_sub_u32 v23, v22, v23
  v_and_b32 v23, 3, v23
  v_and_or_b32 v22, v22, -4, v23
  v_and_b32 v24, 7, v21
  v_add_u32 v24, s53, v24
  v_and_b32 v24, 511, v24
  v_lshrrev_b32 v21, 3, v21
  v_mul_u32_u24 v21, s49, v21
  v_mad_u32_u24 v21, v24, s51, v21
  v_lshl_add_u32 v21, v22, 4, v21
  v_add_u32 v7, 2048, v21
  v_add_u32 v20, 64, v13
  v_mul_u32_u24 v21, s48, v20
  v_lshrrev_b32 v21, 19, v21
  v_mul_u32_u24 v22, 12, v21
  v_sub_u32 v22, v20, v22
  v_lshrrev_b32 v23, 2, v21
  v_and_b32 v24, 2, v21
  v_add_u32 v23, v23, v24
  v_sub_u32 v23, v22, v23
  v_and_b32 v23, 3, v23
  v_and_or_b32 v22, v22, -4, v23
  v_and_b32 v24, 7, v21
  v_add_u32 v24, s53, v24
  v_and_b32 v24, 511, v24
  v_lshrrev_b32 v21, 3, v21
  v_mul_u32_u24 v21, s49, v21
  v_mad_u32_u24 v21, v24, s51, v21
  v_lshl_add_u32 v21, v22, 4, v21
  v_add_u32 v8, 1024, v21
  v_add_u32 v20, 128, v13
  v_mul_u32_u24 v21, s48, v20
  v_lshrrev_b32 v21, 19, v21
  v_mul_u32_u24 v22, 12, v21
  v_sub_u32 v22, v20, v22
  v_lshrrev_b32 v23, 2, v21
  v_and_b32 v24, 2, v21
  v_add_u32 v23, v23, v24
  v_sub_u32 v23, v22, v23
  v_and_b32 v23, 3, v23
  v_and_or_b32 v22, v22, -4, v23
  v_and_b32 v24, 7, v21
  v_add_u32 v24, s53, v24
  v_and_b32 v24, 511, v24
  v_lshrrev_b32 v21, 3, v21
  v_mul_u32_u24 v21, s49, v21
  v_mad_u32_u24 v21, v24, s51, v21
  v_lshl_add_u32 v21, v22, 4, v21
  v_add_u32 v9, 0, v21
  v_mul_u32_u24 v25, s48, v14
  v_lshrrev_b32 v25, 19, v25
  v_mul_u32_u24 v26, 12, v25
  v_sub_u32 v26, v14, v26
  v_mul_u32_u24 v15, 576, v25
  v_lshl_add_u32 v15, v26, 4, v15
  v_lshlrev_b32 v17, 4, v14
  v_cmp_le_u32 vcc, 120, v14
  v_mov_b32 v35, 0
  v_mov_b32 v36, 120
  v_mov_b32 v37, 4
  v_cndmask_b32 v40, v35, v36, vcc
  v_cndmask_b32 v41, v37, v35, vcc
  v_add_u32 v32, 30720, v17
  v_sub_u32 v40, v14, v40
  v_lshrrev_b32 v42, 3, v40
  v_and_b32 v40, 7, v40
  v_mul_u32_u24 v42, 15, v42
  v_add3_u32 v42, v42, v40, v41
  v_lshlrev_b32 v30, 3, v42
  s_waitcnt lgkmcnt(0)
  s_sub_u32 s8, s60, 2048
  s_subb_u32 s9, s61, 0
  s_mov_b32 s10, 50333696
  s_mov_b32 s11, 0x00020000
  s_add_u32 s75, s74, 0
  s_buffer_load_dword s99, s[56:59], s75
  s_add_u32 s75, s74, 8192
  s_buffer_load_dword s99, s[56:59], s75
  s_add_u32 s75, s74, 16384
  s_buffer_load_dword s99, s[56:59], s75
  s_mov_b32 s16, s62
  s_mov_b32 s17, s63
  s_mov_b32 s18, 55296
  s_mov_b32 s19, 0x00020000
  s_mov_b32 s20, s64
  s_mov_b32 s21, s65
  s_mov_b32 s22, 18432
  s_mov_b32 s23, 0x00020000
  s_add_u32 s75, s74, 0
  s_buffer_load_dword s99, s[16:19], s75
  s_add_u32 s75, s74, 8192
  s_buffer_load_dword s99, s[16:19], s75
  s_add_u32 s75, s74, 16384
  s_buffer_load_dword s99, s[16:19], s75
  s_add_u32 s75, s74, 24576
  s_buffer_load_dword s99, s[16:19], s75
  s_add_u32 s75, s74, 32768
  s_buffer_load_dword s99, s[16:19], s75
  s_add_u32 s75, s74, 40960
  s_buffer_load_dword s99, s[16:19], s75
  s_add_u32 s75, s74, 49152
  s_buffer_load_dword s99, s[16:19], s75
  s_add_u32 s75, s74, 0
  s_buffer_load_dword s99, s[20:23], s75
  s_add_u32 s75, s74, 8192
  s_buffer_load_dword s99, s[20:23], s75
  s_add_u32 s75, s74, 16384
  s_buffer_load_dword s99, s[20:23], s75
  s_add_u32 m0, s50, 0
  s_nop 0
  buffer_load_dwordx4 v7, s[8:11], s32 offen offset:0 nt lds
  buffer_load_dwordx4 v8, s[8:11], s32 offen offset:1024 nt lds
  buffer_load_dwordx4 v9, s[8:11], s32 offen offset:2048 nt lds
  s_mov_b32 s24, s66
  s_mov_b32 s25, s67
  s_mov_b32 s26, 1800
  s_mov_b32 s27, 0x00020000
  buffer_load_dwordx4 v[232:235], v30, s[24:27], 0 offen
  buffer_load_dwordx4 v[236:239], v30, s[24:27], 0 offen offset:16
  s_mov_b32 s54, 0
  buffer_load_dwordx4 v[172:175], v15, s[16:19], s54 offen
  s_sub_u32 s12, s68, 2048
  s_subb_u32 s13, s69, 0
  s_mov_b32 s14, 50333696
  s_mov_b32 s15, 0x00020000
  s_add_u32 s54, s55, 128
  s_and_b32 s54, s54, 511
  s_mul_i32 s36, s54, 98304
  s_add_u32 s54, s55, 130
  s_and_b32 s54, s54, 511
  s_mul_i32 s37, s54, 98304
  s_add_u32 s54, s55, 132
  s_and_b32 s54, s54, 511
  s_mul_i32 s38, s54, 98304
  s_add_u32 s54, s55, 134
  s_and_b32 s54, s54, 511
  s_mul_i32 s39, s54, 98304
  s_add_u32 s54, s55, 256
  s_and_b32 s54, s54, 511
  s_mul_i32 s40, s54, 98304
  s_add_u32 s54, s55, 258
  s_and_b32 s54, s54, 511
  s_mul_i32 s41, s54, 98304
  s_add_u32 s54, s55, 260
  s_and_b32 s54, s54, 511
  s_mul_i32 s42, s54, 98304
  s_add_u32 s54, s55, 262
  s_and_b32 s54, s54, 511
  s_mul_i32 s43, s54, 98304
  s_add_u32 s54, s55, 384
  s_and_b32 s54, s54, 511
  s_mul_i32 s44, s54, 98304
  s_mov_b32 s54, 12096
  buffer_load_dwordx4 v[176:179], v15, s[16:19], s54 offen
  s_add_u32 s54, s55, 386
  s_and_b32 s54, s54, 511
  s_mul_i32 s45, s54, 98304
  s_add_u32 s54, s55, 388
  s_and_b32 s54, s54, 511
  s_mul_i32 s46, s54, 98304
  s_add_u32 s54, s55, 390
  s_and_b32 s54, s54, 511
  s_mul_i32 s47, s54, 98304
  v_mul_u32_u24 v47, 11, v26
  v_lshrrev_b32 v47, 5, v47
  v_lshlrev_b32 v50, 6, v25
  v_mad_u32_u24 v48, v47, 3, v26
  v_lshrrev_b32 v49, 2, v48
  v_and_b32 v48, 3, v48
  v_cmp_le_u32 vcc, 5, v49
  s_mov_b32 s54, 24192
  buffer_load_dwordx4 v[180:183], v15, s[16:19], s54 offen
  v_mul_u32_u24 v49, 6144, v49
  v_lshl_add_u32 v49, v48, 4, v49
  v_add_u32 v49, v49, v50
  v_add_u32 v48, 61440, v49
  v_subrev_u32 v49, 30720, v49
  v_cndmask_b32 v44, v48, v49, vcc
  v_mad_u32_u24 v48, v47, 3, v26
  v_add_u32 v48, 3, v48
  v_lshrrev_b32 v49, 2, v48
  v_and_b32 v48, 3, v48
  s_mov_b32 s54, 36288
  buffer_load_dwordx4 v[184:187], v15, s[16:19], s54 offen
  v_cmp_le_u32 vcc, 5, v49
  v_mul_u32_u24 v49, 6144, v49
  v_lshl_add_u32 v49, v48, 4, v49
  v_add_u32 v49, v49, v50
  v_add_u32 v48, 61440, v49
  v_subrev_u32 v49, 30720, v49
  v_cndmask_b32 v45, v48, v49, vcc
  v_lshrrev_b32 v47, 2, v26
  v_and_b32 v48, 3, v26
  v_mul_u32_u24 v47, 6144, v47
  s_mov_b32 s54, 48384
  buffer_load_dwordx4 v[188:191], v15, s[16:19], s54 offen
  v_lshl_add_u32 v47, v48, 4, v47
  v_add_u32 v47, v47, v50
  v_add_u32 v61, 92160, v47
  v_add_u32 v60, 6144, v47
  s_movk_i32 s52, 252
  v_cmp_gt_u32 s[70:71], s52, v14
  s_movk_i32 s52, 144
  v_cmp_gt_u32 s[74:75], s52, v14
  v_mov_b32 v63, v15
  v_mov_b32 v68, v17
  v_and_b32 v50, 31, v13
  v_lshrrev_b32 v51, 5, v13
  s_mov_b32 s54, 192
  buffer_load_dwordx4 v[192:195], v15, s[16:19], s54 offen
  v_bfe_u32 v52, v13, 2, 2
  v_and_b32 v53, 3, v13
  v_bfe_u32 v54, v13, 4, 1
  s_sub_u32 s52, s50, 49152
  v_lshrrev_b32 v55, 2, v50
  v_and_b32 v56, 2, v50
  v_add3_u32 v55, v55, v56, v51
  v_mul_u32_u24 v56, 192, v50
  v_add_u32 v56, s52, v56
  v_and_b32 v57, 3, v55
  s_mov_b32 s54, 12288
  buffer_load_dwordx4 v[196:199], v15, s[16:19], s54 offen
  v_lshl_add_u32 v4, v57, 4, v56
  v_add_u32 v55, 2, v55
  v_and_b32 v57, 3, v55
  v_lshl_add_u32 v5, v57, 4, v56
  v_lshl_add_u32 v6, v13, 4, s52
  v_mul_u32_u24 v55, 1920, v51
  v_lshl_add_u32 v55, v50, 4, v55
  v_add_u32 v55, 30720, v55
  v_bfe_u32 v56, v13, 2, 1
  v_xor_b32 v56, v56, v51
  s_mov_b32 s54, 24384
  buffer_load_dwordx4 v[200:203], v15, s[16:19], s54 offen
  v_mul_u32_u24 v56, 15360, v56
  s_cmp_eq_u32 s31, 63
  s_cselect_b32 s52, -1, 0
  v_and_b32 v56, s52, v56
  v_add_u32 v2, v55, v56
  v_mov_b32 v3, v2
  v_lshlrev_b32 v55, 5, v54
  v_lshl_add_u32 v56, v51, 2, v52
  v_lshl_add_u32 v56, v56, 6, v55
  v_and_b32 v57, 1, v53
  v_lshl_add_u32 v56, v57, 4, v56
  v_lshrrev_b32 v57, 1, v53
  s_mov_b32 s54, 36480
  buffer_load_dwordx4 v[204:207], v15, s[16:19], s54 offen
  v_lshl_add_u32 v56, v57, 3, v56
  v_add_u32 v1, 61440, v56
  v_lshl_add_u32 v56, v51, 3, v52
  v_lshl_add_u32 v56, v56, 6, v55
  v_lshl_add_u32 v0, v53, 3, v56
  v_add_u32 v252, 61440, v0
  v_mov_b32 v10, 1.0
  v_and_b32 v55, 27, v13
  v_mov_b32 v54, 0x3f803f80
  v_cmp_eq_u32 vcc, 24, v55
  s_nop 1
  v_cndmask_b32 v56, 0, v54, vcc
  s_mov_b32 s54, 48576
  buffer_load_dwordx4 v[208:211], v15, s[16:19], s54 offen
  v_cmp_eq_u32 vcc, 16, v55
  s_nop 1
  v_cndmask_b32 v57, 0, v54, vcc
  v_cmp_eq_u32 vcc, 8, v55
  s_nop 1
  v_cndmask_b32 v58, 0, v54, vcc
  v_cmp_eq_u32 vcc, 0, v55
  s_nop 1
  v_cndmask_b32 v59, 0, v54, vcc
  v_mov_b32 v108, v56
  v_mov_b32 v109, v56
  v_mov_b32 v110, v56
  v_mov_b32 v111, v56
  v_mov_b32 v112, v56
  v_mov_b32 v113, v56
  v_mov_b32 v114, v56
  s_add_u32 m0, s50, 3072
  s_nop 0
  buffer_load_dwordx4 v7, s[8:11], s33 offen offset:0 nt lds
  v_mov_b32 v115, v56
  v_mov_b32 v116, v56
  v_mov_b32 v117, v56
  v_mov_b32 v118, v56
  v_mov_b32 v119, v56
  v_mov_b32 v120, v56
  v_mov_b32 v121, v56
  v_mov_b32 v122, v56
  v_mov_b32 v123, v56
  v_mov_b32 v124, v57
  buffer_load_dwordx4 v8, s[8:11], s33 offen offset:1024 nt lds
  v_mov_b32 v125, v57
  v_mov_b32 v126, v57
  v_mov_b32 v127, v57
  v_mov_b32 v128, v57
  v_mov_b32 v129, v57
  v_mov_b32 v130, v57
  v_mov_b32 v131, v57
  v_mov_b32 v64, 0x3fb8aa3b
  v_mov_b32 v65, 0xc31044fe
  v_mov_b32 v66, 0x3e96c740
  buffer_load_dwordx4 v9, s[8:11], s33 offen offset:2048 nt lds
  v_mov_b32 v67, 0x3e96c740
  s_mov_b32 s53, 0x07060302
  s_cmp_eq_u32 s30, 15
  s_cselect_b32 s51, 15360, 0
  s_mov_b32 s52, 46080
  s_lshl_b32 s54, s28, 12
  v_add_u32 v62, s54, v43
  s_mov_b32 s54, L_loop-L_pc
  v_cmp_gt_u32 vcc, 240, v14
  s_waitcnt vmcnt(13)
  v_lshlrev_b32 v76, 16, v238
  v_mul_f32 v76, v76, v64
  v_add_f32 v80, v76, v65
  v_lshlrev_b32 v77, 16, v236
  v_mul_f32 v77, v77, v64
  v_add_f32 v81, v77, v65
  v_lshlrev_b32 v78, 16, v234
  v_mul_f32 v78, v78, v64
  v_add_f32 v82, v78, v65
  v_lshlrev_b32 v79, 16, v232
  v_mul_f32 v79, v79, v64
  v_add_f32 v83, v79, v65
  s_mov_b64 exec, vcc
  ds_write_b128 v32, v[76:79] offset:0
  ds_write_b128 v32, v[80:83] offset:15360
  s_mov_b64 exec, -1
  v_and_b32 v84, 0xffff0000, v238
  v_mul_f32 v84, v84, v64
  v_add_f32 v88, v84, v65
  v_and_b32 v85, 0xffff0000, v236
  v_mul_f32 v85, v85, v64
  v_add_f32 v89, v85, v65
  v_and_b32 v86, 0xffff0000, v234
  v_mul_f32 v86, v86, v64
  v_add_f32 v90, v86, v65
  v_and_b32 v87, 0xffff0000, v232
  v_mul_f32 v87, v87, v64
  v_add_f32 v91, v87, v65
  s_mov_b64 exec, vcc
  ds_write_b128 v32, v[84:87] offset:3840
  ds_write_b128 v32, v[88:91] offset:19200
  s_mov_b64 exec, -1
  s_add_u32 m0, s50, 6144
  s_nop 0
  buffer_load_dwordx4 v7, s[8:11], s34 offen offset:0 nt lds
  v_lshlrev_b32 v92, 16, v239
  v_mul_f32 v92, v92, v64
  v_add_f32 v96, v92, v65
  v_lshlrev_b32 v93, 16, v237
  v_mul_f32 v93, v93, v64
  v_add_f32 v97, v93, v65
  v_lshlrev_b32 v94, 16, v235
  v_mul_f32 v94, v94, v64
  v_add_f32 v98, v94, v65
  v_lshlrev_b32 v95, 16, v233
  v_mul_f32 v95, v95, v64
  v_add_f32 v99, v95, v65
  s_mov_b64 exec, vcc
  ds_write_b128 v32, v[92:95] offset:7680
  ds_write_b128 v32, v[96:99] offset:23040
  s_mov_b64 exec, -1
  v_and_b32 v100, 0xffff0000, v239
  v_mul_f32 v100, v100, v64
  v_add_f32 v104, v100, v65
  v_and_b32 v101, 0xffff0000, v237
  v_mul_f32 v101, v101, v64
  v_add_f32 v105, v101, v65
  v_and_b32 v102, 0xffff0000, v235
  v_mul_f32 v102, v102, v64
  v_add_f32 v106, v102, v65
  v_and_b32 v103, 0xffff0000, v233
  v_mul_f32 v103, v103, v64
  v_add_f32 v107, v103, v65
  s_mov_b64 exec, vcc
  ds_write_b128 v32, v[100:103] offset:11520
  ds_write_b128 v32, v[104:107] offset:26880
  s_mov_b64 exec, -1
  buffer_load_dwordx4 v8, s[8:11], s34 offen offset:1024 nt lds
  buffer_load_dwordx4 v9, s[8:11], s34 offen offset:2048 nt lds
  s_waitcnt vmcnt(15)
  v_lshlrev_b32 v70, 16, v172
  v_and_b32 v71, 0xffff0000, v172
  v_pk_mul_f32 v[70:71], v[70:71], v[66:67]
  v_cvt_pk_bf16_f32 v172, v70, v71
  v_lshlrev_b32 v72, 16, v173
  v_and_b32 v73, 0xffff0000, v173
  v_pk_mul_f32 v[72:73], v[72:73], v[66:67]
  v_cvt_pk_bf16_f32 v173, v72, v73
  v_lshlrev_b32 v70, 16, v174
  v_and_b32 v71, 0xffff0000, v174
  v_pk_mul_f32 v[70:71], v[70:71], v[66:67]
  v_cvt_pk_bf16_f32 v174, v70, v71
  v_lshlrev_b32 v72, 16, v175
  v_and_b32 v73, 0xffff0000, v175
  v_pk_mul_f32 v[72:73], v[72:73], v[66:67]
  v_cvt_pk_bf16_f32 v175, v72, v73
  s_mov_b64 exec, s[70:71]
  ds_write_b128 v44, v[172:175] offset:0
  s_mov_b64 exec, -1
  s_add_u32 m0, s50, 9216
  s_nop 0
  buffer_load_dwordx4 v7, s[8:11], s35 offen offset:0 nt lds
  s_waitcnt vmcnt(15)
  v_lshlrev_b32 v70, 16, v176
  v_and_b32 v71, 0xffff0000, v176
  v_pk_mul_f32 v[70:71], v[70:71], v[66:67]
  v_cvt_pk_bf16_f32 v176, v70, v71
  v_lshlrev_b32 v72, 16, v177
  v_and_b32 v73, 0xffff0000, v177
  v_pk_mul_f32 v[72:73], v[72:73], v[66:67]
  v_cvt_pk_bf16_f32 v177, v72, v73
  v_lshlrev_b32 v70, 16, v178
  v_and_b32 v71, 0xffff0000, v178
  v_pk_mul_f32 v[70:71], v[70:71], v[66:67]
  v_cvt_pk_bf16_f32 v178, v70, v71
  v_lshlrev_b32 v72, 16, v179
  v_and_b32 v73, 0xffff0000, v179
  v_pk_mul_f32 v[72:73], v[72:73], v[66:67]
  v_cvt_pk_bf16_f32 v179, v72, v73
  s_mov_b64 exec, s[70:71]
  ds_write_b128 v44, v[176:179] offset:1344
  s_mov_b64 exec, -1
  buffer_load_dwordx4 v8, s[8:11], s35 offen offset:1024 nt lds
  s_waitcnt vmcnt(15)
  v_lshlrev_b32 v70, 16, v180
  v_and_b32 v71, 0xffff0000, v180
  v_pk_mul_f32 v[70:71], v[70:71], v[66:67]
  v_cvt_pk_bf16_f32 v180, v70, v71
  v_lshlrev_b32 v72, 16, v181
  v_and_b32 v73, 0xffff0000, v181
  v_pk_mul_f32 v[72:73], v[72:73], v[66:67]
  v_cvt_pk_bf16_f32 v181, v72, v73
  v_lshlrev_b32 v70, 16, v182
  v_and_b32 v71, 0xffff0000, v182
  v_pk_mul_f32 v[70:71], v[70:71], v[66:67]
  v_cvt_pk_bf16_f32 v182, v70, v71
  v_lshlrev_b32 v72, 16, v183
  v_and_b32 v73, 0xffff0000, v183
  v_pk_mul_f32 v[72:73], v[72:73], v[66:67]
  v_cvt_pk_bf16_f32 v183, v72, v73
  s_mov_b64 exec, s[70:71]
  ds_write_b128 v44, v[180:183] offset:2688
  s_mov_b64 exec, -1
  buffer_load_dwordx4 v9, s[8:11], s35 offen offset:2048 nt lds
  s_waitcnt vmcnt(15)
  v_lshlrev_b32 v70, 16, v184
  v_and_b32 v71, 0xffff0000, v184
  v_pk_mul_f32 v[70:71], v[70:71], v[66:67]
  v_cvt_pk_bf16_f32 v184, v70, v71
  v_lshlrev_b32 v72, 16, v185
  v_and_b32 v73, 0xffff0000, v185
  v_pk_mul_f32 v[72:73], v[72:73], v[66:67]
  v_cvt_pk_bf16_f32 v185, v72, v73
  v_lshlrev_b32 v70, 16, v186
  v_and_b32 v71, 0xffff0000, v186
  v_pk_mul_f32 v[70:71], v[70:71], v[66:67]
  v_cvt_pk_bf16_f32 v186, v70, v71
  v_lshlrev_b32 v72, 16, v187
  v_and_b32 v73, 0xffff0000, v187
  v_pk_mul_f32 v[72:73], v[72:73], v[66:67]
  v_cvt_pk_bf16_f32 v187, v72, v73
  s_mov_b64 exec, s[70:71]
  ds_write_b128 v44, v[184:187] offset:4032
  s_mov_b64 exec, -1
  s_mov_b32 s54, 384
  buffer_load_dwordx4 v[132:135], v15, s[16:19], s54 offen
  s_waitcnt vmcnt(15)
  v_lshlrev_b32 v70, 16, v188
  v_and_b32 v71, 0xffff0000, v188
  v_pk_mul_f32 v[70:71], v[70:71], v[66:67]
  v_cvt_pk_bf16_f32 v188, v70, v71
  v_lshlrev_b32 v72, 16, v189
  v_and_b32 v73, 0xffff0000, v189
  v_pk_mul_f32 v[72:73], v[72:73], v[66:67]
  v_cvt_pk_bf16_f32 v189, v72, v73
  v_lshlrev_b32 v70, 16, v190
  v_and_b32 v71, 0xffff0000, v190
  v_pk_mul_f32 v[70:71], v[70:71], v[66:67]
  v_cvt_pk_bf16_f32 v190, v70, v71
  v_lshlrev_b32 v72, 16, v191
  v_and_b32 v73, 0xffff0000, v191
  v_pk_mul_f32 v[72:73], v[72:73], v[66:67]
  v_cvt_pk_bf16_f32 v191, v72, v73
  s_mov_b64 exec, s[74:75]
  ds_write_b128 v44, v[188:191] offset:5376
  s_mov_b64 exec, -1
  s_mov_b32 s54, 12480
  buffer_load_dwordx4 v[136:139], v15, s[16:19], s54 offen
  s_waitcnt vmcnt(15)
  s_mov_b64 exec, s[70:71]
  ds_write_b128 v45, v[192:195] offset:0
  s_mov_b64 exec, -1
  s_mov_b32 s54, 24576
  buffer_load_dwordx4 v[140:143], v15, s[16:19], s54 offen
  s_waitcnt vmcnt(15)
  s_mov_b64 exec, s[70:71]
  ds_write_b128 v45, v[196:199] offset:1344
  s_mov_b64 exec, -1
  s_mov_b32 s54, 36672
  buffer_load_dwordx4 v[144:147], v15, s[16:19], s54 offen
  s_waitcnt vmcnt(15)
  s_mov_b64 exec, s[70:71]
  ds_write_b128 v45, v[200:203] offset:2688
  s_mov_b64 exec, -1
  s_mov_b32 s54, 48768
  buffer_load_dwordx4 v[148:151], v15, s[16:19], s54 offen
  s_waitcnt vmcnt(15)
  s_mov_b64 exec, s[70:71]
  ds_write_b128 v45, v[204:207] offset:4032
  s_mov_b64 exec, -1
  s_mov_b32 s54, 0
  buffer_load_dwordx4 v[152:155], v17, s[20:23], s54 offen
  s_waitcnt vmcnt(15)
  s_mov_b64 exec, s[74:75]
  ds_write_b128 v45, v[208:211] offset:5376
  s_mov_b64 exec, -1
  s_mov_b32 s54, 4032
  buffer_load_dwordx4 v[156:159], v17, s[20:23], s54 offen
  s_mov_b32 s54, 8064
  buffer_load_dwordx4 v[160:163], v17, s[20:23], s54 offen
  s_mov_b32 s54, 12096
  buffer_load_dwordx4 v[164:167], v17, s[20:23], s54 offen
  s_mov_b32 s54, 16128
  buffer_load_dwordx4 v[168:171], v17, s[20:23], s54 offen
  s_mov_b32 s48, 0x00ffffff
  s_mov_b32 s49, 0x00ffffff
  s_mov_b32 s60, 0xff000000
  s_mov_b32 s61, 0xff000000
  s_mov_b32 s62, 0x0000ffff
  s_mov_b32 s63, 0x0000ffff
  s_mov_b32 s64, 0xffff0000
  s_mov_b32 s65, 0xffff0000
  s_mov_b32 s66, 0x000000ff
  s_mov_b32 s67, 0x000000ff
  s_mov_b32 s68, 0xffffff00
  s_mov_b32 s69, 0xffffff00
  s_mov_b32 s55, 0x10000
  s_waitcnt lgkmcnt(0)
  s_barrier
.p2align 3
L_loop:
  ds_read_b64_tr_b16 a[48:49], v252 offset:0
  ds_read_b64_tr_b16 a[50:51], v252 offset:256
  ds_read_b64_tr_b16 a[72:73], v252 offset:6144
  ds_read_b64_tr_b16 a[74:75], v252 offset:6400
  ds_read_b64_tr_b16 a[52:53], v252 offset:1024
  ds_read_b64_tr_b16 a[54:55], v252 offset:1280
  ds_read_b64_tr_b16 a[76:77], v252 offset:7168
  s_mov_b32 s73, (L_end-L_loop)/4+L_loop-L_pc
  ds_read_b64_tr_b16 a[78:79], v252 offset:7424
  s_mov_b32 s72, 2*((L_end-L_loop)/4)+L_loop-L_pc
  ds_read_b64_tr_b16 a[56:57], v252 offset:2048
  v_cmp_gt_u32 vcc, s52, v2
  v_nop
  v_nop
  ds_read_b64_tr_b16 a[58:59], v252 offset:2304
  ds_read_b64_tr_b16 a[80:81], v252 offset:8192
  ds_read_b64_tr_b16 a[82:83], v252 offset:8448
  ds_read_b64_tr_b16 a[60:61], v252 offset:3072
  ds_read_b64_tr_b16 a[62:63], v252 offset:3328
  ds_read_b64_tr_b16 a[84:85], v252 offset:9216
  ds_read_b64_tr_b16 a[86:87], v252 offset:9472
  ds_read_b64_tr_b16 a[64:65], v252 offset:4096
  ds_read_b64_tr_b16 a[66:67], v252 offset:4352
  ds_read_b64_tr_b16 a[88:89], v252 offset:10240
  ds_read_b64_tr_b16 a[90:91], v252 offset:10496
  ds_read_b64_tr_b16 a[68:69], v252 offset:5120
  ds_read_b64_tr_b16 a[70:71], v252 offset:5376
  ds_read_b64_tr_b16 a[92:93], v252 offset:11264
  ds_read_b64_tr_b16 a[94:95], v252 offset:11520
  ds_read_b64_tr_b16 a[96:97], v252 offset:12288
  ds_read_b64_tr_b16 a[98:99], v252 offset:12544
  ds_read_b64_tr_b16 a[100:101], v252 offset:13312
  ds_read_b64_tr_b16 a[102:103], v252 offset:13568
  ds_read_b64_tr_b16 a[104:105], v252 offset:14336
  ds_read_b64_tr_b16 a[106:107], v252 offset:14592
  ds_read_b64_tr_b16 a[108:109], v252 offset:15360
  ds_read_b64_tr_b16 a[110:111], v252 offset:15616
  ds_read_b64_tr_b16 a[112:113], v252 offset:16384
  ds_read_b64_tr_b16 a[114:115], v252 offset:16640
  ds_read_b64_tr_b16 a[116:117], v252 offset:17408
  ds_read_b64_tr_b16 a[118:119], v252 offset:17664
  ds_read_b128 v[172:175], v2 offset:896
  ds_read_b128 v[176:179], v2 offset:768
  ds_read_b128 v[180:183], v2 offset:640
  s_waitcnt vmcnt(16)
  ds_read_b128 a[0:3], v4 offset:49152
  ds_read_b128 a[4:7], v5 offset:49152
  ds_read_b128 a[8:11], v4 offset:49216
  ds_read_b128 a[12:15], v5 offset:49216
  ds_read_b128 a[16:19], v4 offset:49280
  ds_read_b128 a[20:23], v5 offset:49280
  ds_read_b128 v[184:187], v2 offset:512
  ds_read_b128 v[188:191], v3 offset:384
  ds_read_b128 v[192:195], v3 offset:256
  s_waitcnt lgkmcnt(8)
  v_mfma_f32_32x32x16_bf16 v[220:235], a[48:51], a[0:3], 0
  ds_read_b128 v[196:199], v3 offset:128
  v_mfma_f32_32x32x16_bf16 v[236:251], a[72:75], a[0:3], 0
  ds_read_b128 v[200:203], v3 offset:0
  ds_read_b64_tr_b16 a[120:121], v252 offset:18432
  ds_read_b64_tr_b16 a[122:123], v252 offset:18688
  s_waitcnt lgkmcnt(9)
  v_mfma_f32_32x32x16_bf16 v[220:235], a[52:55], a[4:7], v[220:235]
  ds_read_b64_tr_b16 a[124:125], v252 offset:19456
  ds_read_b64_tr_b16 a[126:127], v252 offset:19712
  ds_read_b64_tr_b16 a[128:129], v252 offset:20480
  ds_read_b64_tr_b16 a[130:131], v252 offset:20736
  ds_read_b64_tr_b16 a[132:133], v252 offset:21504
  v_mfma_f32_32x32x16_bf16 v[236:251], a[76:79], a[4:7], v[236:251]
  ds_read_b64_tr_b16 a[134:135], v252 offset:21760
  ds_read_b64_tr_b16 a[136:137], v252 offset:22528
  ds_read_b64_tr_b16 a[138:139], v252 offset:22784
  v_mfma_f32_32x32x16_bf16 v[220:235], a[56:59], a[8:11], v[220:235]
  ds_read_b64_tr_b16 a[140:141], v252 offset:23552
  ds_read_b64_tr_b16 a[142:143], v252 offset:23808
  ds_read_b64_tr_b16 a[144:145], v252 offset:24576
  v_mfma_f32_32x32x16_bf16 v[236:251], a[80:83], a[8:11], v[236:251]
  v_mfma_f32_32x32x16_bf16 v[220:235], a[60:63], a[12:15], v[220:235]
  ds_read_b64_tr_b16 a[146:147], v252 offset:24832
  ds_read_b64_tr_b16 a[148:149], v252 offset:25600
  ds_read_b64_tr_b16 a[150:151], v252 offset:25856
  ds_read_b64_tr_b16 a[152:153], v252 offset:26624
  ds_read_b64_tr_b16 a[154:155], v252 offset:26880
  ds_read_b64_tr_b16 a[156:157], v252 offset:27648
  v_mfma_f32_32x32x16_bf16 v[236:251], a[84:87], a[12:15], v[236:251]
  ds_read_b64_tr_b16 a[158:159], v252 offset:27904
  ds_read_b64_tr_b16 a[160:161], v252 offset:28672
  ds_read_b64_tr_b16 a[162:163], v252 offset:28928
  s_waitcnt lgkmcnt(12)
  v_mfma_f32_32x32x16_bf16 v[220:235], a[64:67], a[16:19], v[220:235]
  ds_read_b64_tr_b16 a[164:165], v252 offset:29696
  ds_read_b64_tr_b16 a[166:167], v252 offset:29952
  v_mfma_f32_32x32x16_bf16 v[236:251], a[88:91], a[16:19], v[236:251]
  v_mfma_f32_32x32x16_bf16 v[220:235], a[68:71], a[20:23], v[220:235]
  v_mfma_f32_32x32x16_bf16 v[236:251], a[92:95], a[20:23], v[236:251]
  s_nop 9
  v_cvt_pk_bf16_f32 v12, v220, v221
  v_cvt_pk_bf16_f32 v13, v222, v223
  v_cvt_pk_bf16_f32 v14, v224, v225
  v_cvt_pk_bf16_f32 v15, v226, v227
  v_cvt_pk_bf16_f32 v16, v228, v229
  v_cvt_pk_bf16_f32 v17, v230, v231
  v_cvt_pk_bf16_f32 v84, v232, v233
  v_cvt_pk_bf16_f32 v85, v234, v235
  v_mfma_f32_32x32x16_bf16 v[220:235], a[96:99], a[0:3], 0
  v_mfma_f32_32x32x16_bf16 v[220:235], a[100:103], a[4:7], v[220:235]
  v_cvt_pk_bf16_f32 v86, v236, v237
  v_cvt_pk_bf16_f32 v87, v238, v239
  v_cvt_pk_bf16_f32 v88, v240, v241
  v_cvt_pk_bf16_f32 v89, v242, v243
  v_cvt_pk_bf16_f32 v18, v244, v245
  v_cvt_pk_bf16_f32 v19, v246, v247
  v_mfma_f32_32x32x16_bf16 v[172:187], v[84:87], v[12:15], v[172:187]
  s_waitcnt vmcnt(10)
  ds_read_b128 a[24:27], v4 offset:55296
  ds_read_b128 a[28:31], v5 offset:55296
  ds_read_b128 a[32:35], v4 offset:55360
  v_cvt_pk_bf16_f32 v20, v248, v249
  v_cvt_pk_bf16_f32 v21, v250, v251
  v_mfma_f32_32x32x16_bf16 v[220:235], a[104:107], a[8:11], v[220:235]
  ds_read_b128 a[36:39], v5 offset:55360
  v_mfma_f32_32x32x16_bf16 v[220:235], a[108:111], a[12:15], v[220:235]
  ds_read_b128 a[40:43], v4 offset:55424
  ds_read_b128 a[44:47], v5 offset:55424
  s_add_u32 m0, s50, 0
  s_mov_b64 exec, s[70:71]
  s_waitcnt vmcnt(9)
  ds_write_b128 v60, v[132:135] offset:0
  s_mov_b64 exec, -1
  v_mfma_f32_32x32x8_bf16 v[172:187], v[88:89], v[16:17], v[172:187]
  buffer_load_dwordx4 v7, s[8:11], s36 offen offset:0 nt lds
  v_mov_b32 v132, v57
  v_mov_b32 v133, v57
  v_mov_b32 v134, v57
  v_mov_b32 v135, v57
  s_waitcnt lgkmcnt(6)
  v_mfma_f32_32x32x16_bf16 v[236:251], a[48:51], a[24:27], 0
  s_waitcnt lgkmcnt(3)
  v_mfma_f32_32x32x16_bf16 v[236:251], a[52:55], a[28:31], v[236:251]
  s_mov_b64 exec, s[70:71]
  s_waitcnt vmcnt(9)
  ds_write_b128 v60, v[136:139] offset:1344
  s_mov_b64 exec, -1
  v_mfma_f32_32x32x16_bf16 v[236:251], a[56:59], a[32:35], v[236:251]
  v_mov_b32 v136, v57
  v_mov_b32 v137, v57
  v_mov_b32 v138, v57
  v_mov_b32 v139, v57
  v_exp_f32 v172, v172
  v_mfma_f32_32x32x16_bf16 v[236:251], a[60:63], a[36:39], v[236:251]
  v_exp_f32 v173, v173
  v_exp_f32 v174, v174
  v_exp_f32 v175, v175
  v_mfma_f32_32x32x16_bf16 v[220:235], a[112:115], a[16:19], v[220:235]
  v_exp_f32 v176, v176
  v_exp_f32 v177, v177
  v_cvt_pk_bf16_f32 v172, v172, v173
  s_waitcnt lgkmcnt(1)
  v_mfma_f32_32x32x16_bf16 v[236:251], a[64:67], a[40:43], v[236:251]
  v_exp_f32 v178, v178
  v_exp_f32 v179, v179
  v_cvt_pk_bf16_f32 v173, v174, v175
  v_cvt_pk_bf16_f32 v174, v176, v177
  v_mfma_f32_32x32x16_bf16 v[220:235], a[116:119], a[20:23], v[220:235]
  v_cvt_pk_bf16_f32 v175, v178, v179
  v_exp_f32 v180, v180
  v_exp_f32 v181, v181
  v_mfma_f32_32x32x16_bf16 v[236:251], a[68:71], a[44:47], v[236:251]
  s_mov_b64 exec, s[70:71]
  s_waitcnt vmcnt(8)
  ds_write_b128 v60, v[140:143] offset:2688
  s_mov_b64 exec, -1
  buffer_load_dwordx4 v8, s[8:11], s36 offen offset:1024 nt lds
  s_mov_b64 exec, s[70:71]
  s_waitcnt vmcnt(8)
  ds_write_b128 v60, v[144:147] offset:4032
  s_mov_b64 exec, -1
  v_cvt_pk_bf16_f32 v22, v220, v221
  v_cvt_pk_bf16_f32 v23, v222, v223
  v_cvt_pk_bf16_f32 v96, v224, v225
  v_cvt_pk_bf16_f32 v97, v226, v227
  s_mov_b64 exec, s[74:75]
  s_waitcnt vmcnt(7)
  ds_write_b128 v60, v[148:151] offset:5376
  s_mov_b64 exec, -1
  v_cvt_pk_bf16_f32 v98, v228, v229
  v_cvt_pk_bf16_f32 v99, v230, v231
  v_cvt_pk_bf16_f32 v100, v232, v233
  v_cvt_pk_bf16_f32 v101, v234, v235
  v_mfma_f32_32x32x16_bf16 v[220:235], a[72:75], a[24:27], 0
  v_cvt_pk_bf16_f32 v24, v236, v237
  v_cvt_pk_bf16_f32 v25, v238, v239
  v_cvt_pk_bf16_f32 v26, v240, v241
  v_cvt_pk_bf16_f32 v27, v242, v243
  v_cvt_pk_bf16_f32 v28, v244, v245
  v_cvt_pk_bf16_f32 v29, v246, v247
  v_mfma_f32_32x32x16_bf16 v[220:235], a[76:79], a[28:31], v[220:235]
  v_cvt_pk_bf16_f32 v90, v248, v249
  v_cvt_pk_bf16_f32 v91, v250, v251
  v_exp_f32 v182, v182
  v_exp_f32 v183, v183
  v_mfma_f32_32x32x16_bf16 v[236:251], a[96:99], a[24:27], 0
  v_exp_f32 v184, v184
  v_exp_f32 v185, v185
  v_exp_f32 v186, v186
  v_mfma_f32_32x32x16_bf16 v[236:251], a[100:103], a[28:31], v[236:251]
  v_exp_f32 v187, v187
  v_cvt_pk_bf16_f32 v176, v180, v181
  v_cvt_pk_bf16_f32 v177, v182, v183
  v_cvt_pk_bf16_f32 v178, v184, v185
  v_cvt_pk_bf16_f32 v179, v186, v187
  v_mfma_f32_32x32x16_bf16 v[220:235], a[80:83], a[32:35], v[220:235]
  ds_read_b128 v[180:183], v3 offset:1152
  ds_read_b128 v[184:187], v3 offset:1024
  v_mov_b32 v140, v58
  v_mov_b32 v141, v58
  v_mov_b32 v148, v58
  v_mov_b32 v142, v58
  v_mfma_f32_32x32x16_bf16 v[236:251], a[104:107], a[32:35], v[236:251]
  v_mov_b32 v149, v58
  v_mov_b32 v143, v58
  v_mov_b32 v150, v58
  v_mov_b32 v144, v58
  v_mov_b32 v151, v58
  v_mov_b32 v145, v58
  v_mfma_f32_32x32x16_bf16 v[220:235], a[84:87], a[36:39], v[220:235]
  buffer_load_dwordx4 v9, s[8:11], s36 offen offset:2048 nt lds
  s_add_u32 m0, s50, 3072
  v_mov_b32 v146, v58
  v_mov_b32 v147, v58
  v_mfma_f32_32x32x16_bf16 v[236:251], a[108:111], a[36:39], v[236:251]
  s_mov_b64 exec, s[70:71]
  s_waitcnt vmcnt(7)
  ds_write_b128 v61, v[152:155] offset:0
  s_mov_b64 exec, -1
  v_mfma_f32_32x32x16_bf16 v[220:235], a[88:91], a[40:43], v[220:235]
  v_mov_b32 v152, v58
  v_mov_b32 v153, v58
  v_mov_b32 v154, v58
  v_mov_b32 v155, v58
  v_mfma_f32_32x32x16_bf16 v[236:251], a[112:115], a[40:43], v[236:251]
  s_mov_b64 exec, s[70:71]
  s_waitcnt vmcnt(6)
  ds_write_b128 v61, v[156:159] offset:1344
  s_mov_b64 exec, -1
  v_mfma_f32_32x32x16_bf16 v[220:235], a[92:95], a[44:47], v[220:235]
  v_mov_b32 v156, v59
  v_mov_b32 v157, v59
  v_mov_b32 v158, v59
  v_mov_b32 v159, v59
  v_mfma_f32_32x32x16_bf16 v[236:251], a[116:119], a[44:47], v[236:251]
  s_mov_b64 exec, s[70:71]
  s_waitcnt vmcnt(5)
  ds_write_b128 v61, v[160:163] offset:2688
  s_mov_b64 exec, -1
  s_mov_b64 exec, s[70:71]
  s_waitcnt vmcnt(4)
  ds_write_b128 v61, v[164:167] offset:4032
  s_mov_b64 exec, -1
  v_cvt_pk_bf16_f32 v92, v220, v221
  v_cvt_pk_bf16_f32 v93, v222, v223
  v_cvt_pk_bf16_f32 v94, v224, v225
  v_cvt_pk_bf16_f32 v95, v226, v227
  v_mfma_f32_32x32x16_bf16 v[188:203], v[90:93], v[12:15], v[188:203]
  s_mov_b64 exec, s[74:75]
  s_waitcnt vmcnt(3)
  ds_write_b128 v61, v[168:171] offset:5376
  s_mov_b64 exec, -1
  s_waitcnt lgkmcnt(0)
  s_barrier
  ds_read_b64_tr_b16 a[240:241], v0 offset:6144
  ds_read_b64_tr_b16 a[242:243], v0 offset:6400
  ds_read_b64_tr_b16 a[244:245], v0 offset:7168
  ds_read_b64_tr_b16 a[246:247], v0 offset:7424
  v_mfma_f32_32x32x8_bf16 v[188:203], v[94:95], v[16:17], v[188:203]
  ds_read_b64_tr_b16 a[248:249], v0 offset:8192
  ds_read_b64_tr_b16 a[250:251], v0 offset:8448
  ds_read_b64_tr_b16 a[252:253], v0 offset:9216
  ds_read_b64_tr_b16 a[254:255], v0 offset:9472
  buffer_load_dwordx4 v7, s[8:11], s37 offen offset:0 nt lds
  ds_read_b64_tr_b16 a[168:169], v1 offset:30720
  ds_read_b64_tr_b16 a[170:171], v1 offset:31232
  v_cvt_pk_bf16_f32 v30, v228, v229
  v_cvt_pk_bf16_f32 v31, v230, v231
  v_cvt_pk_bf16_f32 v32, v232, v233
  v_cvt_pk_bf16_f32 v33, v234, v235
  v_cvt_pk_bf16_f32 v34, v236, v237
  v_cvt_pk_bf16_f32 v35, v238, v239
  v_cvt_pk_bf16_f32 v102, v240, v241
  v_cvt_pk_bf16_f32 v103, v242, v243
  v_cvt_pk_bf16_f32 v104, v244, v245
  v_cvt_pk_bf16_f32 v105, v246, v247
  v_cvt_pk_bf16_f32 v106, v248, v249
  v_cvt_pk_bf16_f32 v107, v250, v251
  v_exp_f32 v188, v188
  v_exp_f32 v189, v189
  v_exp_f32 v190, v190
  v_exp_f32 v191, v191
  v_exp_f32 v192, v192
  s_waitcnt lgkmcnt(7)
  v_mfma_f32_32x32x16_bf16 v[220:235], a[0:3], a[240:243], 0
  ds_read_b64_tr_b16 a[172:173], v1 offset:31744
  ds_read_b64_tr_b16 a[174:175], v1 offset:32256
  ds_read_b64_tr_b16 a[176:177], v1 offset:32768
  ds_read_b64_tr_b16 a[178:179], v1 offset:33280
  ds_read_b64_tr_b16 a[180:181], v1 offset:33792
  ds_read_b64_tr_b16 a[182:183], v1 offset:34304
  v_mfma_f32_32x32x16_bf16 v[236:251], a[24:27], a[240:243], 0
  ds_read_b64_tr_b16 a[240:241], v0 offset:10240
  ds_read_b64_tr_b16 a[242:243], v0 offset:10496
  ds_read_b64_tr_b16 a[184:185], v1 offset:34816
  v_exp_f32 v193, v193
  s_waitcnt lgkmcnt(9)
  v_mfma_f32_32x32x16_bf16 v[220:235], a[4:7], a[244:247], v[220:235]
  ds_read_b64_tr_b16 a[186:187], v1 offset:35328
  ds_read_b64_tr_b16 a[188:189], v1 offset:35840
  ds_read_b64_tr_b16 a[190:191], v1 offset:36352
  ds_read_b64_tr_b16 a[192:193], v1 offset:36864
  ds_read_b64_tr_b16 a[194:195], v1 offset:37376
  v_cvt_pk_bf16_f32 v188, v188, v189
  v_mfma_f32_32x32x16_bf16 v[236:251], a[28:31], a[244:247], v[236:251]
  v_exp_f32 v194, v194
  v_exp_f32 v195, v195
  v_cvt_pk_bf16_f32 v189, v190, v191
  v_cvt_pk_bf16_f32 v190, v192, v193
  v_mfma_f32_32x32x16_bf16 v[220:235], a[8:11], a[248:251], v[220:235]
  v_cvt_pk_bf16_f32 v191, v194, v195
  v_exp_f32 v196, v196
  v_exp_f32 v197, v197
  v_mov_b32 v164, v59
  v_mfma_f32_32x32x16_bf16 v[236:251], a[32:35], a[248:251], v[236:251]
  ds_read_b64_tr_b16 a[244:245], v0 offset:11264
  ds_read_b64_tr_b16 a[246:247], v0 offset:11520
  ds_read_b64_tr_b16 a[248:249], v0 offset:12288
  ds_read_b64_tr_b16 a[250:251], v0 offset:12544
  ds_read_b64_tr_b16 a[196:197], v1 offset:37888
  ds_read_b64_tr_b16 a[198:199], v1 offset:38400
  v_mfma_f32_32x32x16_bf16 v[220:235], a[12:15], a[252:255], v[220:235]
  buffer_load_dwordx4 v8, s[8:11], s37 offen offset:1024 nt lds
  ds_read_b64_tr_b16 a[200:201], v1 offset:38912
  ds_read_b64_tr_b16 a[202:203], v1 offset:39424
  ds_read_b64_tr_b16 a[204:205], v1 offset:39936
  ds_read_b64_tr_b16 a[206:207], v1 offset:40448
  v_mfma_f32_32x32x16_bf16 v[236:251], a[36:39], a[252:255], v[236:251]
  ds_read_b64_tr_b16 a[252:253], v0 offset:13312
  ds_read_b64_tr_b16 a[254:255], v0 offset:13568
  ds_read_b64_tr_b16 a[208:209], v1 offset:40960
  v_exp_f32 v198, v198
  s_waitcnt lgkmcnt(13)
  v_mfma_f32_32x32x16_bf16 v[220:235], a[16:19], a[240:243], v[220:235]
  ds_read_b64_tr_b16 a[210:211], v1 offset:41472
  v_exp_f32 v199, v199
  v_exp_f32 v200, v200
  v_cvt_pk_bf16_f32 v192, v196, v197
  v_mfma_f32_32x32x16_bf16 v[236:251], a[40:43], a[240:243], v[236:251]
  v_exp_f32 v201, v201
  v_exp_f32 v202, v202
  v_cvt_pk_bf16_f32 v193, v198, v199
  s_waitcnt lgkmcnt(9)
  v_mfma_f32_32x32x16_bf16 v[220:235], a[20:23], a[244:247], v[220:235]
  ds_read_b64_tr_b16 a[240:241], v0 offset:14336
  ds_read_b64_tr_b16 a[242:243], v0 offset:14592
  ds_read_b128 v[196:199], v2 offset:640
  ds_read_b64_tr_b16 a[212:213], v1 offset:41984
  ds_read_b64_tr_b16 a[214:215], v1 offset:42496
  v_cvt_pk_bf16_f32 v194, v200, v201
  v_mfma_f32_32x32x16_bf16 v[236:251], a[44:47], a[244:247], v[236:251]
  ds_read_b64_tr_b16 a[244:245], v0 offset:15360
  ds_read_b64_tr_b16 a[246:247], v0 offset:15616
  ds_read_b64_tr_b16 a[216:217], v1 offset:43008
  v_exp_f32 v203, v203
  s_mov_b64 exec, s[48:49]
  v_cvt_pk_bf16_f32 v108, v220, v221
  v_cvt_pk_bf16_f32 v109, v222, v223
  v_cvt_pk_bf16_f32 v110, v224, v225
  v_cvt_pk_bf16_f32 v111, v226, v227
  v_cvt_pk_bf16_f32 v112, v228, v229
  v_cvt_pk_bf16_f32 v113, v230, v231
  v_mfma_f32_32x32x16_bf16 v[204:219], v[108:111], v[172:175], 0
  v_cvt_pk_bf16_f32 v114, v232, v233
  v_cvt_pk_bf16_f32 v115, v234, v235
  s_mov_b64 exec, -1
  s_mov_b64 exec, s[60:61]
  v_cvt_pk_bf16_f32 v124, v220, v221
  v_cvt_pk_bf16_f32 v125, v222, v223
  v_mfma_f32_32x32x16_bf16 v[204:219], v[112:115], v[176:179], v[204:219]
  v_cvt_pk_bf16_f32 v126, v224, v225
  v_cvt_pk_bf16_f32 v127, v226, v227
  v_cvt_pk_bf16_f32 v128, v228, v229
  v_cvt_pk_bf16_f32 v129, v230, v231
  v_cvt_pk_bf16_f32 v130, v232, v233
  v_cvt_pk_bf16_f32 v131, v234, v235
  v_mfma_f32_32x32x16_bf16 v[220:235], a[0:3], a[248:251], 0
  s_mov_b64 exec, -1
  ds_read_b128 v[172:175], v3 offset:1408
  ds_read_b128 v[176:179], v3 offset:1280
  ds_read_b64_tr_b16 a[218:219], v1 offset:43520
  s_mov_b64 exec, s[48:49]
  s_waitcnt lgkmcnt(3)
  v_mfma_f32_32x32x16_bf16 v[220:235], a[4:7], a[252:255], v[220:235]
  v_cvt_pk_bf16_f32 v116, v236, v237
  v_cvt_pk_bf16_f32 v117, v238, v239
  v_cvt_pk_bf16_f32 v118, v240, v241
  v_cvt_pk_bf16_f32 v119, v242, v243
  v_cvt_pk_bf16_f32 v120, v244, v245
  v_cvt_pk_bf16_f32 v121, v246, v247
  v_mfma_f32_32x32x16_bf16 v[204:219], v[116:119], v[188:191], v[204:219]
  v_cvt_pk_bf16_f32 v122, v248, v249
  v_cvt_pk_bf16_f32 v123, v250, v251
  s_mov_b64 exec, -1
  s_mov_b64 exec, s[60:61]
  v_cvt_pk_bf16_f32 v132, v236, v237
  v_cvt_pk_bf16_f32 v133, v238, v239
  v_mfma_f32_32x32x16_bf16 v[220:235], a[8:11], a[240:243], v[220:235]
  v_cvt_pk_bf16_f32 v134, v240, v241
  v_cvt_pk_bf16_f32 v135, v242, v243
  v_cvt_pk_bf16_f32 v136, v244, v245
  v_cvt_pk_bf16_f32 v137, v246, v247
  v_cvt_pk_bf16_f32 v138, v248, v249
  v_cvt_pk_bf16_f32 v139, v250, v251
  v_mfma_f32_32x32x16_bf16 v[236:251], a[24:27], a[248:251], 0
  s_mov_b64 exec, -1
  buffer_load_dwordx4 v9, s[8:11], s37 offen offset:2048 nt lds
  s_add_u32 m0, s50, 6144
  ds_read_b64_tr_b16 a[248:249], v0 offset:16384
  s_waitcnt lgkmcnt(1)
  v_mfma_f32_32x32x16_bf16 v[172:187], v[84:87], v[24:27], v[172:187]
  ds_read_b64_tr_b16 a[250:251], v0 offset:16640
  ds_read_b128 v[188:191], v2 offset:896
  ds_read_b64_tr_b16 a[220:221], v1 offset:44032
  ds_read_b64_tr_b16 a[222:223], v1 offset:44544
  ds_read_b64_tr_b16 a[224:225], v1 offset:45056
  v_cvt_pk_bf16_f32 v195, v202, v203
  v_mfma_f32_32x32x16_bf16 v[236:251], a[28:31], a[252:255], v[236:251]
  ds_read_b64_tr_b16 a[252:253], v0 offset:17408
  ds_read_b64_tr_b16 a[254:255], v0 offset:17664
  ds_read_b128 v[200:203], v2 offset:512
  v_mov_b32 v165, v59
  v_mov_b32 v166, v59
  v_mov_b32 v160, v59
  v_mfma_f32_32x32x16_bf16 v[204:219], v[120:123], v[192:195], v[204:219]
  ds_read_b128 v[192:195], v2 offset:768
  v_mov_b32 v167, v59
  v_mov_b32 v161, v59
  v_mov_b32 v168, v59
  v_mov_b32 v162, v59
  v_mov_b32 v169, v59
  v_mov_b32 v163, v59
  v_mfma_f32_32x32x8_bf16 v[172:187], v[88:89], v[28:29], v[172:187]
  v_mov_b32 v170, v59
  v_mov_b32 v171, v59
  ds_read_b64_tr_b16 a[226:227], v1 offset:45568
  ds_read_b64_tr_b16 a[228:229], v1 offset:46080
  ds_read_b64_tr_b16 a[230:231], v1 offset:46592
  ds_read_b64_tr_b16 a[232:233], v1 offset:47104
  v_mfma_f32_32x32x16_bf16 v[236:251], a[32:35], a[240:243], v[236:251]
  ds_read_b64_tr_b16 a[240:241], v0 offset:18432
  ds_read_b64_tr_b16 a[242:243], v0 offset:18688
  ds_read_b64_tr_b16 a[234:235], v1 offset:47616
  ds_read_b64_tr_b16 a[236:237], v1 offset:48128
  ds_read_b64_tr_b16 a[238:239], v1 offset:48640
  v_mov_b32 v1, v62
  v_mfma_f32_32x32x16_bf16 v[220:235], a[12:15], a[244:247], v[220:235]
  v_exp_f32 v172, v172
  v_exp_f32 v173, v173
  v_exp_f32 v174, v174
  v_mfma_f32_32x32x16_bf16 v[236:251], a[36:39], a[244:247], v[236:251]
  ds_read_b64_tr_b16 a[244:245], v0 offset:19456
  ds_read_b64_tr_b16 a[246:247], v0 offset:19712
  v_exp_f32 v175, v175
  v_cvt_pk_bf16_f32 v172, v172, v173
  s_waitcnt lgkmcnt(11)
  v_mfma_f32_32x32x16_bf16 v[188:203], v[90:93], v[24:27], v[188:203]
  v_rcp_f32 v217, v216
  v_exp_f32 v176, v176
  v_exp_f32 v177, v177
  v_mfma_f32_32x32x16_bf16 v[220:235], a[16:19], a[248:251], v[220:235]
  v_exp_f32 v178, v178
  v_exp_f32 v179, v179
  v_cvt_pk_bf16_f32 v173, v174, v175
  v_mul_f32 v204, v204, v217
  v_mul_f32 v205, v205, v217
  v_mfma_f32_32x32x8_bf16 v[188:203], v[94:95], v[28:29], v[188:203]
  v_mul_f32 v206, v206, v217
  v_mul_f32 v207, v207, v217
  v_mul_f32 v208, v208, v217
  v_mul_f32 v209, v209, v217
  v_mul_f32 v210, v210, v217
  v_mul_f32 v211, v211, v217
  v_mul_f32 v212, v212, v217
  v_mul_f32 v213, v213, v217
  v_mfma_f32_32x32x16_bf16 v[236:251], a[40:43], a[248:251], v[236:251]
  buffer_load_dwordx4 v7, s[8:11], s38 offen offset:0 nt lds
  ds_read_b64_tr_b16 a[248:249], v0 offset:20480
  ds_read_b64_tr_b16 a[250:251], v0 offset:20736
  v_mul_f32 v214, v214, v217
  v_mul_f32 v215, v215, v217
  v_mfma_f32_32x32x16_bf16 v[220:235], a[20:23], a[252:255], v[220:235]
  v_cvt_pk_bf16_f32 v174, v176, v177
  v_cvt_pk_bf16_f32 v175, v178, v179
  v_max3_f32 v10, v10, v216, v217
  v_cvt_pk_bf16_f32 v12, v204, v205
  v_cvt_pk_bf16_f32 v13, v206, v207
  v_cvt_pk_bf16_f32 v14, v208, v209
  v_mfma_f32_32x32x16_bf16 v[236:251], a[44:47], a[252:255], v[236:251]
  ds_read_b64_tr_b16 a[252:253], v0 offset:21504
  ds_read_b64_tr_b16 a[254:255], v0 offset:21760
  v_cvt_pk_bf16_f32 v15, v210, v211
  v_cvt_pk_bf16_f32 v16, v212, v213
  s_mov_b64 exec, s[62:63]
  v_cvt_pk_bf16_f32 v124, v220, v221
  v_cvt_pk_bf16_f32 v125, v222, v223
  v_cvt_pk_bf16_f32 v126, v224, v225
  v_cvt_pk_bf16_f32 v127, v226, v227
  v_cvt_pk_bf16_f32 v128, v228, v229
  v_cvt_pk_bf16_f32 v129, v230, v231
  v_cvt_pk_bf16_f32 v130, v232, v233
  v_cvt_pk_bf16_f32 v131, v234, v235
  s_mov_b64 exec, -1
  s_mov_b64 exec, s[64:65]
  v_cvt_pk_bf16_f32 v140, v220, v221
  v_cvt_pk_bf16_f32 v141, v222, v223
  v_cvt_pk_bf16_f32 v142, v224, v225
  v_cvt_pk_bf16_f32 v143, v226, v227
  v_cvt_pk_bf16_f32 v144, v228, v229
  v_cvt_pk_bf16_f32 v145, v230, v231
  v_cvt_pk_bf16_f32 v146, v232, v233
  v_cvt_pk_bf16_f32 v147, v234, v235
  v_mfma_f32_32x32x16_bf16 v[220:235], a[120:123], a[0:3], 0
  s_mov_b64 exec, -1
  s_mov_b64 exec, s[62:63]
  v_cvt_pk_bf16_f32 v132, v236, v237
  v_cvt_pk_bf16_f32 v133, v238, v239
  v_cvt_pk_bf16_f32 v134, v240, v241
  v_cvt_pk_bf16_f32 v135, v242, v243
  v_mfma_f32_32x32x16_bf16 v[220:235], a[124:127], a[4:7], v[220:235]
  v_cvt_pk_bf16_f32 v136, v244, v245
  v_cvt_pk_bf16_f32 v137, v246, v247
  v_cvt_pk_bf16_f32 v138, v248, v249
  v_cvt_pk_bf16_f32 v139, v250, v251
  s_mov_b64 exec, -1
  s_mov_b64 exec, s[64:65]
  v_mfma_f32_32x32x16_bf16 v[220:235], a[128:131], a[8:11], v[220:235]
  v_cvt_pk_bf16_f32 v148, v236, v237
  v_cvt_pk_bf16_f32 v149, v238, v239
  v_cvt_pk_bf16_f32 v150, v240, v241
  v_cvt_pk_bf16_f32 v151, v242, v243
  v_cvt_pk_bf16_f32 v152, v244, v245
  v_cvt_pk_bf16_f32 v153, v246, v247
  v_mfma_f32_32x32x16_bf16 v[220:235], a[132:135], a[12:15], v[220:235]
  v_cvt_pk_bf16_f32 v154, v248, v249
  v_cvt_pk_bf16_f32 v155, v250, v251
  s_mov_b64 exec, -1
  v_cvt_pk_bf16_f32 v17, v214, v215
  v_exp_f32 v180, v180
  v_mfma_f32_32x32x16_bf16 v[204:219], v[108:111], v[172:175], 0
  ds_read_b128 v[172:175], v2 offset:4736
  s_waitcnt lgkmcnt(1)
  s_barrier
  buffer_load_dwordx4 v8, s[8:11], s38 offen offset:1024 nt lds
  v_mfma_f32_32x32x16_bf16 v[236:251], a[120:123], a[24:27], 0
  v_exp_f32 v181, v181
  v_exp_f32 v182, v182
  v_exp_f32 v183, v183
  v_mfma_f32_32x32x16_bf16 v[236:251], a[124:127], a[28:31], v[236:251]
  v_exp_f32 v184, v184
  v_exp_f32 v185, v185
  v_exp_f32 v186, v186
  v_mfma_f32_32x32x16_bf16 v[236:251], a[128:131], a[32:35], v[236:251]
  v_exp_f32 v187, v187
  v_cvt_pk_bf16_f32 v176, v180, v181
  v_cvt_pk_bf16_f32 v177, v182, v183
  v_cvt_pk_bf16_f32 v178, v184, v185
  v_cvt_pk_bf16_f32 v179, v186, v187
  v_mfma_f32_32x32x16_bf16 v[236:251], a[132:135], a[36:39], v[236:251]
  ds_read_b128 v[180:183], v2 offset:4480
  ds_read_b128 v[184:187], v2 offset:4352
  v_exp_f32 v188, v188
  v_exp_f32 v189, v189
  v_mfma_f32_32x32x16_bf16 v[204:219], v[112:115], v[176:179], v[204:219]
  ds_read_b128 v[176:179], v2 offset:4608
  v_exp_f32 v190, v190
  v_exp_f32 v191, v191
  v_cvt_pk_bf16_f32 v188, v188, v189
  v_mfma_f32_32x32x16_bf16 v[220:235], a[136:139], a[16:19], v[220:235]
  v_exp_f32 v192, v192
  v_exp_f32 v193, v193
  v_exp_f32 v194, v194
  v_mfma_f32_32x32x16_bf16 v[236:251], a[136:139], a[40:43], v[236:251]
  v_exp_f32 v195, v195
  v_cvt_pk_bf16_f32 v189, v190, v191
  v_cvt_pk_bf16_f32 v190, v192, v193
  v_cvt_pk_bf16_f32 v191, v194, v195
  v_mfma_f32_32x32x16_bf16 v[220:235], a[140:143], a[20:23], v[220:235]
  v_exp_f32 v196, v196
  v_exp_f32 v197, v197
  v_exp_f32 v198, v198
  v_mfma_f32_32x32x16_bf16 v[204:219], v[116:119], v[188:191], v[204:219]
  ds_read_b128 v[188:191], v3 offset:4224
  v_exp_f32 v199, v199
  v_exp_f32 v200, v200
  s_waitcnt lgkmcnt(1)
  v_mfma_f32_32x32x16_bf16 v[172:187], v[96:99], v[18:21], v[172:187]
  buffer_load_dwordx4 v9, s[8:11], s38 offen offset:2048 nt lds
  s_add_u32 m0, s50, 9216
  v_exp_f32 v201, v201
  v_cvt_pk_bf16_f32 v192, v196, v197
  v_mfma_f32_32x32x16_bf16 v[236:251], a[140:143], a[44:47], v[236:251]
  v_exp_f32 v202, v202
  v_exp_f32 v203, v203
  v_cvt_pk_bf16_f32 v193, v198, v199
  v_cvt_pk_bf16_f32 v194, v200, v201
  v_cvt_pk_bf16_f32 v195, v202, v203
  v_mfma_f32_32x32x8_bf16 v[172:187], v[100:101], v[22:23], v[172:187]
  v_cvt_pk_bf16_f32 v36, v220, v221
  v_cvt_pk_bf16_f32 v37, v222, v223
  v_cvt_pk_bf16_f32 v38, v224, v225
  v_cvt_pk_bf16_f32 v39, v226, v227
  v_cvt_pk_bf16_f32 v40, v228, v229
  v_cvt_pk_bf16_f32 v41, v230, v231
  v_cvt_pk_bf16_f32 v84, v232, v233
  v_cvt_pk_bf16_f32 v85, v234, v235
  v_mfma_f32_32x32x16_bf16 v[204:219], v[120:123], v[192:195], v[204:219]
  ds_read_b128 v[192:195], v3 offset:4096
  ds_read_b128 v[196:199], v3 offset:3968
  ds_read_b128 v[200:203], v3 offset:3840
  v_cvt_pk_bf16_f32 v48, v236, v237
  v_cvt_pk_bf16_f32 v49, v238, v239
  v_cvt_pk_bf16_f32 v50, v240, v241
  v_mfma_f32_32x32x16_bf16 v[220:235], a[144:147], a[0:3], 0
  v_cvt_pk_bf16_f32 v51, v242, v243
  v_cvt_pk_bf16_f32 v52, v244, v245
  v_cvt_pk_bf16_f32 v53, v246, v247
  v_cvt_pk_bf16_f32 v90, v248, v249
  v_cvt_pk_bf16_f32 v91, v250, v251
  v_mfma_f32_32x32x16_bf16 v[236:251], a[144:147], a[24:27], 0
  v_exp_f32 v172, v172
  v_exp_f32 v173, v173
  v_exp_f32 v174, v174
  v_mfma_f32_32x32x16_bf16 v[220:235], a[148:151], a[4:7], v[220:235]
  v_exp_f32 v175, v175
  v_rcp_f32 v217, v216
  v_exp_f32 v176, v176
  v_mfma_f32_32x32x16_bf16 v[236:251], a[148:151], a[28:31], v[236:251]
  v_exp_f32 v177, v177
  v_exp_f32 v178, v178
  v_cvt_pk_bf16_f32 v172, v172, v173
  s_waitcnt lgkmcnt(0)
  v_mfma_f32_32x32x16_bf16 v[188:203], v[102:105], v[18:21], v[188:203]
  v_exp_f32 v179, v179
  v_cvt_pk_bf16_f32 v173, v174, v175
  v_mul_f32 v204, v204, v217
  v_mul_f32 v205, v205, v217
  v_mul_f32 v206, v206, v217
  v_mfma_f32_32x32x16_bf16 v[220:235], a[152:155], a[8:11], v[220:235]
  v_mul_f32 v207, v207, v217
  v_mul_f32 v208, v208, v217
  v_mul_f32 v209, v209, v217
  v_mul_f32 v210, v210, v217
  v_mul_f32 v211, v211, v217
  v_mul_f32 v212, v212, v217
  v_mul_f32 v213, v213, v217
  v_mfma_f32_32x32x8_bf16 v[188:203], v[106:107], v[22:23], v[188:203]
  v_mul_f32 v214, v214, v217
  v_mul_f32 v215, v215, v217
  v_cvt_pk_bf16_f32 v174, v176, v177
  v_cvt_pk_bf16_f32 v175, v178, v179
  v_max3_f32 v10, v10, v216, v217
  v_cvt_pk_bf16_f32 v24, v204, v205
  v_cvt_pk_bf16_f32 v25, v206, v207
  v_cvt_pk_bf16_f32 v26, v208, v209
  v_mfma_f32_32x32x16_bf16 v[236:251], a[152:155], a[32:35], v[236:251]
  buffer_load_dwordx4 v7, s[8:11], s39 offen offset:0 nt lds
  v_cvt_pk_bf16_f32 v27, v210, v211
  v_cvt_pk_bf16_f32 v28, v212, v213
  v_cvt_pk_bf16_f32 v29, v214, v215
  v_mfma_f32_32x32x16_bf16 v[204:219], v[124:127], v[172:175], 0
  ds_read_b128 v[172:175], v3 offset:5248
  v_exp_f32 v180, v180
  v_exp_f32 v181, v181
  v_mfma_f32_32x32x16_bf16 v[220:235], a[156:159], a[12:15], v[220:235]
  v_exp_f32 v182, v182
  v_exp_f32 v183, v183
  v_exp_f32 v184, v184
  v_mfma_f32_32x32x16_bf16 v[236:251], a[156:159], a[36:39], v[236:251]
  v_exp_f32 v185, v185
  v_exp_f32 v186, v186
  v_exp_f32 v187, v187
  v_mfma_f32_32x32x16_bf16 v[220:235], a[160:163], a[16:19], v[220:235]
  v_cvt_pk_bf16_f32 v176, v180, v181
  v_cvt_pk_bf16_f32 v177, v182, v183
  v_cvt_pk_bf16_f32 v178, v184, v185
  v_cvt_pk_bf16_f32 v179, v186, v187
  v_exp_f32 v188, v188
  v_mfma_f32_32x32x16_bf16 v[204:219], v[128:131], v[176:179], v[204:219]
  ds_read_b128 v[176:179], v3 offset:5120
  ds_read_b128 v[180:183], v3 offset:4992
  ds_read_b128 v[184:187], v3 offset:4864
  v_exp_f32 v189, v189
  v_mfma_f32_32x32x16_bf16 v[236:251], a[160:163], a[40:43], v[236:251]
  v_exp_f32 v190, v190
  v_exp_f32 v191, v191
  v_exp_f32 v192, v192
  v_mfma_f32_32x32x16_bf16 v[220:235], a[164:167], a[20:23], v[220:235]
  v_exp_f32 v193, v193
  v_exp_f32 v194, v194
  v_exp_f32 v195, v195
  v_mfma_f32_32x32x16_bf16 v[236:251], a[164:167], a[44:47], v[236:251]
  v_cvt_pk_bf16_f32 v188, v188, v189
  v_cvt_pk_bf16_f32 v189, v190, v191
  v_cvt_pk_bf16_f32 v190, v192, v193
  v_cvt_pk_bf16_f32 v191, v194, v195
  v_cvt_pk_bf16_f32 v86, v220, v221
  v_cvt_pk_bf16_f32 v87, v222, v223
  v_mfma_f32_32x32x16_bf16 v[204:219], v[132:135], v[188:191], v[204:219]
  ds_read_b128 v[188:191], v2 offset:4736
  v_cvt_pk_bf16_f32 v88, v224, v225
  v_cvt_pk_bf16_f32 v89, v226, v227
  v_cvt_pk_bf16_f32 v42, v228, v229
  v_cvt_pk_bf16_f32 v43, v230, v231
  s_waitcnt lgkmcnt(1)
  v_mfma_f32_32x32x16_bf16 v[172:187], v[96:99], v[30:33], v[172:187]
  buffer_load_dwordx4 v8, s[8:11], s39 offen offset:1024 nt lds
  v_cvt_pk_bf16_f32 v44, v232, v233
  v_cvt_pk_bf16_f32 v45, v234, v235
  v_cvt_pk_bf16_f32 v92, v236, v237
  v_cvt_pk_bf16_f32 v93, v238, v239
  v_mfma_f32_32x32x16_bf16 v[220:235], a[0:3], a[240:243], 0
  v_cvt_pk_bf16_f32 v94, v240, v241
  v_cvt_pk_bf16_f32 v95, v242, v243
  v_cvt_pk_bf16_f32 v54, v244, v245
  v_cvt_pk_bf16_f32 v55, v246, v247
  v_cvt_pk_bf16_f32 v56, v248, v249
  v_cvt_pk_bf16_f32 v57, v250, v251
  v_mfma_f32_32x32x8_bf16 v[172:187], v[100:101], v[34:35], v[172:187]
  v_exp_f32 v196, v196
  v_exp_f32 v197, v197
  v_exp_f32 v198, v198
  v_exp_f32 v199, v199
  v_mfma_f32_32x32x16_bf16 v[236:251], a[24:27], a[240:243], 0
  ds_read_b64_tr_b16 a[240:241], v0 offset:22528
  ds_read_b64_tr_b16 a[242:243], v0 offset:22784
  v_exp_f32 v200, v200
  v_exp_f32 v201, v201
  v_mfma_f32_32x32x16_bf16 v[220:235], a[4:7], a[244:247], v[220:235]
  v_exp_f32 v202, v202
  v_exp_f32 v203, v203
  v_cvt_pk_bf16_f32 v192, v196, v197
  v_cvt_pk_bf16_f32 v193, v198, v199
  v_mfma_f32_32x32x16_bf16 v[236:251], a[28:31], a[244:247], v[236:251]
  ds_read_b128 v[196:199], v2 offset:4480
  ds_read_b64_tr_b16 a[244:245], v0 offset:23552
  ds_read_b64_tr_b16 a[246:247], v0 offset:23808
  v_cvt_pk_bf16_f32 v194, v200, v201
  v_cvt_pk_bf16_f32 v195, v202, v203
  v_mfma_f32_32x32x16_bf16 v[220:235], a[8:11], a[248:251], v[220:235]
  ds_read_b128 v[200:203], v2 offset:4352
  v_exp_f32 v172, v172
  v_exp_f32 v173, v173
  v_mfma_f32_32x32x16_bf16 v[204:219], v[136:139], v[192:195], v[204:219]
  ds_read_b128 v[192:195], v2 offset:4608
  v_exp_f32 v174, v174
  v_exp_f32 v175, v175
  v_cvt_pk_bf16_f32 v172, v172, v173
  v_mfma_f32_32x32x16_bf16 v[236:251], a[32:35], a[248:251], v[236:251]
  ds_read_b64_tr_b16 a[248:249], v0 offset:0
  ds_read_b64_tr_b16 a[250:251], v0 offset:256
  v_exp_f32 v176, v176
  v_rcp_f32 v213, v212
  v_mfma_f32_32x32x16_bf16 v[220:235], a[12:15], a[252:255], v[220:235]
  v_exp_f32 v177, v177
  v_exp_f32 v178, v178
  v_exp_f32 v179, v179
  v_mfma_f32_32x32x16_bf16 v[236:251], a[36:39], a[252:255], v[236:251]
  buffer_load_dwordx4 v9, s[8:11], s39 offen offset:2048 nt lds
  ds_read_b64_tr_b16 a[252:253], v0 offset:1024
  ds_read_b64_tr_b16 a[254:255], v0 offset:1280
  s_mov_b32 m0, 159744
  s_waitcnt lgkmcnt(5)
  v_mfma_f32_32x32x16_bf16 v[220:235], a[16:19], a[240:243], v[220:235]
  v_cvt_pk_bf16_f32 v173, v174, v175
  v_mul_f32 v216, v216, v213
  v_mul_f32 v217, v217, v213
  v_mul_f32 v218, v218, v213
  v_mul_f32 v219, v219, v213
  s_waitcnt lgkmcnt(4)
  v_mfma_f32_32x32x16_bf16 v[188:203], v[102:105], v[30:33], v[188:203]
  v_mul_f32 v204, v204, v213
  v_mul_f32 v205, v205, v213
  v_mul_f32 v206, v206, v213
  v_mul_f32 v207, v207, v213
  v_mul_f32 v208, v208, v213
  v_mul_f32 v209, v209, v213
  v_mfma_f32_32x32x16_bf16 v[236:251], a[40:43], a[240:243], v[236:251]
  ds_read_b64_tr_b16 a[240:241], v0 offset:2048
  ds_read_b64_tr_b16 a[242:243], v0 offset:2304
  v_mul_f32 v210, v210, v213
  v_mul_f32 v211, v211, v213
  v_cvt_pk_bf16_f32 v174, v176, v177
  v_cvt_pk_bf16_f32 v175, v178, v179
  v_max3_f32 v10, v10, v212, v213
  v_mfma_f32_32x32x8_bf16 v[188:203], v[106:107], v[34:35], v[188:203]
  v_cvt_pk_bf16_f32 v18, v216, v217
  v_cvt_pk_bf16_f32 v19, v218, v219
  v_cvt_pk_bf16_f32 v20, v204, v205
  v_cvt_pk_bf16_f32 v21, v206, v207
  v_cvt_pk_bf16_f32 v22, v208, v209
  v_cvt_pk_bf16_f32 v23, v210, v211
  v_exp_f32 v180, v180
  v_mfma_f32_32x32x16_bf16 v[204:219], v[124:127], v[172:175], 0
  ds_read_b128 v[172:175], v2 offset:8576
  v_exp_f32 v181, v181
  v_exp_f32 v182, v182
  v_cvt_pk_bf16_f32 v176, v180, v181
  v_mfma_f32_32x32x16_bf16 v[220:235], a[20:23], a[244:247], v[220:235]
  v_exp_f32 v183, v183
  v_exp_f32 v184, v184
  v_exp_f32 v185, v185
  v_mfma_f32_32x32x16_bf16 v[236:251], a[44:47], a[244:247], v[236:251]
  ds_read_b64_tr_b16 a[244:245], v0 offset:3072
  ds_read_b64_tr_b16 a[246:247], v0 offset:3328
  v_exp_f32 v186, v186
  s_mov_b64 exec, s[66:67]
  v_cvt_pk_bf16_f32 v140, v220, v221
  v_cvt_pk_bf16_f32 v141, v222, v223
  v_cvt_pk_bf16_f32 v142, v224, v225
  v_cvt_pk_bf16_f32 v143, v226, v227
  v_cvt_pk_bf16_f32 v144, v228, v229
  v_cvt_pk_bf16_f32 v145, v230, v231
  v_cvt_pk_bf16_f32 v146, v232, v233
  v_cvt_pk_bf16_f32 v147, v234, v235
  s_mov_b64 exec, -1
  s_mov_b64 exec, s[68:69]
  v_cvt_pk_bf16_f32 v156, v220, v221
  v_cvt_pk_bf16_f32 v157, v222, v223
  v_cvt_pk_bf16_f32 v158, v224, v225
  v_cvt_pk_bf16_f32 v159, v226, v227
  v_cvt_pk_bf16_f32 v160, v228, v229
  v_cvt_pk_bf16_f32 v161, v230, v231
  v_cvt_pk_bf16_f32 v162, v232, v233
  v_cvt_pk_bf16_f32 v163, v234, v235
  s_waitcnt lgkmcnt(2)
  v_mfma_f32_32x32x16_bf16 v[220:235], a[248:251], a[0:3], 0
  s_mov_b64 exec, -1
  s_waitcnt vmcnt(6)
  ds_read_b128 a[0:3], v4 offset:49152
  buffer_load_dword v1, s[56:59], s73 offen lds
  s_add_u32 m0, s50, 0
  v_mfma_f32_32x32x16_bf16 v[220:235], a[252:255], a[4:7], v[220:235]
  ds_read_b128 a[4:7], v5 offset:49152
  s_mov_b32 s73, 3*((L_end-L_loop)/4)+L_loop-L_pc
  s_mov_b64 exec, s[66:67]
  v_cvt_pk_bf16_f32 v148, v236, v237
  v_cvt_pk_bf16_f32 v149, v238, v239
  v_cvt_pk_bf16_f32 v150, v240, v241
  v_mfma_f32_32x32x16_bf16 v[220:235], a[240:243], a[8:11], v[220:235]
  v_cvt_pk_bf16_f32 v151, v242, v243
  v_cvt_pk_bf16_f32 v152, v244, v245
  v_cvt_pk_bf16_f32 v153, v246, v247
  v_cvt_pk_bf16_f32 v154, v248, v249
  v_cvt_pk_bf16_f32 v155, v250, v251
  s_waitcnt lgkmcnt(2)
  v_mfma_f32_32x32x16_bf16 v[220:235], a[244:247], a[12:15], v[220:235]
  s_mov_b64 exec, -1
  ds_read_b128 a[8:11], v4 offset:49216
  ds_read_b128 a[12:15], v5 offset:49216
  s_mov_b64 exec, s[68:69]
  v_cvt_pk_bf16_f32 v164, v236, v237
  v_cvt_pk_bf16_f32 v165, v238, v239
  v_cvt_pk_bf16_f32 v166, v240, v241
  v_cvt_pk_bf16_f32 v167, v242, v243
  v_cvt_pk_bf16_f32 v168, v244, v245
  v_cvt_pk_bf16_f32 v169, v246, v247
  v_cvt_pk_bf16_f32 v170, v248, v249
  v_cvt_pk_bf16_f32 v171, v250, v251
  v_mfma_f32_32x32x16_bf16 v[236:251], a[248:251], a[24:27], 0
  s_mov_b64 exec, -1
  ds_read_b64_tr_b16 a[248:249], v0 offset:4096
  ds_read_b64_tr_b16 a[250:251], v0 offset:4352
  v_exp_f32 v187, v187
  v_cvt_pk_bf16_f32 v177, v182, v183
  v_mfma_f32_32x32x16_bf16 v[236:251], a[252:255], a[28:31], v[236:251]
  ds_read_b128 v[180:183], v2 offset:8320
  ds_read_b64_tr_b16 a[252:253], v0 offset:5120
  ds_read_b64_tr_b16 a[254:255], v0 offset:5376
  v_cvt_pk_bf16_f32 v178, v184, v185
  v_cvt_pk_bf16_f32 v179, v186, v187
  v_mfma_f32_32x32x16_bf16 v[236:251], a[240:243], a[32:35], v[236:251]
  ds_read_b128 v[184:187], v2 offset:8192
  ds_read_b64_tr_b16 a[240:241], v0 offset:6144
  ds_read_b64_tr_b16 a[242:243], v0 offset:6400
  v_exp_f32 v188, v188
  v_mfma_f32_32x32x16_bf16 v[204:219], v[128:131], v[176:179], v[204:219]
  ds_read_b128 v[176:179], v2 offset:8448
  v_exp_f32 v189, v189
  v_exp_f32 v190, v190
  v_cvt_pk_bf16_f32 v188, v188, v189
  v_mfma_f32_32x32x16_bf16 v[236:251], a[244:247], a[36:39], v[236:251]
  ds_read_b64_tr_b16 a[244:245], v0 offset:7168
  ds_read_b64_tr_b16 a[246:247], v0 offset:7424
  v_exp_f32 v191, v191
  s_waitcnt lgkmcnt(9)
  v_mfma_f32_32x32x16_bf16 v[220:235], a[248:251], a[16:19], v[220:235]
  ds_read_b128 a[16:19], v4 offset:49280
  v_exp_f32 v192, v192
  v_exp_f32 v193, v193
  v_cvt_pk_bf16_f32 v189, v190, v191
  v_mfma_f32_32x32x16_bf16 v[236:251], a[248:251], a[40:43], v[236:251]
  ds_read_b64_tr_b16 a[248:249], v0 offset:8192
  ds_read_b64_tr_b16 a[250:251], v0 offset:8448
  v_exp_f32 v194, v194
  v_cvt_pk_bf16_f32 v190, v192, v193
  s_waitcnt lgkmcnt(6)
  v_mfma_f32_32x32x16_bf16 v[220:235], a[252:255], a[20:23], v[220:235]
  ds_read_b128 a[20:23], v5 offset:49280
  v_exp_f32 v195, v195
  v_exp_f32 v196, v196
  s_waitcnt lgkmcnt(6)
  v_mfma_f32_32x32x16_bf16 v[172:187], v[84:87], v[36:39], v[172:187]
  v_cvt_pk_bf16_f32 v191, v194, v195
  v_exp_f32 v197, v197
  v_exp_f32 v198, v198
  v_cvt_pk_bf16_f32 v192, v196, v197
  v_mfma_f32_32x32x16_bf16 v[204:219], v[132:135], v[188:191], v[204:219]
  ds_read_b128 v[188:191], v3 offset:8064
  v_exp_f32 v199, v199
  v_exp_f32 v200, v200
  v_exp_f32 v201, v201
  v_mfma_f32_32x32x8_bf16 v[172:187], v[88:89], v[40:41], v[172:187]
  v_exp_f32 v202, v202
  v_exp_f32 v203, v203
  v_cvt_pk_bf16_f32 v193, v198, v199
  v_cvt_pk_bf16_f32 v194, v200, v201
  v_cvt_pk_bf16_f32 v195, v202, v203
  v_cvt_pk_bf16_f32 v46, v220, v221
  v_mfma_f32_32x32x16_bf16 v[236:251], a[252:255], a[44:47], v[236:251]
  ds_read_b128 v[196:199], v3 offset:7808
  ds_read_b128 v[200:203], v3 offset:7680
  ds_read_b64_tr_b16 a[252:253], v0 offset:9216
  s_waitcnt lgkmcnt(4)
  buffer_load_dwordx4 v7, s[8:11], s40 offen offset:0 nt lds
  v_mfma_f32_32x32x16_bf16 v[204:219], v[136:139], v[192:195], v[204:219]
  ds_read_b128 v[192:195], v3 offset:7936
  ds_read_b64_tr_b16 a[254:255], v0 offset:9472
  v_cvt_pk_bf16_f32 v47, v222, v223
  v_cvt_pk_bf16_f32 v96, v224, v225
  v_cvt_pk_bf16_f32 v97, v226, v227
  v_cvt_pk_bf16_f32 v98, v228, v229
  v_cvt_pk_bf16_f32 v99, v230, v231
  v_cvt_pk_bf16_f32 v100, v232, v233
  v_cvt_pk_bf16_f32 v101, v234, v235
  v_mfma_f32_32x32x16_bf16 v[220:235], a[0:3], a[240:243], 0
  v_cvt_pk_bf16_f32 v58, v236, v237
  v_cvt_pk_bf16_f32 v59, v238, v239
  v_cvt_pk_bf16_f32 v102, v240, v241
  v_cvt_pk_bf16_f32 v103, v242, v243
  v_cvt_pk_bf16_f32 v104, v244, v245
  v_cvt_pk_bf16_f32 v105, v246, v247
  v_mfma_f32_32x32x16_bf16 v[220:235], a[4:7], a[244:247], v[220:235]
  v_cvt_pk_bf16_f32 v106, v248, v249
  v_cvt_pk_bf16_f32 v107, v250, v251
  v_exp_f32 v172, v172
  v_exp_f32 v173, v173
  v_mfma_f32_32x32x16_bf16 v[220:235], a[8:11], a[248:251], v[220:235]
  v_exp_f32 v174, v174
  v_exp_f32 v175, v175
  v_cvt_pk_bf16_f32 v172, v172, v173
  s_waitcnt lgkmcnt(1)
  v_mfma_f32_32x32x16_bf16 v[188:203], v[90:93], v[36:39], v[188:203]
  v_rcp_f32 v213, v212
  v_exp_f32 v176, v176
  v_cvt_pk_bf16_f32 v173, v174, v175
  s_waitcnt lgkmcnt(0)
  v_mfma_f32_32x32x16_bf16 v[220:235], a[12:15], a[252:255], v[220:235]
  v_exp_f32 v177, v177
  v_exp_f32 v178, v178
  v_exp_f32 v179, v179
  v_mul_f32 v216, v216, v213
  v_mfma_f32_32x32x8_bf16 v[188:203], v[94:95], v[40:41], v[188:203]
  v_mul_f32 v217, v217, v213
  v_mul_f32 v218, v218, v213
  v_mul_f32 v219, v219, v213
  v_mul_f32 v204, v204, v213
  v_mul_f32 v205, v205, v213
  v_mul_f32 v206, v206, v213
  v_mul_f32 v207, v207, v213
  v_mul_f32 v208, v208, v213
  v_mul_f32 v209, v209, v213
  v_mul_f32 v210, v210, v213
  v_mul_f32 v211, v211, v213
  v_cvt_pk_bf16_f32 v174, v176, v177
  v_cvt_pk_bf16_f32 v175, v178, v179
  v_max3_f32 v10, v10, v212, v213
  v_cvt_pk_bf16_f32 v30, v216, v217
  v_cvt_pk_bf16_f32 v31, v218, v219
  v_cvt_pk_bf16_f32 v32, v204, v205
  v_cvt_pk_bf16_f32 v33, v206, v207
  v_cvt_pk_bf16_f32 v34, v208, v209
  v_cvt_pk_bf16_f32 v35, v210, v211
  v_mfma_f32_32x32x16_bf16 v[204:219], v[140:143], v[172:175], 0
  ds_read_b128 v[172:175], v3 offset:9088
  buffer_load_dwordx4 v8, s[8:11], s40 offen offset:1024 nt lds
  v_exp_f32 v180, v180
  v_exp_f32 v181, v181
  v_exp_f32 v182, v182
  v_exp_f32 v183, v183
  v_exp_f32 v184, v184
  v_exp_f32 v185, v185
  v_exp_f32 v186, v186
  v_exp_f32 v187, v187
  v_cvt_pk_bf16_f32 v176, v180, v181
  v_cvt_pk_bf16_f32 v177, v182, v183
  v_cvt_pk_bf16_f32 v178, v184, v185
  v_cvt_pk_bf16_f32 v179, v186, v187
  v_exp_f32 v188, v188
  v_mfma_f32_32x32x16_bf16 v[204:219], v[144:147], v[176:179], v[204:219]
  ds_read_b128 v[176:179], v3 offset:8960
  ds_read_b128 v[180:183], v3 offset:8832
  ds_read_b128 v[184:187], v3 offset:8704
  v_exp_f32 v189, v189
  v_exp_f32 v190, v190
  v_exp_f32 v191, v191
  v_exp_f32 v192, v192
  v_exp_f32 v193, v193
  v_exp_f32 v194, v194
  v_exp_f32 v195, v195
  v_cvt_pk_bf16_f32 v188, v188, v189
  v_cvt_pk_bf16_f32 v189, v190, v191
  v_cvt_pk_bf16_f32 v190, v192, v193
  v_cvt_pk_bf16_f32 v191, v194, v195
  v_exp_f32 v196, v196
  v_mfma_f32_32x32x16_bf16 v[204:219], v[148:151], v[188:191], v[204:219]
  ds_read_b128 v[188:191], v2 offset:8576
  v_exp_f32 v197, v197
  v_exp_f32 v198, v198
  v_exp_f32 v199, v199
  v_exp_f32 v200, v200
  v_exp_f32 v201, v201
  s_waitcnt lgkmcnt(1)
  v_mfma_f32_32x32x16_bf16 v[172:187], v[84:87], v[48:51], v[172:187]
  buffer_load_dwordx4 v9, s[8:11], s40 offen offset:2048 nt lds
  s_add_u32 m0, s50, 3072
  v_exp_f32 v202, v202
  v_exp_f32 v203, v203
  v_cvt_pk_bf16_f32 v192, v196, v197
  v_cvt_pk_bf16_f32 v193, v198, v199
  v_cvt_pk_bf16_f32 v194, v200, v201
  v_cvt_pk_bf16_f32 v195, v202, v203
  ds_read_b128 v[196:199], v2 offset:8320
  v_mfma_f32_32x32x8_bf16 v[172:187], v[88:89], v[52:53], v[172:187]
  ds_read_b128 v[200:203], v2 offset:8192
  s_waitcnt vmcnt(4)
  ds_read_b128 a[24:27], v4 offset:55296
  v_mfma_f32_32x32x16_bf16 v[204:219], v[152:155], v[192:195], v[204:219]
  ds_read_b128 a[28:31], v5 offset:55296
  ds_read_b128 a[32:35], v4 offset:55360
  ds_read_b128 a[36:39], v5 offset:55360
  s_nop 3
  v_exp_f32 v172, v172
  v_exp_f32 v173, v173
  v_exp_f32 v174, v174
  v_exp_f32 v175, v175
  v_exp_f32 v176, v176
  v_rcp_f32 v209, v208
  v_exp_f32 v177, v177
  v_exp_f32 v178, v178
  v_exp_f32 v179, v179
  v_cvt_pk_bf16_f32 v172, v172, v173
  v_cvt_pk_bf16_f32 v173, v174, v175
  v_mul_f32 v212, v212, v209
  v_mul_f32 v213, v213, v209
  s_waitcnt lgkmcnt(3)
  v_mfma_f32_32x32x16_bf16 v[236:251], a[24:27], a[240:243], 0
  ds_read_b64_tr_b16 a[240:241], v0 offset:10240
  ds_read_b64_tr_b16 a[242:243], v0 offset:10496
  ds_read_b128 a[40:43], v4 offset:55424
  ds_read_b128 a[44:47], v5 offset:55424
  v_mul_f32 v214, v214, v209
  s_waitcnt lgkmcnt(6)
  v_mfma_f32_32x32x16_bf16 v[236:251], a[28:31], a[244:247], v[236:251]
  ds_read_b64_tr_b16 a[244:245], v0 offset:11264
  ds_read_b64_tr_b16 a[246:247], v0 offset:11520
  ds_read_b128 v[192:195], v2 offset:8448
  v_mul_f32 v215, v215, v209
  v_mul_f32 v216, v216, v209
  s_waitcnt lgkmcnt(7)
  v_mfma_f32_32x32x16_bf16 v[236:251], a[32:35], a[248:251], v[236:251]
  buffer_load_dwordx4 v7, s[8:11], s41 offen offset:0 nt lds
  ds_read_b64_tr_b16 a[248:249], v0 offset:12288
  ds_read_b64_tr_b16 a[250:251], v0 offset:12544
  v_mul_f32 v217, v217, v209
  v_mul_f32 v218, v218, v209
  v_mfma_f32_32x32x16_bf16 v[236:251], a[36:39], a[252:255], v[236:251]
  ds_read_b64_tr_b16 a[252:253], v0 offset:13312
  ds_read_b64_tr_b16 a[254:255], v0 offset:13568
  v_mul_f32 v219, v219, v209
  v_mul_f32 v204, v204, v209
  v_mul_f32 v205, v205, v209
  v_mul_f32 v206, v206, v209
  v_mul_f32 v207, v207, v209
  v_cvt_pk_bf16_f32 v174, v176, v177
  v_cvt_pk_bf16_f32 v175, v178, v179
  v_max3_f32 v10, v10, v208, v209
  s_waitcnt lgkmcnt(9)
  v_mfma_f32_32x32x16_bf16 v[220:235], a[16:19], a[240:243], v[220:235]
  v_cvt_pk_bf16_f32 v36, v212, v213
  v_cvt_pk_bf16_f32 v37, v214, v215
  v_cvt_pk_bf16_f32 v38, v216, v217
  v_cvt_pk_bf16_f32 v39, v218, v219
  v_cvt_pk_bf16_f32 v40, v204, v205
  s_waitcnt lgkmcnt(4)
  v_mfma_f32_32x32x16_bf16 v[188:203], v[90:93], v[48:51], v[188:203]
  v_cvt_pk_bf16_f32 v41, v206, v207
  v_exp_f32 v180, v180
  v_exp_f32 v181, v181
  v_mfma_f32_32x32x16_bf16 v[204:219], v[140:143], v[172:175], 0
  ds_read_b128 v[172:175], v2 offset:12416
  v_exp_f32 v182, v182
  v_exp_f32 v183, v183
  v_exp_f32 v184, v184
  v_mfma_f32_32x32x8_bf16 v[188:203], v[94:95], v[52:53], v[188:203]
  v_exp_f32 v185, v185
  v_exp_f32 v186, v186
  v_exp_f32 v187, v187
  v_cvt_pk_bf16_f32 v176, v180, v181
  v_cvt_pk_bf16_f32 v177, v182, v183
  v_mfma_f32_32x32x16_bf16 v[220:235], a[20:23], a[244:247], v[220:235]
  ds_read_b128 v[180:183], v2 offset:12160
  v_cvt_pk_bf16_f32 v178, v184, v185
  v_cvt_pk_bf16_f32 v179, v186, v187
  v_exp_f32 v188, v188
  v_mfma_f32_32x32x16_bf16 v[204:219], v[144:147], v[176:179], v[204:219]
  ds_read_b128 v[176:179], v2 offset:12288
  ds_read_b128 v[184:187], v2 offset:12032
  buffer_load_dwordx4 v8, s[8:11], s41 offen offset:1024 nt lds
  v_exp_f32 v189, v189
  v_mfma_f32_32x32x16_bf16 v[236:251], a[40:43], a[240:243], v[236:251]
  ds_read_b64_tr_b16 a[240:241], v0 offset:14336
  ds_read_b64_tr_b16 a[242:243], v0 offset:14592
  s_mov_b64 exec, s[48:49]
  v_cvt_pk_bf16_f32 v108, v220, v221
  v_cvt_pk_bf16_f32 v109, v222, v223
  v_cvt_pk_bf16_f32 v110, v224, v225
  v_mfma_f32_32x32x16_bf16 v[236:251], a[44:47], a[244:247], v[236:251]
  v_cvt_pk_bf16_f32 v111, v226, v227
  v_cvt_pk_bf16_f32 v112, v228, v229
  v_cvt_pk_bf16_f32 v113, v230, v231
  v_cvt_pk_bf16_f32 v114, v232, v233
  v_cvt_pk_bf16_f32 v115, v234, v235
  s_mov_b64 exec, -1
  s_mov_b64 exec, s[60:61]
  v_cvt_pk_bf16_f32 v124, v220, v221
  v_cvt_pk_bf16_f32 v125, v222, v223
  v_cvt_pk_bf16_f32 v126, v224, v225
  v_cvt_pk_bf16_f32 v127, v226, v227
  v_cvt_pk_bf16_f32 v128, v228, v229
  v_cvt_pk_bf16_f32 v129, v230, v231
  v_cvt_pk_bf16_f32 v130, v232, v233
  v_cvt_pk_bf16_f32 v131, v234, v235
  v_mfma_f32_32x32x16_bf16 v[220:235], a[48:51], a[0:3], 0
  s_mov_b64 exec, -1
  ds_read_b64_tr_b16 a[244:245], v0 offset:15360
  ds_read_b64_tr_b16 a[246:247], v0 offset:15616
  s_mov_b64 exec, s[48:49]
  v_cvt_pk_bf16_f32 v116, v236, v237
  s_waitcnt lgkmcnt(4)
  v_mfma_f32_32x32x16_bf16 v[172:187], v[96:99], v[42:45], v[172:187]
  v_cvt_pk_bf16_f32 v117, v238, v239
  v_cvt_pk_bf16_f32 v118, v240, v241
  v_cvt_pk_bf16_f32 v119, v242, v243
  v_cvt_pk_bf16_f32 v120, v244, v245
  v_cvt_pk_bf16_f32 v121, v246, v247
  v_cvt_pk_bf16_f32 v122, v248, v249
  v_mfma_f32_32x32x16_bf16 v[220:235], a[52:55], a[4:7], v[220:235]
  v_cvt_pk_bf16_f32 v123, v250, v251
  s_mov_b64 exec, -1
  s_mov_b64 exec, s[60:61]
  v_cvt_pk_bf16_f32 v132, v236, v237
  v_cvt_pk_bf16_f32 v133, v238, v239
  v_cvt_pk_bf16_f32 v134, v240, v241
  v_mfma_f32_32x32x16_bf16 v[220:235], a[56:59], a[8:11], v[220:235]
  v_cvt_pk_bf16_f32 v135, v242, v243
  v_cvt_pk_bf16_f32 v136, v244, v245
  v_cvt_pk_bf16_f32 v137, v246, v247
  v_cvt_pk_bf16_f32 v138, v248, v249
  v_cvt_pk_bf16_f32 v139, v250, v251
  s_mov_b64 exec, -1
  v_cvt_pk_bf16_f32 v188, v188, v189
  v_mfma_f32_32x32x8_bf16 v[172:187], v[100:101], v[46:47], v[172:187]
  v_exp_f32 v190, v190
  v_exp_f32 v191, v191
  v_exp_f32 v192, v192
  v_exp_f32 v193, v193
  v_mfma_f32_32x32x16_bf16 v[236:251], a[48:51], a[24:27], 0
  buffer_load_dwordx4 v9, s[8:11], s41 offen offset:2048 nt lds
  s_add_u32 m0, s50, 6144
  v_exp_f32 v194, v194
  v_cvt_pk_bf16_f32 v189, v190, v191
  v_mfma_f32_32x32x16_bf16 v[236:251], a[52:55], a[28:31], v[236:251]
  v_exp_f32 v195, v195
  v_cvt_pk_bf16_f32 v190, v192, v193
  v_cvt_pk_bf16_f32 v191, v194, v195
  v_exp_f32 v196, v196
  v_mfma_f32_32x32x16_bf16 v[204:219], v[148:151], v[188:191], v[204:219]
  ds_read_b128 v[188:191], v3 offset:11904
  v_exp_f32 v197, v197
  v_exp_f32 v198, v198
  v_cvt_pk_bf16_f32 v192, v196, v197
  v_mfma_f32_32x32x16_bf16 v[220:235], a[60:63], a[12:15], v[220:235]
  v_exp_f32 v199, v199
  v_exp_f32 v200, v200
  v_exp_f32 v201, v201
  v_mfma_f32_32x32x16_bf16 v[236:251], a[56:59], a[32:35], v[236:251]
  v_exp_f32 v202, v202
  v_exp_f32 v203, v203
  v_cvt_pk_bf16_f32 v193, v198, v199
  v_cvt_pk_bf16_f32 v194, v200, v201
  v_mfma_f32_32x32x16_bf16 v[220:235], a[64:67], a[16:19], v[220:235]
  ds_read_b128 v[196:199], v3 offset:11648
  v_cvt_pk_bf16_f32 v195, v202, v203
  v_exp_f32 v172, v172
  v_exp_f32 v173, v173
  v_mfma_f32_32x32x16_bf16 v[204:219], v[152:155], v[192:195], v[204:219]
  ds_read_b128 v[192:195], v3 offset:11776
  ds_read_b128 v[200:203], v3 offset:11520
  v_exp_f32 v174, v174
  v_exp_f32 v175, v175
  v_mfma_f32_32x32x16_bf16 v[236:251], a[60:63], a[36:39], v[236:251]
  v_exp_f32 v176, v176
  v_exp_f32 v177, v177
  v_rcp_f32 v209, v208
  v_mfma_f32_32x32x16_bf16 v[220:235], a[68:71], a[20:23], v[220:235]
  v_exp_f32 v178, v178
  v_exp_f32 v179, v179
  v_cvt_pk_bf16_f32 v172, v172, v173
  v_cvt_pk_bf16_f32 v173, v174, v175
  v_mfma_f32_32x32x16_bf16 v[236:251], a[64:67], a[40:43], v[236:251]
  buffer_load_dwordx4 v7, s[8:11], s42 offen offset:0 nt lds
  v_mul_f32 v212, v212, v209
  v_mul_f32 v213, v213, v209
  v_mul_f32 v214, v214, v209
  v_cvt_pk_bf16_f32 v60, v220, v221
  v_mfma_f32_32x32x16_bf16 v[236:251], a[68:71], a[44:47], v[236:251]
  v_cvt_pk_bf16_f32 v61, v222, v223
  v_cvt_pk_bf16_f32 v62, v224, v225
  v_cvt_pk_bf16_f32 v63, v226, v227
  v_cvt_pk_bf16_f32 v64, v228, v229
  v_cvt_pk_bf16_f32 v65, v230, v231
  s_waitcnt lgkmcnt(0)
  v_mfma_f32_32x32x16_bf16 v[188:203], v[102:105], v[42:45], v[188:203]
  v_cvt_pk_bf16_f32 v84, v232, v233
  v_cvt_pk_bf16_f32 v85, v234, v235
  v_mul_f32 v215, v215, v209
  v_mul_f32 v216, v216, v209
  v_cvt_pk_bf16_f32 v72, v236, v237
  v_cvt_pk_bf16_f32 v73, v238, v239
  v_mfma_f32_32x32x16_bf16 v[220:235], a[72:75], a[0:3], 0
  v_cvt_pk_bf16_f32 v74, v240, v241
  v_cvt_pk_bf16_f32 v75, v242, v243
  v_cvt_pk_bf16_f32 v76, v244, v245
  v_cvt_pk_bf16_f32 v77, v246, v247
  v_cvt_pk_bf16_f32 v90, v248, v249
  v_cvt_pk_bf16_f32 v91, v250, v251
  v_mul_f32 v217, v217, v209
  v_mfma_f32_32x32x8_bf16 v[188:203], v[106:107], v[46:47], v[188:203]
  v_mul_f32 v218, v218, v209
  v_mul_f32 v219, v219, v209
  v_mul_f32 v204, v204, v209
  v_mul_f32 v205, v205, v209
  v_mul_f32 v206, v206, v209
  v_mul_f32 v207, v207, v209
  v_cvt_pk_bf16_f32 v174, v176, v177
  v_cvt_pk_bf16_f32 v175, v178, v179
  v_mfma_f32_32x32x16_bf16 v[220:235], a[76:79], a[4:7], v[220:235]
  v_max3_f32 v10, v10, v208, v209
  v_cvt_pk_bf16_f32 v48, v212, v213
  v_cvt_pk_bf16_f32 v49, v214, v215
  v_cvt_pk_bf16_f32 v50, v216, v217
  v_cvt_pk_bf16_f32 v51, v218, v219
  v_cvt_pk_bf16_f32 v52, v204, v205
  v_mfma_f32_32x32x16_bf16 v[236:251], a[72:75], a[24:27], 0
  v_cvt_pk_bf16_f32 v53, v206, v207
  v_exp_f32 v180, v180
  v_exp_f32 v181, v181
  v_mfma_f32_32x32x16_bf16 v[204:219], v[156:159], v[172:175], 0
  ds_read_b128 v[172:175], v3 offset:12928
  v_exp_f32 v182, v182
  v_exp_f32 v183, v183
  v_cvt_pk_bf16_f32 v176, v180, v181
  v_mfma_f32_32x32x16_bf16 v[220:235], a[80:83], a[8:11], v[220:235]
  buffer_load_dwordx4 v8, s[8:11], s42 offen offset:1024 nt lds
  v_exp_f32 v184, v184
  v_exp_f32 v185, v185
  v_mfma_f32_32x32x16_bf16 v[236:251], a[76:79], a[28:31], v[236:251]
  v_exp_f32 v186, v186
  v_exp_f32 v187, v187
  v_cvt_pk_bf16_f32 v177, v182, v183
  v_cvt_pk_bf16_f32 v178, v184, v185
  v_mfma_f32_32x32x16_bf16 v[220:235], a[84:87], a[12:15], v[220:235]
  ds_read_b128 v[180:183], v3 offset:12672
  v_cvt_pk_bf16_f32 v179, v186, v187
  v_exp_f32 v188, v188
  v_exp_f32 v189, v189
  v_mfma_f32_32x32x16_bf16 v[204:219], v[160:163], v[176:179], v[204:219]
  ds_read_b128 v[176:179], v3 offset:12800
  ds_read_b128 v[184:187], v3 offset:12544
  v_exp_f32 v190, v190
  v_exp_f32 v191, v191
  v_mfma_f32_32x32x16_bf16 v[236:251], a[80:83], a[32:35], v[236:251]
  v_exp_f32 v192, v192
  v_exp_f32 v193, v193
  v_exp_f32 v194, v194
  v_mfma_f32_32x32x16_bf16 v[220:235], a[88:91], a[16:19], v[220:235]
  v_exp_f32 v195, v195
  v_cvt_pk_bf16_f32 v188, v188, v189
  v_cvt_pk_bf16_f32 v189, v190, v191
  v_cvt_pk_bf16_f32 v190, v192, v193
  v_cvt_pk_bf16_f32 v191, v194, v195
  v_mfma_f32_32x32x16_bf16 v[236:251], a[84:87], a[36:39], v[236:251]
  v_exp_f32 v196, v196
  v_exp_f32 v197, v197
  v_exp_f32 v198, v198
  v_mfma_f32_32x32x16_bf16 v[204:219], v[164:167], v[188:191], v[204:219]
  ds_read_b128 v[188:191], v2 offset:12416
  v_exp_f32 v199, v199
  v_exp_f32 v200, v200
  s_waitcnt lgkmcnt(1)
  v_mfma_f32_32x32x16_bf16 v[172:187], v[96:99], v[54:57], v[172:187]
  v_exp_f32 v201, v201
  v_exp_f32 v202, v202
  v_exp_f32 v203, v203
  v_mfma_f32_32x32x16_bf16 v[220:235], a[92:95], a[20:23], v[220:235]
  buffer_load_dwordx4 v9, s[8:11], s42 offen offset:2048 nt lds
  s_add_u32 m0, s50, 9216
  v_cvt_pk_bf16_f32 v192, v196, v197
  v_cvt_pk_bf16_f32 v193, v198, v199
  v_cvt_pk_bf16_f32 v194, v200, v201
  v_cvt_pk_bf16_f32 v195, v202, v203
  v_mfma_f32_32x32x8_bf16 v[172:187], v[100:101], v[58:59], v[172:187]
  ds_read_b128 v[196:199], v2 offset:12160
  ds_read_b128 v[200:203], v2 offset:12032
  v_mfma_f32_32x32x16_bf16 v[204:219], v[168:171], v[192:195], v[204:219]
  ds_read_b128 v[192:195], v2 offset:12288
  v_cvt_pk_bf16_f32 v86, v220, v221
  v_cvt_pk_bf16_f32 v87, v222, v223
  v_cvt_pk_bf16_f32 v88, v224, v225
  v_cvt_pk_bf16_f32 v89, v226, v227
  v_cvt_pk_bf16_f32 v66, v228, v229
  v_mfma_f32_32x32x16_bf16 v[236:251], a[88:91], a[40:43], v[236:251]
  v_cvt_pk_bf16_f32 v67, v230, v231
  v_cvt_pk_bf16_f32 v68, v232, v233
  v_cvt_pk_bf16_f32 v69, v234, v235
  v_exp_f32 v172, v172
  v_mfma_f32_32x32x16_bf16 v[236:251], a[92:95], a[44:47], v[236:251]
  v_rcp_f32 v205, v204
  v_exp_f32 v173, v173
  v_mul_f32 v208, v208, v205
  v_mul_f32 v209, v209, v205
  v_mfma_f32_32x32x16_bf16 v[220:235], a[168:171], v[12:15], 0
  v_mul_f32 v210, v210, v205
  v_mul_f32 v211, v211, v205
  v_cvt_pk_bf16_f32 v42, v208, v209
  v_cvt_pk_bf16_f32 v43, v210, v211
  v_cvt_pk_bf16_f32 v92, v236, v237
  v_cvt_pk_bf16_f32 v93, v238, v239
  v_mfma_f32_32x32x16_bf16 v[220:235], a[172:175], v[16:19], v[220:235]
  v_cvt_pk_bf16_f32 v94, v240, v241
  v_cvt_pk_bf16_f32 v95, v242, v243
  v_cvt_pk_bf16_f32 v78, v244, v245
  v_cvt_pk_bf16_f32 v79, v246, v247
  v_cvt_pk_bf16_f32 v80, v248, v249
  s_waitcnt lgkmcnt(0)
  v_mfma_f32_32x32x16_bf16 v[188:203], v[102:105], v[54:57], v[188:203]
  v_cvt_pk_bf16_f32 v81, v250, v251
  v_mul_f32 v212, v212, v205
  v_mul_f32 v213, v213, v205
  v_mul_f32 v214, v214, v205
  v_mul_f32 v215, v215, v205
  v_mul_f32 v216, v216, v205
  v_mfma_f32_32x32x16_bf16 v[236:251], a[192:195], v[12:15], 0
  buffer_load_dwordx4 v7, s[8:11], s43 offen offset:0 nt lds
  v_mul_f32 v217, v217, v205
  v_mul_f32 v218, v218, v205
  v_mul_f32 v219, v219, v205
  v_cvt_pk_bf16_f32 v44, v212, v213
  v_cvt_pk_bf16_f32 v45, v214, v215
  v_mfma_f32_32x32x8_bf16 v[188:203], v[106:107], v[58:59], v[188:203]
  v_cvt_pk_bf16_f32 v46, v216, v217
  v_cvt_pk_bf16_f32 v47, v218, v219
  v_exp_f32 v174, v174
  v_exp_f32 v175, v175
  v_exp_f32 v176, v176
  v_mfma_f32_32x32x16_bf16 v[220:235], a[176:179], v[20:23], v[220:235]
  v_exp_f32 v177, v177
  v_exp_f32 v178, v178
  v_exp_f32 v179, v179
  v_mfma_f32_32x32x16_bf16 v[236:251], a[196:199], v[16:19], v[236:251]
  v_cvt_pk_bf16_f32 v172, v172, v173
  v_cvt_pk_bf16_f32 v173, v174, v175
  v_cvt_pk_bf16_f32 v174, v176, v177
  v_cvt_pk_bf16_f32 v175, v178, v179
  v_max3_f32 v10, v10, v204, v205
  v_mfma_f32_32x32x16_bf16 v[220:235], a[180:183], v[36:39], v[220:235]
  v_exp_f32 v180, v180
  v_exp_f32 v181, v181
  v_exp_f32 v182, v182
  v_mfma_f32_32x32x16_bf16 v[204:219], v[156:159], v[172:175], 0
  ds_read_b128 v[172:175], v2 offset:896
  v_exp_f32 v183, v183
  v_exp_f32 v184, v184
  v_cvt_pk_bf16_f32 v176, v180, v181
  v_mfma_f32_32x32x16_bf16 v[236:251], a[200:203], v[20:23], v[236:251]
  v_exp_f32 v185, v185
  v_exp_f32 v186, v186
  v_exp_f32 v187, v187
  v_mfma_f32_32x32x16_bf16 v[220:235], a[184:187], v[40:43], v[220:235]
  v_cvt_pk_bf16_f32 v177, v182, v183
  v_cvt_pk_bf16_f32 v178, v184, v185
  v_cvt_pk_bf16_f32 v179, v186, v187
  v_exp_f32 v188, v188
  v_mfma_f32_32x32x16_bf16 v[204:219], v[160:163], v[176:179], v[204:219]
  ds_read_b128 v[176:179], v2 offset:768
  ds_read_b128 v[180:183], v2 offset:640
  ds_read_b128 v[184:187], v2 offset:512
  buffer_load_dwordx4 v8, s[8:11], s43 offen offset:1024 nt lds
  v_mfma_f32_32x32x16_bf16 v[236:251], a[204:207], v[36:39], v[236:251]
  v_exp_f32 v189, v189
  v_exp_f32 v190, v190
  v_exp_f32 v191, v191
  v_mfma_f32_32x32x16_bf16 v[220:235], a[188:191], v[44:47], v[220:235]
  v_exp_f32 v192, v192
  v_exp_f32 v193, v193
  v_exp_f32 v194, v194
  v_mfma_f32_32x32x16_bf16 v[236:251], a[208:211], v[40:43], v[236:251]
  v_exp_f32 v195, v195
  v_cvt_pk_bf16_f32 v188, v188, v189
  v_cvt_pk_bf16_f32 v189, v190, v191
  v_cvt_pk_bf16_f32 v220, v220, v221
  v_cvt_pk_bf16_f32 v221, v222, v223
  v_mfma_f32_32x32x16_bf16 v[236:251], a[212:215], v[44:47], v[236:251]
  v_cvt_pk_bf16_f32 v222, v224, v225
  v_cvt_pk_bf16_f32 v223, v226, v227
  v_cvt_pk_bf16_f32 v224, v228, v229
  v_cvt_pk_bf16_f32 v225, v230, v231
  v_cvt_pk_bf16_f32 v226, v232, v233
  s_waitcnt lgkmcnt(0)
  v_mfma_f32_32x32x16_bf16 v[172:187], v[84:87], v[60:63], v[172:187]
  ds_write_b128 v4, v[220:223] offset:0
  v_cvt_pk_bf16_f32 v227, v234, v235
  v_cvt_pk_bf16_f32 v190, v192, v193
  v_cvt_pk_bf16_f32 v191, v194, v195
  v_cvt_pk_bf16_f32 v236, v236, v237
  v_cvt_pk_bf16_f32 v237, v238, v239
  v_mfma_f32_32x32x16_bf16 v[204:219], v[164:167], v[188:191], v[204:219]
  ds_write_b128 v5, v[224:227] offset:0
  v_cvt_pk_bf16_f32 v238, v240, v241
  v_cvt_pk_bf16_f32 v239, v242, v243
  v_mfma_f32_32x32x8_bf16 v[172:187], v[88:89], v[64:65], v[172:187]
  v_cvt_pk_bf16_f32 v240, v244, v245
  v_cvt_pk_bf16_f32 v241, v246, v247
  v_cvt_pk_bf16_f32 v242, v248, v249
  v_cvt_pk_bf16_f32 v243, v250, v251
  v_exp_f32 v196, v196
  v_exp_f32 v197, v197
  v_mfma_f32_32x32x16_bf16 v[220:235], a[216:219], v[12:15], 0
  ds_write_b128 v4, v[236:239] offset:64
  v_cvt_pk_bf16_f32 v192, v196, v197
  v_mfma_f32_32x32x16_bf16 v[220:235], a[220:223], v[16:19], v[220:235]
  ds_write_b128 v5, v[240:243] offset:64
  buffer_load_dwordx4 v9, s[8:11], s43 offen offset:2048 nt lds
  v_mfma_f32_32x32x16_bf16 v[236:251], a[168:171], v[24:27], 0
  s_mov_b32 m0, 159744
  v_exp_f32 v198, v198
  v_exp_f32 v199, v199
  v_mfma_f32_32x32x16_bf16 v[220:235], a[224:227], v[20:23], v[220:235]
  ds_read_b128 v[188:191], v3 offset:384
  v_exp_f32 v200, v200
  v_exp_f32 v201, v201
  v_cvt_pk_bf16_f32 v193, v198, v199
  v_mfma_f32_32x32x16_bf16 v[236:251], a[172:175], v[28:31], v[236:251]
  ds_read_b128 v[196:199], v3 offset:128
  v_exp_f32 v202, v202
  v_exp_f32 v203, v203
  v_cvt_pk_bf16_f32 v194, v200, v201
  v_mfma_f32_32x32x16_bf16 v[220:235], a[228:231], v[36:39], v[220:235]
  v_cvt_pk_bf16_f32 v195, v202, v203
  v_exp_f32 v172, v172
  v_exp_f32 v173, v173
  v_mfma_f32_32x32x16_bf16 v[204:219], v[168:171], v[192:195], v[204:219]
  ds_read_b128 v[192:195], v3 offset:256
  ds_read_b128 v[200:203], v3 offset:0
  v_exp_f32 v174, v174
  v_exp_f32 v175, v175
  v_mfma_f32_32x32x16_bf16 v[236:251], a[176:179], v[32:35], v[236:251]
  v_exp_f32 v176, v176
  v_exp_f32 v177, v177
  v_rcp_f32 v205, v204
  v_mfma_f32_32x32x16_bf16 v[220:235], a[232:235], v[40:43], v[220:235]
  v_mul_f32 v208, v208, v205
  v_mul_f32 v209, v209, v205
  v_mul_f32 v210, v210, v205
  v_mul_f32 v211, v211, v205
  v_cvt_pk_bf16_f32 v54, v208, v209
  v_cvt_pk_bf16_f32 v55, v210, v211
  v_mfma_f32_32x32x16_bf16 v[236:251], a[180:183], v[48:51], v[236:251]
  v_mul_f32 v212, v212, v205
  v_mul_f32 v213, v213, v205
  v_mul_f32 v214, v214, v205
  v_mul_f32 v215, v215, v205
  v_mul_f32 v216, v216, v205
  v_mul_f32 v217, v217, v205
  v_mfma_f32_32x32x16_bf16 v[220:235], a[236:239], v[44:47], v[220:235]
  buffer_load_dword v1, s[56:59], s72 offen lds
  s_add_u32 m0, s50, 0
  v_mul_f32 v218, v218, v205
  v_mul_f32 v219, v219, v205
  s_waitcnt lgkmcnt(0)
  v_mfma_f32_32x32x16_bf16 v[188:203], v[90:93], v[60:63], v[188:203]
  v_cvt_pk_bf16_f32 v56, v212, v213
  v_cvt_pk_bf16_f32 v57, v214, v215
  v_cvt_pk_bf16_f32 v58, v216, v217
  v_cvt_pk_bf16_f32 v59, v218, v219
  v_exp_f32 v178, v178
  v_mfma_f32_32x32x16_bf16 v[236:251], a[184:187], v[52:55], v[236:251]
  v_cvt_pk_bf16_f32 v220, v220, v221
  v_cvt_pk_bf16_f32 v221, v222, v223
  v_cvt_pk_bf16_f32 v222, v224, v225
  v_cvt_pk_bf16_f32 v223, v226, v227
  v_cvt_pk_bf16_f32 v224, v228, v229
  v_cvt_pk_bf16_f32 v225, v230, v231
  v_cvt_pk_bf16_f32 v226, v232, v233
  v_mfma_f32_32x32x8_bf16 v[188:203], v[94:95], v[64:65], v[188:203]
  v_cvt_pk_bf16_f32 v227, v234, v235
  v_exp_f32 v179, v179
  v_cvt_pk_bf16_f32 v172, v172, v173
  v_cvt_pk_bf16_f32 v173, v174, v175
  v_cvt_pk_bf16_f32 v174, v176, v177
  v_cvt_pk_bf16_f32 v175, v178, v179
  v_max3_f32 v10, v10, v204, v205
  v_mfma_f32_32x32x16_bf16 v[236:251], a[188:191], v[56:59], v[236:251]
  ds_write_b128 v4, v[220:223] offset:128
  v_exp_f32 v180, v180
  v_mfma_f32_32x32x16_bf16 v[204:219], v[108:111], v[172:175], 0
  ds_write_b128 v5, v[224:227] offset:128
  v_exp_f32 v181, v181
  v_mfma_f32_32x32x16_bf16 v[220:235], a[192:195], v[24:27], 0
  v_exp_f32 v182, v182
  v_cvt_pk_bf16_f32 v236, v236, v237
  v_cvt_pk_bf16_f32 v237, v238, v239
  v_cvt_pk_bf16_f32 v238, v240, v241
  v_cvt_pk_bf16_f32 v239, v242, v243
  v_mfma_f32_32x32x16_bf16 v[220:235], a[196:199], v[28:31], v[220:235]
  ds_write_b128 v4, v[236:239] offset:6144
  v_cvt_pk_bf16_f32 v240, v244, v245
  v_mfma_f32_32x32x16_bf16 v[220:235], a[200:203], v[32:35], v[220:235]
  ds_read_b128 v[172:175], v3 offset:1408
  v_cvt_pk_bf16_f32 v241, v246, v247
  v_cvt_pk_bf16_f32 v242, v248, v249
  v_cvt_pk_bf16_f32 v243, v250, v251
  v_exp_f32 v183, v183
  v_mfma_f32_32x32x16_bf16 v[220:235], a[204:207], v[48:51], v[220:235]
  ds_write_b128 v5, v[240:243] offset:6144
  v_cvt_pk_bf16_f32 v176, v180, v181
  v_mfma_f32_32x32x16_bf16 v[236:251], a[216:219], v[24:27], 0
  v_exp_f32 v184, v184
  v_exp_f32 v185, v185
  v_exp_f32 v186, v186
  v_mfma_f32_32x32x16_bf16 v[236:251], a[220:223], v[28:31], v[236:251]
  ds_read_b128 v[252:255], v6 offset:0
  v_exp_f32 v187, v187
  v_cvt_pk_bf16_f32 v177, v182, v183
  v_cvt_pk_bf16_f32 v178, v184, v185
  v_cvt_pk_bf16_f32 v179, v186, v187
  v_mfma_f32_32x32x16_bf16 v[236:251], a[224:227], v[32:35], v[236:251]
  ds_read_b128 v[180:183], v3 offset:1152
  ds_read_b128 v[184:187], v3 offset:1024
  v_exp_f32 v188, v188
  v_exp_f32 v189, v189
  v_mfma_f32_32x32x16_bf16 v[204:219], v[112:115], v[176:179], v[204:219]
  ds_read_b128 v[176:179], v3 offset:1280
  v_exp_f32 v190, v190
  v_exp_f32 v191, v191
  v_cvt_pk_bf16_f32 v188, v188, v189
  v_mfma_f32_32x32x16_bf16 v[220:235], a[208:211], v[52:55], v[220:235]
  v_exp_f32 v192, v192
  v_exp_f32 v193, v193
  v_exp_f32 v194, v194
  v_mfma_f32_32x32x16_bf16 v[236:251], a[228:231], v[48:51], v[236:251]
  v_exp_f32 v195, v195
  v_cvt_pk_bf16_f32 v189, v190, v191
  v_cvt_pk_bf16_f32 v190, v192, v193
  v_cvt_pk_bf16_f32 v191, v194, v195
  v_mfma_f32_32x32x16_bf16 v[220:235], a[212:215], v[56:59], v[220:235]
  v_exp_f32 v196, v196
  v_exp_f32 v197, v197
  v_exp_f32 v198, v198
  v_mfma_f32_32x32x16_bf16 v[204:219], v[116:119], v[188:191], v[204:219]
  ds_read_b128 v[188:191], v2 offset:896
  v_exp_f32 v199, v199
  v_exp_f32 v200, v200
  s_waitcnt lgkmcnt(1)
  v_mfma_f32_32x32x16_bf16 v[172:187], v[84:87], v[72:75], v[172:187]
  v_cvt_pk_bf16_f32 v220, v220, v221
  v_cvt_pk_bf16_f32 v221, v222, v223
  v_cvt_pk_bf16_f32 v222, v224, v225
  v_cvt_pk_bf16_f32 v223, v226, v227
  v_cvt_pk_bf16_f32 v224, v228, v229
  v_cvt_pk_bf16_f32 v225, v230, v231
  v_mfma_f32_32x32x16_bf16 v[236:251], a[232:235], v[52:55], v[236:251]
  ds_write_b128 v4, v[220:223] offset:6208
  v_cvt_pk_bf16_f32 v226, v232, v233
  v_cvt_pk_bf16_f32 v227, v234, v235
  v_mfma_f32_32x32x8_bf16 v[172:187], v[88:89], v[76:77], v[172:187]
  v_exp_f32 v201, v201
  v_exp_f32 v202, v202
  v_exp_f32 v203, v203
  v_cvt_pk_bf16_f32 v192, v196, v197
  v_cvt_pk_bf16_f32 v193, v198, v199
  v_mfma_f32_32x32x16_bf16 v[236:251], a[236:239], v[56:59], v[236:251]
  ds_write_b128 v5, v[224:227] offset:6208
  v_cvt_pk_bf16_f32 v194, v200, v201
  v_mfma_f32_32x32x16_bf16 v[220:235], a[96:99], a[0:3], 0
  ds_read_b128 v[196:199], v2 offset:640
  v_cvt_pk_bf16_f32 v195, v202, v203
  v_exp_f32 v172, v172
  v_exp_f32 v173, v173
  v_mfma_f32_32x32x16_bf16 v[204:219], v[120:123], v[192:195], v[204:219]
  ds_read_b128 v[192:195], v2 offset:768
  ds_read_b128 v[200:203], v2 offset:512
  v_cvt_pk_bf16_f32 v236, v236, v237
  v_cvt_pk_bf16_f32 v237, v238, v239
  v_cvt_pk_bf16_f32 v238, v240, v241
  v_cvt_pk_bf16_f32 v239, v242, v243
  v_mfma_f32_32x32x16_bf16 v[220:235], a[100:103], a[4:7], v[220:235]
  ds_write_b128 v4, v[236:239] offset:6272
  v_cvt_pk_bf16_f32 v240, v244, v245
  v_mfma_f32_32x32x16_bf16 v[220:235], a[104:107], a[8:11], v[220:235]
  v_cvt_pk_bf16_f32 v241, v246, v247
  v_cvt_pk_bf16_f32 v242, v248, v249
  v_cvt_pk_bf16_f32 v243, v250, v251
  v_exp_f32 v174, v174
  v_cvt_pk_bf16_f32 v172, v172, v173
  v_mfma_f32_32x32x16_bf16 v[220:235], a[108:111], a[12:15], v[220:235]
  ds_write_b128 v5, v[240:243] offset:6272
  v_exp_f32 v175, v175
  v_mfma_f32_32x32x16_bf16 v[236:251], a[96:99], a[24:27], 0
  v_rcp_f32 v217, v216
  v_exp_f32 v176, v176
  v_cvt_pk_bf16_f32 v173, v174, v175
  s_waitcnt lgkmcnt(2)
  v_mfma_f32_32x32x16_bf16 v[188:203], v[90:93], v[72:75], v[188:203]
  v_exp_f32 v177, v177
  v_exp_f32 v178, v178
  v_exp_f32 v179, v179
  v_mfma_f32_32x32x16_bf16 v[236:251], a[100:103], a[28:31], v[236:251]
  v_mul_f32 v204, v204, v217
  v_mul_f32 v205, v205, v217
  v_mul_f32 v206, v206, v217
  v_mul_f32 v207, v207, v217
  v_mul_f32 v208, v208, v217
  v_mul_f32 v209, v209, v217
  v_mul_f32 v210, v210, v217
  v_mfma_f32_32x32x8_bf16 v[188:203], v[94:95], v[76:77], v[188:203]
  v_mul_f32 v211, v211, v217
  v_mul_f32 v212, v212, v217
  v_mul_f32 v213, v213, v217
  v_mul_f32 v214, v214, v217
  v_mul_f32 v215, v215, v217
  v_cvt_pk_bf16_f32 v174, v176, v177
  v_cvt_pk_bf16_f32 v175, v178, v179
  v_max3_f32 v10, v10, v216, v217
  v_mfma_f32_32x32x16_bf16 v[236:251], a[104:107], a[32:35], v[236:251]
  v_cvt_pk_bf16_f32 v60, v204, v205
  v_cvt_pk_bf16_f32 v61, v206, v207
  v_cvt_pk_bf16_f32 v62, v208, v209
  v_cvt_pk_bf16_f32 v63, v210, v211
  v_cvt_pk_bf16_f32 v64, v212, v213
  v_cvt_pk_bf16_f32 v65, v214, v215
  v_mfma_f32_32x32x16_bf16 v[204:219], v[108:111], v[172:175], 0
  ds_read_b128 v[172:175], v2 offset:4736
  v_exp_f32 v180, v180
  v_exp_f32 v181, v181
  v_mfma_f32_32x32x16_bf16 v[236:251], a[108:111], a[36:39], v[236:251]
  v_exp_f32 v182, v182
  v_exp_f32 v183, v183
  v_exp_f32 v184, v184
  v_mfma_f32_32x32x16_bf16 v[220:235], a[112:115], a[16:19], v[220:235]
  v_exp_f32 v185, v185
  v_exp_f32 v186, v186
  v_exp_f32 v187, v187
  v_mfma_f32_32x32x16_bf16 v[236:251], a[112:115], a[40:43], v[236:251]
  v_cvt_pk_bf16_f32 v176, v180, v181
  v_cvt_pk_bf16_f32 v177, v182, v183
  v_cvt_pk_bf16_f32 v178, v184, v185
  v_cvt_pk_bf16_f32 v179, v186, v187
  v_exp_f32 v188, v188
  v_mfma_f32_32x32x16_bf16 v[204:219], v[112:115], v[176:179], v[204:219]
  ds_read_b128 v[176:179], v2 offset:4608
  ds_read_b128 v[180:183], v2 offset:4480
  ds_read_b128 v[184:187], v2 offset:4352
  v_exp_f32 v189, v189
  v_mfma_f32_32x32x16_bf16 v[220:235], a[116:119], a[20:23], v[220:235]
  v_exp_f32 v190, v190
  v_exp_f32 v191, v191
  v_exp_f32 v192, v192
  v_mfma_f32_32x32x16_bf16 v[236:251], a[116:119], a[44:47], v[236:251]
  s_waitcnt vmcnt(1)
  buffer_store_dwordx4 v[252:255], v7, s[12:15], s32 offen offset:0 sc1
  v_exp_f32 v193, v193
  v_cvt_pk_bf16_f32 v70, v220, v221
  v_cvt_pk_bf16_f32 v71, v222, v223
  v_cvt_pk_bf16_f32 v96, v224, v225
  v_cvt_pk_bf16_f32 v97, v226, v227
  v_cvt_pk_bf16_f32 v98, v228, v229
  v_cvt_pk_bf16_f32 v99, v230, v231
  v_cvt_pk_bf16_f32 v100, v232, v233
  v_cvt_pk_bf16_f32 v101, v234, v235
  v_mfma_f32_32x32x16_bf16 v[220:235], a[0:3], a[248:251], 0
  ds_read_b128 v[252:255], v6 offset:1024
  v_cvt_pk_bf16_f32 v82, v236, v237
  v_cvt_pk_bf16_f32 v83, v238, v239
  v_cvt_pk_bf16_f32 v102, v240, v241
  v_cvt_pk_bf16_f32 v103, v242, v243
  s_waitcnt lgkmcnt(1)
  v_mfma_f32_32x32x16_bf16 v[172:187], v[96:99], v[66:69], v[172:187]
  v_cvt_pk_bf16_f32 v104, v244, v245
  v_cvt_pk_bf16_f32 v105, v246, v247
  v_cvt_pk_bf16_f32 v106, v248, v249
  v_cvt_pk_bf16_f32 v107, v250, v251
  v_exp_f32 v194, v194
  v_mfma_f32_32x32x16_bf16 v[236:251], a[24:27], a[248:251], 0
  ds_read_b64_tr_b16 a[248:249], v0 offset:16384
  ds_read_b64_tr_b16 a[250:251], v0 offset:16640
  v_exp_f32 v195, v195
  v_cvt_pk_bf16_f32 v188, v188, v189
  v_cvt_pk_bf16_f32 v189, v190, v191
  v_cvt_pk_bf16_f32 v190, v192, v193
  v_mfma_f32_32x32x8_bf16 v[172:187], v[100:101], v[70:71], v[172:187]
  v_cvt_pk_bf16_f32 v191, v194, v195
  v_exp_f32 v196, v196
  v_exp_f32 v197, v197
  v_exp_f32 v198, v198
  v_cvt_pk_bf16_f32 v192, v196, v197
  v_mfma_f32_32x32x16_bf16 v[204:219], v[116:119], v[188:191], v[204:219]
  ds_read_b128 v[188:191], v3 offset:4224
  v_exp_f32 v199, v199
  v_exp_f32 v200, v200
  v_cvt_pk_bf16_f32 v193, v198, v199
  v_mfma_f32_32x32x16_bf16 v[220:235], a[4:7], a[252:255], v[220:235]
  ds_read_b128 v[196:199], v3 offset:3968
  v_exp_f32 v201, v201
  v_exp_f32 v202, v202
  v_cvt_pk_bf16_f32 v194, v200, v201
  v_mfma_f32_32x32x16_bf16 v[236:251], a[28:31], a[252:255], v[236:251]
  ds_read_b64_tr_b16 a[252:253], v0 offset:17408
  ds_read_b64_tr_b16 a[254:255], v0 offset:17664
  v_exp_f32 v203, v203
  v_exp_f32 v172, v172
  v_mfma_f32_32x32x16_bf16 v[220:235], a[8:11], a[240:243], v[220:235]
  s_waitcnt lgkmcnt(4)
  buffer_store_dwordx4 v[252:255], v8, s[12:15], s32 offen offset:1024 sc1
  v_mfma_f32_32x32x16_bf16 v[236:251], a[32:35], a[240:243], v[236:251]
  ds_read_b64_tr_b16 a[240:241], v0 offset:18432
  ds_read_b64_tr_b16 a[242:243], v0 offset:18688
  ds_read_b128 v[252:255], v6 offset:2048
  v_cvt_pk_bf16_f32 v195, v202, v203
  v_exp_f32 v173, v173
  v_mfma_f32_32x32x16_bf16 v[204:219], v[120:123], v[192:195], v[204:219]
  ds_read_b128 v[192:195], v3 offset:4096
  ds_read_b128 v[200:203], v3 offset:3840
  v_exp_f32 v174, v174
  v_exp_f32 v175, v175
  v_mfma_f32_32x32x16_bf16 v[220:235], a[12:15], a[244:247], v[220:235]
  v_exp_f32 v176, v176
  v_exp_f32 v177, v177
  v_rcp_f32 v217, v216
  v_mfma_f32_32x32x16_bf16 v[236:251], a[36:39], a[244:247], v[236:251]
  ds_read_b64_tr_b16 a[244:245], v0 offset:19456
  ds_read_b64_tr_b16 a[246:247], v0 offset:19712
  v_exp_f32 v178, v178
  v_exp_f32 v179, v179
  v_mfma_f32_32x32x16_bf16 v[220:235], a[16:19], a[248:251], v[220:235]
  v_cvt_pk_bf16_f32 v172, v172, v173
  v_cvt_pk_bf16_f32 v173, v174, v175
  v_mul_f32 v204, v204, v217
  v_mul_f32 v205, v205, v217
  v_mul_f32 v206, v206, v217
  v_mul_f32 v207, v207, v217
  v_mfma_f32_32x32x16_bf16 v[236:251], a[40:43], a[248:251], v[236:251]
  ds_read_b64_tr_b16 a[248:249], v0 offset:20480
  ds_read_b64_tr_b16 a[250:251], v0 offset:20736
  v_mul_f32 v208, v208, v217
  v_mul_f32 v209, v209, v217
  v_mul_f32 v210, v210, v217
  s_waitcnt lgkmcnt(4)
  v_mfma_f32_32x32x16_bf16 v[188:203], v[102:105], v[66:69], v[188:203]
  v_mul_f32 v211, v211, v217
  v_mul_f32 v212, v212, v217
  v_mul_f32 v213, v213, v217
  v_mul_f32 v214, v214, v217
  v_mul_f32 v215, v215, v217
  v_cvt_pk_bf16_f32 v174, v176, v177
  v_mfma_f32_32x32x16_bf16 v[220:235], a[20:23], a[252:255], v[220:235]
  v_cvt_pk_bf16_f32 v175, v178, v179
  v_max3_f32 v10, v10, v216, v217
  v_cvt_pk_bf16_f32 v72, v204, v205
  v_cvt_pk_bf16_f32 v73, v206, v207
  v_cvt_pk_bf16_f32 v74, v208, v209
  v_cvt_pk_bf16_f32 v75, v210, v211
  v_cvt_pk_bf16_f32 v76, v212, v213
  v_mfma_f32_32x32x8_bf16 v[188:203], v[106:107], v[70:71], v[188:203]
  v_cvt_pk_bf16_f32 v77, v214, v215
  v_exp_f32 v180, v180
  v_exp_f32 v181, v181
  s_mov_b64 exec, s[62:63]
  v_cvt_pk_bf16_f32 v124, v220, v221
  v_cvt_pk_bf16_f32 v125, v222, v223
  v_mfma_f32_32x32x16_bf16 v[236:251], a[44:47], a[252:255], v[236:251]
  v_cvt_pk_bf16_f32 v126, v224, v225
  v_cvt_pk_bf16_f32 v127, v226, v227
  v_cvt_pk_bf16_f32 v128, v228, v229
  v_cvt_pk_bf16_f32 v129, v230, v231
  v_cvt_pk_bf16_f32 v130, v232, v233
  v_cvt_pk_bf16_f32 v131, v234, v235
  v_mfma_f32_32x32x16_bf16 v[204:219], v[124:127], v[172:175], 0
  s_mov_b64 exec, -1
  ds_read_b128 v[172:175], v3 offset:5248
  ds_read_b64_tr_b16 a[252:253], v0 offset:21504
  ds_read_b64_tr_b16 a[254:255], v0 offset:21760
  buffer_store_dwordx4 v[252:255], v9, s[12:15], s32 offen offset:2048 sc1
  s_mov_b64 exec, s[64:65]
  v_cvt_pk_bf16_f32 v140, v220, v221
  v_cvt_pk_bf16_f32 v141, v222, v223
  v_cvt_pk_bf16_f32 v142, v224, v225
  v_cvt_pk_bf16_f32 v143, v226, v227
  v_cvt_pk_bf16_f32 v144, v228, v229
  v_cvt_pk_bf16_f32 v145, v230, v231
  v_cvt_pk_bf16_f32 v146, v232, v233
  v_cvt_pk_bf16_f32 v147, v234, v235
  v_mfma_f32_32x32x16_bf16 v[220:235], a[120:123], a[0:3], 0
  s_mov_b64 exec, -1
  ds_read_b128 v[252:255], v6 offset:3072
  s_mov_b64 exec, s[62:63]
  v_cvt_pk_bf16_f32 v132, v236, v237
  v_cvt_pk_bf16_f32 v133, v238, v239
  v_cvt_pk_bf16_f32 v134, v240, v241
  v_mfma_f32_32x32x16_bf16 v[220:235], a[124:127], a[4:7], v[220:235]
  v_cvt_pk_bf16_f32 v135, v242, v243
  v_cvt_pk_bf16_f32 v136, v244, v245
  v_cvt_pk_bf16_f32 v137, v246, v247
  v_cvt_pk_bf16_f32 v138, v248, v249
  v_cvt_pk_bf16_f32 v139, v250, v251
  s_mov_b64 exec, -1
  v_mfma_f32_32x32x16_bf16 v[220:235], a[128:131], a[8:11], v[220:235]
  s_mov_b64 exec, s[64:65]
  v_cvt_pk_bf16_f32 v148, v236, v237
  v_cvt_pk_bf16_f32 v149, v238, v239
  v_cvt_pk_bf16_f32 v150, v240, v241
  v_cvt_pk_bf16_f32 v151, v242, v243
  v_cvt_pk_bf16_f32 v152, v244, v245
  v_mfma_f32_32x32x16_bf16 v[220:235], a[132:135], a[12:15], v[220:235]
  v_cvt_pk_bf16_f32 v153, v246, v247
  v_cvt_pk_bf16_f32 v154, v248, v249
  v_cvt_pk_bf16_f32 v155, v250, v251
  s_mov_b64 exec, -1
  v_exp_f32 v182, v182
  v_mfma_f32_32x32x16_bf16 v[236:251], a[120:123], a[24:27], 0
  v_exp_f32 v183, v183
  v_exp_f32 v184, v184
  v_exp_f32 v185, v185
  v_mfma_f32_32x32x16_bf16 v[236:251], a[124:127], a[28:31], v[236:251]
  v_exp_f32 v186, v186
  v_exp_f32 v187, v187
  v_cvt_pk_bf16_f32 v176, v180, v181
  v_cvt_pk_bf16_f32 v177, v182, v183
  v_mfma_f32_32x32x16_bf16 v[236:251], a[128:131], a[32:35], v[236:251]
  ds_read_b128 v[180:183], v3 offset:4992
  v_cvt_pk_bf16_f32 v178, v184, v185
  v_cvt_pk_bf16_f32 v179, v186, v187
  v_exp_f32 v188, v188
  v_mfma_f32_32x32x16_bf16 v[204:219], v[128:131], v[176:179], v[204:219]
  ds_read_b128 v[176:179], v3 offset:5120
  ds_read_b128 v[184:187], v3 offset:4864
  v_exp_f32 v189, v189
  v_exp_f32 v190, v190
  v_mfma_f32_32x32x16_bf16 v[236:251], a[132:135], a[36:39], v[236:251]
  s_waitcnt lgkmcnt(3)
  buffer_store_dwordx4 v[252:255], v7, s[12:15], s33 offen offset:0 sc1
  v_mfma_f32_32x32x16_bf16 v[220:235], a[136:139], a[16:19], v[220:235]
  ds_read_b128 v[252:255], v6 offset:4096
  v_exp_f32 v191, v191
  v_exp_f32 v192, v192
  v_cvt_pk_bf16_f32 v188, v188, v189
  v_mfma_f32_32x32x16_bf16 v[236:251], a[136:139], a[40:43], v[236:251]
  v_exp_f32 v193, v193
  v_exp_f32 v194, v194
  v_exp_f32 v195, v195
  v_mfma_f32_32x32x16_bf16 v[220:235], a[140:143], a[20:23], v[220:235]
  v_cvt_pk_bf16_f32 v189, v190, v191
  v_cvt_pk_bf16_f32 v190, v192, v193
  v_cvt_pk_bf16_f32 v191, v194, v195
  v_exp_f32 v196, v196
  v_mfma_f32_32x32x16_bf16 v[204:219], v[132:135], v[188:191], v[204:219]
  ds_read_b128 v[188:191], v2 offset:4736
  v_exp_f32 v197, v197
  v_exp_f32 v198, v198
  s_waitcnt lgkmcnt(2)
  v_mfma_f32_32x32x16_bf16 v[172:187], v[96:99], v[78:81], v[172:187]
  v_cvt_pk_bf16_f32 v12, v220, v221
  v_cvt_pk_bf16_f32 v13, v222, v223
  v_cvt_pk_bf16_f32 v14, v224, v225
  v_cvt_pk_bf16_f32 v15, v226, v227
  v_cvt_pk_bf16_f32 v16, v228, v229
  v_cvt_pk_bf16_f32 v17, v230, v231
  v_mfma_f32_32x32x16_bf16 v[236:251], a[140:143], a[44:47], v[236:251]
  v_cvt_pk_bf16_f32 v84, v232, v233
  v_cvt_pk_bf16_f32 v85, v234, v235
  v_exp_f32 v199, v199
  v_exp_f32 v200, v200
  v_cvt_pk_bf16_f32 v192, v196, v197
  v_mfma_f32_32x32x8_bf16 v[172:187], v[100:101], v[82:83], v[172:187]
  v_exp_f32 v201, v201
  v_exp_f32 v202, v202
  v_cvt_pk_bf16_f32 v24, v236, v237
  v_cvt_pk_bf16_f32 v25, v238, v239
  v_cvt_pk_bf16_f32 v26, v240, v241
  v_cvt_pk_bf16_f32 v27, v242, v243
  v_mfma_f32_32x32x16_bf16 v[220:235], a[144:147], a[0:3], 0
  v_cvt_pk_bf16_f32 v28, v244, v245
  v_cvt_pk_bf16_f32 v29, v246, v247
  v_cvt_pk_bf16_f32 v90, v248, v249
  v_cvt_pk_bf16_f32 v91, v250, v251
  v_exp_f32 v203, v203
  v_mfma_f32_32x32x16_bf16 v[236:251], a[144:147], a[24:27], 0
  s_waitcnt lgkmcnt(0)
  buffer_store_dwordx4 v[252:255], v8, s[12:15], s33 offen offset:1024 sc1
  v_mfma_f32_32x32x16_bf16 v[220:235], a[148:151], a[4:7], v[220:235]
  ds_read_b128 v[252:255], v6 offset:5120
  v_cvt_pk_bf16_f32 v193, v198, v199
  v_cvt_pk_bf16_f32 v194, v200, v201
  v_cvt_pk_bf16_f32 v195, v202, v203
  v_exp_f32 v172, v172
  v_mfma_f32_32x32x16_bf16 v[204:219], v[136:139], v[192:195], v[204:219]
  ds_read_b128 v[192:195], v2 offset:4608
  ds_read_b128 v[196:199], v2 offset:4480
  ds_read_b128 v[200:203], v2 offset:4352
  v_exp_f32 v173, v173
  v_mfma_f32_32x32x16_bf16 v[236:251], a[148:151], a[28:31], v[236:251]
  v_exp_f32 v174, v174
  v_exp_f32 v175, v175
  v_exp_f32 v176, v176
  v_mfma_f32_32x32x16_bf16 v[220:235], a[152:155], a[8:11], v[220:235]
  v_rcp_f32 v213, v212
  v_exp_f32 v177, v177
  v_exp_f32 v178, v178
  v_mfma_f32_32x32x16_bf16 v[236:251], a[152:155], a[32:35], v[236:251]
  v_exp_f32 v179, v179
  v_cvt_pk_bf16_f32 v172, v172, v173
  v_cvt_pk_bf16_f32 v173, v174, v175
  v_mul_f32 v216, v216, v213
  v_mul_f32 v217, v217, v213
  v_mfma_f32_32x32x16_bf16 v[220:235], a[156:159], a[12:15], v[220:235]
  v_mul_f32 v218, v218, v213
  v_mul_f32 v219, v219, v213
  v_mul_f32 v204, v204, v213
  v_mul_f32 v205, v205, v213
  v_mul_f32 v206, v206, v213
  s_waitcnt lgkmcnt(0)
  v_mfma_f32_32x32x16_bf16 v[188:203], v[102:105], v[78:81], v[188:203]
  v_mul_f32 v207, v207, v213
  v_mul_f32 v208, v208, v213
  v_mul_f32 v209, v209, v213
  v_mul_f32 v210, v210, v213
  v_mul_f32 v211, v211, v213
  v_cvt_pk_bf16_f32 v174, v176, v177
  v_mfma_f32_32x32x16_bf16 v[236:251], a[156:159], a[36:39], v[236:251]
  v_cvt_pk_bf16_f32 v175, v178, v179
  v_max3_f32 v10, v10, v212, v213
  v_cvt_pk_bf16_f32 v66, v216, v217
  v_cvt_pk_bf16_f32 v67, v218, v219
  v_cvt_pk_bf16_f32 v68, v204, v205
  v_cvt_pk_bf16_f32 v69, v206, v207
  v_cvt_pk_bf16_f32 v70, v208, v209
  v_mfma_f32_32x32x8_bf16 v[188:203], v[106:107], v[82:83], v[188:203]
  v_cvt_pk_bf16_f32 v71, v210, v211
  v_exp_f32 v180, v180
  v_exp_f32 v181, v181
  v_exp_f32 v182, v182
  v_cvt_pk_bf16_f32 v176, v180, v181
  v_mfma_f32_32x32x16_bf16 v[204:219], v[124:127], v[172:175], 0
  ds_read_b128 v[172:175], v2 offset:8576
  buffer_store_dwordx4 v[252:255], v9, s[12:15], s33 offen offset:2048 sc1
  v_mfma_f32_32x32x16_bf16 v[220:235], a[160:163], a[16:19], v[220:235]
  ds_read_b128 v[252:255], v6 offset:6144
  v_exp_f32 v183, v183
  v_exp_f32 v184, v184
  v_cvt_pk_bf16_f32 v177, v182, v183
  v_mfma_f32_32x32x16_bf16 v[236:251], a[160:163], a[40:43], v[236:251]
  ds_read_b128 v[180:183], v2 offset:8320
  v_exp_f32 v185, v185
  v_exp_f32 v186, v186
  v_cvt_pk_bf16_f32 v178, v184, v185
  v_mfma_f32_32x32x16_bf16 v[220:235], a[164:167], a[20:23], v[220:235]
  v_exp_f32 v187, v187
  v_exp_f32 v188, v188
  v_cvt_pk_bf16_f32 v179, v186, v187
  v_mfma_f32_32x32x16_bf16 v[236:251], a[164:167], a[44:47], v[236:251]
  ds_read_b128 v[184:187], v2 offset:8192
  v_exp_f32 v189, v189
  v_exp_f32 v190, v190
  v_cvt_pk_bf16_f32 v86, v220, v221
  v_mfma_f32_32x32x16_bf16 v[204:219], v[128:131], v[176:179], v[204:219]
  ds_read_b128 v[176:179], v2 offset:8448
  v_cvt_pk_bf16_f32 v87, v222, v223
  v_cvt_pk_bf16_f32 v88, v224, v225
  v_cvt_pk_bf16_f32 v89, v226, v227
  v_cvt_pk_bf16_f32 v18, v228, v229
  v_cvt_pk_bf16_f32 v19, v230, v231
  v_cvt_pk_bf16_f32 v20, v232, v233
  v_cvt_pk_bf16_f32 v21, v234, v235
  v_mfma_f32_32x32x16_bf16 v[220:235], a[0:3], a[240:243], 0
  v_cvt_pk_bf16_f32 v92, v236, v237
  v_cvt_pk_bf16_f32 v93, v238, v239
  v_cvt_pk_bf16_f32 v94, v240, v241
  v_cvt_pk_bf16_f32 v95, v242, v243
  v_cvt_pk_bf16_f32 v30, v244, v245
  v_cvt_pk_bf16_f32 v31, v246, v247
  v_mfma_f32_32x32x16_bf16 v[220:235], a[4:7], a[244:247], v[220:235]
  v_cvt_pk_bf16_f32 v32, v248, v249
  v_cvt_pk_bf16_f32 v33, v250, v251
  v_exp_f32 v191, v191
  v_exp_f32 v192, v192
  v_mfma_f32_32x32x16_bf16 v[236:251], a[24:27], a[240:243], 0
  ds_read_b64_tr_b16 a[240:241], v0 offset:22528
  ds_read_b64_tr_b16 a[242:243], v0 offset:22784
  v_exp_f32 v193, v193
  v_exp_f32 v194, v194
  v_mfma_f32_32x32x16_bf16 v[236:251], a[28:31], a[244:247], v[236:251]
  ds_read_b64_tr_b16 a[244:245], v0 offset:23552
  ds_read_b64_tr_b16 a[246:247], v0 offset:23808
  v_exp_f32 v195, v195
  v_cvt_pk_bf16_f32 v188, v188, v189
  s_waitcnt lgkmcnt(4)
  v_mfma_f32_32x32x16_bf16 v[172:187], v[84:87], v[12:15], v[172:187]
  buffer_store_dwordx4 v[252:255], v7, s[12:15], s34 offen offset:0 sc1
  v_cvt_pk_bf16_f32 v189, v190, v191
  v_mfma_f32_32x32x16_bf16 v[220:235], a[8:11], a[248:251], v[220:235]
  ds_read_b128 v[252:255], v6 offset:7168
  v_cvt_pk_bf16_f32 v190, v192, v193
  v_cvt_pk_bf16_f32 v191, v194, v195
  v_exp_f32 v196, v196
  v_mfma_f32_32x32x16_bf16 v[204:219], v[132:135], v[188:191], v[204:219]
  ds_read_b128 v[188:191], v3 offset:8064
  v_exp_f32 v197, v197
  v_exp_f32 v198, v198
  v_exp_f32 v199, v199
  v_mfma_f32_32x32x8_bf16 v[172:187], v[88:89], v[16:17], v[172:187]
  v_exp_f32 v200, v200
  v_exp_f32 v201, v201
  v_exp_f32 v202, v202
  v_exp_f32 v203, v203
  v_mfma_f32_32x32x16_bf16 v[236:251], a[32:35], a[248:251], v[236:251]
  ds_read_b64_tr_b16 a[248:249], v0 offset:0
  ds_read_b64_tr_b16 a[250:251], v0 offset:256
  v_cvt_pk_bf16_f32 v192, v196, v197
  v_cvt_pk_bf16_f32 v193, v198, v199
  v_cvt_pk_bf16_f32 v194, v200, v201
  v_cvt_pk_bf16_f32 v195, v202, v203
  v_mfma_f32_32x32x16_bf16 v[220:235], a[12:15], a[252:255], v[220:235]
  ds_read_b128 v[196:199], v3 offset:7808
  ds_read_b128 v[200:203], v3 offset:7680
  v_exp_f32 v172, v172
  v_exp_f32 v173, v173
  v_mfma_f32_32x32x16_bf16 v[204:219], v[136:139], v[192:195], v[204:219]
  ds_read_b128 v[192:195], v3 offset:7936
  v_exp_f32 v174, v174
  v_exp_f32 v175, v175
  v_cvt_pk_bf16_f32 v172, v172, v173
  v_mfma_f32_32x32x16_bf16 v[236:251], a[36:39], a[252:255], v[236:251]
  ds_read_b64_tr_b16 a[252:253], v0 offset:1024
  ds_read_b64_tr_b16 a[254:255], v0 offset:1280
  v_exp_f32 v176, v176
  v_cvt_pk_bf16_f32 v173, v174, v175
  s_waitcnt lgkmcnt(7)
  v_mfma_f32_32x32x16_bf16 v[220:235], a[16:19], a[240:243], v[220:235]
  v_rcp_f32 v213, v212
  v_exp_f32 v177, v177
  v_exp_f32 v178, v178
  v_mfma_f32_32x32x16_bf16 v[236:251], a[40:43], a[240:243], v[236:251]
  ds_read_b64_tr_b16 a[240:241], v0 offset:2048
  ds_read_b64_tr_b16 a[242:243], v0 offset:2304
  v_exp_f32 v179, v179
  v_mul_f32 v216, v216, v213
  v_mul_f32 v217, v217, v213
  v_mfma_f32_32x32x16_bf16 v[220:235], a[20:23], a[244:247], v[220:235]
  buffer_store_dwordx4 v[252:255], v8, s[12:15], s34 offen offset:1024 sc1
  s_waitcnt lgkmcnt(4)
  v_mfma_f32_32x32x16_bf16 v[188:203], v[90:93], v[12:15], v[188:203]
  ds_read_b128 v[252:255], v6 offset:8192
  v_mul_f32 v218, v218, v213
  v_mul_f32 v219, v219, v213
  v_mul_f32 v204, v204, v213
  v_mul_f32 v205, v205, v213
  v_mul_f32 v206, v206, v213
  v_mfma_f32_32x32x16_bf16 v[236:251], a[44:47], a[244:247], v[236:251]
  ds_read_b64_tr_b16 a[244:245], v0 offset:3072
  ds_read_b64_tr_b16 a[246:247], v0 offset:3328
  s_mov_b64 exec, s[66:67]
  v_cvt_pk_bf16_f32 v140, v220, v221
  v_cvt_pk_bf16_f32 v141, v222, v223
  v_cvt_pk_bf16_f32 v142, v224, v225
  v_cvt_pk_bf16_f32 v143, v226, v227
  v_cvt_pk_bf16_f32 v144, v228, v229
  v_cvt_pk_bf16_f32 v145, v230, v231
  v_cvt_pk_bf16_f32 v146, v232, v233
  v_cvt_pk_bf16_f32 v147, v234, v235
  s_mov_b64 exec, -1
  v_mfma_f32_32x32x8_bf16 v[188:203], v[94:95], v[16:17], v[188:203]
  s_mov_b64 exec, s[68:69]
  v_cvt_pk_bf16_f32 v156, v220, v221
  v_cvt_pk_bf16_f32 v157, v222, v223
  v_cvt_pk_bf16_f32 v158, v224, v225
  v_cvt_pk_bf16_f32 v159, v226, v227
  v_cvt_pk_bf16_f32 v160, v228, v229
  v_cvt_pk_bf16_f32 v161, v230, v231
  v_cvt_pk_bf16_f32 v162, v232, v233
  v_cvt_pk_bf16_f32 v163, v234, v235
  v_mfma_f32_32x32x16_bf16 v[220:235], a[248:251], a[0:3], 0
  s_mov_b64 exec, -1
  ds_read_b128 a[0:3], v4 offset:49152
  s_mov_b64 exec, s[66:67]
  v_cvt_pk_bf16_f32 v148, v236, v237
  v_cvt_pk_bf16_f32 v149, v238, v239
  s_waitcnt lgkmcnt(3)
  v_mfma_f32_32x32x16_bf16 v[220:235], a[252:255], a[4:7], v[220:235]
  v_cvt_pk_bf16_f32 v150, v240, v241
  v_cvt_pk_bf16_f32 v151, v242, v243
  v_cvt_pk_bf16_f32 v152, v244, v245
  v_cvt_pk_bf16_f32 v153, v246, v247
  v_cvt_pk_bf16_f32 v154, v248, v249
  v_cvt_pk_bf16_f32 v155, v250, v251
  v_mfma_f32_32x32x16_bf16 v[220:235], a[240:243], a[8:11], v[220:235]
  s_mov_b64 exec, -1
  ds_read_b128 a[4:7], v5 offset:49152
  ds_read_b128 a[8:11], v4 offset:49216
  s_mov_b64 exec, s[68:69]
  v_cvt_pk_bf16_f32 v164, v236, v237
  s_waitcnt lgkmcnt(3)
  v_mfma_f32_32x32x16_bf16 v[220:235], a[244:247], a[12:15], v[220:235]
  v_cvt_pk_bf16_f32 v165, v238, v239
  v_cvt_pk_bf16_f32 v166, v240, v241
  v_cvt_pk_bf16_f32 v167, v242, v243
  v_cvt_pk_bf16_f32 v168, v244, v245
  v_cvt_pk_bf16_f32 v169, v246, v247
  v_cvt_pk_bf16_f32 v170, v248, v249
  v_cvt_pk_bf16_f32 v171, v250, v251
  v_mfma_f32_32x32x16_bf16 v[236:251], a[248:251], a[24:27], 0
  s_mov_b64 exec, -1
  ds_read_b64_tr_b16 a[248:249], v0 offset:4096
  ds_read_b64_tr_b16 a[250:251], v0 offset:4352
  ds_read_b128 a[24:27], v4 offset:55296
  ds_read_b128 a[12:15], v5 offset:49216
  v_mul_f32 v207, v207, v213
  v_mfma_f32_32x32x16_bf16 v[236:251], a[252:255], a[28:31], v[236:251]
  ds_read_b64_tr_b16 a[252:253], v0 offset:5120
  ds_read_b64_tr_b16 a[254:255], v0 offset:5376
  v_mul_f32 v208, v208, v213
  v_mul_f32 v209, v209, v213
  v_mul_f32 v210, v210, v213
  v_mul_f32 v211, v211, v213
  v_mfma_f32_32x32x16_bf16 v[236:251], a[240:243], a[32:35], v[236:251]
  ds_read_b64_tr_b16 a[240:241], v0 offset:6144
  ds_read_b64_tr_b16 a[242:243], v0 offset:6400
  ds_read_b128 a[28:31], v5 offset:55296
  ds_read_b128 a[32:35], v4 offset:55360
  v_cvt_pk_bf16_f32 v174, v176, v177
  v_cvt_pk_bf16_f32 v175, v178, v179
  v_mfma_f32_32x32x16_bf16 v[236:251], a[244:247], a[36:39], v[236:251]
  ds_read_b64_tr_b16 a[244:245], v0 offset:7168
  ds_read_b64_tr_b16 a[246:247], v0 offset:7424
  buffer_store_dwordx4 v[252:255], v9, s[12:15], s34 offen offset:2048 sc1
  ds_read_b128 a[36:39], v5 offset:55360
  v_max3_f32 v10, v10, v212, v213
  v_cvt_pk_bf16_f32 v78, v216, v217
  v_cvt_pk_bf16_f32 v79, v218, v219
  s_waitcnt lgkmcnt(11)
  v_mfma_f32_32x32x16_bf16 v[220:235], a[248:251], a[16:19], v[220:235]
  ds_read_b128 a[16:19], v4 offset:49280
  ds_read_b128 v[252:255], v6 offset:9216
  v_cvt_pk_bf16_f32 v80, v204, v205
  v_cvt_pk_bf16_f32 v81, v206, v207
  v_cvt_pk_bf16_f32 v82, v208, v209
  v_cvt_pk_bf16_f32 v83, v210, v211
  v_mfma_f32_32x32x16_bf16 v[204:219], v[140:143], v[172:175], 0
  ds_read_b128 v[172:175], v3 offset:9088
  v_exp_f32 v180, v180
  v_exp_f32 v181, v181
  v_mfma_f32_32x32x16_bf16 v[236:251], a[248:251], a[40:43], v[236:251]
  ds_read_b64_tr_b16 a[248:249], v0 offset:8192
  ds_read_b64_tr_b16 a[250:251], v0 offset:8448
  ds_read_b128 a[40:43], v4 offset:55424
  v_exp_f32 v182, v182
  s_waitcnt lgkmcnt(7)
  v_mfma_f32_32x32x16_bf16 v[220:235], a[252:255], a[20:23], v[220:235]
  ds_read_b128 a[20:23], v5 offset:49280
  v_exp_f32 v183, v183
  v_exp_f32 v184, v184
  v_cvt_pk_bf16_f32 v176, v180, v181
  v_mfma_f32_32x32x16_bf16 v[236:251], a[252:255], a[44:47], v[236:251]
  ds_read_b64_tr_b16 a[252:253], v0 offset:9216
  ds_read_b64_tr_b16 a[254:255], v0 offset:9472
  ds_read_b128 a[44:47], v5 offset:55424
  v_exp_f32 v185, v185
  v_cvt_pk_bf16_f32 v22, v220, v221
  v_cvt_pk_bf16_f32 v23, v222, v223
  v_cvt_pk_bf16_f32 v96, v224, v225
  v_cvt_pk_bf16_f32 v97, v226, v227
  v_cvt_pk_bf16_f32 v98, v228, v229
  v_cvt_pk_bf16_f32 v99, v230, v231
  v_cvt_pk_bf16_f32 v100, v232, v233
  v_cvt_pk_bf16_f32 v101, v234, v235
  v_mfma_f32_32x32x16_bf16 v[220:235], a[0:3], a[240:243], 0
  v_cvt_pk_bf16_f32 v34, v236, v237
  v_cvt_pk_bf16_f32 v35, v238, v239
  v_cvt_pk_bf16_f32 v102, v240, v241
  v_cvt_pk_bf16_f32 v103, v242, v243
  v_cvt_pk_bf16_f32 v104, v244, v245
  v_cvt_pk_bf16_f32 v105, v246, v247
  v_mfma_f32_32x32x16_bf16 v[220:235], a[4:7], a[244:247], v[220:235]
  v_cvt_pk_bf16_f32 v106, v248, v249
  v_cvt_pk_bf16_f32 v107, v250, v251
  v_exp_f32 v186, v186
  v_exp_f32 v187, v187
  v_mfma_f32_32x32x16_bf16 v[236:251], a[24:27], a[240:243], 0
  ds_read_b64_tr_b16 a[240:241], v0 offset:10240
  ds_read_b64_tr_b16 a[242:243], v0 offset:10496
  v_cvt_pk_bf16_f32 v177, v182, v183
  v_cvt_pk_bf16_f32 v178, v184, v185
  v_cvt_pk_bf16_f32 v179, v186, v187
  v_mfma_f32_32x32x16_bf16 v[236:251], a[28:31], a[244:247], v[236:251]
  ds_read_b64_tr_b16 a[244:245], v0 offset:11264
  ds_read_b64_tr_b16 a[246:247], v0 offset:11520
  ds_read_b128 v[180:183], v3 offset:8832
  ds_read_b128 v[184:187], v3 offset:8704
  v_exp_f32 v188, v188
  v_mfma_f32_32x32x16_bf16 v[204:219], v[144:147], v[176:179], v[204:219]
  ds_read_b128 v[176:179], v3 offset:8960
  v_exp_f32 v189, v189
  v_exp_f32 v190, v190
  s_waitcnt lgkmcnt(7)
  v_mfma_f32_32x32x16_bf16 v[220:235], a[8:11], a[248:251], v[220:235]
  buffer_store_dwordx4 v[252:255], v7, s[12:15], s35 offen offset:0 sc1
  v_cvt_pk_bf16_f32 v188, v188, v189
  v_mfma_f32_32x32x16_bf16 v[220:235], a[12:15], a[252:255], v[220:235]
  ds_read_b128 v[252:255], v6 offset:10240
  v_exp_f32 v191, v191
  v_exp_f32 v192, v192
  v_cvt_pk_bf16_f32 v189, v190, v191
  v_mfma_f32_32x32x16_bf16 v[236:251], a[32:35], a[248:251], v[236:251]
  ds_read_b64_tr_b16 a[248:249], v0 offset:12288
  ds_read_b64_tr_b16 a[250:251], v0 offset:12544
  v_exp_f32 v193, v193
  s_waitcnt lgkmcnt(4)
  v_mfma_f32_32x32x16_bf16 v[220:235], a[16:19], a[240:243], v[220:235]
  v_exp_f32 v194, v194
  v_exp_f32 v195, v195
  v_cvt_pk_bf16_f32 v190, v192, v193
  s_waitcnt lgkmcnt(3)
  v_mfma_f32_32x32x16_bf16 v[172:187], v[84:87], v[24:27], v[172:187]
  v_cvt_pk_bf16_f32 v191, v194, v195
  v_exp_f32 v196, v196
  v_exp_f32 v197, v197
  v_mfma_f32_32x32x16_bf16 v[204:219], v[148:151], v[188:191], v[204:219]
  ds_read_b128 v[188:191], v2 offset:8576
  v_exp_f32 v198, v198
  v_exp_f32 v199, v199
  v_exp_f32 v200, v200
  v_mfma_f32_32x32x8_bf16 v[172:187], v[88:89], v[28:29], v[172:187]
  v_exp_f32 v201, v201
  v_exp_f32 v202, v202
  v_exp_f32 v203, v203
  v_cvt_pk_bf16_f32 v192, v196, v197
  v_cvt_pk_bf16_f32 v193, v198, v199
  v_mfma_f32_32x32x16_bf16 v[236:251], a[36:39], a[252:255], v[236:251]
  ds_read_b128 v[196:199], v2 offset:8320
  ds_read_b64_tr_b16 a[252:253], v0 offset:13312
  ds_read_b64_tr_b16 a[254:255], v0 offset:13568
  v_cvt_pk_bf16_f32 v194, v200, v201
  v_cvt_pk_bf16_f32 v195, v202, v203
  v_mfma_f32_32x32x16_bf16 v[220:235], a[20:23], a[244:247], v[220:235]
  ds_read_b128 v[200:203], v2 offset:8192
  v_exp_f32 v172, v172
  v_exp_f32 v173, v173
  v_mfma_f32_32x32x16_bf16 v[204:219], v[152:155], v[192:195], v[204:219]
  ds_read_b128 v[192:195], v2 offset:8448
  v_exp_f32 v174, v174
  v_exp_f32 v175, v175
  s_mov_b64 exec, s[48:49]
  v_mfma_f32_32x32x16_bf16 v[236:251], a[40:43], a[240:243], v[236:251]
  v_cvt_pk_bf16_f32 v108, v220, v221
  v_cvt_pk_bf16_f32 v109, v222, v223
  v_cvt_pk_bf16_f32 v110, v224, v225
  v_cvt_pk_bf16_f32 v111, v226, v227
  v_cvt_pk_bf16_f32 v112, v228, v229
  v_cvt_pk_bf16_f32 v113, v230, v231
  v_mfma_f32_32x32x16_bf16 v[236:251], a[44:47], a[244:247], v[236:251]
  v_cvt_pk_bf16_f32 v114, v232, v233
  v_cvt_pk_bf16_f32 v115, v234, v235
  s_mov_b64 exec, -1
  s_waitcnt lgkmcnt(2)
  buffer_store_dwordx4 v[252:255], v8, s[12:15], s35 offen offset:1024 sc1
  ds_read_b64_tr_b16 a[240:241], v0 offset:14336
  ds_read_b64_tr_b16 a[242:243], v0 offset:14592
  ds_read_b128 v[252:255], v6 offset:11264
  ds_read_b64_tr_b16 a[244:245], v0 offset:15360
  ds_read_b64_tr_b16 a[246:247], v0 offset:15616
  s_mov_b64 exec, s[60:61]
  v_cvt_pk_bf16_f32 v124, v220, v221
  v_cvt_pk_bf16_f32 v125, v222, v223
  s_waitcnt lgkmcnt(5)
  v_mfma_f32_32x32x16_bf16 v[188:203], v[90:93], v[24:27], v[188:203]
  v_cvt_pk_bf16_f32 v126, v224, v225
  v_cvt_pk_bf16_f32 v127, v226, v227
  v_cvt_pk_bf16_f32 v128, v228, v229
  v_cvt_pk_bf16_f32 v129, v230, v231
  v_cvt_pk_bf16_f32 v130, v232, v233
  v_cvt_pk_bf16_f32 v131, v234, v235
  v_mfma_f32_32x32x16_bf16 v[220:235], a[48:51], a[0:3], 0
  s_mov_b64 exec, -1
  s_mov_b64 exec, s[48:49]
  v_cvt_pk_bf16_f32 v116, v236, v237
  v_cvt_pk_bf16_f32 v117, v238, v239
  v_cvt_pk_bf16_f32 v118, v240, v241
  v_cvt_pk_bf16_f32 v119, v242, v243
  v_mfma_f32_32x32x16_bf16 v[220:235], a[52:55], a[4:7], v[220:235]
  v_cvt_pk_bf16_f32 v120, v244, v245
  v_cvt_pk_bf16_f32 v121, v246, v247
  v_cvt_pk_bf16_f32 v122, v248, v249
  v_cvt_pk_bf16_f32 v123, v250, v251
  s_mov_b64 exec, -1
  s_mov_b64 exec, s[60:61]
  v_mfma_f32_32x32x16_bf16 v[220:235], a[56:59], a[8:11], v[220:235]
  v_cvt_pk_bf16_f32 v132, v236, v237
  v_cvt_pk_bf16_f32 v133, v238, v239
  v_cvt_pk_bf16_f32 v134, v240, v241
  v_cvt_pk_bf16_f32 v135, v242, v243
  v_cvt_pk_bf16_f32 v136, v244, v245
  v_cvt_pk_bf16_f32 v137, v246, v247
  v_mfma_f32_32x32x16_bf16 v[220:235], a[60:63], a[12:15], v[220:235]
  v_cvt_pk_bf16_f32 v138, v248, v249
  v_cvt_pk_bf16_f32 v139, v250, v251
  s_mov_b64 exec, -1
  v_rcp_f32 v209, v208
  v_exp_f32 v176, v176
  v_mfma_f32_32x32x8_bf16 v[188:203], v[94:95], v[28:29], v[188:203]
  v_exp_f32 v177, v177
  v_exp_f32 v178, v178
  v_exp_f32 v179, v179
  v_cvt_pk_bf16_f32 v172, v172, v173
  v_cvt_pk_bf16_f32 v173, v174, v175
  v_mfma_f32_32x32x16_bf16 v[236:251], a[48:51], a[24:27], 0
  v_mul_f32 v212, v212, v209
  v_mul_f32 v213, v213, v209
  v_mul_f32 v214, v214, v209
  v_mul_f32 v215, v215, v209
  v_mul_f32 v216, v216, v209
  v_mul_f32 v217, v217, v209
  v_mfma_f32_32x32x16_bf16 v[236:251], a[52:55], a[28:31], v[236:251]
  s_waitcnt lgkmcnt(0)
  buffer_store_dwordx4 v[252:255], v9, s[12:15], s35 offen offset:2048 sc1
  v_mfma_f32_32x32x16_bf16 v[236:251], a[56:59], a[32:35], v[236:251]
  v_mul_f32 v218, v218, v209
  v_mul_f32 v219, v219, v209
  v_mul_f32 v204, v204, v209
  v_mul_f32 v205, v205, v209
  v_mul_f32 v206, v206, v209
  v_mul_f32 v207, v207, v209
  v_mfma_f32_32x32x16_bf16 v[220:235], a[64:67], a[16:19], v[220:235]
  v_cvt_pk_bf16_f32 v174, v176, v177
  v_cvt_pk_bf16_f32 v175, v178, v179
  v_max3_f32 v10, v10, v208, v209
  v_cvt_pk_bf16_f32 v12, v212, v213
  v_cvt_pk_bf16_f32 v13, v214, v215
  v_cvt_pk_bf16_f32 v14, v216, v217
  v_mfma_f32_32x32x16_bf16 v[236:251], a[60:63], a[36:39], v[236:251]
  v_cvt_pk_bf16_f32 v15, v218, v219
  v_cvt_pk_bf16_f32 v16, v204, v205
  v_cvt_pk_bf16_f32 v17, v206, v207
  v_exp_f32 v180, v180
  v_mfma_f32_32x32x16_bf16 v[204:219], v[140:143], v[172:175], 0
  ds_read_b128 v[172:175], v2 offset:12416
  v_exp_f32 v181, v181
  v_exp_f32 v182, v182
  v_cvt_pk_bf16_f32 v176, v180, v181
  v_mfma_f32_32x32x16_bf16 v[220:235], a[68:71], a[20:23], v[220:235]
  v_exp_f32 v183, v183
  v_exp_f32 v184, v184
  v_exp_f32 v185, v185
  v_mfma_f32_32x32x16_bf16 v[236:251], a[64:67], a[40:43], v[236:251]
  v_exp_f32 v186, v186
  v_exp_f32 v187, v187
  v_cvt_pk_bf16_f32 v177, v182, v183
  v_cvt_pk_bf16_f32 v178, v184, v185
  v_mfma_f32_32x32x16_bf16 v[236:251], a[68:71], a[44:47], v[236:251]
  ds_read_b128 v[180:183], v2 offset:12160
  v_cvt_pk_bf16_f32 v179, v186, v187
  v_exp_f32 v188, v188
  v_exp_f32 v189, v189
  v_mfma_f32_32x32x16_bf16 v[204:219], v[144:147], v[176:179], v[204:219]
  ds_read_b128 v[176:179], v2 offset:12288
  ds_read_b128 v[184:187], v2 offset:12032
  v_exp_f32 v190, v190
  v_exp_f32 v191, v191
  v_exp_f32 v192, v192
  v_exp_f32 v193, v193
  v_exp_f32 v194, v194
  v_exp_f32 v195, v195
  v_cvt_pk_bf16_f32 v188, v188, v189
  v_cvt_pk_bf16_f32 v189, v190, v191
  v_cvt_pk_bf16_f32 v190, v192, v193
  v_cvt_pk_bf16_f32 v191, v194, v195
  v_exp_f32 v196, v196
  v_mfma_f32_32x32x16_bf16 v[204:219], v[148:151], v[188:191], v[204:219]
  ds_read_b128 v[188:191], v3 offset:11904
  buffer_load_dwordx4 v7, s[8:11], s44 offen offset:0 nt lds
  v_exp_f32 v197, v197
  v_exp_f32 v198, v198
  v_exp_f32 v199, v199
  v_exp_f32 v200, v200
  v_exp_f32 v201, v201
  s_waitcnt lgkmcnt(1)
  v_mfma_f32_32x32x16_bf16 v[172:187], v[96:99], v[18:21], v[172:187]
  v_exp_f32 v202, v202
  v_exp_f32 v203, v203
  v_cvt_pk_bf16_f32 v192, v196, v197
  v_cvt_pk_bf16_f32 v193, v198, v199
  v_cvt_pk_bf16_f32 v194, v200, v201
  v_cvt_pk_bf16_f32 v195, v202, v203
  v_cvt_pk_bf16_f32 v36, v220, v221
  v_cvt_pk_bf16_f32 v37, v222, v223
  v_mfma_f32_32x32x16_bf16 v[204:219], v[152:155], v[192:195], v[204:219]
  ds_read_b128 v[192:195], v3 offset:11776
  ds_read_b128 v[196:199], v3 offset:11648
  ds_read_b128 v[200:203], v3 offset:11520
  v_cvt_pk_bf16_f32 v38, v224, v225
  v_cvt_pk_bf16_f32 v39, v226, v227
  v_cvt_pk_bf16_f32 v40, v228, v229
  v_cvt_pk_bf16_f32 v41, v230, v231
  v_mfma_f32_32x32x8_bf16 v[172:187], v[100:101], v[22:23], v[172:187]
  v_cvt_pk_bf16_f32 v84, v232, v233
  v_cvt_pk_bf16_f32 v85, v234, v235
  v_cvt_pk_bf16_f32 v48, v236, v237
  v_cvt_pk_bf16_f32 v49, v238, v239
  v_cvt_pk_bf16_f32 v50, v240, v241
  v_cvt_pk_bf16_f32 v51, v242, v243
  v_cvt_pk_bf16_f32 v52, v244, v245
  v_cvt_pk_bf16_f32 v53, v246, v247
  v_mfma_f32_32x32x16_bf16 v[220:235], a[72:75], a[0:3], 0
  v_cvt_pk_bf16_f32 v90, v248, v249
  v_cvt_pk_bf16_f32 v91, v250, v251
  v_rcp_f32 v209, v208
  v_exp_f32 v172, v172
  v_mfma_f32_32x32x16_bf16 v[220:235], a[76:79], a[4:7], v[220:235]
  v_exp_f32 v173, v173
  v_exp_f32 v174, v174
  v_exp_f32 v175, v175
  v_mfma_f32_32x32x16_bf16 v[236:251], a[72:75], a[24:27], 0
  v_exp_f32 v176, v176
  v_exp_f32 v177, v177
  v_cvt_pk_bf16_f32 v172, v172, v173
  s_waitcnt lgkmcnt(0)
  v_mfma_f32_32x32x16_bf16 v[188:203], v[102:105], v[18:21], v[188:203]
  v_exp_f32 v178, v178
  v_exp_f32 v179, v179
  v_cvt_pk_bf16_f32 v173, v174, v175
  v_mul_f32 v212, v212, v209
  v_mfma_f32_32x32x16_bf16 v[220:235], a[80:83], a[8:11], v[220:235]
  buffer_load_dwordx4 v8, s[8:11], s44 offen offset:1024 nt lds
  v_mul_f32 v213, v213, v209
  v_mul_f32 v214, v214, v209
  v_mul_f32 v215, v215, v209
  v_mul_f32 v216, v216, v209
  v_mul_f32 v217, v217, v209
  v_mfma_f32_32x32x8_bf16 v[188:203], v[106:107], v[22:23], v[188:203]
  v_mul_f32 v218, v218, v209
  v_mul_f32 v219, v219, v209
  v_mul_f32 v204, v204, v209
  v_mul_f32 v205, v205, v209
  v_mul_f32 v206, v206, v209
  v_mul_f32 v207, v207, v209
  v_cvt_pk_bf16_f32 v174, v176, v177
  v_cvt_pk_bf16_f32 v175, v178, v179
  v_mfma_f32_32x32x16_bf16 v[236:251], a[76:79], a[28:31], v[236:251]
  v_max3_f32 v10, v10, v208, v209
  v_cvt_pk_bf16_f32 v24, v212, v213
  v_cvt_pk_bf16_f32 v25, v214, v215
  v_cvt_pk_bf16_f32 v26, v216, v217
  v_cvt_pk_bf16_f32 v27, v218, v219
  v_cvt_pk_bf16_f32 v28, v204, v205
  v_mfma_f32_32x32x16_bf16 v[220:235], a[84:87], a[12:15], v[220:235]
  v_cvt_pk_bf16_f32 v29, v206, v207
  v_exp_f32 v180, v180
  v_exp_f32 v181, v181
  v_mfma_f32_32x32x16_bf16 v[204:219], v[156:159], v[172:175], 0
  ds_read_b128 v[172:175], v3 offset:12928
  v_exp_f32 v182, v182
  v_exp_f32 v183, v183
  v_cvt_pk_bf16_f32 v176, v180, v181
  v_mfma_f32_32x32x16_bf16 v[236:251], a[80:83], a[32:35], v[236:251]
  v_exp_f32 v184, v184
  v_exp_f32 v185, v185
  v_exp_f32 v186, v186
  v_mfma_f32_32x32x16_bf16 v[220:235], a[88:91], a[16:19], v[220:235]
  v_exp_f32 v187, v187
  v_cvt_pk_bf16_f32 v177, v182, v183
  v_cvt_pk_bf16_f32 v178, v184, v185
  v_cvt_pk_bf16_f32 v179, v186, v187
  v_mfma_f32_32x32x16_bf16 v[236:251], a[84:87], a[36:39], v[236:251]
  ds_read_b128 v[180:183], v3 offset:12672
  ds_read_b128 v[184:187], v3 offset:12544
  v_exp_f32 v188, v188
  v_exp_f32 v189, v189
  v_mfma_f32_32x32x16_bf16 v[204:219], v[160:163], v[176:179], v[204:219]
  ds_read_b128 v[176:179], v3 offset:12800
  v_exp_f32 v190, v190
  v_exp_f32 v191, v191
  v_cvt_pk_bf16_f32 v188, v188, v189
  v_mfma_f32_32x32x16_bf16 v[220:235], a[92:95], a[20:23], v[220:235]
  v_exp_f32 v192, v192
  v_exp_f32 v193, v193
  v_exp_f32 v194, v194
  v_mfma_f32_32x32x16_bf16 v[236:251], a[88:91], a[40:43], v[236:251]
  buffer_load_dwordx4 v9, s[8:11], s44 offen offset:2048 nt lds
  s_add_u32 m0, s50, 3072
  v_exp_f32 v195, v195
  v_cvt_pk_bf16_f32 v189, v190, v191
  v_mfma_f32_32x32x16_bf16 v[236:251], a[92:95], a[44:47], v[236:251]
  v_cvt_pk_bf16_f32 v86, v220, v221
  v_cvt_pk_bf16_f32 v87, v222, v223
  v_cvt_pk_bf16_f32 v88, v224, v225
  v_cvt_pk_bf16_f32 v89, v226, v227
  v_cvt_pk_bf16_f32 v42, v228, v229
  v_cvt_pk_bf16_f32 v43, v230, v231
  v_cvt_pk_bf16_f32 v44, v232, v233
  v_cvt_pk_bf16_f32 v45, v234, v235
  v_mfma_f32_32x32x16_bf16 v[220:235], a[168:171], v[60:63], 0
  v_cvt_pk_bf16_f32 v190, v192, v193
  v_cvt_pk_bf16_f32 v191, v194, v195
  v_exp_f32 v196, v196
  v_exp_f32 v197, v197
  v_mfma_f32_32x32x16_bf16 v[204:219], v[164:167], v[188:191], v[204:219]
  ds_read_b128 v[188:191], v2 offset:12416
  v_exp_f32 v198, v198
  v_exp_f32 v199, v199
  s_waitcnt lgkmcnt(1)
  v_mfma_f32_32x32x16_bf16 v[172:187], v[96:99], v[30:33], v[172:187]
  v_exp_f32 v200, v200
  v_exp_f32 v201, v201
  v_exp_f32 v202, v202
  v_mfma_f32_32x32x16_bf16 v[220:235], a[172:175], v[64:67], v[220:235]
  v_exp_f32 v203, v203
  v_cvt_pk_bf16_f32 v192, v196, v197
  v_cvt_pk_bf16_f32 v193, v198, v199
  v_cvt_pk_bf16_f32 v194, v200, v201
  v_cvt_pk_bf16_f32 v195, v202, v203
  v_cvt_pk_bf16_f32 v92, v236, v237
  v_mfma_f32_32x32x8_bf16 v[172:187], v[100:101], v[34:35], v[172:187]
  v_cvt_pk_bf16_f32 v93, v238, v239
  v_cvt_pk_bf16_f32 v94, v240, v241
  v_cvt_pk_bf16_f32 v95, v242, v243
  v_cvt_pk_bf16_f32 v54, v244, v245
  v_cvt_pk_bf16_f32 v55, v246, v247
  v_cvt_pk_bf16_f32 v56, v248, v249
  v_cvt_pk_bf16_f32 v57, v250, v251
  v_mfma_f32_32x32x16_bf16 v[204:219], v[168:171], v[192:195], v[204:219]
  ds_read_b128 v[192:195], v2 offset:12288
  ds_read_b128 v[196:199], v2 offset:12160
  ds_read_b128 v[200:203], v2 offset:12032
  v_exp_f32 v172, v172
  v_mfma_f32_32x32x16_bf16 v[236:251], a[192:195], v[60:63], 0
  v_exp_f32 v173, v173
  v_exp_f32 v174, v174
  v_exp_f32 v175, v175
  v_mfma_f32_32x32x16_bf16 v[220:235], a[176:179], v[68:71], v[220:235]
  buffer_load_dwordx4 v7, s[8:11], s45 offen offset:0 nt lds
  v_rcp_f32 v205, v204
  v_exp_f32 v176, v176
  v_mfma_f32_32x32x16_bf16 v[236:251], a[196:199], v[64:67], v[236:251]
  v_mul_f32 v208, v208, v205
  v_mul_f32 v209, v209, v205
  v_mul_f32 v210, v210, v205
  v_mul_f32 v211, v211, v205
  v_cvt_pk_bf16_f32 v18, v208, v209
  v_cvt_pk_bf16_f32 v19, v210, v211
  v_mfma_f32_32x32x16_bf16 v[220:235], a[180:183], v[12:15], v[220:235]
  v_mul_f32 v212, v212, v205
  v_mul_f32 v213, v213, v205
  v_mul_f32 v214, v214, v205
  v_mul_f32 v215, v215, v205
  v_mul_f32 v216, v216, v205
  s_waitcnt lgkmcnt(0)
  v_mfma_f32_32x32x16_bf16 v[188:203], v[102:105], v[30:33], v[188:203]
  v_mul_f32 v217, v217, v205
  v_mul_f32 v218, v218, v205
  v_mul_f32 v219, v219, v205
  v_cvt_pk_bf16_f32 v20, v212, v213
  v_cvt_pk_bf16_f32 v21, v214, v215
  v_cvt_pk_bf16_f32 v22, v216, v217
  v_mfma_f32_32x32x16_bf16 v[236:251], a[200:203], v[68:71], v[236:251]
  v_cvt_pk_bf16_f32 v23, v218, v219
  v_exp_f32 v177, v177
  v_exp_f32 v178, v178
  v_exp_f32 v179, v179
  v_mfma_f32_32x32x8_bf16 v[188:203], v[106:107], v[34:35], v[188:203]
  v_cvt_pk_bf16_f32 v172, v172, v173
  v_cvt_pk_bf16_f32 v173, v174, v175
  v_cvt_pk_bf16_f32 v174, v176, v177
  v_cvt_pk_bf16_f32 v175, v178, v179
  v_max3_f32 v10, v10, v204, v205
  v_exp_f32 v180, v180
  v_mfma_f32_32x32x16_bf16 v[204:219], v[156:159], v[172:175], 0
  ds_read_b128 v[172:175], v2 offset:896
  v_exp_f32 v181, v181
  v_exp_f32 v182, v182
  v_cvt_pk_bf16_f32 v176, v180, v181
  v_mfma_f32_32x32x16_bf16 v[220:235], a[184:187], v[16:19], v[220:235]
  v_exp_f32 v183, v183
  v_exp_f32 v184, v184
  v_exp_f32 v185, v185
  v_mfma_f32_32x32x16_bf16 v[236:251], a[204:207], v[12:15], v[236:251]
  v_exp_f32 v186, v186
  v_exp_f32 v187, v187
  v_cvt_pk_bf16_f32 v177, v182, v183
  v_cvt_pk_bf16_f32 v178, v184, v185
  v_mfma_f32_32x32x16_bf16 v[220:235], a[188:191], v[20:23], v[220:235]
  ds_read_b128 v[180:183], v2 offset:640
  buffer_load_dwordx4 v8, s[8:11], s45 offen offset:1024 nt lds
  v_cvt_pk_bf16_f32 v179, v186, v187
  v_exp_f32 v188, v188
  v_mfma_f32_32x32x16_bf16 v[204:219], v[160:163], v[176:179], v[204:219]
  ds_read_b128 v[176:179], v2 offset:768
  ds_read_b128 v[184:187], v2 offset:512
  v_exp_f32 v189, v189
  v_exp_f32 v190, v190
  v_mfma_f32_32x32x16_bf16 v[236:251], a[208:211], v[16:19], v[236:251]
  v_cvt_pk_bf16_f32 v220, v220, v221
  v_cvt_pk_bf16_f32 v221, v222, v223
  v_cvt_pk_bf16_f32 v222, v224, v225
  v_cvt_pk_bf16_f32 v223, v226, v227
  v_cvt_pk_bf16_f32 v224, v228, v229
  v_cvt_pk_bf16_f32 v225, v230, v231
  v_mfma_f32_32x32x16_bf16 v[236:251], a[212:215], v[20:23], v[236:251]
  ds_write_b128 v4, v[220:223] offset:0
  v_cvt_pk_bf16_f32 v226, v232, v233
  v_cvt_pk_bf16_f32 v227, v234, v235
  v_exp_f32 v191, v191
  v_exp_f32 v192, v192
  v_exp_f32 v193, v193
  v_exp_f32 v194, v194
  v_exp_f32 v195, v195
  v_cvt_pk_bf16_f32 v236, v236, v237
  s_waitcnt lgkmcnt(1)
  v_mfma_f32_32x32x16_bf16 v[172:187], v[84:87], v[36:39], v[172:187]
  ds_write_b128 v5, v[224:227] offset:0
  v_cvt_pk_bf16_f32 v237, v238, v239
  v_mfma_f32_32x32x16_bf16 v[220:235], a[216:219], v[60:63], 0
  v_cvt_pk_bf16_f32 v238, v240, v241
  v_cvt_pk_bf16_f32 v239, v242, v243
  v_cvt_pk_bf16_f32 v240, v244, v245
  v_cvt_pk_bf16_f32 v241, v246, v247
  v_cvt_pk_bf16_f32 v242, v248, v249
  v_cvt_pk_bf16_f32 v243, v250, v251
  v_cvt_pk_bf16_f32 v188, v188, v189
  v_mfma_f32_32x32x8_bf16 v[172:187], v[88:89], v[40:41], v[172:187]
  v_cvt_pk_bf16_f32 v189, v190, v191
  v_cvt_pk_bf16_f32 v190, v192, v193
  v_cvt_pk_bf16_f32 v191, v194, v195
  v_exp_f32 v196, v196
  v_exp_f32 v197, v197
  v_mfma_f32_32x32x16_bf16 v[204:219], v[164:167], v[188:191], v[204:219]
  ds_write_b128 v4, v[236:239] offset:64
  v_cvt_pk_bf16_f32 v192, v196, v197
  v_mfma_f32_32x32x16_bf16 v[220:235], a[220:223], v[64:67], v[220:235]
  ds_write_b128 v5, v[240:243] offset:64
  buffer_load_dwordx4 v9, s[8:11], s45 offen offset:2048 nt lds
  v_mfma_f32_32x32x16_bf16 v[236:251], a[168:171], v[72:75], 0
  s_add_u32 m0, s50, 6144
  v_exp_f32 v198, v198
  v_exp_f32 v199, v199
  v_mfma_f32_32x32x16_bf16 v[220:235], a[224:227], v[68:71], v[220:235]
  ds_read_b128 v[188:191], v3 offset:384
  v_exp_f32 v200, v200
  v_exp_f32 v201, v201
  v_cvt_pk_bf16_f32 v193, v198, v199
  v_mfma_f32_32x32x16_bf16 v[236:251], a[172:175], v[76:79], v[236:251]
  ds_read_b128 v[196:199], v3 offset:128
  v_exp_f32 v202, v202
  v_exp_f32 v203, v203
  v_cvt_pk_bf16_f32 v194, v200, v201
  v_mfma_f32_32x32x16_bf16 v[220:235], a[228:231], v[12:15], v[220:235]
  v_cvt_pk_bf16_f32 v195, v202, v203
  v_exp_f32 v172, v172
  v_exp_f32 v173, v173
  v_mfma_f32_32x32x16_bf16 v[204:219], v[168:171], v[192:195], v[204:219]
  ds_read_b128 v[192:195], v3 offset:256
  ds_read_b128 v[200:203], v3 offset:0
  v_exp_f32 v174, v174
  v_exp_f32 v175, v175
  v_mfma_f32_32x32x16_bf16 v[236:251], a[176:179], v[80:83], v[236:251]
  v_exp_f32 v176, v176
  v_exp_f32 v177, v177
  v_rcp_f32 v205, v204
  v_mfma_f32_32x32x16_bf16 v[220:235], a[232:235], v[16:19], v[220:235]
  v_mul_f32 v208, v208, v205
  v_mul_f32 v209, v209, v205
  v_mul_f32 v210, v210, v205
  v_mul_f32 v211, v211, v205
  v_cvt_pk_bf16_f32 v30, v208, v209
  v_cvt_pk_bf16_f32 v31, v210, v211
  v_mfma_f32_32x32x16_bf16 v[236:251], a[180:183], v[24:27], v[236:251]
  v_mul_f32 v212, v212, v205
  v_mul_f32 v213, v213, v205
  v_mul_f32 v214, v214, v205
  v_mul_f32 v215, v215, v205
  v_mul_f32 v216, v216, v205
  v_mul_f32 v217, v217, v205
  v_mfma_f32_32x32x16_bf16 v[220:235], a[236:239], v[20:23], v[220:235]
  v_mul_f32 v218, v218, v205
  v_mul_f32 v219, v219, v205
  v_cvt_pk_bf16_f32 v32, v212, v213
  v_cvt_pk_bf16_f32 v33, v214, v215
  v_cvt_pk_bf16_f32 v34, v216, v217
  s_waitcnt lgkmcnt(0)
  v_mfma_f32_32x32x16_bf16 v[188:203], v[90:93], v[36:39], v[188:203]
  buffer_load_dwordx4 v7, s[8:11], s46 offen offset:0 nt lds
  v_cvt_pk_bf16_f32 v35, v218, v219
  v_exp_f32 v178, v178
  v_cvt_pk_bf16_f32 v220, v220, v221
  v_mfma_f32_32x32x16_bf16 v[236:251], a[184:187], v[28:31], v[236:251]
  v_cvt_pk_bf16_f32 v221, v222, v223
  v_cvt_pk_bf16_f32 v222, v224, v225
  v_cvt_pk_bf16_f32 v223, v226, v227
  v_cvt_pk_bf16_f32 v224, v228, v229
  v_cvt_pk_bf16_f32 v225, v230, v231
  v_cvt_pk_bf16_f32 v226, v232, v233
  v_cvt_pk_bf16_f32 v227, v234, v235
  v_mfma_f32_32x32x8_bf16 v[188:203], v[94:95], v[40:41], v[188:203]
  v_exp_f32 v179, v179
  v_cvt_pk_bf16_f32 v172, v172, v173
  v_cvt_pk_bf16_f32 v173, v174, v175
  v_cvt_pk_bf16_f32 v174, v176, v177
  v_cvt_pk_bf16_f32 v175, v178, v179
  v_max3_f32 v10, v10, v204, v205
  v_mfma_f32_32x32x16_bf16 v[236:251], a[188:191], v[32:35], v[236:251]
  ds_write_b128 v4, v[220:223] offset:128
  v_exp_f32 v180, v180
  v_mfma_f32_32x32x16_bf16 v[204:219], v[108:111], v[172:175], 0
  ds_write_b128 v5, v[224:227] offset:128
  v_exp_f32 v181, v181
  v_mfma_f32_32x32x16_bf16 v[220:235], a[192:195], v[72:75], 0
  v_exp_f32 v182, v182
  v_cvt_pk_bf16_f32 v236, v236, v237
  v_cvt_pk_bf16_f32 v237, v238, v239
  v_cvt_pk_bf16_f32 v238, v240, v241
  v_cvt_pk_bf16_f32 v239, v242, v243
  v_mfma_f32_32x32x16_bf16 v[220:235], a[196:199], v[76:79], v[220:235]
  ds_write_b128 v4, v[236:239] offset:6144
  v_cvt_pk_bf16_f32 v240, v244, v245
  v_mfma_f32_32x32x16_bf16 v[220:235], a[200:203], v[80:83], v[220:235]
  ds_read_b128 v[172:175], v3 offset:1408
  v_cvt_pk_bf16_f32 v241, v246, v247
  v_cvt_pk_bf16_f32 v242, v248, v249
  v_cvt_pk_bf16_f32 v243, v250, v251
  v_exp_f32 v183, v183
  v_mfma_f32_32x32x16_bf16 v[220:235], a[204:207], v[24:27], v[220:235]
  ds_write_b128 v5, v[240:243] offset:6144
  v_cvt_pk_bf16_f32 v176, v180, v181
  v_mfma_f32_32x32x16_bf16 v[236:251], a[216:219], v[72:75], 0
  buffer_load_dwordx4 v8, s[8:11], s46 offen offset:1024 nt lds
  ds_read_b128 v[252:255], v6 offset:0
  v_exp_f32 v184, v184
  v_cvt_pk_bf16_f32 v177, v182, v183
  v_mfma_f32_32x32x16_bf16 v[236:251], a[220:223], v[76:79], v[236:251]
  ds_read_b128 v[180:183], v3 offset:1152
  v_exp_f32 v185, v185
  v_exp_f32 v186, v186
  v_cvt_pk_bf16_f32 v178, v184, v185
  v_mfma_f32_32x32x16_bf16 v[236:251], a[224:227], v[80:83], v[236:251]
  v_exp_f32 v187, v187
  v_exp_f32 v188, v188
  v_cvt_pk_bf16_f32 v179, v186, v187
  v_mfma_f32_32x32x16_bf16 v[220:235], a[208:211], v[28:31], v[220:235]
  ds_read_b128 v[184:187], v3 offset:1024
  v_exp_f32 v189, v189
  v_exp_f32 v190, v190
  v_cvt_pk_bf16_f32 v188, v188, v189
  v_mfma_f32_32x32x16_bf16 v[204:219], v[112:115], v[176:179], v[204:219]
  ds_read_b128 v[176:179], v3 offset:1280
  v_exp_f32 v191, v191
  v_exp_f32 v192, v192
  v_cvt_pk_bf16_f32 v189, v190, v191
  v_mfma_f32_32x32x16_bf16 v[236:251], a[228:231], v[24:27], v[236:251]
  v_exp_f32 v193, v193
  v_exp_f32 v194, v194
  v_exp_f32 v195, v195
  v_mfma_f32_32x32x16_bf16 v[220:235], a[212:215], v[32:35], v[220:235]
  v_cvt_pk_bf16_f32 v190, v192, v193
  v_cvt_pk_bf16_f32 v191, v194, v195
  v_exp_f32 v196, v196
  v_exp_f32 v197, v197
  v_mfma_f32_32x32x16_bf16 v[204:219], v[116:119], v[188:191], v[204:219]
  ds_read_b128 v[188:191], v2 offset:896
  v_exp_f32 v198, v198
  v_exp_f32 v199, v199
  v_cvt_pk_bf16_f32 v220, v220, v221
  v_mfma_f32_32x32x16_bf16 v[236:251], a[232:235], v[28:31], v[236:251]
  v_cvt_pk_bf16_f32 v221, v222, v223
  v_cvt_pk_bf16_f32 v222, v224, v225
  v_cvt_pk_bf16_f32 v223, v226, v227
  v_cvt_pk_bf16_f32 v224, v228, v229
  v_cvt_pk_bf16_f32 v225, v230, v231
  s_waitcnt lgkmcnt(1)
  v_mfma_f32_32x32x16_bf16 v[172:187], v[84:87], v[48:51], v[172:187]
  ds_write_b128 v4, v[220:223] offset:6208
  v_cvt_pk_bf16_f32 v226, v232, v233
  v_mfma_f32_32x32x16_bf16 v[236:251], a[236:239], v[32:35], v[236:251]
  buffer_load_dwordx4 v9, s[8:11], s46 offen offset:2048 nt lds
  s_add_u32 m0, s50, 9216
  v_cvt_pk_bf16_f32 v227, v234, v235
  v_exp_f32 v200, v200
  v_exp_f32 v201, v201
  v_mfma_f32_32x32x8_bf16 v[172:187], v[88:89], v[52:53], v[172:187]
  v_exp_f32 v202, v202
  v_exp_f32 v203, v203
  v_cvt_pk_bf16_f32 v236, v236, v237
  v_cvt_pk_bf16_f32 v237, v238, v239
  v_cvt_pk_bf16_f32 v238, v240, v241
  v_cvt_pk_bf16_f32 v239, v242, v243
  v_cvt_pk_bf16_f32 v240, v244, v245
  v_cvt_pk_bf16_f32 v241, v246, v247
  v_cvt_pk_bf16_f32 v242, v248, v249
  v_cvt_pk_bf16_f32 v243, v250, v251
  v_cvt_pk_bf16_f32 v192, v196, v197
  v_cvt_pk_bf16_f32 v193, v198, v199
  v_cvt_pk_bf16_f32 v194, v200, v201
  v_cvt_pk_bf16_f32 v195, v202, v203
  v_exp_f32 v172, v172
  v_mfma_f32_32x32x16_bf16 v[204:219], v[120:123], v[192:195], v[204:219]
  ds_write_b128 v5, v[224:227] offset:6208
  v_exp_f32 v173, v173
  v_mfma_f32_32x32x16_bf16 v[220:235], a[96:99], a[0:3], 0
  ds_write_b128 v4, v[236:239] offset:6272
  v_cvt_pk_bf16_f32 v172, v172, v173
  v_mfma_f32_32x32x16_bf16 v[220:235], a[100:103], a[4:7], v[220:235]
  v_exp_f32 v174, v174
  v_exp_f32 v175, v175
  v_rcp_f32 v217, v216
  v_mfma_f32_32x32x16_bf16 v[220:235], a[104:107], a[8:11], v[220:235]
  ds_write_b128 v5, v[240:243] offset:6272
  v_cvt_pk_bf16_f32 v173, v174, v175
  v_mfma_f32_32x32x16_bf16 v[236:251], a[96:99], a[24:27], 0
  v_exp_f32 v176, v176
  v_exp_f32 v177, v177
  v_exp_f32 v178, v178
  v_mfma_f32_32x32x16_bf16 v[236:251], a[100:103], a[28:31], v[236:251]
  ds_read_b128 v[192:195], v2 offset:768
  ds_read_b128 v[196:199], v2 offset:640
  ds_read_b128 v[200:203], v2 offset:512
  v_exp_f32 v179, v179
  v_mul_f32 v204, v204, v217
  v_mfma_f32_32x32x16_bf16 v[236:251], a[104:107], a[32:35], v[236:251]
  buffer_load_dwordx4 v7, s[8:11], s47 offen offset:0 nt lds
  v_mul_f32 v205, v205, v217
  v_mul_f32 v206, v206, v217
  v_mul_f32 v207, v207, v217
  v_mul_f32 v208, v208, v217
  v_mfma_f32_32x32x16_bf16 v[220:235], a[108:111], a[12:15], v[220:235]
  v_mul_f32 v209, v209, v217
  v_mul_f32 v210, v210, v217
  v_mul_f32 v211, v211, v217
  v_mul_f32 v212, v212, v217
  v_mul_f32 v213, v213, v217
  v_mul_f32 v214, v214, v217
  v_mfma_f32_32x32x16_bf16 v[236:251], a[108:111], a[36:39], v[236:251]
  v_mul_f32 v215, v215, v217
  v_cvt_pk_bf16_f32 v174, v176, v177
  v_cvt_pk_bf16_f32 v175, v178, v179
  v_max3_f32 v10, v10, v216, v217
  v_cvt_pk_bf16_f32 v36, v204, v205
  v_cvt_pk_bf16_f32 v37, v206, v207
  v_mfma_f32_32x32x16_bf16 v[220:235], a[112:115], a[16:19], v[220:235]
  v_cvt_pk_bf16_f32 v38, v208, v209
  v_cvt_pk_bf16_f32 v39, v210, v211
  v_cvt_pk_bf16_f32 v40, v212, v213
  v_cvt_pk_bf16_f32 v41, v214, v215
  s_waitcnt lgkmcnt(0)
  v_mfma_f32_32x32x16_bf16 v[188:203], v[90:93], v[48:51], v[188:203]
  v_exp_f32 v180, v180
  v_exp_f32 v181, v181
  v_exp_f32 v182, v182
  v_mfma_f32_32x32x16_bf16 v[204:219], v[108:111], v[172:175], 0
  ds_read_b128 v[172:175], v2 offset:4736
  v_exp_f32 v183, v183
  v_exp_f32 v184, v184
  v_exp_f32 v185, v185
  v_mfma_f32_32x32x8_bf16 v[188:203], v[94:95], v[52:53], v[188:203]
  v_exp_f32 v186, v186
  v_exp_f32 v187, v187
  v_cvt_pk_bf16_f32 v176, v180, v181
  v_cvt_pk_bf16_f32 v177, v182, v183
  v_cvt_pk_bf16_f32 v178, v184, v185
  v_cvt_pk_bf16_f32 v179, v186, v187
  v_mfma_f32_32x32x16_bf16 v[236:251], a[112:115], a[40:43], v[236:251]
  ds_read_b128 v[180:183], v2 offset:4480
  ds_read_b128 v[184:187], v2 offset:4352
  v_mfma_f32_32x32x16_bf16 v[204:219], v[112:115], v[176:179], v[204:219]
  ds_read_b128 v[176:179], v2 offset:4608
  v_exp_f32 v188, v188
  v_exp_f32 v189, v189
  v_mfma_f32_32x32x16_bf16 v[220:235], a[116:119], a[20:23], v[220:235]
  v_exp_f32 v190, v190
  v_exp_f32 v191, v191
  v_exp_f32 v192, v192
  v_mfma_f32_32x32x16_bf16 v[236:251], a[116:119], a[44:47], v[236:251]
  buffer_load_dwordx4 v8, s[8:11], s47 offen offset:1024 nt lds
  v_exp_f32 v193, v193
  v_exp_f32 v194, v194
  v_cvt_pk_bf16_f32 v46, v220, v221
  v_cvt_pk_bf16_f32 v47, v222, v223
  v_cvt_pk_bf16_f32 v96, v224, v225
  v_cvt_pk_bf16_f32 v97, v226, v227
  v_cvt_pk_bf16_f32 v98, v228, v229
  v_cvt_pk_bf16_f32 v99, v230, v231
  v_cvt_pk_bf16_f32 v100, v232, v233
  v_cvt_pk_bf16_f32 v101, v234, v235
  v_mfma_f32_32x32x16_bf16 v[220:235], a[0:3], a[248:251], 0
  v_cvt_pk_bf16_f32 v58, v236, v237
  v_cvt_pk_bf16_f32 v59, v238, v239
  v_cvt_pk_bf16_f32 v102, v240, v241
  v_cvt_pk_bf16_f32 v103, v242, v243
  v_cvt_pk_bf16_f32 v104, v244, v245
  s_waitcnt lgkmcnt(0)
  v_mfma_f32_32x32x16_bf16 v[172:187], v[96:99], v[42:45], v[172:187]
  v_cvt_pk_bf16_f32 v105, v246, v247
  v_cvt_pk_bf16_f32 v106, v248, v249
  v_cvt_pk_bf16_f32 v107, v250, v251
  v_exp_f32 v195, v195
  v_cvt_pk_bf16_f32 v188, v188, v189
  v_mfma_f32_32x32x16_bf16 v[236:251], a[24:27], a[248:251], 0
  ds_read_b64_tr_b16 a[248:249], v0 offset:16384
  ds_read_b64_tr_b16 a[250:251], v0 offset:16640
  v_cvt_pk_bf16_f32 v189, v190, v191
  v_cvt_pk_bf16_f32 v190, v192, v193
  v_cvt_pk_bf16_f32 v191, v194, v195
  v_exp_f32 v196, v196
  v_mfma_f32_32x32x16_bf16 v[204:219], v[116:119], v[188:191], v[204:219]
  ds_read_b128 v[188:191], v3 offset:4224
  v_exp_f32 v197, v197
  v_exp_f32 v198, v198
  v_exp_f32 v199, v199
  v_mfma_f32_32x32x8_bf16 v[172:187], v[100:101], v[46:47], v[172:187]
  v_exp_f32 v200, v200
  v_exp_f32 v201, v201
  v_exp_f32 v202, v202
  v_exp_f32 v203, v203
  v_mfma_f32_32x32x16_bf16 v[220:235], a[4:7], a[252:255], v[220:235]
  v_cvt_pk_bf16_f32 v192, v196, v197
  v_cvt_pk_bf16_f32 v193, v198, v199
  v_cvt_pk_bf16_f32 v194, v200, v201
  v_cvt_pk_bf16_f32 v195, v202, v203
  v_exp_f32 v172, v172
  v_mfma_f32_32x32x16_bf16 v[204:219], v[120:123], v[192:195], v[204:219]
  ds_read_b128 v[192:195], v3 offset:4096
  ds_read_b128 v[196:199], v3 offset:3968
  ds_read_b128 v[200:203], v3 offset:3840
  v_exp_f32 v173, v173
  v_mfma_f32_32x32x16_bf16 v[236:251], a[28:31], a[252:255], v[236:251]
  buffer_load_dwordx4 v9, s[8:11], s47 offen offset:2048 nt lds
  ds_read_b64_tr_b16 a[252:253], v0 offset:17408
  ds_read_b64_tr_b16 a[254:255], v0 offset:17664
  s_mov_b32 m0, 159744
  v_cvt_pk_bf16_f32 v172, v172, v173
  v_mfma_f32_32x32x16_bf16 v[220:235], a[8:11], a[240:243], v[220:235]
  v_exp_f32 v174, v174
  v_exp_f32 v175, v175
  v_rcp_f32 v217, v216
  v_mfma_f32_32x32x16_bf16 v[236:251], a[32:35], a[240:243], v[236:251]
  ds_read_b64_tr_b16 a[240:241], v0 offset:18432
  ds_read_b64_tr_b16 a[242:243], v0 offset:18688
  v_exp_f32 v176, v176
  v_exp_f32 v177, v177
  v_mfma_f32_32x32x16_bf16 v[220:235], a[12:15], a[244:247], v[220:235]
  v_exp_f32 v178, v178
  v_exp_f32 v179, v179
  v_cvt_pk_bf16_f32 v173, v174, v175
  s_waitcnt lgkmcnt(4)
  v_mfma_f32_32x32x16_bf16 v[188:203], v[102:105], v[42:45], v[188:203]
  v_mul_f32 v204, v204, v217
  v_mul_f32 v205, v205, v217
  v_mul_f32 v206, v206, v217
  v_mul_f32 v207, v207, v217
  v_mul_f32 v208, v208, v217
  v_mul_f32 v209, v209, v217
  v_mfma_f32_32x32x16_bf16 v[236:251], a[36:39], a[244:247], v[236:251]
  ds_read_b64_tr_b16 a[244:245], v0 offset:19456
  ds_read_b64_tr_b16 a[246:247], v0 offset:19712
  v_mul_f32 v210, v210, v217
  v_mul_f32 v211, v211, v217
  v_mul_f32 v212, v212, v217
  v_mul_f32 v213, v213, v217
  v_mul_f32 v214, v214, v217
  v_mfma_f32_32x32x8_bf16 v[188:203], v[106:107], v[46:47], v[188:203]
  v_mul_f32 v215, v215, v217
  v_cvt_pk_bf16_f32 v174, v176, v177
  v_cvt_pk_bf16_f32 v175, v178, v179
  v_max3_f32 v10, v10, v216, v217
  v_cvt_pk_bf16_f32 v48, v204, v205
  v_cvt_pk_bf16_f32 v49, v206, v207
  v_cvt_pk_bf16_f32 v50, v208, v209
  v_cvt_pk_bf16_f32 v51, v210, v211
  v_mfma_f32_32x32x16_bf16 v[220:235], a[16:19], a[248:251], v[220:235]
  v_cvt_pk_bf16_f32 v52, v212, v213
  v_cvt_pk_bf16_f32 v53, v214, v215
  v_exp_f32 v180, v180
  v_exp_f32 v181, v181
  v_mfma_f32_32x32x16_bf16 v[236:251], a[40:43], a[248:251], v[236:251]
  ds_read_b64_tr_b16 a[248:249], v0 offset:20480
  ds_read_b64_tr_b16 a[250:251], v0 offset:20736
  buffer_load_dword v1, s[56:59], s73 offen lds
  v_cvt_pk_bf16_f32 v176, v180, v181
  s_waitcnt lgkmcnt(4)
  v_mfma_f32_32x32x16_bf16 v[220:235], a[20:23], a[252:255], v[220:235]
  v_exp_f32 v182, v182
  v_exp_f32 v183, v183
  v_exp_f32 v184, v184
  v_mfma_f32_32x32x16_bf16 v[236:251], a[44:47], a[252:255], v[236:251]
  ds_read_b64_tr_b16 a[252:253], v0 offset:21504
  ds_read_b64_tr_b16 a[254:255], v0 offset:21760
  v_exp_f32 v185, v185
  s_mov_b64 exec, s[62:63]
  v_cvt_pk_bf16_f32 v124, v220, v221
  v_cvt_pk_bf16_f32 v125, v222, v223
  v_cvt_pk_bf16_f32 v126, v224, v225
  v_cvt_pk_bf16_f32 v127, v226, v227
  v_cvt_pk_bf16_f32 v128, v228, v229
  v_cvt_pk_bf16_f32 v129, v230, v231
  v_mfma_f32_32x32x16_bf16 v[204:219], v[124:127], v[172:175], 0
  v_cvt_pk_bf16_f32 v130, v232, v233
  v_cvt_pk_bf16_f32 v131, v234, v235
  s_mov_b64 exec, -1
  s_mov_b64 exec, s[64:65]
  v_cvt_pk_bf16_f32 v140, v220, v221
  v_cvt_pk_bf16_f32 v141, v222, v223
  v_cvt_pk_bf16_f32 v142, v224, v225
  v_cvt_pk_bf16_f32 v143, v226, v227
  v_cvt_pk_bf16_f32 v144, v228, v229
  v_cvt_pk_bf16_f32 v145, v230, v231
  v_cvt_pk_bf16_f32 v146, v232, v233
  v_cvt_pk_bf16_f32 v147, v234, v235
  v_mfma_f32_32x32x16_bf16 v[220:235], a[120:123], a[0:3], 0
  s_mov_b64 exec, -1
  ds_read_b128 v[172:175], v3 offset:5248
  s_mov_b64 exec, s[62:63]
  v_cvt_pk_bf16_f32 v132, v236, v237
  v_cvt_pk_bf16_f32 v133, v238, v239
  v_cvt_pk_bf16_f32 v134, v240, v241
  v_mfma_f32_32x32x16_bf16 v[220:235], a[124:127], a[4:7], v[220:235]
  v_cvt_pk_bf16_f32 v135, v242, v243
  v_cvt_pk_bf16_f32 v136, v244, v245
  v_cvt_pk_bf16_f32 v137, v246, v247
  v_cvt_pk_bf16_f32 v138, v248, v249
  v_cvt_pk_bf16_f32 v139, v250, v251
  s_mov_b64 exec, -1
  v_mfma_f32_32x32x16_bf16 v[220:235], a[128:131], a[8:11], v[220:235]
  s_mov_b64 exec, s[64:65]
  v_cvt_pk_bf16_f32 v148, v236, v237
  v_cvt_pk_bf16_f32 v149, v238, v239
  v_cvt_pk_bf16_f32 v150, v240, v241
  v_cvt_pk_bf16_f32 v151, v242, v243
  v_cvt_pk_bf16_f32 v152, v244, v245
  v_mfma_f32_32x32x16_bf16 v[220:235], a[132:135], a[12:15], v[220:235]
  v_cvt_pk_bf16_f32 v153, v246, v247
  v_cvt_pk_bf16_f32 v154, v248, v249
  v_cvt_pk_bf16_f32 v155, v250, v251
  s_mov_b64 exec, -1
  v_exp_f32 v186, v186
  v_mfma_f32_32x32x16_bf16 v[236:251], a[120:123], a[24:27], 0
  v_exp_f32 v187, v187
  v_cvt_pk_bf16_f32 v177, v182, v183
  v_cvt_pk_bf16_f32 v178, v184, v185
  v_cvt_pk_bf16_f32 v179, v186, v187
  v_mfma_f32_32x32x16_bf16 v[236:251], a[124:127], a[28:31], v[236:251]
  ds_read_b128 v[180:183], v3 offset:4992
  ds_read_b128 v[184:187], v3 offset:4864
  v_exp_f32 v188, v188
  v_exp_f32 v189, v189
  v_mfma_f32_32x32x16_bf16 v[204:219], v[128:131], v[176:179], v[204:219]
  ds_read_b128 v[176:179], v3 offset:5120
  v_exp_f32 v190, v190
  v_exp_f32 v191, v191
  v_cvt_pk_bf16_f32 v188, v188, v189
  v_mfma_f32_32x32x16_bf16 v[236:251], a[128:131], a[32:35], v[236:251]
  v_exp_f32 v192, v192
  v_exp_f32 v193, v193
  v_exp_f32 v194, v194
  v_mfma_f32_32x32x16_bf16 v[236:251], a[132:135], a[36:39], v[236:251]
  v_exp_f32 v195, v195
  v_cvt_pk_bf16_f32 v189, v190, v191
  v_cvt_pk_bf16_f32 v190, v192, v193
  v_cvt_pk_bf16_f32 v191, v194, v195
  v_mfma_f32_32x32x16_bf16 v[220:235], a[136:139], a[16:19], v[220:235]
  v_exp_f32 v196, v196
  v_exp_f32 v197, v197
  v_exp_f32 v198, v198
  v_mfma_f32_32x32x16_bf16 v[204:219], v[132:135], v[188:191], v[204:219]
  ds_read_b128 v[188:191], v2 offset:4736
  v_exp_f32 v199, v199
  v_exp_f32 v200, v200
  s_waitcnt lgkmcnt(1)
  v_mfma_f32_32x32x16_bf16 v[172:187], v[96:99], v[54:57], v[172:187]
  v_exp_f32 v201, v201
  v_exp_f32 v202, v202
  v_exp_f32 v203, v203
  v_mfma_f32_32x32x16_bf16 v[236:251], a[136:139], a[40:43], v[236:251]
  v_cvt_pk_bf16_f32 v192, v196, v197
  v_cvt_pk_bf16_f32 v193, v198, v199
  v_cvt_pk_bf16_f32 v194, v200, v201
  v_cvt_pk_bf16_f32 v195, v202, v203
  ds_read_b128 v[196:199], v2 offset:4480
  v_mfma_f32_32x32x8_bf16 v[172:187], v[100:101], v[58:59], v[172:187]
  ds_read_b128 v[200:203], v2 offset:4352
  v_mfma_f32_32x32x16_bf16 v[204:219], v[136:139], v[192:195], v[204:219]
  ds_read_b128 v[192:195], v2 offset:4608
  v_mfma_f32_32x32x16_bf16 v[220:235], a[140:143], a[20:23], v[220:235]
  v_mfma_f32_32x32x16_bf16 v[236:251], a[140:143], a[44:47], v[236:251]
  s_nop 3
  v_exp_f32 v172, v172
  v_exp_f32 v173, v173
  v_exp_f32 v174, v174
  v_exp_f32 v175, v175
  v_rcp_f32 v213, v212
  v_cvt_pk_bf16_f32 v60, v220, v221
  v_cvt_pk_bf16_f32 v61, v222, v223
  v_cvt_pk_bf16_f32 v62, v224, v225
  v_cvt_pk_bf16_f32 v63, v226, v227
  v_cvt_pk_bf16_f32 v64, v228, v229
  v_cvt_pk_bf16_f32 v65, v230, v231
  v_cvt_pk_bf16_f32 v84, v232, v233
  s_waitcnt lgkmcnt(0)
  v_mfma_f32_32x32x16_bf16 v[188:203], v[102:105], v[54:57], v[188:203]
  v_cvt_pk_bf16_f32 v85, v234, v235
  v_cvt_pk_bf16_f32 v72, v236, v237
  v_cvt_pk_bf16_f32 v73, v238, v239
  v_cvt_pk_bf16_f32 v74, v240, v241
  v_cvt_pk_bf16_f32 v75, v242, v243
  v_cvt_pk_bf16_f32 v76, v244, v245
  v_mfma_f32_32x32x16_bf16 v[220:235], a[144:147], a[0:3], 0
  v_cvt_pk_bf16_f32 v77, v246, v247
  v_cvt_pk_bf16_f32 v90, v248, v249
  v_cvt_pk_bf16_f32 v91, v250, v251
  v_exp_f32 v176, v176
  v_exp_f32 v177, v177
  v_mfma_f32_32x32x8_bf16 v[188:203], v[106:107], v[58:59], v[188:203]
  v_exp_f32 v178, v178
  v_exp_f32 v179, v179
  v_cvt_pk_bf16_f32 v172, v172, v173
  v_cvt_pk_bf16_f32 v173, v174, v175
  v_mul_f32 v216, v216, v213
  v_mul_f32 v217, v217, v213
  v_mfma_f32_32x32x16_bf16 v[236:251], a[144:147], a[24:27], 0
  v_mul_f32 v218, v218, v213
  v_mul_f32 v219, v219, v213
  v_mul_f32 v204, v204, v213
  v_mul_f32 v205, v205, v213
  v_mul_f32 v206, v206, v213
  v_mul_f32 v207, v207, v213
  v_mfma_f32_32x32x16_bf16 v[220:235], a[148:151], a[4:7], v[220:235]
  v_mul_f32 v208, v208, v213
  v_mul_f32 v209, v209, v213
  v_mul_f32 v210, v210, v213
  v_mul_f32 v211, v211, v213
  v_cvt_pk_bf16_f32 v174, v176, v177
  v_cvt_pk_bf16_f32 v175, v178, v179
  v_mfma_f32_32x32x16_bf16 v[236:251], a[148:151], a[28:31], v[236:251]
  v_max3_f32 v10, v10, v212, v213
  v_cvt_pk_bf16_f32 v42, v216, v217
  v_cvt_pk_bf16_f32 v43, v218, v219
  v_cvt_pk_bf16_f32 v44, v204, v205
  v_cvt_pk_bf16_f32 v45, v206, v207
  v_cvt_pk_bf16_f32 v46, v208, v209
  v_mfma_f32_32x32x16_bf16 v[220:235], a[152:155], a[8:11], v[220:235]
  v_cvt_pk_bf16_f32 v47, v210, v211
  v_exp_f32 v180, v180
  v_exp_f32 v181, v181
  v_mfma_f32_32x32x16_bf16 v[204:219], v[124:127], v[172:175], 0
  ds_read_b128 v[172:175], v2 offset:8576
  v_exp_f32 v182, v182
  v_exp_f32 v183, v183
  v_cvt_pk_bf16_f32 v176, v180, v181
  v_mfma_f32_32x32x16_bf16 v[236:251], a[152:155], a[32:35], v[236:251]
  v_exp_f32 v184, v184
  v_exp_f32 v185, v185
  v_exp_f32 v186, v186
  v_mfma_f32_32x32x16_bf16 v[220:235], a[156:159], a[12:15], v[220:235]
  v_exp_f32 v187, v187
  v_cvt_pk_bf16_f32 v177, v182, v183
  v_cvt_pk_bf16_f32 v178, v184, v185
  v_cvt_pk_bf16_f32 v179, v186, v187
  v_mfma_f32_32x32x16_bf16 v[236:251], a[156:159], a[36:39], v[236:251]
  ds_read_b128 v[180:183], v2 offset:8320
  ds_read_b128 v[184:187], v2 offset:8192
  v_exp_f32 v188, v188
  v_exp_f32 v189, v189
  v_mfma_f32_32x32x16_bf16 v[204:219], v[128:131], v[176:179], v[204:219]
  ds_read_b128 v[176:179], v2 offset:8448
  v_exp_f32 v190, v190
  v_exp_f32 v191, v191
  v_cvt_pk_bf16_f32 v188, v188, v189
  v_mfma_f32_32x32x16_bf16 v[220:235], a[160:163], a[16:19], v[220:235]
  v_exp_f32 v192, v192
  v_exp_f32 v193, v193
  v_exp_f32 v194, v194
  v_mfma_f32_32x32x16_bf16 v[236:251], a[160:163], a[40:43], v[236:251]
  v_exp_f32 v195, v195
  v_cvt_pk_bf16_f32 v189, v190, v191
  v_cvt_pk_bf16_f32 v190, v192, v193
  v_cvt_pk_bf16_f32 v191, v194, v195
  v_mfma_f32_32x32x16_bf16 v[220:235], a[164:167], a[20:23], v[220:235]
  v_exp_f32 v196, v196
  v_exp_f32 v197, v197
  v_exp_f32 v198, v198
  v_mfma_f32_32x32x16_bf16 v[204:219], v[132:135], v[188:191], v[204:219]
  ds_read_b128 v[188:191], v3 offset:8064
  v_exp_f32 v199, v199
  v_exp_f32 v200, v200
  v_cvt_pk_bf16_f32 v86, v220, v221
  v_mfma_f32_32x32x16_bf16 v[236:251], a[164:167], a[44:47], v[236:251]
  s_waitcnt vmcnt(1)
  buffer_store_dwordx4 v[252:255], v7, s[12:15], s36 offen offset:0 sc1
  v_cvt_pk_bf16_f32 v87, v222, v223
  v_cvt_pk_bf16_f32 v88, v224, v225
  v_cvt_pk_bf16_f32 v89, v226, v227
  s_waitcnt lgkmcnt(1)
  v_mfma_f32_32x32x16_bf16 v[172:187], v[84:87], v[60:63], v[172:187]
  ds_read_b128 v[252:255], v6 offset:1024
  v_cvt_pk_bf16_f32 v66, v228, v229
  v_cvt_pk_bf16_f32 v67, v230, v231
  v_cvt_pk_bf16_f32 v68, v232, v233
  v_cvt_pk_bf16_f32 v69, v234, v235
  v_cvt_pk_bf16_f32 v92, v236, v237
  v_mfma_f32_32x32x16_bf16 v[220:235], a[0:3], a[240:243], 0
  v_cvt_pk_bf16_f32 v93, v238, v239
  v_cvt_pk_bf16_f32 v94, v240, v241
  v_cvt_pk_bf16_f32 v95, v242, v243
  v_cvt_pk_bf16_f32 v78, v244, v245
  v_cvt_pk_bf16_f32 v79, v246, v247
  v_cvt_pk_bf16_f32 v80, v248, v249
  v_cvt_pk_bf16_f32 v81, v250, v251
  v_mfma_f32_32x32x8_bf16 v[172:187], v[88:89], v[64:65], v[172:187]
  v_exp_f32 v201, v201
  v_exp_f32 v202, v202
  v_exp_f32 v203, v203
  v_cvt_pk_bf16_f32 v192, v196, v197
  v_cvt_pk_bf16_f32 v193, v198, v199
  v_mfma_f32_32x32x16_bf16 v[236:251], a[24:27], a[240:243], 0
  ds_read_b64_tr_b16 a[240:241], v0 offset:22528
  ds_read_b64_tr_b16 a[242:243], v0 offset:22784
  ds_read_b128 v[196:199], v3 offset:7808
  v_cvt_pk_bf16_f32 v194, v200, v201
  v_cvt_pk_bf16_f32 v195, v202, v203
  v_mfma_f32_32x32x16_bf16 v[220:235], a[4:7], a[244:247], v[220:235]
  ds_read_b128 v[200:203], v3 offset:7680
  v_exp_f32 v172, v172
  v_exp_f32 v173, v173
  v_mfma_f32_32x32x16_bf16 v[204:219], v[136:139], v[192:195], v[204:219]
  ds_read_b128 v[192:195], v3 offset:7936
  v_exp_f32 v174, v174
  v_exp_f32 v175, v175
  v_cvt_pk_bf16_f32 v172, v172, v173
  v_mfma_f32_32x32x16_bf16 v[236:251], a[28:31], a[244:247], v[236:251]
  ds_read_b64_tr_b16 a[244:245], v0 offset:23552
  ds_read_b64_tr_b16 a[246:247], v0 offset:23808
  v_exp_f32 v176, v176
  v_rcp_f32 v213, v212
  v_mfma_f32_32x32x16_bf16 v[220:235], a[8:11], a[248:251], v[220:235]
  v_exp_f32 v177, v177
  v_exp_f32 v178, v178
  v_exp_f32 v179, v179
  v_mfma_f32_32x32x16_bf16 v[236:251], a[32:35], a[248:251], v[236:251]
  ds_read_b64_tr_b16 a[248:249], v0 offset:0
  ds_read_b64_tr_b16 a[250:251], v0 offset:256
  v_cvt_pk_bf16_f32 v173, v174, v175
  v_mul_f32 v216, v216, v213
  v_mul_f32 v217, v217, v213
  v_mul_f32 v218, v218, v213
  v_mfma_f32_32x32x16_bf16 v[220:235], a[12:15], a[252:255], v[220:235]
  v_mul_f32 v219, v219, v213
  v_mul_f32 v204, v204, v213
  v_mul_f32 v205, v205, v213
  v_mul_f32 v206, v206, v213
  v_mul_f32 v207, v207, v213
  s_waitcnt lgkmcnt(4)
  v_mfma_f32_32x32x16_bf16 v[188:203], v[90:93], v[60:63], v[188:203]
  buffer_store_dwordx4 v[252:255], v8, s[12:15], s36 offen offset:1024 sc1
  v_mul_f32 v208, v208, v213
  v_mfma_f32_32x32x16_bf16 v[236:251], a[36:39], a[252:255], v[236:251]
  ds_read_b64_tr_b16 a[252:253], v0 offset:1024
  ds_read_b64_tr_b16 a[254:255], v0 offset:1280
  ds_read_b128 v[252:255], v6 offset:2048
  v_mul_f32 v209, v209, v213
  v_mul_f32 v210, v210, v213
  v_mul_f32 v211, v211, v213
  v_cvt_pk_bf16_f32 v174, v176, v177
  v_mfma_f32_32x32x8_bf16 v[188:203], v[94:95], v[64:65], v[188:203]
  v_cvt_pk_bf16_f32 v175, v178, v179
  v_max3_f32 v10, v10, v212, v213
  v_cvt_pk_bf16_f32 v54, v216, v217
  v_cvt_pk_bf16_f32 v55, v218, v219
  v_cvt_pk_bf16_f32 v56, v204, v205
  v_cvt_pk_bf16_f32 v57, v206, v207
  v_cvt_pk_bf16_f32 v58, v208, v209
  v_cvt_pk_bf16_f32 v59, v210, v211
  v_mfma_f32_32x32x16_bf16 v[220:235], a[16:19], a[240:243], v[220:235]
  v_exp_f32 v180, v180
  v_exp_f32 v181, v181
  v_exp_f32 v182, v182
  v_mfma_f32_32x32x16_bf16 v[236:251], a[40:43], a[240:243], v[236:251]
  ds_read_b64_tr_b16 a[240:241], v0 offset:2048
  ds_read_b64_tr_b16 a[242:243], v0 offset:2304
  v_exp_f32 v183, v183
  v_cvt_pk_bf16_f32 v176, v180, v181
  s_waitcnt lgkmcnt(5)
  v_mfma_f32_32x32x16_bf16 v[220:235], a[20:23], a[244:247], v[220:235]
  v_exp_f32 v184, v184
  v_exp_f32 v185, v185
  v_exp_f32 v186, v186
  v_mfma_f32_32x32x16_bf16 v[236:251], a[44:47], a[244:247], v[236:251]
  ds_read_b64_tr_b16 a[244:245], v0 offset:3072
  ds_read_b64_tr_b16 a[246:247], v0 offset:3328
  v_exp_f32 v187, v187
  s_mov_b64 exec, s[66:67]
  v_cvt_pk_bf16_f32 v140, v220, v221
  v_cvt_pk_bf16_f32 v141, v222, v223
  v_cvt_pk_bf16_f32 v142, v224, v225
  v_cvt_pk_bf16_f32 v143, v226, v227
  v_cvt_pk_bf16_f32 v144, v228, v229
  v_cvt_pk_bf16_f32 v145, v230, v231
  v_mfma_f32_32x32x16_bf16 v[204:219], v[140:143], v[172:175], 0
  v_cvt_pk_bf16_f32 v146, v232, v233
  v_cvt_pk_bf16_f32 v147, v234, v235
  s_mov_b64 exec, -1
  s_mov_b64 exec, s[68:69]
  v_cvt_pk_bf16_f32 v156, v220, v221
  v_cvt_pk_bf16_f32 v157, v222, v223
  v_cvt_pk_bf16_f32 v158, v224, v225
  v_cvt_pk_bf16_f32 v159, v226, v227
  v_cvt_pk_bf16_f32 v160, v228, v229
  v_cvt_pk_bf16_f32 v161, v230, v231
  v_cvt_pk_bf16_f32 v162, v232, v233
  v_cvt_pk_bf16_f32 v163, v234, v235
  v_mfma_f32_32x32x16_bf16 v[220:235], a[248:251], a[0:3], 0
  s_mov_b64 exec, -1
  ds_read_b128 a[0:3], v4 offset:49152
  ds_read_b128 v[172:175], v3 offset:9088
  s_mov_b64 exec, s[66:67]
  v_cvt_pk_bf16_f32 v148, v236, v237
  s_waitcnt lgkmcnt(4)
  v_mfma_f32_32x32x16_bf16 v[220:235], a[252:255], a[4:7], v[220:235]
  v_cvt_pk_bf16_f32 v149, v238, v239
  v_cvt_pk_bf16_f32 v150, v240, v241
  v_cvt_pk_bf16_f32 v151, v242, v243
  v_cvt_pk_bf16_f32 v152, v244, v245
  v_cvt_pk_bf16_f32 v153, v246, v247
  v_cvt_pk_bf16_f32 v154, v248, v249
  v_mfma_f32_32x32x16_bf16 v[220:235], a[240:243], a[8:11], v[220:235]
  v_cvt_pk_bf16_f32 v155, v250, v251
  s_mov_b64 exec, -1
  s_mov_b64 exec, s[68:69]
  v_cvt_pk_bf16_f32 v164, v236, v237
  v_cvt_pk_bf16_f32 v165, v238, v239
  s_waitcnt lgkmcnt(2)
  v_mfma_f32_32x32x16_bf16 v[220:235], a[244:247], a[12:15], v[220:235]
  v_cvt_pk_bf16_f32 v166, v240, v241
  v_cvt_pk_bf16_f32 v167, v242, v243
  v_cvt_pk_bf16_f32 v168, v244, v245
  v_cvt_pk_bf16_f32 v169, v246, v247
  v_cvt_pk_bf16_f32 v170, v248, v249
  v_cvt_pk_bf16_f32 v171, v250, v251
  v_mfma_f32_32x32x16_bf16 v[236:251], a[248:251], a[24:27], 0
  s_mov_b64 exec, -1
  ds_read_b64_tr_b16 a[248:249], v0 offset:4096
  ds_read_b64_tr_b16 a[250:251], v0 offset:4352
  ds_read_b128 a[24:27], v4 offset:55296
  ds_read_b128 a[4:7], v5 offset:49152
  v_cvt_pk_bf16_f32 v177, v182, v183
  v_mfma_f32_32x32x16_bf16 v[236:251], a[252:255], a[28:31], v[236:251]
  ds_read_b64_tr_b16 a[252:253], v0 offset:5120
  ds_read_b64_tr_b16 a[254:255], v0 offset:5376
  v_cvt_pk_bf16_f32 v178, v184, v185
  v_cvt_pk_bf16_f32 v179, v186, v187
  v_exp_f32 v188, v188
  v_mfma_f32_32x32x16_bf16 v[204:219], v[144:147], v[176:179], v[204:219]
  ds_read_b128 a[28:31], v5 offset:55296
  ds_read_b128 a[8:11], v4 offset:49216
  v_exp_f32 v189, v189
  v_exp_f32 v190, v190
  v_mfma_f32_32x32x16_bf16 v[236:251], a[240:243], a[32:35], v[236:251]
  ds_read_b64_tr_b16 a[240:241], v0 offset:6144
  ds_read_b64_tr_b16 a[242:243], v0 offset:6400
  ds_read_b128 a[12:15], v5 offset:49216
  ds_read_b128 a[32:35], v4 offset:55360
  v_exp_f32 v191, v191
  v_mfma_f32_32x32x16_bf16 v[236:251], a[244:247], a[36:39], v[236:251]
  ds_read_b64_tr_b16 a[244:245], v0 offset:7168
  ds_read_b64_tr_b16 a[246:247], v0 offset:7424
  v_exp_f32 v192, v192
  v_cvt_pk_bf16_f32 v188, v188, v189
  s_waitcnt lgkmcnt(10)
  v_mfma_f32_32x32x16_bf16 v[220:235], a[248:251], a[16:19], v[220:235]
  ds_read_b128 a[16:19], v4 offset:49280
  ds_read_b128 a[36:39], v5 offset:55360
  v_exp_f32 v193, v193
  v_exp_f32 v194, v194
  v_mfma_f32_32x32x16_bf16 v[236:251], a[248:251], a[40:43], v[236:251]
  ds_read_b64_tr_b16 a[248:249], v0 offset:8192
  ds_read_b64_tr_b16 a[250:251], v0 offset:8448
  ds_read_b128 a[40:43], v4 offset:55424
  ds_read_b128 v[176:179], v3 offset:8960
  v_cvt_pk_bf16_f32 v189, v190, v191
  s_waitcnt lgkmcnt(12)
  v_mfma_f32_32x32x16_bf16 v[220:235], a[252:255], a[20:23], v[220:235]
  ds_read_b128 a[20:23], v5 offset:49280
  buffer_store_dwordx4 v[252:255], v9, s[12:15], s36 offen offset:2048 sc1
  v_mfma_f32_32x32x16_bf16 v[236:251], a[252:255], a[44:47], v[236:251]
  ds_read_b64_tr_b16 a[252:253], v0 offset:9216
  ds_read_b64_tr_b16 a[254:255], v0 offset:9472
  ds_read_b128 v[180:183], v3 offset:8832
  ds_read_b128 v[184:187], v3 offset:8704
  v_exp_f32 v195, v195
  v_cvt_pk_bf16_f32 v190, v192, v193
  v_cvt_pk_bf16_f32 v191, v194, v195
  v_cvt_pk_bf16_f32 v70, v220, v221
  v_cvt_pk_bf16_f32 v71, v222, v223
  v_mfma_f32_32x32x16_bf16 v[204:219], v[148:151], v[188:191], v[204:219]
  ds_read_b128 a[44:47], v5 offset:55424
  ds_read_b128 v[188:191], v2 offset:8576
  v_cvt_pk_bf16_f32 v96, v224, v225
  v_cvt_pk_bf16_f32 v97, v226, v227
  v_cvt_pk_bf16_f32 v98, v228, v229
  v_cvt_pk_bf16_f32 v99, v230, v231
  v_cvt_pk_bf16_f32 v100, v232, v233
  v_cvt_pk_bf16_f32 v101, v234, v235
  s_waitcnt lgkmcnt(7)
  v_mfma_f32_32x32x16_bf16 v[220:235], a[0:3], a[240:243], 0
  ds_read_b128 v[252:255], v6 offset:3072
  v_cvt_pk_bf16_f32 v82, v236, v237
  v_cvt_pk_bf16_f32 v83, v238, v239
  v_cvt_pk_bf16_f32 v102, v240, v241
  v_cvt_pk_bf16_f32 v103, v242, v243
  v_cvt_pk_bf16_f32 v104, v244, v245
  v_mfma_f32_32x32x16_bf16 v[220:235], a[4:7], a[244:247], v[220:235]
  v_cvt_pk_bf16_f32 v105, v246, v247
  v_cvt_pk_bf16_f32 v106, v248, v249
  v_cvt_pk_bf16_f32 v107, v250, v251
  v_exp_f32 v196, v196
  s_waitcnt lgkmcnt(3)
  v_mfma_f32_32x32x16_bf16 v[172:187], v[84:87], v[72:75], v[172:187]
  v_exp_f32 v197, v197
  v_exp_f32 v198, v198
  v_exp_f32 v199, v199
  v_mfma_f32_32x32x16_bf16 v[236:251], a[24:27], a[240:243], 0
  ds_read_b64_tr_b16 a[240:241], v0 offset:10240
  ds_read_b64_tr_b16 a[242:243], v0 offset:10496
  v_exp_f32 v200, v200
  v_exp_f32 v201, v201
  v_cvt_pk_bf16_f32 v192, v196, v197
  v_mfma_f32_32x32x8_bf16 v[172:187], v[88:89], v[76:77], v[172:187]
  v_exp_f32 v202, v202
  v_exp_f32 v203, v203
  v_cvt_pk_bf16_f32 v193, v198, v199
  v_cvt_pk_bf16_f32 v194, v200, v201
  v_cvt_pk_bf16_f32 v195, v202, v203
  v_mfma_f32_32x32x16_bf16 v[236:251], a[28:31], a[244:247], v[236:251]
  ds_read_b64_tr_b16 a[244:245], v0 offset:11264
  ds_read_b64_tr_b16 a[246:247], v0 offset:11520
  ds_read_b128 v[196:199], v2 offset:8320
  ds_read_b128 v[200:203], v2 offset:8192
  v_exp_f32 v172, v172
  v_mfma_f32_32x32x16_bf16 v[204:219], v[152:155], v[192:195], v[204:219]
  ds_read_b128 v[192:195], v2 offset:8448
  v_exp_f32 v173, v173
  v_exp_f32 v174, v174
  v_cvt_pk_bf16_f32 v172, v172, v173
  v_mfma_f32_32x32x16_bf16 v[220:235], a[8:11], a[248:251], v[220:235]
  s_waitcnt lgkmcnt(5)
  buffer_store_dwordx4 v[252:255], v7, s[12:15], s37 offen offset:0 sc1
  v_mfma_f32_32x32x16_bf16 v[220:235], a[12:15], a[252:255], v[220:235]
  ds_read_b128 v[252:255], v6 offset:4096
  v_exp_f32 v175, v175
  v_rcp_f32 v209, v208
  v_cvt_pk_bf16_f32 v173, v174, v175
  v_mfma_f32_32x32x16_bf16 v[236:251], a[32:35], a[248:251], v[236:251]
  ds_read_b64_tr_b16 a[248:249], v0 offset:12288
  ds_read_b64_tr_b16 a[250:251], v0 offset:12544
  v_exp_f32 v176, v176
  v_exp_f32 v177, v177
  v_mfma_f32_32x32x16_bf16 v[220:235], a[16:19], a[240:243], v[220:235]
  v_exp_f32 v178, v178
  v_exp_f32 v179, v179
  v_mul_f32 v212, v212, v209
  s_waitcnt lgkmcnt(3)
  v_mfma_f32_32x32x16_bf16 v[188:203], v[90:93], v[72:75], v[188:203]
  v_mul_f32 v213, v213, v209
  v_mul_f32 v214, v214, v209
  v_mul_f32 v215, v215, v209
  v_mul_f32 v216, v216, v209
  v_mul_f32 v217, v217, v209
  v_mul_f32 v218, v218, v209
  v_mfma_f32_32x32x16_bf16 v[236:251], a[36:39], a[252:255], v[236:251]
  ds_read_b64_tr_b16 a[252:253], v0 offset:13312
  ds_read_b64_tr_b16 a[254:255], v0 offset:13568
  v_mul_f32 v219, v219, v209
  v_mul_f32 v204, v204, v209
  v_mul_f32 v205, v205, v209
  v_mul_f32 v206, v206, v209
  v_mul_f32 v207, v207, v209
  v_mfma_f32_32x32x8_bf16 v[188:203], v[94:95], v[76:77], v[188:203]
  v_cvt_pk_bf16_f32 v174, v176, v177
  v_cvt_pk_bf16_f32 v175, v178, v179
  v_max3_f32 v10, v10, v208, v209
  v_cvt_pk_bf16_f32 v60, v212, v213
  v_cvt_pk_bf16_f32 v61, v214, v215
  v_cvt_pk_bf16_f32 v62, v216, v217
  v_cvt_pk_bf16_f32 v63, v218, v219
  v_cvt_pk_bf16_f32 v64, v204, v205
  v_mfma_f32_32x32x16_bf16 v[220:235], a[20:23], a[244:247], v[220:235]
  v_cvt_pk_bf16_f32 v65, v206, v207
  v_exp_f32 v180, v180
  v_exp_f32 v181, v181
  v_mfma_f32_32x32x16_bf16 v[204:219], v[140:143], v[172:175], 0
  ds_read_b128 v[172:175], v2 offset:12416
  v_exp_f32 v182, v182
  v_exp_f32 v183, v183
  s_mov_b64 exec, s[48:49]
  v_mfma_f32_32x32x16_bf16 v[236:251], a[40:43], a[240:243], v[236:251]
  v_cvt_pk_bf16_f32 v108, v220, v221
  v_cvt_pk_bf16_f32 v109, v222, v223
  v_cvt_pk_bf16_f32 v110, v224, v225
  v_cvt_pk_bf16_f32 v111, v226, v227
  v_cvt_pk_bf16_f32 v112, v228, v229
  v_cvt_pk_bf16_f32 v113, v230, v231
  v_mfma_f32_32x32x16_bf16 v[236:251], a[44:47], a[244:247], v[236:251]
  v_cvt_pk_bf16_f32 v114, v232, v233
  v_cvt_pk_bf16_f32 v115, v234, v235
  s_mov_b64 exec, -1
  s_mov_b64 exec, s[60:61]
  v_cvt_pk_bf16_f32 v124, v220, v221
  v_cvt_pk_bf16_f32 v125, v222, v223
  v_cvt_pk_bf16_f32 v126, v224, v225
  v_cvt_pk_bf16_f32 v127, v226, v227
  v_cvt_pk_bf16_f32 v128, v228, v229
  v_cvt_pk_bf16_f32 v129, v230, v231
  v_cvt_pk_bf16_f32 v130, v232, v233
  v_cvt_pk_bf16_f32 v131, v234, v235
  v_mfma_f32_32x32x16_bf16 v[220:235], a[48:51], a[0:3], 0
  s_mov_b64 exec, -1
  ds_read_b64_tr_b16 a[240:241], v0 offset:14336
  ds_read_b64_tr_b16 a[242:243], v0 offset:14592
  ds_read_b64_tr_b16 a[244:245], v0 offset:15360
  ds_read_b64_tr_b16 a[246:247], v0 offset:15616
  s_mov_b64 exec, s[48:49]
  v_mfma_f32_32x32x16_bf16 v[220:235], a[52:55], a[4:7], v[220:235]
  v_cvt_pk_bf16_f32 v116, v236, v237
  v_cvt_pk_bf16_f32 v117, v238, v239
  v_cvt_pk_bf16_f32 v118, v240, v241
  v_cvt_pk_bf16_f32 v119, v242, v243
  v_cvt_pk_bf16_f32 v120, v244, v245
  v_cvt_pk_bf16_f32 v121, v246, v247
  v_mfma_f32_32x32x16_bf16 v[220:235], a[56:59], a[8:11], v[220:235]
  v_cvt_pk_bf16_f32 v122, v248, v249
  v_cvt_pk_bf16_f32 v123, v250, v251
  s_mov_b64 exec, -1
  s_mov_b64 exec, s[60:61]
  v_cvt_pk_bf16_f32 v132, v236, v237
  v_cvt_pk_bf16_f32 v133, v238, v239
  v_mfma_f32_32x32x16_bf16 v[220:235], a[60:63], a[12:15], v[220:235]
  v_cvt_pk_bf16_f32 v134, v240, v241
  v_cvt_pk_bf16_f32 v135, v242, v243
  v_cvt_pk_bf16_f32 v136, v244, v245
  v_cvt_pk_bf16_f32 v137, v246, v247
  v_cvt_pk_bf16_f32 v138, v248, v249
  v_cvt_pk_bf16_f32 v139, v250, v251
  v_mfma_f32_32x32x16_bf16 v[236:251], a[48:51], a[24:27], 0
  s_mov_b64 exec, -1
  v_exp_f32 v184, v184
  v_exp_f32 v185, v185
  v_cvt_pk_bf16_f32 v176, v180, v181
  v_mfma_f32_32x32x16_bf16 v[236:251], a[52:55], a[28:31], v[236:251]
  s_waitcnt lgkmcnt(0)
  buffer_store_dwordx4 v[252:255], v8, s[12:15], s37 offen offset:1024 sc1
  v_mfma_f32_32x32x16_bf16 v[236:251], a[56:59], a[32:35], v[236:251]
  ds_read_b128 v[252:255], v6 offset:5120
  v_exp_f32 v186, v186
  v_exp_f32 v187, v187
  v_cvt_pk_bf16_f32 v177, v182, v183
  v_mfma_f32_32x32x16_bf16 v[220:235], a[64:67], a[16:19], v[220:235]
  ds_read_b128 v[180:183], v2 offset:12160
  v_cvt_pk_bf16_f32 v178, v184, v185
  v_cvt_pk_bf16_f32 v179, v186, v187
  v_exp_f32 v188, v188
  v_mfma_f32_32x32x16_bf16 v[204:219], v[144:147], v[176:179], v[204:219]
  ds_read_b128 v[176:179], v2 offset:12288
  ds_read_b128 v[184:187], v2 offset:12032
  v_exp_f32 v189, v189
  v_exp_f32 v190, v190
  v_mfma_f32_32x32x16_bf16 v[236:251], a[60:63], a[36:39], v[236:251]
  v_exp_f32 v191, v191
  v_exp_f32 v192, v192
  v_exp_f32 v193, v193
  v_mfma_f32_32x32x16_bf16 v[220:235], a[68:71], a[20:23], v[220:235]
  v_exp_f32 v194, v194
  v_exp_f32 v195, v195
  v_cvt_pk_bf16_f32 v188, v188, v189
  v_cvt_pk_bf16_f32 v189, v190, v191
  v_mfma_f32_32x32x16_bf16 v[236:251], a[64:67], a[40:43], v[236:251]
  v_cvt_pk_bf16_f32 v190, v192, v193
  v_cvt_pk_bf16_f32 v191, v194, v195
  v_exp_f32 v196, v196
  v_exp_f32 v197, v197
  v_mfma_f32_32x32x16_bf16 v[204:219], v[148:151], v[188:191], v[204:219]
  ds_read_b128 v[188:191], v3 offset:11904
  v_exp_f32 v198, v198
  v_exp_f32 v199, v199
  s_waitcnt lgkmcnt(1)
  v_mfma_f32_32x32x16_bf16 v[172:187], v[96:99], v[66:69], v[172:187]
  v_exp_f32 v200, v200
  v_exp_f32 v201, v201
  v_exp_f32 v202, v202
  v_mfma_f32_32x32x16_bf16 v[236:251], a[68:71], a[44:47], v[236:251]
  v_exp_f32 v203, v203
  v_cvt_pk_bf16_f32 v192, v196, v197
  v_cvt_pk_bf16_f32 v193, v198, v199
  v_cvt_pk_bf16_f32 v194, v200, v201
  v_cvt_pk_bf16_f32 v195, v202, v203
  v_cvt_pk_bf16_f32 v12, v220, v221
  v_mfma_f32_32x32x8_bf16 v[172:187], v[100:101], v[70:71], v[172:187]
  v_cvt_pk_bf16_f32 v13, v222, v223
  v_cvt_pk_bf16_f32 v14, v224, v225
  v_cvt_pk_bf16_f32 v15, v226, v227
  v_cvt_pk_bf16_f32 v16, v228, v229
  v_cvt_pk_bf16_f32 v17, v230, v231
  v_cvt_pk_bf16_f32 v84, v232, v233
  v_cvt_pk_bf16_f32 v85, v234, v235
  v_cvt_pk_bf16_f32 v24, v236, v237
  v_mfma_f32_32x32x16_bf16 v[204:219], v[152:155], v[192:195], v[204:219]
  ds_read_b128 v[192:195], v3 offset:11776
  ds_read_b128 v[196:199], v3 offset:11648
  ds_read_b128 v[200:203], v3 offset:11520
  v_cvt_pk_bf16_f32 v25, v238, v239
  v_cvt_pk_bf16_f32 v26, v240, v241
  v_cvt_pk_bf16_f32 v27, v242, v243
  v_mfma_f32_32x32x16_bf16 v[220:235], a[72:75], a[0:3], 0
  buffer_store_dwordx4 v[252:255], v9, s[12:15], s37 offen offset:2048 sc1
  v_cvt_pk_bf16_f32 v28, v244, v245
  v_mfma_f32_32x32x16_bf16 v[220:235], a[76:79], a[4:7], v[220:235]
  ds_read_b128 v[252:255], v6 offset:6144
  v_cvt_pk_bf16_f32 v29, v246, v247
  v_cvt_pk_bf16_f32 v90, v248, v249
  v_cvt_pk_bf16_f32 v91, v250, v251
  v_exp_f32 v172, v172
  v_mfma_f32_32x32x16_bf16 v[236:251], a[72:75], a[24:27], 0
  v_exp_f32 v173, v173
  v_exp_f32 v174, v174
  v_exp_f32 v175, v175
  v_mfma_f32_32x32x16_bf16 v[220:235], a[80:83], a[8:11], v[220:235]
  v_rcp_f32 v209, v208
  v_exp_f32 v176, v176
  v_cvt_pk_bf16_f32 v172, v172, v173
  s_waitcnt lgkmcnt(1)
  v_mfma_f32_32x32x16_bf16 v[188:203], v[102:105], v[66:69], v[188:203]
  v_exp_f32 v177, v177
  v_exp_f32 v178, v178
  v_exp_f32 v179, v179
  v_mfma_f32_32x32x16_bf16 v[236:251], a[76:79], a[28:31], v[236:251]
  v_cvt_pk_bf16_f32 v173, v174, v175
  v_mul_f32 v212, v212, v209
  v_mul_f32 v213, v213, v209
  v_mul_f32 v214, v214, v209
  v_mul_f32 v215, v215, v209
  v_mul_f32 v216, v216, v209
  v_mul_f32 v217, v217, v209
  v_mfma_f32_32x32x8_bf16 v[188:203], v[106:107], v[70:71], v[188:203]
  v_mul_f32 v218, v218, v209
  v_mul_f32 v219, v219, v209
  v_mul_f32 v204, v204, v209
  v_mul_f32 v205, v205, v209
  v_mul_f32 v206, v206, v209
  v_mul_f32 v207, v207, v209
  v_cvt_pk_bf16_f32 v174, v176, v177
  v_cvt_pk_bf16_f32 v175, v178, v179
  v_mfma_f32_32x32x16_bf16 v[220:235], a[84:87], a[12:15], v[220:235]
  v_max3_f32 v10, v10, v208, v209
  v_cvt_pk_bf16_f32 v72, v212, v213
  v_cvt_pk_bf16_f32 v73, v214, v215
  v_cvt_pk_bf16_f32 v74, v216, v217
  v_cvt_pk_bf16_f32 v75, v218, v219
  v_cvt_pk_bf16_f32 v76, v204, v205
  v_mfma_f32_32x32x16_bf16 v[236:251], a[80:83], a[32:35], v[236:251]
  v_cvt_pk_bf16_f32 v77, v206, v207
  v_exp_f32 v180, v180
  v_exp_f32 v181, v181
  v_mfma_f32_32x32x16_bf16 v[204:219], v[156:159], v[172:175], 0
  ds_read_b128 v[172:175], v3 offset:12928
  v_exp_f32 v182, v182
  v_exp_f32 v183, v183
  v_cvt_pk_bf16_f32 v176, v180, v181
  v_mfma_f32_32x32x16_bf16 v[220:235], a[88:91], a[16:19], v[220:235]
  s_waitcnt lgkmcnt(1)
  buffer_store_dwordx4 v[252:255], v7, s[12:15], s38 offen offset:0 sc1
  v_mfma_f32_32x32x16_bf16 v[236:251], a[84:87], a[36:39], v[236:251]
  ds_read_b128 v[252:255], v6 offset:7168
  v_exp_f32 v184, v184
  v_exp_f32 v185, v185
  v_cvt_pk_bf16_f32 v177, v182, v183
  v_mfma_f32_32x32x16_bf16 v[220:235], a[92:95], a[20:23], v[220:235]
  ds_read_b128 v[180:183], v3 offset:12672
  v_exp_f32 v186, v186
  v_exp_f32 v187, v187
  v_cvt_pk_bf16_f32 v178, v184, v185
  v_mfma_f32_32x32x16_bf16 v[236:251], a[88:91], a[40:43], v[236:251]
  v_cvt_pk_bf16_f32 v179, v186, v187
  v_exp_f32 v188, v188
  v_exp_f32 v189, v189
  v_cvt_pk_bf16_f32 v86, v220, v221
  v_mfma_f32_32x32x16_bf16 v[204:219], v[160:163], v[176:179], v[204:219]
  ds_read_b128 v[176:179], v3 offset:12800
  ds_read_b128 v[184:187], v3 offset:12544
  v_exp_f32 v190, v190
  v_exp_f32 v191, v191
  v_mfma_f32_32x32x16_bf16 v[236:251], a[92:95], a[44:47], v[236:251]
  v_exp_f32 v192, v192
  v_exp_f32 v193, v193
  v_exp_f32 v194, v194
  v_exp_f32 v195, v195
  v_cvt_pk_bf16_f32 v188, v188, v189
  v_cvt_pk_bf16_f32 v189, v190, v191
  v_cvt_pk_bf16_f32 v87, v222, v223
  v_cvt_pk_bf16_f32 v88, v224, v225
  v_cvt_pk_bf16_f32 v89, v226, v227
  v_cvt_pk_bf16_f32 v18, v228, v229
  v_cvt_pk_bf16_f32 v19, v230, v231
  v_cvt_pk_bf16_f32 v20, v232, v233
  v_cvt_pk_bf16_f32 v21, v234, v235
  v_mfma_f32_32x32x16_bf16 v[220:235], a[168:171], v[36:39], 0
  v_cvt_pk_bf16_f32 v190, v192, v193
  v_cvt_pk_bf16_f32 v191, v194, v195
  v_exp_f32 v196, v196
  v_exp_f32 v197, v197
  v_mfma_f32_32x32x16_bf16 v[204:219], v[164:167], v[188:191], v[204:219]
  ds_read_b128 v[188:191], v2 offset:12416
  v_exp_f32 v198, v198
  v_exp_f32 v199, v199
  s_waitcnt lgkmcnt(1)
  v_mfma_f32_32x32x16_bf16 v[172:187], v[96:99], v[78:81], v[172:187]
  v_exp_f32 v200, v200
  v_exp_f32 v201, v201
  v_exp_f32 v202, v202
  v_mfma_f32_32x32x16_bf16 v[220:235], a[172:175], v[40:43], v[220:235]
  buffer_store_dwordx4 v[252:255], v8, s[12:15], s38 offen offset:1024 sc1
  v_cvt_pk_bf16_f32 v192, v196, v197
  v_cvt_pk_bf16_f32 v193, v198, v199
  v_mfma_f32_32x32x8_bf16 v[172:187], v[100:101], v[82:83], v[172:187]
  v_exp_f32 v203, v203
  v_cvt_pk_bf16_f32 v194, v200, v201
  v_cvt_pk_bf16_f32 v195, v202, v203
  v_cvt_pk_bf16_f32 v92, v236, v237
  v_cvt_pk_bf16_f32 v93, v238, v239
  v_cvt_pk_bf16_f32 v94, v240, v241
  v_cvt_pk_bf16_f32 v95, v242, v243
  v_mfma_f32_32x32x16_bf16 v[204:219], v[168:171], v[192:195], v[204:219]
  ds_read_b128 v[192:195], v2 offset:12288
  ds_read_b128 v[196:199], v2 offset:12160
  ds_read_b128 v[200:203], v2 offset:12032
  v_cvt_pk_bf16_f32 v30, v244, v245
  v_cvt_pk_bf16_f32 v31, v246, v247
  v_cvt_pk_bf16_f32 v32, v248, v249
  v_mfma_f32_32x32x16_bf16 v[220:235], a[176:179], v[44:47], v[220:235]
  ds_read_b128 v[252:255], v6 offset:8192
  v_cvt_pk_bf16_f32 v33, v250, v251
  v_exp_f32 v172, v172
  v_rcp_f32 v205, v204
  v_mfma_f32_32x32x16_bf16 v[236:251], a[192:195], v[36:39], 0
  v_mul_f32 v208, v208, v205
  v_mul_f32 v209, v209, v205
  v_mul_f32 v210, v210, v205
  v_mul_f32 v211, v211, v205
  v_cvt_pk_bf16_f32 v66, v208, v209
  v_cvt_pk_bf16_f32 v67, v210, v211
  v_mfma_f32_32x32x16_bf16 v[236:251], a[196:199], v[40:43], v[236:251]
  v_mul_f32 v212, v212, v205
  v_mul_f32 v213, v213, v205
  v_mul_f32 v214, v214, v205
  v_mul_f32 v215, v215, v205
  v_mul_f32 v216, v216, v205
  v_mul_f32 v217, v217, v205
  v_mfma_f32_32x32x16_bf16 v[220:235], a[180:183], v[60:63], v[220:235]
  v_mul_f32 v218, v218, v205
  v_mul_f32 v219, v219, v205
  v_cvt_pk_bf16_f32 v68, v212, v213
  v_cvt_pk_bf16_f32 v69, v214, v215
  v_cvt_pk_bf16_f32 v70, v216, v217
  s_waitcnt lgkmcnt(1)
  v_mfma_f32_32x32x16_bf16 v[188:203], v[102:105], v[78:81], v[188:203]
  v_cvt_pk_bf16_f32 v71, v218, v219
  v_exp_f32 v173, v173
  v_exp_f32 v174, v174
  v_cvt_pk_bf16_f32 v172, v172, v173
  v_mfma_f32_32x32x16_bf16 v[236:251], a[200:203], v[44:47], v[236:251]
  v_exp_f32 v175, v175
  v_exp_f32 v176, v176
  v_exp_f32 v177, v177
  v_cvt_pk_bf16_f32 v173, v174, v175
  v_mfma_f32_32x32x8_bf16 v[188:203], v[106:107], v[82:83], v[188:203]
  v_exp_f32 v178, v178
  v_exp_f32 v179, v179
  v_cvt_pk_bf16_f32 v174, v176, v177
  v_cvt_pk_bf16_f32 v175, v178, v179
  v_max3_f32 v10, v10, v204, v205
  v_mov_b32 v3, s51
  v_mfma_f32_32x32x16_bf16 v[204:219], v[156:159], v[172:175], 0
  s_waitcnt lgkmcnt(0)
  buffer_store_dwordx4 v[252:255], v9, s[12:15], s38 offen offset:2048 sc1
  v_mfma_f32_32x32x16_bf16 v[220:235], a[184:187], v[64:67], v[220:235]
  ds_read_b128 v[252:255], v6 offset:9216
  ds_read_b128 v[172:175], v2 offset:896
  v_exp_f32 v180, v180
  v_exp_f32 v181, v181
  v_mfma_f32_32x32x16_bf16 v[236:251], a[204:207], v[60:63], v[236:251]
  v_exp_f32 v182, v182
  v_exp_f32 v183, v183
  v_exp_f32 v184, v184
  v_mfma_f32_32x32x16_bf16 v[220:235], a[188:191], v[68:71], v[220:235]
  v_exp_f32 v185, v185
  v_exp_f32 v186, v186
  v_exp_f32 v187, v187
  v_mfma_f32_32x32x16_bf16 v[236:251], a[208:211], v[64:67], v[236:251]
  v_cvt_pk_bf16_f32 v176, v180, v181
  v_cvt_pk_bf16_f32 v177, v182, v183
  v_cvt_pk_bf16_f32 v178, v184, v185
  v_cvt_pk_bf16_f32 v179, v186, v187
  v_cvt_pk_bf16_f32 v220, v220, v221
  v_cvt_pk_bf16_f32 v221, v222, v223
  v_mfma_f32_32x32x16_bf16 v[204:219], v[160:163], v[176:179], v[204:219]
  ds_read_b128 v[176:179], v2 offset:768
  ds_read_b128 v[180:183], v2 offset:640
  ds_read_b128 v[184:187], v2 offset:512
  v_cvt_pk_bf16_f32 v222, v224, v225
  v_cvt_pk_bf16_f32 v223, v226, v227
  v_cvt_pk_bf16_f32 v224, v228, v229
  v_mfma_f32_32x32x16_bf16 v[236:251], a[212:215], v[68:71], v[236:251]
  ds_write_b128 v4, v[220:223] offset:0
  v_cvt_pk_bf16_f32 v225, v230, v231
  v_cvt_pk_bf16_f32 v226, v232, v233
  v_cvt_pk_bf16_f32 v227, v234, v235
  v_exp_f32 v188, v188
  v_exp_f32 v189, v189
  v_exp_f32 v190, v190
  v_exp_f32 v191, v191
  v_cvt_pk_bf16_f32 v236, v236, v237
  v_cvt_pk_bf16_f32 v237, v238, v239
  v_cvt_pk_bf16_f32 v238, v240, v241
  v_cvt_pk_bf16_f32 v239, v242, v243
  v_cvt_pk_bf16_f32 v240, v244, v245
  v_cvt_pk_bf16_f32 v241, v246, v247
  v_cvt_pk_bf16_f32 v242, v248, v249
  v_cvt_pk_bf16_f32 v243, v250, v251
  v_exp_f32 v192, v192
  v_exp_f32 v193, v193
  s_waitcnt lgkmcnt(1)
  v_mfma_f32_32x32x16_bf16 v[172:187], v[84:87], v[12:15], v[172:187]
  ds_write_b128 v5, v[224:227] offset:0
  v_cvt_pk_bf16_f32 v188, v188, v189
  v_mfma_f32_32x32x16_bf16 v[220:235], a[216:219], v[36:39], 0
  ds_write_b128 v4, v[236:239] offset:64
  v_cvt_pk_bf16_f32 v189, v190, v191
  v_mfma_f32_32x32x16_bf16 v[220:235], a[220:223], v[40:43], v[220:235]
  buffer_store_dwordx4 v[252:255], v7, s[12:15], s39 offen offset:0 sc1
  v_cvt_pk_bf16_f32 v190, v192, v193
  v_cndmask_b32 v3, 0, v3, vcc
  v_mfma_f32_32x32x8_bf16 v[172:187], v[88:89], v[16:17], v[172:187]
  v_exp_f32 v194, v194
  v_exp_f32 v195, v195
  v_exp_f32 v196, v196
  v_cvt_pk_bf16_f32 v191, v194, v195
  v_add_u32 v3, v3, v2
  v_mfma_f32_32x32x16_bf16 v[220:235], a[224:227], v[44:47], v[220:235]
  ds_write_b128 v5, v[240:243] offset:64
  v_exp_f32 v197, v197
  v_mfma_f32_32x32x16_bf16 v[204:219], v[164:167], v[188:191], v[204:219]
  ds_read_b128 v[252:255], v6 offset:10240
  v_exp_f32 v198, v198
  v_exp_f32 v199, v199
  v_cvt_pk_bf16_f32 v192, v196, v197
  v_mfma_f32_32x32x16_bf16 v[236:251], a[168:171], v[48:51], 0
  ds_read_b128 v[188:191], v3 offset:384
  v_exp_f32 v200, v200
  v_exp_f32 v201, v201
  v_cvt_pk_bf16_f32 v193, v198, v199
  v_mfma_f32_32x32x16_bf16 v[236:251], a[172:175], v[52:55], v[236:251]
  ds_read_b128 v[196:199], v3 offset:128
  v_exp_f32 v202, v202
  v_exp_f32 v203, v203
  v_cvt_pk_bf16_f32 v194, v200, v201
  v_mfma_f32_32x32x16_bf16 v[220:235], a[228:231], v[60:63], v[220:235]
  v_cvt_pk_bf16_f32 v195, v202, v203
  v_exp_f32 v172, v172
  v_exp_f32 v173, v173
  v_mfma_f32_32x32x16_bf16 v[204:219], v[168:171], v[192:195], v[204:219]
  ds_read_b128 v[192:195], v3 offset:256
  ds_read_b128 v[200:203], v3 offset:0
  v_exp_f32 v174, v174
  v_exp_f32 v175, v175
  v_mfma_f32_32x32x16_bf16 v[236:251], a[176:179], v[56:59], v[236:251]
  v_exp_f32 v176, v176
  v_exp_f32 v177, v177
  v_rcp_f32 v205, v204
  v_mfma_f32_32x32x16_bf16 v[220:235], a[232:235], v[64:67], v[220:235]
  v_mul_f32 v208, v208, v205
  v_mul_f32 v209, v209, v205
  v_mul_f32 v210, v210, v205
  v_mul_f32 v211, v211, v205
  v_cvt_pk_bf16_f32 v78, v208, v209
  v_cvt_pk_bf16_f32 v79, v210, v211
  v_mfma_f32_32x32x16_bf16 v[236:251], a[180:183], v[72:75], v[236:251]
  s_waitcnt lgkmcnt(2)
  buffer_store_dwordx4 v[252:255], v8, s[12:15], s39 offen offset:1024 sc1
  v_mfma_f32_32x32x16_bf16 v[220:235], a[236:239], v[68:71], v[220:235]
  ds_read_b128 v[252:255], v6 offset:11264
  v_mul_f32 v212, v212, v205
  v_mul_f32 v213, v213, v205
  v_mul_f32 v214, v214, v205
  v_mul_f32 v215, v215, v205
  s_waitcnt lgkmcnt(1)
  v_mfma_f32_32x32x16_bf16 v[188:203], v[90:93], v[12:15], v[188:203]
  v_mul_f32 v216, v216, v205
  v_mul_f32 v217, v217, v205
  v_mul_f32 v218, v218, v205
  v_mul_f32 v219, v219, v205
  v_cvt_pk_bf16_f32 v80, v212, v213
  v_cvt_pk_bf16_f32 v81, v214, v215
  v_mfma_f32_32x32x16_bf16 v[236:251], a[184:187], v[76:79], v[236:251]
  v_cvt_pk_bf16_f32 v82, v216, v217
  v_cvt_pk_bf16_f32 v83, v218, v219
  v_cvt_pk_bf16_f32 v220, v220, v221
  v_cvt_pk_bf16_f32 v221, v222, v223
  v_cvt_pk_bf16_f32 v222, v224, v225
  v_cvt_pk_bf16_f32 v223, v226, v227
  v_cvt_pk_bf16_f32 v224, v228, v229
  v_mfma_f32_32x32x8_bf16 v[188:203], v[94:95], v[16:17], v[188:203]
  v_cvt_pk_bf16_f32 v225, v230, v231
  v_cvt_pk_bf16_f32 v226, v232, v233
  v_cvt_pk_bf16_f32 v227, v234, v235
  v_exp_f32 v178, v178
  v_exp_f32 v179, v179
  v_cvt_pk_bf16_f32 v172, v172, v173
  v_mfma_f32_32x32x16_bf16 v[236:251], a[188:191], v[80:83], v[236:251]
  ds_write_b128 v4, v[220:223] offset:128
  v_cvt_pk_bf16_f32 v173, v174, v175
  v_cvt_pk_bf16_f32 v174, v176, v177
  v_cvt_pk_bf16_f32 v175, v178, v179
  v_max3_f32 v10, v10, v204, v205
  v_exp_f32 v180, v180
  v_mfma_f32_32x32x16_bf16 v[204:219], v[108:111], v[172:175], 0
  ds_write_b128 v5, v[224:227] offset:128
  v_exp_f32 v181, v181
  v_mfma_f32_32x32x16_bf16 v[220:235], a[192:195], v[48:51], 0
  ds_read_b128 v[172:175], v3 offset:1408
  v_cvt_pk_bf16_f32 v236, v236, v237
  v_cvt_pk_bf16_f32 v237, v238, v239
  v_cvt_pk_bf16_f32 v238, v240, v241
  v_cvt_pk_bf16_f32 v239, v242, v243
  v_cvt_pk_bf16_f32 v240, v244, v245
  v_mfma_f32_32x32x16_bf16 v[220:235], a[196:199], v[52:55], v[220:235]
  ds_write_b128 v4, v[236:239] offset:6144
  v_cvt_pk_bf16_f32 v241, v246, v247
  v_mfma_f32_32x32x16_bf16 v[220:235], a[200:203], v[56:59], v[220:235]
  s_waitcnt lgkmcnt(3)
  buffer_store_dwordx4 v[252:255], v9, s[12:15], s39 offen offset:2048 sc1
  v_mfma_f32_32x32x16_bf16 v[220:235], a[204:207], v[72:75], v[220:235]
  ds_read_b128 v[252:255], v6 offset:0
  v_cvt_pk_bf16_f32 v242, v248, v249
  v_cvt_pk_bf16_f32 v243, v250, v251
  v_exp_f32 v182, v182
  v_cvt_pk_bf16_f32 v176, v180, v181
  v_mfma_f32_32x32x16_bf16 v[220:235], a[208:211], v[76:79], v[220:235]
  ds_write_b128 v5, v[240:243] offset:6144
  v_exp_f32 v183, v183
  v_mfma_f32_32x32x16_bf16 v[236:251], a[216:219], v[48:51], 0
  v_exp_f32 v184, v184
  v_exp_f32 v185, v185
  v_exp_f32 v186, v186
  v_mfma_f32_32x32x16_bf16 v[236:251], a[220:223], v[52:55], v[236:251]
  v_exp_f32 v187, v187
  v_cvt_pk_bf16_f32 v177, v182, v183
  v_cvt_pk_bf16_f32 v178, v184, v185
  v_cvt_pk_bf16_f32 v179, v186, v187
  v_mfma_f32_32x32x16_bf16 v[236:251], a[224:227], v[56:59], v[236:251]
  ds_read_b128 v[180:183], v3 offset:1152
  ds_read_b128 v[184:187], v3 offset:1024
  v_exp_f32 v188, v188
  v_exp_f32 v189, v189
  v_mfma_f32_32x32x16_bf16 v[204:219], v[112:115], v[176:179], v[204:219]
  ds_read_b128 v[176:179], v3 offset:1280
  v_exp_f32 v190, v190
  v_exp_f32 v191, v191
  v_cvt_pk_bf16_f32 v188, v188, v189
  v_mfma_f32_32x32x16_bf16 v[236:251], a[228:231], v[72:75], v[236:251]
  v_exp_f32 v192, v192
  v_exp_f32 v193, v193
  v_exp_f32 v194, v194
  v_mfma_f32_32x32x16_bf16 v[220:235], a[212:215], v[80:83], v[220:235]
  v_exp_f32 v195, v195
  v_cvt_pk_bf16_f32 v189, v190, v191
  v_cvt_pk_bf16_f32 v190, v192, v193
  v_cvt_pk_bf16_f32 v191, v194, v195
  v_mfma_f32_32x32x16_bf16 v[236:251], a[232:235], v[76:79], v[236:251]
  v_exp_f32 v196, v196
  v_exp_f32 v197, v197
  v_exp_f32 v198, v198
  v_mfma_f32_32x32x16_bf16 v[204:219], v[116:119], v[188:191], v[204:219]
  ds_read_b128 v[188:191], v2 offset:896
  v_cvt_pk_bf16_f32 v220, v220, v221
  v_cvt_pk_bf16_f32 v221, v222, v223
  v_cvt_pk_bf16_f32 v222, v224, v225
  v_cvt_pk_bf16_f32 v223, v226, v227
  s_waitcnt lgkmcnt(1)
  v_mfma_f32_32x32x16_bf16 v[172:187], v[84:87], v[24:27], v[172:187]
  ds_write_b128 v4, v[220:223] offset:6208
  v_cvt_pk_bf16_f32 v224, v228, v229
  v_mfma_f32_32x32x16_bf16 v[236:251], a[236:239], v[80:83], v[236:251]
  buffer_store_dwordx4 v[252:255], v7, s[12:15], s40 offen offset:0 sc1
  v_cvt_pk_bf16_f32 v225, v230, v231
  v_cvt_pk_bf16_f32 v226, v232, v233
  v_cvt_pk_bf16_f32 v227, v234, v235
  v_exp_f32 v199, v199
  v_mfma_f32_32x32x8_bf16 v[172:187], v[88:89], v[28:29], v[172:187]
  v_exp_f32 v200, v200
  v_exp_f32 v201, v201
  v_exp_f32 v202, v202
  v_cvt_pk_bf16_f32 v236, v236, v237
  v_cvt_pk_bf16_f32 v237, v238, v239
  v_cvt_pk_bf16_f32 v238, v240, v241
  v_cvt_pk_bf16_f32 v239, v242, v243
  v_cvt_pk_bf16_f32 v240, v244, v245
  v_cvt_pk_bf16_f32 v241, v246, v247
  v_cvt_pk_bf16_f32 v242, v248, v249
  v_cvt_pk_bf16_f32 v243, v250, v251
  v_exp_f32 v203, v203
  ds_read_b128 v[252:255], v6 offset:1024
  ds_write_b128 v5, v[224:227] offset:6208
  v_mfma_f32_32x32x16_bf16 v[220:235], a[96:99], a[0:3], 0
  v_cvt_pk_bf16_f32 v192, v196, v197
  v_cvt_pk_bf16_f32 v193, v198, v199
  v_cvt_pk_bf16_f32 v194, v200, v201
  v_cvt_pk_bf16_f32 v195, v202, v203
  v_exp_f32 v172, v172
  v_mfma_f32_32x32x16_bf16 v[204:219], v[120:123], v[192:195], v[204:219]
  ds_write_b128 v4, v[236:239] offset:6272
  v_exp_f32 v173, v173
  v_mfma_f32_32x32x16_bf16 v[220:235], a[100:103], a[4:7], v[220:235]
  ds_write_b128 v5, v[240:243] offset:6272
  v_cvt_pk_bf16_f32 v172, v172, v173
  v_mfma_f32_32x32x16_bf16 v[236:251], a[96:99], a[24:27], 0
  v_exp_f32 v174, v174
  v_exp_f32 v175, v175
  v_rcp_f32 v217, v216
  v_mfma_f32_32x32x16_bf16 v[236:251], a[100:103], a[28:31], v[236:251]
  ds_read_b128 v[192:195], v2 offset:768
  ds_read_b128 v[196:199], v2 offset:640
  v_exp_f32 v176, v176
  v_exp_f32 v177, v177
  v_mfma_f32_32x32x16_bf16 v[220:235], a[104:107], a[8:11], v[220:235]
  ds_read_b128 v[200:203], v2 offset:512
  v_exp_f32 v178, v178
  v_exp_f32 v179, v179
  v_cvt_pk_bf16_f32 v173, v174, v175
  v_mfma_f32_32x32x16_bf16 v[236:251], a[104:107], a[32:35], v[236:251]
  s_waitcnt lgkmcnt(4)
  buffer_store_dwordx4 v[252:255], v8, s[12:15], s40 offen offset:1024 sc1
  v_mfma_f32_32x32x16_bf16 v[220:235], a[108:111], a[12:15], v[220:235]
  ds_read_b128 v[252:255], v6 offset:2048
  v_mul_f32 v204, v204, v217
  v_mul_f32 v205, v205, v217
  v_mul_f32 v206, v206, v217
  v_mul_f32 v207, v207, v217
  v_mul_f32 v208, v208, v217
  v_mfma_f32_32x32x16_bf16 v[236:251], a[108:111], a[36:39], v[236:251]
  v_mul_f32 v209, v209, v217
  v_mul_f32 v210, v210, v217
  v_mul_f32 v211, v211, v217
  v_mul_f32 v212, v212, v217
  v_mul_f32 v213, v213, v217
  v_mul_f32 v214, v214, v217
  v_mfma_f32_32x32x16_bf16 v[220:235], a[112:115], a[16:19], v[220:235]
  v_mul_f32 v215, v215, v217
  v_cvt_pk_bf16_f32 v174, v176, v177
  v_cvt_pk_bf16_f32 v175, v178, v179
  v_max3_f32 v10, v10, v216, v217
  v_cvt_pk_bf16_f32 v12, v204, v205
  s_waitcnt lgkmcnt(1)
  v_mfma_f32_32x32x16_bf16 v[188:203], v[90:93], v[24:27], v[188:203]
  v_cvt_pk_bf16_f32 v13, v206, v207
  v_cvt_pk_bf16_f32 v14, v208, v209
  v_cvt_pk_bf16_f32 v15, v210, v211
  v_cvt_pk_bf16_f32 v16, v212, v213
  v_cvt_pk_bf16_f32 v17, v214, v215
  v_mfma_f32_32x32x16_bf16 v[204:219], v[108:111], v[172:175], 0
  ds_read_b128 v[172:175], v2 offset:4736
  v_exp_f32 v180, v180
  v_exp_f32 v181, v181
  v_exp_f32 v182, v182
  v_mfma_f32_32x32x8_bf16 v[188:203], v[94:95], v[28:29], v[188:203]
  v_exp_f32 v183, v183
  v_exp_f32 v184, v184
  v_exp_f32 v185, v185
  v_exp_f32 v186, v186
  v_mfma_f32_32x32x16_bf16 v[236:251], a[112:115], a[40:43], v[236:251]
  v_exp_f32 v187, v187
  v_cvt_pk_bf16_f32 v176, v180, v181
  v_cvt_pk_bf16_f32 v177, v182, v183
  v_cvt_pk_bf16_f32 v178, v184, v185
  v_cvt_pk_bf16_f32 v179, v186, v187
  v_mfma_f32_32x32x16_bf16 v[220:235], a[116:119], a[20:23], v[220:235]
  ds_read_b128 v[180:183], v2 offset:4480
  ds_read_b128 v[184:187], v2 offset:4352
  v_exp_f32 v188, v188
  v_exp_f32 v189, v189
  v_mfma_f32_32x32x16_bf16 v[204:219], v[112:115], v[176:179], v[204:219]
  ds_read_b128 v[176:179], v2 offset:4608
  v_exp_f32 v190, v190
  v_exp_f32 v191, v191
  v_cvt_pk_bf16_f32 v22, v220, v221
  v_mfma_f32_32x32x16_bf16 v[236:251], a[116:119], a[44:47], v[236:251]
  v_cvt_pk_bf16_f32 v23, v222, v223
  v_cvt_pk_bf16_f32 v96, v224, v225
  v_cvt_pk_bf16_f32 v97, v226, v227
  v_cvt_pk_bf16_f32 v98, v228, v229
  v_cvt_pk_bf16_f32 v99, v230, v231
  v_cvt_pk_bf16_f32 v100, v232, v233
  v_mfma_f32_32x32x16_bf16 v[60:75], a[216:219], v[12:15], 0
  s_waitcnt lgkmcnt(3)
  buffer_store_dwordx4 v[252:255], v9, s[12:15], s40 offen offset:2048 sc1
  v_cvt_pk_bf16_f32 v101, v234, v235
  v_mfma_f32_32x32x16_bf16 v[220:235], a[0:3], a[248:251], 0
  ds_read_b128 v[252:255], v6 offset:3072
  v_cvt_pk_bf16_f32 v34, v236, v237
  v_cvt_pk_bf16_f32 v35, v238, v239
  v_cvt_pk_bf16_f32 v102, v240, v241
  v_cvt_pk_bf16_f32 v103, v242, v243
  v_cvt_pk_bf16_f32 v104, v244, v245
  v_mfma_f32_32x32x16_bf16 v[220:235], a[4:7], a[252:255], v[220:235]
  v_cvt_pk_bf16_f32 v105, v246, v247
  v_cvt_pk_bf16_f32 v106, v248, v249
  v_cvt_pk_bf16_f32 v107, v250, v251
  v_exp_f32 v192, v192
  s_waitcnt lgkmcnt(1)
  v_mfma_f32_32x32x16_bf16 v[172:187], v[96:99], v[18:21], v[172:187]
  v_exp_f32 v193, v193
  v_exp_f32 v194, v194
  v_exp_f32 v195, v195
  v_mfma_f32_32x32x16_bf16 v[236:251], a[24:27], a[248:251], 0
  ds_read_b64_tr_b16 a[248:249], v0 offset:16384
  ds_read_b64_tr_b16 a[250:251], v0 offset:16640
  v_cvt_pk_bf16_f32 v188, v188, v189
  v_cvt_pk_bf16_f32 v189, v190, v191
  v_cvt_pk_bf16_f32 v190, v192, v193
  v_cvt_pk_bf16_f32 v191, v194, v195
  v_mfma_f32_32x32x8_bf16 v[172:187], v[100:101], v[22:23], v[172:187]
  v_exp_f32 v196, v196
  v_exp_f32 v197, v197
  v_exp_f32 v198, v198
  v_exp_f32 v199, v199
  v_mfma_f32_32x32x16_bf16 v[204:219], v[116:119], v[188:191], v[204:219]
  ds_read_b128 v[188:191], v3 offset:4224
  v_exp_f32 v200, v200
  v_exp_f32 v201, v201
  v_cvt_pk_bf16_f32 v192, v196, v197
  v_mfma_f32_32x32x16_bf16 v[236:251], a[28:31], a[252:255], v[236:251]
  ds_read_b64_tr_b16 a[252:253], v0 offset:17408
  ds_read_b64_tr_b16 a[254:255], v0 offset:17664
  v_exp_f32 v202, v202
  v_exp_f32 v203, v203
  v_mfma_f32_32x32x16_bf16 v[220:235], a[8:11], a[240:243], v[220:235]
  v_cvt_pk_bf16_f32 v193, v198, v199
  v_cvt_pk_bf16_f32 v194, v200, v201
  v_cvt_pk_bf16_f32 v195, v202, v203
  v_exp_f32 v172, v172
  v_mfma_f32_32x32x16_bf16 v[204:219], v[120:123], v[192:195], v[204:219]
  ds_read_b128 v[192:195], v3 offset:4096
  ds_read_b128 v[196:199], v3 offset:3968
  ds_read_b128 v[200:203], v3 offset:3840
  v_exp_f32 v173, v173
  v_mfma_f32_32x32x16_bf16 v[236:251], a[32:35], a[240:243], v[236:251]
  ds_read_b64_tr_b16 a[240:241], v0 offset:18432
  ds_read_b64_tr_b16 a[242:243], v0 offset:18688
  v_exp_f32 v174, v174
  v_exp_f32 v175, v175
  v_mfma_f32_32x32x16_bf16 v[220:235], a[12:15], a[244:247], v[220:235]
  s_waitcnt lgkmcnt(7)
  buffer_store_dwordx4 v[252:255], v7, s[12:15], s41 offen offset:0 sc1
  v_mfma_f32_32x32x16_bf16 v[236:251], a[36:39], a[244:247], v[236:251]
  ds_read_b64_tr_b16 a[244:245], v0 offset:19456
  ds_read_b64_tr_b16 a[246:247], v0 offset:19712
  ds_read_b128 v[252:255], v6 offset:4096
  v_rcp_f32 v217, v216
  v_cvt_pk_bf16_f32 v172, v172, v173
  v_mfma_f32_32x32x16_bf16 v[220:235], a[16:19], a[248:251], v[220:235]
  v_exp_f32 v176, v176
  v_exp_f32 v177, v177
  v_cvt_pk_bf16_f32 v173, v174, v175
  s_waitcnt lgkmcnt(5)
  v_mfma_f32_32x32x16_bf16 v[188:203], v[102:105], v[18:21], v[188:203]
  v_exp_f32 v178, v178
  v_exp_f32 v179, v179
  v_mul_f32 v204, v204, v217
  v_mul_f32 v205, v205, v217
  v_mfma_f32_32x32x16_bf16 v[236:251], a[40:43], a[248:251], v[236:251]
  ds_read_b64_tr_b16 a[248:249], v0 offset:20480
  ds_read_b64_tr_b16 a[250:251], v0 offset:20736
  v_mul_f32 v206, v206, v217
  v_mul_f32 v207, v207, v217
  v_mul_f32 v208, v208, v217
  v_mul_f32 v209, v209, v217
  v_mul_f32 v210, v210, v217
  v_mfma_f32_32x32x8_bf16 v[188:203], v[106:107], v[22:23], v[188:203]
  v_mul_f32 v211, v211, v217
  v_mul_f32 v212, v212, v217
  v_mul_f32 v213, v213, v217
  v_mul_f32 v214, v214, v217
  v_mul_f32 v215, v215, v217
  v_cvt_pk_bf16_f32 v174, v176, v177
  v_cvt_pk_bf16_f32 v175, v178, v179
  v_max3_f32 v10, v10, v216, v217
  v_mfma_f32_32x32x16_bf16 v[220:235], a[20:23], a[252:255], v[220:235]
  v_cvt_pk_bf16_f32 v24, v204, v205
  v_cvt_pk_bf16_f32 v25, v206, v207
  v_cvt_pk_bf16_f32 v26, v208, v209
  v_cvt_pk_bf16_f32 v27, v210, v211
  v_cvt_pk_bf16_f32 v28, v212, v213
  v_cvt_pk_bf16_f32 v29, v214, v215
  v_mfma_f32_32x32x16_bf16 v[236:251], a[44:47], a[252:255], v[236:251]
  ds_read_b64_tr_b16 a[252:253], v0 offset:21504
  ds_read_b64_tr_b16 a[254:255], v0 offset:21760
  v_exp_f32 v180, v180
  s_mov_b64 exec, s[62:63]
  v_cvt_pk_bf16_f32 v124, v220, v221
  v_cvt_pk_bf16_f32 v125, v222, v223
  v_cvt_pk_bf16_f32 v126, v224, v225
  v_cvt_pk_bf16_f32 v127, v226, v227
  v_cvt_pk_bf16_f32 v128, v228, v229
  v_cvt_pk_bf16_f32 v129, v230, v231
  v_mfma_f32_32x32x16_bf16 v[204:219], v[124:127], v[172:175], 0
  v_cvt_pk_bf16_f32 v130, v232, v233
  v_cvt_pk_bf16_f32 v131, v234, v235
  s_mov_b64 exec, -1
  s_mov_b64 exec, s[64:65]
  v_cvt_pk_bf16_f32 v140, v220, v221
  v_cvt_pk_bf16_f32 v141, v222, v223
  v_cvt_pk_bf16_f32 v142, v224, v225
  v_cvt_pk_bf16_f32 v143, v226, v227
  v_cvt_pk_bf16_f32 v144, v228, v229
  v_cvt_pk_bf16_f32 v145, v230, v231
  v_cvt_pk_bf16_f32 v146, v232, v233
  v_cvt_pk_bf16_f32 v147, v234, v235
  v_mfma_f32_32x32x16_bf16 v[220:235], a[120:123], a[0:3], 0
  s_mov_b64 exec, -1
  ds_read_b128 v[172:175], v3 offset:5248
  s_mov_b64 exec, s[62:63]
  v_cvt_pk_bf16_f32 v132, v236, v237
  v_cvt_pk_bf16_f32 v133, v238, v239
  v_cvt_pk_bf16_f32 v134, v240, v241
  v_mfma_f32_32x32x16_bf16 v[220:235], a[124:127], a[4:7], v[220:235]
  v_cvt_pk_bf16_f32 v135, v242, v243
  v_cvt_pk_bf16_f32 v136, v244, v245
  v_cvt_pk_bf16_f32 v137, v246, v247
  v_cvt_pk_bf16_f32 v138, v248, v249
  v_cvt_pk_bf16_f32 v139, v250, v251
  s_mov_b64 exec, -1
  v_mfma_f32_32x32x16_bf16 v[220:235], a[128:131], a[8:11], v[220:235]
  s_waitcnt lgkmcnt(1)
  buffer_store_dwordx4 v[252:255], v8, s[12:15], s41 offen offset:1024 sc1
  v_mfma_f32_32x32x16_bf16 v[220:235], a[132:135], a[12:15], v[220:235]
  ds_read_b128 v[252:255], v6 offset:5120
  s_mov_b64 exec, s[64:65]
  v_cvt_pk_bf16_f32 v148, v236, v237
  v_cvt_pk_bf16_f32 v149, v238, v239
  v_cvt_pk_bf16_f32 v150, v240, v241
  v_cvt_pk_bf16_f32 v151, v242, v243
  v_mfma_f32_32x32x16_bf16 v[220:235], a[136:139], a[16:19], v[220:235]
  v_cvt_pk_bf16_f32 v152, v244, v245
  v_cvt_pk_bf16_f32 v153, v246, v247
  v_cvt_pk_bf16_f32 v154, v248, v249
  v_cvt_pk_bf16_f32 v155, v250, v251
  s_mov_b64 exec, -1
  v_mfma_f32_32x32x16_bf16 v[236:251], a[120:123], a[24:27], 0
  v_exp_f32 v181, v181
  v_exp_f32 v182, v182
  v_exp_f32 v183, v183
  v_mfma_f32_32x32x16_bf16 v[236:251], a[124:127], a[28:31], v[236:251]
  v_exp_f32 v184, v184
  v_exp_f32 v185, v185
  v_exp_f32 v186, v186
  v_mfma_f32_32x32x16_bf16 v[236:251], a[128:131], a[32:35], v[236:251]
  v_exp_f32 v187, v187
  v_cvt_pk_bf16_f32 v176, v180, v181
  v_cvt_pk_bf16_f32 v177, v182, v183
  v_cvt_pk_bf16_f32 v178, v184, v185
  v_cvt_pk_bf16_f32 v179, v186, v187
  v_mfma_f32_32x32x16_bf16 v[236:251], a[132:135], a[36:39], v[236:251]
  ds_read_b128 v[180:183], v3 offset:4992
  ds_read_b128 v[184:187], v3 offset:4864
  v_exp_f32 v188, v188
  v_exp_f32 v189, v189
  v_mfma_f32_32x32x16_bf16 v[204:219], v[128:131], v[176:179], v[204:219]
  ds_read_b128 v[176:179], v3 offset:5120
  v_exp_f32 v190, v190
  v_exp_f32 v191, v191
  v_cvt_pk_bf16_f32 v188, v188, v189
  v_mfma_f32_32x32x16_bf16 v[236:251], a[136:139], a[40:43], v[236:251]
  v_exp_f32 v192, v192
  v_exp_f32 v193, v193
  v_exp_f32 v194, v194
  v_mfma_f32_32x32x16_bf16 v[220:235], a[140:143], a[20:23], v[220:235]
  v_exp_f32 v195, v195
  v_cvt_pk_bf16_f32 v189, v190, v191
  v_cvt_pk_bf16_f32 v190, v192, v193
  v_cvt_pk_bf16_f32 v191, v194, v195
  v_mfma_f32_32x32x16_bf16 v[236:251], a[140:143], a[44:47], v[236:251]
  v_exp_f32 v196, v196
  v_exp_f32 v197, v197
  v_exp_f32 v198, v198
  v_mfma_f32_32x32x16_bf16 v[204:219], v[132:135], v[188:191], v[204:219]
  ds_read_b128 v[188:191], v2 offset:4736
  v_cvt_pk_bf16_f32 v36, v220, v221
  v_cvt_pk_bf16_f32 v37, v222, v223
  v_cvt_pk_bf16_f32 v38, v224, v225
  v_cvt_pk_bf16_f32 v39, v226, v227
  s_waitcnt lgkmcnt(1)
  v_mfma_f32_32x32x16_bf16 v[172:187], v[96:99], v[30:33], v[172:187]
  buffer_store_dwordx4 v[252:255], v9, s[12:15], s41 offen offset:2048 sc1
  v_cvt_pk_bf16_f32 v40, v228, v229
  v_cvt_pk_bf16_f32 v41, v230, v231
  v_cvt_pk_bf16_f32 v84, v232, v233
  v_cvt_pk_bf16_f32 v85, v234, v235
  v_mfma_f32_32x32x16_bf16 v[220:235], a[144:147], a[0:3], 0
  ds_read_b128 v[252:255], v6 offset:6144
  v_cvt_pk_bf16_f32 v48, v236, v237
  v_cvt_pk_bf16_f32 v49, v238, v239
  v_cvt_pk_bf16_f32 v50, v240, v241
  v_cvt_pk_bf16_f32 v51, v242, v243
  v_cvt_pk_bf16_f32 v52, v244, v245
  v_cvt_pk_bf16_f32 v53, v246, v247
  v_mfma_f32_32x32x8_bf16 v[172:187], v[100:101], v[34:35], v[172:187]
  v_cvt_pk_bf16_f32 v90, v248, v249
  v_cvt_pk_bf16_f32 v91, v250, v251
  v_exp_f32 v199, v199
  v_exp_f32 v200, v200
  v_exp_f32 v201, v201
  v_mfma_f32_32x32x16_bf16 v[236:251], a[144:147], a[24:27], 0
  v_exp_f32 v202, v202
  v_exp_f32 v203, v203
  v_cvt_pk_bf16_f32 v192, v196, v197
  v_cvt_pk_bf16_f32 v193, v198, v199
  v_mfma_f32_32x32x16_bf16 v[220:235], a[148:151], a[4:7], v[220:235]
  ds_read_b128 v[196:199], v2 offset:4480
  v_cvt_pk_bf16_f32 v194, v200, v201
  v_cvt_pk_bf16_f32 v195, v202, v203
  v_exp_f32 v172, v172
  v_mfma_f32_32x32x16_bf16 v[204:219], v[136:139], v[192:195], v[204:219]
  ds_read_b128 v[192:195], v2 offset:4608
  ds_read_b128 v[200:203], v2 offset:4352
  v_exp_f32 v173, v173
  v_exp_f32 v174, v174
  v_mfma_f32_32x32x16_bf16 v[236:251], a[148:151], a[28:31], v[236:251]
  v_exp_f32 v175, v175
  v_exp_f32 v176, v176
  v_rcp_f32 v213, v212
  v_mfma_f32_32x32x16_bf16 v[220:235], a[152:155], a[8:11], v[220:235]
  v_exp_f32 v177, v177
  v_exp_f32 v178, v178
  v_exp_f32 v179, v179
  v_mfma_f32_32x32x16_bf16 v[236:251], a[152:155], a[32:35], v[236:251]
  v_cvt_pk_bf16_f32 v172, v172, v173
  v_cvt_pk_bf16_f32 v173, v174, v175
  v_mul_f32 v216, v216, v213
  v_mul_f32 v217, v217, v213
  v_mul_f32 v218, v218, v213
  v_mul_f32 v219, v219, v213
  v_mfma_f32_32x32x16_bf16 v[220:235], a[156:159], a[12:15], v[220:235]
  v_mul_f32 v204, v204, v213
  v_mul_f32 v205, v205, v213
  v_mul_f32 v206, v206, v213
  v_mul_f32 v207, v207, v213
  v_mul_f32 v208, v208, v213
  s_waitcnt lgkmcnt(0)
  v_mfma_f32_32x32x16_bf16 v[188:203], v[102:105], v[30:33], v[188:203]
  buffer_store_dwordx4 v[252:255], v7, s[12:15], s42 offen offset:0 sc1
  v_mul_f32 v209, v209, v213
  v_mfma_f32_32x32x16_bf16 v[236:251], a[156:159], a[36:39], v[236:251]
  ds_read_b128 v[252:255], v6 offset:7168
  v_mul_f32 v210, v210, v213
  v_mul_f32 v211, v211, v213
  v_cvt_pk_bf16_f32 v174, v176, v177
  v_cvt_pk_bf16_f32 v175, v178, v179
  v_max3_f32 v10, v10, v212, v213
  v_cvt_pk_bf16_f32 v18, v216, v217
  v_mfma_f32_32x32x8_bf16 v[188:203], v[106:107], v[34:35], v[188:203]
  v_cvt_pk_bf16_f32 v19, v218, v219
  v_cvt_pk_bf16_f32 v20, v204, v205
  v_cvt_pk_bf16_f32 v21, v206, v207
  v_cvt_pk_bf16_f32 v22, v208, v209
  v_cvt_pk_bf16_f32 v23, v210, v211
  v_exp_f32 v180, v180
  v_mfma_f32_32x32x16_bf16 v[204:219], v[124:127], v[172:175], 0
  ds_read_b128 v[172:175], v2 offset:8576
  v_exp_f32 v181, v181
  v_exp_f32 v182, v182
  v_cvt_pk_bf16_f32 v176, v180, v181
  v_mfma_f32_32x32x16_bf16 v[220:235], a[160:163], a[16:19], v[220:235]
  v_exp_f32 v183, v183
  v_exp_f32 v184, v184
  v_exp_f32 v185, v185
  v_mfma_f32_32x32x16_bf16 v[236:251], a[160:163], a[40:43], v[236:251]
  v_exp_f32 v186, v186
  v_exp_f32 v187, v187
  v_cvt_pk_bf16_f32 v177, v182, v183
  v_cvt_pk_bf16_f32 v178, v184, v185
  v_mfma_f32_32x32x16_bf16 v[220:235], a[164:167], a[20:23], v[220:235]
  ds_read_b128 v[180:183], v2 offset:8320
  v_cvt_pk_bf16_f32 v179, v186, v187
  v_exp_f32 v188, v188
  v_exp_f32 v189, v189
  v_mfma_f32_32x32x16_bf16 v[204:219], v[128:131], v[176:179], v[204:219]
  ds_read_b128 v[176:179], v2 offset:8448
  ds_read_b128 v[184:187], v2 offset:8192
  v_exp_f32 v190, v190
  v_cvt_pk_bf16_f32 v86, v220, v221
  v_cvt_pk_bf16_f32 v87, v222, v223
  v_mfma_f32_32x32x16_bf16 v[236:251], a[164:167], a[44:47], v[236:251]
  v_cvt_pk_bf16_f32 v88, v224, v225
  v_cvt_pk_bf16_f32 v89, v226, v227
  v_cvt_pk_bf16_f32 v42, v228, v229
  v_cvt_pk_bf16_f32 v43, v230, v231
  v_cvt_pk_bf16_f32 v44, v232, v233
  v_cvt_pk_bf16_f32 v45, v234, v235
  v_mfma_f32_32x32x16_bf16 v[220:235], a[0:3], a[240:243], 0
  v_exp_f32 v191, v191
  v_exp_f32 v192, v192
  v_cvt_pk_bf16_f32 v92, v236, v237
  v_cvt_pk_bf16_f32 v93, v238, v239
  v_mfma_f32_32x32x16_bf16 v[220:235], a[4:7], a[244:247], v[220:235]
  v_cvt_pk_bf16_f32 v94, v240, v241
  v_cvt_pk_bf16_f32 v95, v242, v243
  v_cvt_pk_bf16_f32 v54, v244, v245
  v_cvt_pk_bf16_f32 v55, v246, v247
  v_cvt_pk_bf16_f32 v56, v248, v249
  v_cvt_pk_bf16_f32 v57, v250, v251
  v_mfma_f32_32x32x16_bf16 v[236:251], a[24:27], a[240:243], 0
  ds_read_b64_tr_b16 a[240:241], v0 offset:22528
  ds_read_b64_tr_b16 a[242:243], v0 offset:22784
  v_exp_f32 v193, v193
  v_cvt_pk_bf16_f32 v188, v188, v189
  s_waitcnt lgkmcnt(2)
  v_mfma_f32_32x32x16_bf16 v[172:187], v[84:87], v[36:39], v[172:187]
  buffer_store_dwordx4 v[252:255], v8, s[12:15], s42 offen offset:1024 sc1
  v_cvt_pk_bf16_f32 v189, v190, v191
  v_mfma_f32_32x32x16_bf16 v[236:251], a[28:31], a[244:247], v[236:251]
  ds_read_b64_tr_b16 a[244:245], v0 offset:23552
  ds_read_b64_tr_b16 a[246:247], v0 offset:23808
  ds_read_b128 v[252:255], v6 offset:8192
  v_exp_f32 v194, v194
  v_cvt_pk_bf16_f32 v190, v192, v193
  v_mfma_f32_32x32x8_bf16 v[172:187], v[88:89], v[40:41], v[172:187]
  v_exp_f32 v195, v195
  v_exp_f32 v196, v196
  v_cvt_pk_bf16_f32 v191, v194, v195
  v_exp_f32 v197, v197
  v_mfma_f32_32x32x16_bf16 v[204:219], v[132:135], v[188:191], v[204:219]
  ds_read_b128 v[188:191], v3 offset:8064
  v_exp_f32 v198, v198
  v_exp_f32 v199, v199
  v_cvt_pk_bf16_f32 v192, v196, v197
  v_mfma_f32_32x32x16_bf16 v[220:235], a[8:11], a[248:251], v[220:235]
  v_exp_f32 v200, v200
  v_exp_f32 v201, v201
  v_exp_f32 v202, v202
  v_mfma_f32_32x32x16_bf16 v[236:251], a[32:35], a[248:251], v[236:251]
  ds_read_b64_tr_b16 a[248:249], v0 offset:0
  ds_read_b64_tr_b16 a[250:251], v0 offset:256
  v_exp_f32 v203, v203
  v_cvt_pk_bf16_f32 v193, v198, v199
  v_cvt_pk_bf16_f32 v194, v200, v201
  v_mfma_f32_32x32x16_bf16 v[220:235], a[12:15], a[252:255], v[220:235]
  ds_read_b128 v[196:199], v3 offset:7808
  v_cvt_pk_bf16_f32 v195, v202, v203
  v_exp_f32 v172, v172
  v_exp_f32 v173, v173
  v_mfma_f32_32x32x16_bf16 v[204:219], v[136:139], v[192:195], v[204:219]
  ds_read_b128 v[192:195], v3 offset:7936
  ds_read_b128 v[200:203], v3 offset:7680
  v_exp_f32 v174, v174
  v_exp_f32 v175, v175
  v_mfma_f32_32x32x16_bf16 v[236:251], a[36:39], a[252:255], v[236:251]
  ds_read_b64_tr_b16 a[252:253], v0 offset:1024
  ds_read_b64_tr_b16 a[254:255], v0 offset:1280
  v_exp_f32 v176, v176
  v_cvt_pk_bf16_f32 v172, v172, v173
  s_waitcnt lgkmcnt(7)
  v_mfma_f32_32x32x16_bf16 v[220:235], a[16:19], a[240:243], v[220:235]
  v_rcp_f32 v213, v212
  v_exp_f32 v177, v177
  v_exp_f32 v178, v178
  v_mfma_f32_32x32x16_bf16 v[236:251], a[40:43], a[240:243], v[236:251]
  ds_read_b64_tr_b16 a[240:241], v0 offset:2048
  ds_read_b64_tr_b16 a[242:243], v0 offset:2304
  v_exp_f32 v179, v179
  v_cvt_pk_bf16_f32 v173, v174, v175
  v_mul_f32 v216, v216, v213
  v_mfma_f32_32x32x16_bf16 v[220:235], a[20:23], a[244:247], v[220:235]
  buffer_store_dwordx4 v[252:255], v9, s[12:15], s42 offen offset:2048 sc1
  s_waitcnt lgkmcnt(4)
  v_mfma_f32_32x32x16_bf16 v[188:203], v[90:93], v[36:39], v[188:203]
  ds_read_b128 v[252:255], v6 offset:9216
  v_mul_f32 v217, v217, v213
  v_mul_f32 v218, v218, v213
  v_mul_f32 v219, v219, v213
  v_mul_f32 v204, v204, v213
  v_mul_f32 v205, v205, v213
  v_mfma_f32_32x32x16_bf16 v[236:251], a[44:47], a[244:247], v[236:251]
  ds_read_b64_tr_b16 a[244:245], v0 offset:3072
  ds_read_b64_tr_b16 a[246:247], v0 offset:3328
  s_mov_b64 exec, s[66:67]
  v_cvt_pk_bf16_f32 v140, v220, v221
  v_cvt_pk_bf16_f32 v141, v222, v223
  v_cvt_pk_bf16_f32 v142, v224, v225
  v_mfma_f32_32x32x16_bf16 v[60:75], a[220:223], v[16:19], v[60:75]
  v_cvt_pk_bf16_f32 v143, v226, v227
  v_cvt_pk_bf16_f32 v144, v228, v229
  v_cvt_pk_bf16_f32 v145, v230, v231
  v_cvt_pk_bf16_f32 v146, v232, v233
  v_cvt_pk_bf16_f32 v147, v234, v235
  s_mov_b64 exec, -1
  s_mov_b64 exec, s[68:69]
  v_mfma_f32_32x32x16_bf16 v[60:75], a[224:227], v[20:23], v[60:75]
  v_cvt_pk_bf16_f32 v156, v220, v221
  v_cvt_pk_bf16_f32 v157, v222, v223
  v_cvt_pk_bf16_f32 v158, v224, v225
  v_cvt_pk_bf16_f32 v159, v226, v227
  v_cvt_pk_bf16_f32 v160, v228, v229
  v_cvt_pk_bf16_f32 v161, v230, v231
  v_cvt_pk_bf16_f32 v162, v232, v233
  v_cvt_pk_bf16_f32 v163, v234, v235
  v_mfma_f32_32x32x16_bf16 v[220:235], a[248:251], a[0:3], 0
  s_mov_b64 exec, -1
  s_mov_b64 exec, s[66:67]
  v_cvt_pk_bf16_f32 v148, v236, v237
  v_cvt_pk_bf16_f32 v149, v238, v239
  v_cvt_pk_bf16_f32 v150, v240, v241
  s_waitcnt lgkmcnt(2)
  v_mfma_f32_32x32x16_bf16 v[220:235], a[252:255], a[4:7], v[220:235]
  v_cvt_pk_bf16_f32 v151, v242, v243
  v_cvt_pk_bf16_f32 v152, v244, v245
  v_cvt_pk_bf16_f32 v153, v246, v247
  v_cvt_pk_bf16_f32 v154, v248, v249
  v_cvt_pk_bf16_f32 v155, v250, v251
  s_mov_b64 exec, -1
  s_mov_b64 exec, s[68:69]
  v_mfma_f32_32x32x16_bf16 v[220:235], a[240:243], a[8:11], v[220:235]
  v_cvt_pk_bf16_f32 v164, v236, v237
  v_cvt_pk_bf16_f32 v165, v238, v239
  v_cvt_pk_bf16_f32 v166, v240, v241
  v_cvt_pk_bf16_f32 v167, v242, v243
  v_cvt_pk_bf16_f32 v168, v244, v245
  s_waitcnt lgkmcnt(0)
  v_mfma_f32_32x32x16_bf16 v[220:235], a[244:247], a[12:15], v[220:235]
  v_cvt_pk_bf16_f32 v169, v246, v247
  v_cvt_pk_bf16_f32 v170, v248, v249
  v_cvt_pk_bf16_f32 v171, v250, v251
  s_mov_b64 exec, -1
  v_mul_f32 v206, v206, v213
  v_mul_f32 v207, v207, v213
  v_mul_f32 v208, v208, v213
  v_mfma_f32_32x32x8_bf16 v[188:203], v[94:95], v[40:41], v[188:203]
  v_mul_f32 v209, v209, v213
  v_mul_f32 v210, v210, v213
  v_mul_f32 v211, v211, v213
  v_cvt_pk_bf16_f32 v174, v176, v177
  v_cvt_pk_bf16_f32 v175, v178, v179
  v_max3_f32 v10, v10, v212, v213
  v_cvt_pk_bf16_f32 v30, v216, v217
  v_cvt_pk_bf16_f32 v31, v218, v219
  v_mfma_f32_32x32x16_bf16 v[236:251], a[248:251], a[24:27], 0
  ds_read_b64_tr_b16 a[248:249], v0 offset:4096
  ds_read_b64_tr_b16 a[250:251], v0 offset:4352
  v_cvt_pk_bf16_f32 v32, v204, v205
  v_cvt_pk_bf16_f32 v33, v206, v207
  v_cvt_pk_bf16_f32 v34, v208, v209
  v_cvt_pk_bf16_f32 v35, v210, v211
  v_mfma_f32_32x32x16_bf16 v[204:219], v[140:143], v[172:175], 0
  ds_read_b128 v[172:175], v2 offset:12416
  buffer_store_dwordx4 v[252:255], v7, s[12:15], s43 offen offset:0 sc1
  v_mfma_f32_32x32x16_bf16 v[236:251], a[252:255], a[28:31], v[236:251]
  ds_read_b64_tr_b16 a[252:253], v0 offset:5120
  ds_read_b64_tr_b16 a[254:255], v0 offset:5376
  ds_read_b128 v[252:255], v6 offset:10240
  v_exp_f32 v180, v180
  v_mfma_f32_32x32x16_bf16 v[236:251], a[240:243], a[32:35], v[236:251]
  v_exp_f32 v181, v181
  v_exp_f32 v182, v182
  v_exp_f32 v183, v183
  v_mfma_f32_32x32x16_bf16 v[236:251], a[244:247], a[36:39], v[236:251]
  v_exp_f32 v184, v184
  v_exp_f32 v185, v185
  v_cvt_pk_bf16_f32 v176, v180, v181
  s_waitcnt lgkmcnt(4)
  v_mfma_f32_32x32x16_bf16 v[220:235], a[248:251], a[16:19], v[220:235]
  v_exp_f32 v186, v186
  v_exp_f32 v187, v187
  v_cvt_pk_bf16_f32 v177, v182, v183
  v_cvt_pk_bf16_f32 v178, v184, v185
  v_mfma_f32_32x32x16_bf16 v[236:251], a[248:251], a[40:43], v[236:251]
  ds_read_b128 v[180:183], v2 offset:12160
  v_cvt_pk_bf16_f32 v179, v186, v187
  v_exp_f32 v188, v188
  v_exp_f32 v189, v189
  v_mfma_f32_32x32x16_bf16 v[204:219], v[144:147], v[176:179], v[204:219]
  ds_read_b128 v[176:179], v2 offset:12288
  ds_read_b128 v[184:187], v2 offset:12032
  v_exp_f32 v190, v190
  v_cvt_pk_bf16_f32 v188, v188, v189
  s_waitcnt lgkmcnt(3)
  v_mfma_f32_32x32x16_bf16 v[220:235], a[252:255], a[20:23], v[220:235]
  v_exp_f32 v191, v191
  v_exp_f32 v192, v192
  v_exp_f32 v193, v193
  v_mfma_f32_32x32x16_bf16 v[236:251], a[252:255], a[44:47], v[236:251]
  v_exp_f32 v194, v194
  v_exp_f32 v195, v195
  v_cvt_pk_bf16_f32 v189, v190, v191
  v_cvt_pk_bf16_f32 v190, v192, v193
  v_cvt_pk_bf16_f32 v191, v194, v195
  v_exp_f32 v196, v196
  v_mfma_f32_32x32x16_bf16 v[204:219], v[148:151], v[188:191], v[204:219]
  ds_read_b128 v[188:191], v3 offset:11904
  v_exp_f32 v197, v197
  v_exp_f32 v198, v198
  v_exp_f32 v199, v199
  v_exp_f32 v200, v200
  v_exp_f32 v201, v201
  v_exp_f32 v202, v202
  v_exp_f32 v203, v203
  v_cvt_pk_bf16_f32 v192, v196, v197
  v_cvt_pk_bf16_f32 v193, v198, v199
  v_cvt_pk_bf16_f32 v194, v200, v201
  v_cvt_pk_bf16_f32 v195, v202, v203
  v_cvt_pk_bf16_f32 v96, v224, v225
  v_cvt_pk_bf16_f32 v97, v226, v227
  v_mfma_f32_32x32x16_bf16 v[204:219], v[152:155], v[192:195], v[204:219]
  ds_read_b128 v[192:195], v3 offset:11776
  ds_read_b128 v[196:199], v3 offset:11648
  ds_read_b128 v[200:203], v3 offset:11520
  buffer_store_dwordx4 v[252:255], v8, s[12:15], s43 offen offset:1024 sc1
  v_cvt_pk_bf16_f32 v98, v228, v229
  v_cvt_pk_bf16_f32 v99, v230, v231
  v_cvt_pk_bf16_f32 v46, v220, v221
  v_cvt_pk_bf16_f32 v47, v222, v223
  s_waitcnt lgkmcnt(3)
  v_mfma_f32_32x32x16_bf16 v[172:187], v[96:99], v[42:45], v[172:187]
  ds_read_b128 v[252:255], v6 offset:11264
  v_cvt_pk_bf16_f32 v100, v232, v233
  v_cvt_pk_bf16_f32 v101, v234, v235
  v_cvt_pk_bf16_f32 v102, v240, v241
  v_cvt_pk_bf16_f32 v103, v242, v243
  v_cvt_pk_bf16_f32 v104, v244, v245
  v_mfma_f32_32x32x16_bf16 v[220:235], a[168:171], v[12:15], 0
  v_cvt_pk_bf16_f32 v105, v246, v247
  v_cvt_pk_bf16_f32 v106, v248, v249
  v_cvt_pk_bf16_f32 v107, v250, v251
  v_rcp_f32 v209, v208
  v_cvt_pk_bf16_f32 v58, v236, v237
  v_mul_f32 v212, v212, v209
  v_mfma_f32_32x32x8_bf16 v[172:187], v[100:101], v[46:47], v[172:187]
  v_mul_f32 v213, v213, v209
  v_mul_f32 v214, v214, v209
  v_mul_f32 v215, v215, v209
  v_mul_f32 v216, v216, v209
  v_mul_f32 v217, v217, v209
  v_mul_f32 v218, v218, v209
  v_mul_f32 v219, v219, v209
  s_waitcnt lgkmcnt(1)
  v_mfma_f32_32x32x16_bf16 v[188:203], v[102:105], v[42:45], v[188:203]
  v_mul_f32 v204, v204, v209
  v_mul_f32 v205, v205, v209
  v_mul_f32 v206, v206, v209
  v_exp_f32 v172, v172
  v_mul_f32 v207, v207, v209
  v_mfma_f32_32x32x16_bf16 v[220:235], a[172:175], v[16:19], v[220:235]
  v_exp_f32 v173, v173
  v_exp_f32 v174, v174
  v_exp_f32 v175, v175
  v_cvt_pk_bf16_f32 v172, v172, v173
  v_mfma_f32_32x32x8_bf16 v[188:203], v[106:107], v[46:47], v[188:203]
  v_exp_f32 v176, v176
  v_exp_f32 v177, v177
  v_exp_f32 v178, v178
  v_exp_f32 v179, v179
  v_mfma_f32_32x32x16_bf16 v[220:235], a[176:179], v[20:23], v[220:235]
  v_cvt_pk_bf16_f32 v173, v174, v175
  v_cvt_pk_bf16_f32 v174, v176, v177
  v_cvt_pk_bf16_f32 v175, v178, v179
  v_max3_f32 v10, v10, v208, v209
  v_cvt_pk_bf16_f32 v36, v212, v213
  v_cvt_pk_bf16_f32 v37, v214, v215
  v_cvt_pk_bf16_f32 v38, v216, v217
  v_cvt_pk_bf16_f32 v39, v218, v219
  v_cvt_pk_bf16_f32 v40, v204, v205
  v_cvt_pk_bf16_f32 v41, v206, v207
  v_mfma_f32_32x32x16_bf16 v[204:219], v[156:159], v[172:175], 0
  ds_read_b128 v[172:175], v3 offset:9088
  v_exp_f32 v180, v180
  v_exp_f32 v181, v181
  v_cvt_pk_bf16_f32 v59, v238, v239
  v_mfma_f32_32x32x16_bf16 v[236:251], a[192:195], v[12:15], 0
  s_waitcnt lgkmcnt(1)
  buffer_store_dwordx4 v[252:255], v9, s[12:15], s43 offen offset:2048 sc1
  v_mfma_f32_32x32x16_bf16 v[236:251], a[196:199], v[16:19], v[236:251]
  v_exp_f32 v182, v182
  v_exp_f32 v183, v183
  v_exp_f32 v184, v184
  v_mfma_f32_32x32x16_bf16 v[220:235], a[180:183], v[36:39], v[220:235]
  v_exp_f32 v185, v185
  v_exp_f32 v186, v186
  v_exp_f32 v187, v187
  v_mfma_f32_32x32x16_bf16 v[236:251], a[200:203], v[20:23], v[236:251]
  v_cvt_pk_bf16_f32 v176, v180, v181
  v_cvt_pk_bf16_f32 v177, v182, v183
  v_cvt_pk_bf16_f32 v178, v184, v185
  v_cvt_pk_bf16_f32 v179, v186, v187
  v_exp_f32 v188, v188
  v_mfma_f32_32x32x16_bf16 v[204:219], v[160:163], v[176:179], v[204:219]
  ds_read_b128 v[176:179], v3 offset:8960
  ds_read_b128 v[180:183], v3 offset:8832
  ds_read_b128 v[184:187], v3 offset:8704
  v_exp_f32 v189, v189
  v_mfma_f32_32x32x16_bf16 v[236:251], a[204:207], v[36:39], v[236:251]
  v_exp_f32 v190, v190
  v_exp_f32 v191, v191
  v_exp_f32 v192, v192
  v_mfma_f32_32x32x16_bf16 v[60:75], a[228:231], v[36:39], v[60:75]
  v_exp_f32 v193, v193
  v_exp_f32 v194, v194
  v_exp_f32 v195, v195
  v_cvt_pk_bf16_f32 v188, v188, v189
  v_cvt_pk_bf16_f32 v189, v190, v191
  v_cvt_pk_bf16_f32 v190, v192, v193
  v_cvt_pk_bf16_f32 v191, v194, v195
  v_exp_f32 v196, v196
  v_mfma_f32_32x32x16_bf16 v[204:219], v[164:167], v[188:191], v[204:219]
  ds_read_b128 v[188:191], v2 offset:8576
  v_exp_f32 v197, v197
  v_exp_f32 v198, v198
  s_waitcnt lgkmcnt(1)
  v_mfma_f32_32x32x16_bf16 v[172:187], v[84:87], v[48:51], v[172:187]
  v_exp_f32 v199, v199
  v_exp_f32 v200, v200
  v_exp_f32 v201, v201
  v_exp_f32 v202, v202
  v_exp_f32 v203, v203
  v_cvt_pk_bf16_f32 v192, v196, v197
  v_cvt_pk_bf16_f32 v193, v198, v199
  v_cvt_pk_bf16_f32 v194, v200, v201
  v_mfma_f32_32x32x8_bf16 v[172:187], v[88:89], v[52:53], v[172:187]
  v_cvt_pk_bf16_f32 v195, v202, v203
  ds_read_b128 v[196:199], v2 offset:8320
  ds_read_b128 v[200:203], v2 offset:8192
  v_mfma_f32_32x32x16_bf16 v[204:219], v[168:171], v[192:195], v[204:219]
  ds_read_b128 v[192:195], v2 offset:8448
  s_nop 5
  v_exp_f32 v172, v172
  v_exp_f32 v173, v173
  v_exp_f32 v174, v174
  v_exp_f32 v175, v175
  v_exp_f32 v176, v176
  v_exp_f32 v177, v177
  v_rcp_f32 v205, v204
  v_exp_f32 v178, v178
  v_mul_f32 v208, v208, v205
  v_mul_f32 v209, v209, v205
  v_mul_f32 v210, v210, v205
  v_mul_f32 v211, v211, v205
  v_cvt_pk_bf16_f32 v42, v208, v209
  v_cvt_pk_bf16_f32 v43, v210, v211
  v_mul_f32 v212, v212, v205
  v_mul_f32 v213, v213, v205
  v_mfma_f32_32x32x16_bf16 v[220:235], a[184:187], v[40:43], v[220:235]
  v_mul_f32 v214, v214, v205
  v_mul_f32 v215, v215, v205
  v_mul_f32 v216, v216, v205
  v_mul_f32 v217, v217, v205
  v_mul_f32 v218, v218, v205
  s_waitcnt lgkmcnt(0)
  v_mfma_f32_32x32x16_bf16 v[188:203], v[90:93], v[48:51], v[188:203]
  v_mul_f32 v219, v219, v205
  v_cvt_pk_bf16_f32 v44, v212, v213
  v_cvt_pk_bf16_f32 v45, v214, v215
  v_cvt_pk_bf16_f32 v46, v216, v217
  v_cvt_pk_bf16_f32 v47, v218, v219
  v_cvt_pk_bf16_f32 v172, v172, v173
  v_mfma_f32_32x32x16_bf16 v[236:251], a[208:211], v[40:43], v[236:251]
  v_exp_f32 v179, v179
  v_cvt_pk_bf16_f32 v173, v174, v175
  v_cvt_pk_bf16_f32 v174, v176, v177
  v_cvt_pk_bf16_f32 v175, v178, v179
  v_max3_f32 v10, v10, v204, v205
  v_mfma_f32_32x32x8_bf16 v[188:203], v[94:95], v[52:53], v[188:203]
  v_exp_f32 v180, v180
  v_exp_f32 v181, v181
  v_exp_f32 v182, v182
  v_exp_f32 v183, v183
  v_mfma_f32_32x32x16_bf16 v[204:219], v[140:143], v[172:175], 0
  ds_read_b128 v[172:175], v3 offset:12928
  v_exp_f32 v184, v184
  v_exp_f32 v185, v185
  v_cvt_pk_bf16_f32 v176, v180, v181
  v_mfma_f32_32x32x16_bf16 v[220:235], a[188:191], v[44:47], v[220:235]
  v_exp_f32 v186, v186
  v_exp_f32 v187, v187
  v_cvt_pk_bf16_f32 v177, v182, v183
  v_cvt_pk_bf16_f32 v178, v184, v185
  v_mfma_f32_32x32x16_bf16 v[236:251], a[212:215], v[44:47], v[236:251]
  ds_read_b128 v[180:183], v3 offset:12672
  v_cvt_pk_bf16_f32 v179, v186, v187
  v_exp_f32 v188, v188
  v_cvt_pk_bf16_f32 v220, v220, v221
  v_cvt_pk_bf16_f32 v221, v222, v223
  v_mfma_f32_32x32x16_bf16 v[204:219], v[144:147], v[176:179], v[204:219]
  ds_read_b128 v[176:179], v3 offset:12800
  ds_read_b128 v[184:187], v3 offset:12544
  v_cvt_pk_bf16_f32 v222, v224, v225
  v_cvt_pk_bf16_f32 v223, v226, v227
  v_cvt_pk_bf16_f32 v224, v228, v229
  v_cvt_pk_bf16_f32 v225, v230, v231
  v_mfma_f32_32x32x16_bf16 v[60:75], a[232:235], v[40:43], v[60:75]
  ds_write_b128 v4, v[220:223] offset:0
  v_cvt_pk_bf16_f32 v226, v232, v233
  v_mfma_f32_32x32x16_bf16 v[60:75], a[236:239], v[44:47], v[60:75]
  v_cvt_pk_bf16_f32 v227, v234, v235
  v_cvt_pk_bf16_f32 v236, v236, v237
  v_cvt_pk_bf16_f32 v237, v238, v239
  v_cvt_pk_bf16_f32 v238, v240, v241
  v_cvt_pk_bf16_f32 v239, v242, v243
  v_cvt_pk_bf16_f32 v240, v244, v245
  v_cvt_pk_bf16_f32 v241, v246, v247
  v_cvt_pk_bf16_f32 v242, v248, v249
  v_cvt_pk_bf16_f32 v243, v250, v251
  v_exp_f32 v189, v189
  v_exp_f32 v190, v190
  v_cvt_pk_bf16_f32 v60, v60, v61
  v_cvt_pk_bf16_f32 v61, v62, v63
  v_cvt_pk_bf16_f32 v62, v64, v65
  v_cvt_pk_bf16_f32 v63, v66, v67
  v_cvt_pk_bf16_f32 v64, v68, v69
  s_waitcnt lgkmcnt(1)
  v_mfma_f32_32x32x16_bf16 v[172:187], v[96:99], v[54:57], v[172:187]
  ds_write_b128 v5, v[224:227] offset:0
  v_cvt_pk_bf16_f32 v65, v70, v71
  v_mfma_f32_32x32x16_bf16 v[220:235], a[168:171], v[24:27], 0
  ds_write_b128 v4, v[236:239] offset:64
  v_cvt_pk_bf16_f32 v66, v72, v73
  v_mfma_f32_32x32x16_bf16 v[220:235], a[172:175], v[28:31], v[220:235]
  v_cvt_pk_bf16_f32 v67, v74, v75
  v_exp_f32 v191, v191
  v_exp_f32 v192, v192
  v_exp_f32 v193, v193
  v_mfma_f32_32x32x8_bf16 v[172:187], v[100:101], v[58:59], v[172:187]
  v_exp_f32 v194, v194
  v_exp_f32 v195, v195
  v_cvt_pk_bf16_f32 v188, v188, v189
  v_cvt_pk_bf16_f32 v189, v190, v191
  v_cvt_pk_bf16_f32 v190, v192, v193
  v_cvt_pk_bf16_f32 v191, v194, v195
  v_mfma_f32_32x32x16_bf16 v[220:235], a[176:179], v[32:35], v[220:235]
  ds_write_b128 v5, v[240:243] offset:64
  v_exp_f32 v196, v196
  v_mfma_f32_32x32x16_bf16 v[204:219], v[148:151], v[188:191], v[204:219]
  ds_write_b128 v4, v[60:63] offset:128
  v_exp_f32 v197, v197
  v_mfma_f32_32x32x16_bf16 v[236:251], a[192:195], v[24:27], 0
  v_exp_f32 v198, v198
  v_exp_f32 v199, v199
  v_exp_f32 v200, v200
  v_mfma_f32_32x32x16_bf16 v[236:251], a[196:199], v[28:31], v[236:251]
  ds_write_b128 v5, v[64:67] offset:128
  v_cvt_pk_bf16_f32 v192, v196, v197
  v_mfma_f32_32x32x16_bf16 v[60:75], a[216:219], v[24:27], 0
  ds_read_b128 a[0:3], v6 offset:0
  v_exp_f32 v201, v201
  v_exp_f32 v202, v202
  v_cvt_pk_bf16_f32 v193, v198, v199
  v_mfma_f32_32x32x16_bf16 v[236:251], a[200:203], v[32:35], v[236:251]
  ds_read_b128 a[4:7], v6 offset:1024
  ds_read_b128 a[8:11], v6 offset:2048
  v_exp_f32 v203, v203
  v_cvt_pk_bf16_f32 v194, v200, v201
  v_cvt_pk_bf16_f32 v195, v202, v203
  v_mfma_f32_32x32x16_bf16 v[60:75], a[220:223], v[28:31], v[60:75]
  ds_read_b128 a[12:15], v6 offset:3072
  ds_read_b128 a[16:19], v6 offset:4096
  v_exp_f32 v172, v172
  v_exp_f32 v173, v173
  v_mfma_f32_32x32x16_bf16 v[204:219], v[152:155], v[192:195], v[204:219]
  ds_read_b128 a[20:23], v6 offset:5120
  ds_read_b128 v[188:191], v2 offset:12416
  v_exp_f32 v174, v174
  v_exp_f32 v175, v175
  v_mfma_f32_32x32x16_bf16 v[60:75], a[224:227], v[32:35], v[60:75]
  ds_read_b128 v[192:195], v2 offset:12288
  s_waitcnt lgkmcnt(7)
  buffer_store_dwordx4 a[0:3], v7, s[12:15], s44 offen offset:0 sc1
  ds_read_b128 v[196:199], v2 offset:12160
  ds_read_b128 v[200:203], v2 offset:12032
  v_rcp_f32 v209, v208
  v_exp_f32 v176, v176
  v_exp_f32 v177, v177
  v_exp_f32 v178, v178
  v_exp_f32 v179, v179
  v_cvt_pk_bf16_f32 v172, v172, v173
  v_cvt_pk_bf16_f32 v173, v174, v175
  v_mul_f32 v212, v212, v209
  v_mul_f32 v213, v213, v209
  v_mul_f32 v214, v214, v209
  v_mul_f32 v215, v215, v209
  v_mul_f32 v216, v216, v209
  v_mul_f32 v217, v217, v209
  v_mul_f32 v218, v218, v209
  v_mul_f32 v219, v219, v209
  v_mul_f32 v204, v204, v209
  v_mul_f32 v205, v205, v209
  v_mul_f32 v206, v206, v209
  v_mul_f32 v207, v207, v209
  v_cvt_pk_bf16_f32 v174, v176, v177
  v_cvt_pk_bf16_f32 v175, v178, v179
  v_max3_f32 v10, v10, v208, v209
  v_cvt_pk_bf16_f32 v48, v212, v213
  v_cvt_pk_bf16_f32 v49, v214, v215
  v_cvt_pk_bf16_f32 v50, v216, v217
  v_cvt_pk_bf16_f32 v51, v218, v219
  v_cvt_pk_bf16_f32 v52, v204, v205
  s_waitcnt lgkmcnt(0)
  v_mfma_f32_32x32x16_bf16 v[188:203], v[102:105], v[54:57], v[188:203]
  v_cvt_pk_bf16_f32 v53, v206, v207
  v_exp_f32 v180, v180
  v_exp_f32 v181, v181
  v_mfma_f32_32x32x16_bf16 v[204:219], v[156:159], v[172:175], 0
  v_exp_f32 v182, v182
  v_exp_f32 v183, v183
  v_exp_f32 v184, v184
  v_cvt_pk_bf16_f32 v176, v180, v181
  v_mfma_f32_32x32x8_bf16 v[188:203], v[106:107], v[58:59], v[188:203]
  v_exp_f32 v185, v185
  v_exp_f32 v186, v186
  v_exp_f32 v187, v187
  v_cvt_pk_bf16_f32 v177, v182, v183
  v_cvt_pk_bf16_f32 v178, v184, v185
  v_mfma_f32_32x32x16_bf16 v[220:235], a[180:183], v[48:51], v[220:235]
  buffer_store_dwordx4 a[4:7], v8, s[12:15], s44 offen offset:1024 sc1
  v_cvt_pk_bf16_f32 v179, v186, v187
  v_mfma_f32_32x32x16_bf16 v[236:251], a[204:207], v[48:51], v[236:251]
  v_exp_f32 v188, v188
  v_exp_f32 v189, v189
  v_exp_f32 v190, v190
  v_mfma_f32_32x32x16_bf16 v[204:219], v[160:163], v[176:179], v[204:219]
  v_exp_f32 v191, v191
  v_exp_f32 v192, v192
  v_exp_f32 v193, v193
  v_mfma_f32_32x32x16_bf16 v[60:75], a[228:231], v[48:51], v[60:75]
  v_exp_f32 v194, v194
  v_exp_f32 v195, v195
  v_cvt_pk_bf16_f32 v188, v188, v189
  v_cvt_pk_bf16_f32 v189, v190, v191
  v_cvt_pk_bf16_f32 v190, v192, v193
  v_cvt_pk_bf16_f32 v191, v194, v195
  v_exp_f32 v196, v196
  v_mfma_f32_32x32x16_bf16 v[204:219], v[164:167], v[188:191], v[204:219]
  v_exp_f32 v197, v197
  v_exp_f32 v198, v198
  v_exp_f32 v199, v199
  v_exp_f32 v200, v200
  v_exp_f32 v201, v201
  v_exp_f32 v202, v202
  v_exp_f32 v203, v203
  v_cvt_pk_bf16_f32 v192, v196, v197
  v_cvt_pk_bf16_f32 v193, v198, v199
  v_cvt_pk_bf16_f32 v194, v200, v201
  v_cvt_pk_bf16_f32 v195, v202, v203
  s_nop 1
  v_mfma_f32_32x32x16_bf16 v[204:219], v[168:171], v[192:195], v[204:219]
  buffer_store_dwordx4 a[8:11], v9, s[12:15], s44 offen offset:2048 sc1
  s_nop 10
  v_rcp_f32 v205, v204
  s_nop 0
  v_mul_f32 v208, v208, v205
  v_mul_f32 v209, v209, v205
  v_mul_f32 v210, v210, v205
  v_cvt_pk_bf16_f32 v54, v208, v209
  v_mul_f32 v211, v211, v205
  v_mul_f32 v212, v212, v205
  v_cvt_pk_bf16_f32 v55, v210, v211
  v_mul_f32 v213, v213, v205
  v_mul_f32 v214, v214, v205
  v_mfma_f32_32x32x16_bf16 v[220:235], a[184:187], v[52:55], v[220:235]
  v_mul_f32 v215, v215, v205
  v_mul_f32 v216, v216, v205
  v_mul_f32 v217, v217, v205
  v_mul_f32 v218, v218, v205
  v_mul_f32 v219, v219, v205
  v_cvt_pk_bf16_f32 v56, v212, v213
  v_mfma_f32_32x32x16_bf16 v[236:251], a[208:211], v[52:55], v[236:251]
  v_cvt_pk_bf16_f32 v57, v214, v215
  v_cvt_pk_bf16_f32 v58, v216, v217
  v_cvt_pk_bf16_f32 v59, v218, v219
  v_max3_f32 v10, v10, v204, v205
  v_mfma_f32_32x32x16_bf16 v[60:75], a[232:235], v[52:55], v[60:75]
  v_mfma_f32_32x32x16_bf16 v[220:235], a[188:191], v[56:59], v[220:235]
  v_mfma_f32_32x32x16_bf16 v[236:251], a[212:215], v[56:59], v[236:251]
  v_mfma_f32_32x32x16_bf16 v[60:75], a[236:239], v[56:59], v[60:75]
  buffer_store_dwordx4 a[12:15], v7, s[12:15], s45 offen offset:0 sc1
  s_nop 6
  v_cvt_pk_bf16_f32 v220, v220, v221
  v_cvt_pk_bf16_f32 v221, v222, v223
  v_cvt_pk_bf16_f32 v222, v224, v225
  v_cvt_pk_bf16_f32 v223, v226, v227
  v_cvt_pk_bf16_f32 v224, v228, v229
  ds_write_b128 v4, v[220:223] offset:6144
  v_cvt_pk_bf16_f32 v225, v230, v231
  v_cvt_pk_bf16_f32 v226, v232, v233
  v_cvt_pk_bf16_f32 v227, v234, v235
  v_cvt_pk_bf16_f32 v236, v236, v237
  v_cvt_pk_bf16_f32 v237, v238, v239
  v_cvt_pk_bf16_f32 v238, v240, v241
  v_cvt_pk_bf16_f32 v239, v242, v243
  v_cvt_pk_bf16_f32 v240, v244, v245
  v_cvt_pk_bf16_f32 v241, v246, v247
  v_cvt_pk_bf16_f32 v242, v248, v249
  v_cvt_pk_bf16_f32 v243, v250, v251
  v_cvt_pk_bf16_f32 v60, v60, v61
  v_cvt_pk_bf16_f32 v61, v62, v63
  v_cvt_pk_bf16_f32 v62, v64, v65
  v_cvt_pk_bf16_f32 v63, v66, v67
  v_cvt_pk_bf16_f32 v64, v68, v69
  v_cvt_pk_bf16_f32 v65, v70, v71
  v_cvt_pk_bf16_f32 v66, v72, v73
  v_cvt_pk_bf16_f32 v67, v74, v75
  ds_write_b128 v5, v[224:227] offset:6144
  ds_write_b128 v4, v[236:239] offset:6208
  ds_write_b128 v5, v[240:243] offset:6208
  buffer_store_dwordx4 a[16:19], v8, s[12:15], s45 offen offset:1024 sc1
  ds_write_b128 v4, v[60:63] offset:6272
  ds_write_b128 v5, v[64:67] offset:6272
  ds_read_b128 a[24:27], v6 offset:6144
  ds_read_b128 a[28:31], v6 offset:7168
  ds_read_b128 a[32:35], v6 offset:8192
  ds_read_b128 a[36:39], v6 offset:9216
  ds_read_b128 a[40:43], v6 offset:10240
  ds_read_b128 a[44:47], v6 offset:11264
  buffer_store_dwordx4 a[20:23], v9, s[12:15], s45 offen offset:2048 sc1
  s_waitcnt lgkmcnt(5)
  buffer_store_dwordx4 a[24:27], v7, s[12:15], s46 offen offset:0 sc1
  s_waitcnt lgkmcnt(4)
  buffer_store_dwordx4 a[28:31], v8, s[12:15], s46 offen offset:1024 sc1
  s_waitcnt lgkmcnt(3)
  buffer_store_dwordx4 a[32:35], v9, s[12:15], s46 offen offset:2048 sc1
  s_waitcnt lgkmcnt(1)
  buffer_store_dwordx4 a[36:39], v7, s[12:15], s47 offen offset:0 sc1
  buffer_store_dwordx4 a[40:43], v8, s[12:15], s47 offen offset:1024 sc1
  s_waitcnt lgkmcnt(0)
  buffer_store_dwordx4 a[44:47], v9, s[12:15], s47 offen offset:2048 sc1
  v_cmp_lt_f32 vcc, 0x4b800000, v10
  s_nop 4
  s_cmp_lg_u64 vcc, 0
  s_cbranch_scc1 L_redo
L_end:
  s_endpgm
L_redo:
  s_waitcnt vmcnt(0) lgkmcnt(0)
  v_mbcnt_lo_u32_b32 v12, -1, 0
  v_mbcnt_hi_u32_b32 v12, -1, v12
  v_cmp_gt_u32 vcc, 32, v12
  v_mov_b32 v13, 0xbf80bf80
  v_mov_b32 v14, 0xbf800000
  v_cndmask_b32 v10, 0, v13, vcc
  v_cndmask_b32 v11, 0, v14, vcc
  v_mov_b32 v3, v2
  s_add_u32 m0, s50, 0
  s_nop 0
  buffer_load_dwordx4 v7, s[8:11], s32 offen offset:0 lds
  buffer_load_dwordx4 v8, s[8:11], s32 offen offset:1024 lds
  buffer_load_dwordx4 v9, s[8:11], s32 offen offset:2048 lds
  s_add_u32 m0, s50, 3072
  s_nop 0
  buffer_load_dwordx4 v7, s[8:11], s33 offen offset:0 lds
  buffer_load_dwordx4 v8, s[8:11], s33 offen offset:1024 lds
  buffer_load_dwordx4 v9, s[8:11], s33 offen offset:2048 lds
  s_add_u32 m0, s50, 6144
  s_nop 0
  buffer_load_dwordx4 v7, s[8:11], s34 offen offset:0 lds
  buffer_load_dwordx4 v8, s[8:11], s34 offen offset:1024 lds
  buffer_load_dwordx4 v9, s[8:11], s34 offen offset:2048 lds
  s_add_u32 m0, s50, 9216
  s_nop 0
  buffer_load_dwordx4 v7, s[8:11], s35 offen offset:0 lds
  buffer_load_dwordx4 v8, s[8:11], s35 offen offset:1024 lds
  buffer_load_dwordx4 v9, s[8:11], s35 offen offset:2048 lds
  s_waitcnt vmcnt(0)
  ds_read_b128 a[0:3], v4 offset:49152
  ds_read_b128 a[4:7], v5 offset:49152
  ds_read_b128 a[8:11], v4 offset:49216
  s_add_u32 m0, s50, 0
  v_cmp_gt_u32 vcc, s52, v2
  v_nop
  v_nop
  ds_read_b128 a[12:15], v5 offset:49216
  ds_read_b128 a[16:19], v4 offset:49280
  ds_read_b128 a[20:23], v5 offset:49280
  ds_read_b128 a[24:27], v4 offset:55296
  ds_read_b128 a[28:31], v5 offset:55296
  ds_read_b128 a[32:35], v4 offset:55360
  ds_read_b128 a[36:39], v5 offset:55360
  s_waitcnt lgkmcnt(9)
  v_mfma_f32_32x32x16_bf16 v[220:235], a[48:51], a[0:3], 0
  ds_read_b128 a[40:43], v4 offset:55424
  s_waitcnt lgkmcnt(8)
  v_mfma_f32_32x32x16_bf16 v[220:235], a[52:55], a[4:7], v[220:235]
  ds_read_b128 a[44:47], v5 offset:55424
  ds_read_b128 v[172:175], v2 offset:896
  v_mfma_f32_32x32x16_bf16 v[220:235], a[56:59], a[8:11], v[220:235]
  ds_read_b128 v[176:179], v2 offset:768
  ds_read_b128 v[180:183], v2 offset:640
  s_waitcnt lgkmcnt(8)
  buffer_load_dwordx4 v7, s[8:11], s36 offen offset:0 nt lds
  ds_read_b128 v[184:187], v2 offset:512
  v_mfma_f32_32x32x16_bf16 v[220:235], a[60:63], a[12:15], v[220:235]
  ds_read_b128 v[188:191], v3 offset:384
  v_mfma_f32_32x32x16_bf16 v[236:251], a[72:75], a[0:3], 0
  ds_read_b128 v[192:195], v3 offset:256
  ds_read_b128 v[196:199], v3 offset:128
  v_mfma_f32_32x32x16_bf16 v[220:235], a[64:67], a[16:19], v[220:235]
  ds_read_b128 v[200:203], v3 offset:0
  ds_read_b64_tr_b16 a[240:241], v0 offset:6144
  ds_read_b64_tr_b16 a[242:243], v0 offset:6400
  v_mfma_f32_32x32x16_bf16 v[236:251], a[76:79], a[4:7], v[236:251]
  ds_read_b64_tr_b16 a[244:245], v0 offset:7168
  ds_read_b64_tr_b16 a[246:247], v0 offset:7424
  ds_read_b64_tr_b16 a[248:249], v0 offset:8192
  ds_read_b64_tr_b16 a[250:251], v0 offset:8448
  ds_read_b64_tr_b16 a[252:253], v0 offset:9216
  v_mfma_f32_32x32x16_bf16 v[220:235], a[68:71], a[20:23], v[220:235]
  ds_read_b64_tr_b16 a[254:255], v0 offset:9472
  v_mfma_f32_32x32x16_bf16 v[236:251], a[80:83], a[8:11], v[236:251]
  v_mfma_f32_32x32x16_bf16 v[236:251], a[84:87], a[12:15], v[236:251]
  v_mfma_f32_32x32x16_bf16 v[236:251], a[88:91], a[16:19], v[236:251]
  v_mfma_f32_32x32x16_bf16 v[236:251], a[92:95], a[20:23], v[236:251]
  s_nop 2
  v_cvt_pk_bf16_f32 v12, v220, v221
  v_cvt_pk_bf16_f32 v13, v222, v223
  v_cvt_pk_bf16_f32 v14, v224, v225
  v_cvt_pk_bf16_f32 v15, v226, v227
  v_cvt_pk_bf16_f32 v16, v228, v229
  v_cvt_pk_bf16_f32 v17, v230, v231
  v_cvt_pk_bf16_f32 v84, v232, v233
  v_cvt_pk_bf16_f32 v85, v234, v235
  v_mfma_f32_32x32x16_bf16 v[220:235], a[96:99], a[0:3], 0
  buffer_load_dwordx4 v8, s[8:11], s36 offen offset:1024 nt lds
  v_mfma_f32_32x32x16_bf16 v[220:235], a[100:103], a[4:7], v[220:235]
  v_cvt_pk_bf16_f32 v86, v236, v237
  v_cvt_pk_bf16_f32 v87, v238, v239
  v_cvt_pk_bf16_f32 v88, v240, v241
  v_cvt_pk_bf16_f32 v89, v242, v243
  v_cvt_pk_bf16_f32 v18, v244, v245
  s_waitcnt lgkmcnt(0)
  v_mfma_f32_32x32x16_bf16 v[172:187], v[84:87], v[12:15], v[172:187]
  v_cvt_pk_bf16_f32 v19, v246, v247
  v_cvt_pk_bf16_f32 v20, v248, v249
  v_cvt_pk_bf16_f32 v21, v250, v251
  v_mfma_f32_32x32x16_bf16 v[220:235], a[104:107], a[8:11], v[220:235]
  v_mfma_f32_32x32x16_bf16 v[220:235], a[108:111], a[12:15], v[220:235]
  v_mfma_f32_32x32x16_bf16 v[236:251], a[48:51], a[24:27], 0
  v_mfma_f32_32x32x16_bf16 v[220:235], a[112:115], a[16:19], v[220:235]
  v_mfma_f32_32x32x8_bf16 v[172:187], v[88:89], v[16:17], v[172:187]
  v_mfma_f32_32x32x16_bf16 v[236:251], a[52:55], a[28:31], v[236:251]
  v_mfma_f32_32x32x16_bf16 v[220:235], a[116:119], a[20:23], v[220:235]
  v_mfma_f32_32x32x16_bf16 v[236:251], a[56:59], a[32:35], v[236:251]
  buffer_load_dwordx4 v9, s[8:11], s36 offen offset:2048 nt lds
  s_add_u32 m0, s50, 3072
  v_mfma_f32_32x32x16_bf16 v[236:251], a[60:63], a[36:39], v[236:251]
  v_mfma_f32_32x32x16_bf16 v[236:251], a[64:67], a[40:43], v[236:251]
  v_mfma_f32_32x32x16_bf16 v[236:251], a[68:71], a[44:47], v[236:251]
  s_nop 1
  v_cvt_pk_bf16_f32 v22, v220, v221
  v_cvt_pk_bf16_f32 v23, v222, v223
  v_cvt_pk_bf16_f32 v96, v224, v225
  v_cvt_pk_bf16_f32 v97, v226, v227
  v_cvt_pk_bf16_f32 v98, v228, v229
  v_cvt_pk_bf16_f32 v99, v230, v231
  v_cvt_pk_bf16_f32 v100, v232, v233
  v_cvt_pk_bf16_f32 v101, v234, v235
  v_mfma_f32_32x32x16_bf16 v[220:235], a[72:75], a[24:27], 0
  v_mfma_f32_32x32x16_bf16 v[220:235], a[76:79], a[28:31], v[220:235]
  v_cvt_pk_bf16_f32 v24, v236, v237
  v_cvt_pk_bf16_f32 v25, v238, v239
  v_cvt_pk_bf16_f32 v26, v240, v241
  v_cvt_pk_bf16_f32 v27, v242, v243
  v_cvt_pk_bf16_f32 v28, v244, v245
  v_cvt_pk_bf16_f32 v29, v246, v247
  v_mfma_f32_32x32x16_bf16 v[220:235], a[80:83], a[32:35], v[220:235]
  v_cvt_pk_bf16_f32 v90, v248, v249
  v_cvt_pk_bf16_f32 v91, v250, v251
  v_mfma_f32_32x32x16_bf16 v[220:235], a[84:87], a[36:39], v[220:235]
  v_mfma_f32_32x32x16_bf16 v[236:251], a[96:99], a[24:27], 0
  v_mfma_f32_32x32x16_bf16 v[220:235], a[88:91], a[40:43], v[220:235]
  v_mfma_f32_32x32x16_bf16 v[236:251], a[100:103], a[28:31], v[236:251]
  buffer_load_dwordx4 v7, s[8:11], s37 offen offset:0 nt lds
  v_mfma_f32_32x32x16_bf16 v[220:235], a[92:95], a[44:47], v[220:235]
  v_mfma_f32_32x32x16_bf16 v[236:251], a[104:107], a[32:35], v[236:251]
  v_mfma_f32_32x32x16_bf16 v[236:251], a[108:111], a[36:39], v[236:251]
  v_mfma_f32_32x32x16_bf16 v[236:251], a[112:115], a[40:43], v[236:251]
  v_mfma_f32_32x32x16_bf16 v[236:251], a[116:119], a[44:47], v[236:251]
  s_nop 3
  v_cvt_pk_bf16_f32 v92, v220, v221
  v_cvt_pk_bf16_f32 v93, v222, v223
  v_cvt_pk_bf16_f32 v94, v224, v225
  v_cvt_pk_bf16_f32 v95, v226, v227
  v_cvt_pk_bf16_f32 v30, v228, v229
  v_cvt_pk_bf16_f32 v31, v230, v231
  v_mfma_f32_32x32x16_bf16 v[188:203], v[90:93], v[12:15], v[188:203]
  v_cvt_pk_bf16_f32 v32, v232, v233
  v_cvt_pk_bf16_f32 v33, v234, v235
  v_max3_f32 v14, v172, v173, v174
  v_mfma_f32_32x32x16_bf16 v[220:235], a[0:3], a[240:243], 0
  v_cvt_pk_bf16_f32 v34, v236, v237
  v_cvt_pk_bf16_f32 v35, v238, v239
  v_cvt_pk_bf16_f32 v102, v240, v241
  v_cvt_pk_bf16_f32 v103, v242, v243
  v_cvt_pk_bf16_f32 v104, v244, v245
  v_cvt_pk_bf16_f32 v105, v246, v247
  v_cvt_pk_bf16_f32 v106, v248, v249
  v_mfma_f32_32x32x8_bf16 v[188:203], v[94:95], v[16:17], v[188:203]
  v_cvt_pk_bf16_f32 v107, v250, v251
  v_max3_f32 v14, v14, v175, v176
  v_mfma_f32_32x32x16_bf16 v[236:251], a[24:27], a[240:243], 0
  ds_read_b64_tr_b16 a[240:241], v0 offset:10240
  ds_read_b64_tr_b16 a[242:243], v0 offset:10496
  buffer_load_dwordx4 v8, s[8:11], s37 offen offset:1024 nt lds
  v_max3_f32 v14, v14, v177, v178
  v_mfma_f32_32x32x16_bf16 v[220:235], a[4:7], a[244:247], v[220:235]
  v_max3_f32 v14, v14, v179, v180
  v_mfma_f32_32x32x16_bf16 v[236:251], a[28:31], a[244:247], v[236:251]
  ds_read_b64_tr_b16 a[244:245], v0 offset:11264
  ds_read_b64_tr_b16 a[246:247], v0 offset:11520
  v_max3_f32 v15, v188, v189, v190
  v_max3_f32 v14, v14, v181, v182
  v_max3_f32 v15, v15, v191, v192
  v_max3_f32 v14, v14, v183, v184
  v_mfma_f32_32x32x16_bf16 v[220:235], a[8:11], a[248:251], v[220:235]
  v_max3_f32 v15, v15, v193, v194
  v_max3_f32 v14, v14, v185, v186
  v_max3_f32 v15, v15, v195, v196
  v_max3_f32 v14, v14, v187, v203
  v_max3_f32 v15, v15, v197, v198
  v_mfma_f32_32x32x16_bf16 v[220:235], a[12:15], a[252:255], v[220:235]
  v_max3_f32 v15, v15, v199, v200
  v_mfma_f32_32x32x16_bf16 v[236:251], a[32:35], a[248:251], v[236:251]
  ds_read_b64_tr_b16 a[248:249], v0 offset:12288
  ds_read_b64_tr_b16 a[250:251], v0 offset:12544
  v_max3_f32 v15, v15, v201, v202
  s_waitcnt lgkmcnt(4)
  v_mfma_f32_32x32x16_bf16 v[220:235], a[16:19], a[240:243], v[220:235]
  v_max_f32 v14, v14, v15
  v_mfma_f32_32x32x16_bf16 v[236:251], a[36:39], a[252:255], v[236:251]
  ds_read_b64_tr_b16 a[252:253], v0 offset:13312
  ds_read_b64_tr_b16 a[254:255], v0 offset:13568
  v_permlane32_swap_b32 v14, v15
  s_waitcnt lgkmcnt(4)
  v_mfma_f32_32x32x16_bf16 v[220:235], a[20:23], a[244:247], v[220:235]
  v_max_f32 v14, v14, v15
  v_mfma_f32_32x32x16_bf16 v[236:251], a[40:43], a[240:243], v[236:251]
  ds_read_b64_tr_b16 a[240:241], v0 offset:14336
  ds_read_b64_tr_b16 a[242:243], v0 offset:14592
  v_and_b32 v15, 0xffff0000, v14
  v_mfma_f32_32x32x16_bf16 v[236:251], a[44:47], a[244:247], v[236:251]
  ds_read_b64_tr_b16 a[244:245], v0 offset:15360
  ds_read_b64_tr_b16 a[246:247], v0 offset:15616
  buffer_load_dwordx4 v9, s[8:11], s37 offen offset:2048 nt lds
  s_add_u32 m0, s50, 6144
  v_sub_f32 v15, v14, v15
  s_mov_b64 exec, s[48:49]
  v_cvt_pk_bf16_f32 v108, v220, v221
  v_cvt_pk_bf16_f32 v109, v222, v223
  v_cvt_pk_bf16_f32 v110, v224, v225
  v_cvt_pk_bf16_f32 v111, v226, v227
  v_cvt_pk_bf16_f32 v112, v228, v229
  v_cvt_pk_bf16_f32 v113, v230, v231
  v_cvt_pk_bf16_f32 v114, v232, v233
  v_cvt_pk_bf16_f32 v115, v234, v235
  s_mov_b64 exec, -1
  v_perm_b32 v12, v15, v14, s53
  v_and_b32 v14, 0xffff0000, v15
  s_mov_b64 exec, s[48:49]
  v_cvt_pk_bf16_f32 v116, v236, v237
  v_cvt_pk_bf16_f32 v117, v238, v239
  v_cvt_pk_bf16_f32 v118, v240, v241
  v_cvt_pk_bf16_f32 v119, v242, v243
  v_cvt_pk_bf16_f32 v120, v244, v245
  v_cvt_pk_bf16_f32 v121, v246, v247
  v_cvt_pk_bf16_f32 v122, v248, v249
  v_cvt_pk_bf16_f32 v123, v250, v251
  s_mov_b64 exec, -1
  v_sub_f32 v13, v15, v14
  s_mov_b64 exec, s[60:61]
  v_cvt_pk_bf16_f32 v124, v220, v221
  v_cvt_pk_bf16_f32 v125, v222, v223
  v_cvt_pk_bf16_f32 v126, v224, v225
  v_cvt_pk_bf16_f32 v127, v226, v227
  v_cvt_pk_bf16_f32 v128, v228, v229
  v_cvt_pk_bf16_f32 v129, v230, v231
  v_cvt_pk_bf16_f32 v130, v232, v233
  v_cvt_pk_bf16_f32 v131, v234, v235
  s_waitcnt lgkmcnt(0)
  v_mfma_f32_32x32x16_bf16 v[220:235], a[0:3], a[248:251], 0
  s_mov_b64 exec, -1
  s_mov_b64 exec, s[60:61]
  v_cvt_pk_bf16_f32 v132, v236, v237
  v_cvt_pk_bf16_f32 v133, v238, v239
  v_cvt_pk_bf16_f32 v134, v240, v241
  v_cvt_pk_bf16_f32 v135, v242, v243
  v_mfma_f32_32x32x16_bf16 v[220:235], a[4:7], a[252:255], v[220:235]
  v_cvt_pk_bf16_f32 v136, v244, v245
  v_cvt_pk_bf16_f32 v137, v246, v247
  v_cvt_pk_bf16_f32 v138, v248, v249
  v_cvt_pk_bf16_f32 v139, v250, v251
  s_mov_b64 exec, -1
  v_mfma_f32_32x32x8_bf16 v[172:187], v[10:11], v[12:13], v[172:187]
  v_mfma_f32_32x32x8_bf16 v[188:203], v[10:11], v[12:13], v[188:203]
  v_mfma_f32_32x32x16_bf16 v[236:251], a[24:27], a[248:251], 0
  ds_read_b64_tr_b16 a[248:249], v0 offset:16384
  ds_read_b64_tr_b16 a[250:251], v0 offset:16640
  buffer_load_dwordx4 v7, s[8:11], s38 offen offset:0 nt lds
  v_mfma_f32_32x32x16_bf16 v[236:251], a[28:31], a[252:255], v[236:251]
  ds_read_b64_tr_b16 a[252:253], v0 offset:17408
  ds_read_b64_tr_b16 a[254:255], v0 offset:17664
  v_mfma_f32_32x32x16_bf16 v[220:235], a[8:11], a[240:243], v[220:235]
  v_exp_f32 v172, v172
  v_exp_f32 v173, v173
  v_exp_f32 v174, v174
  v_mfma_f32_32x32x16_bf16 v[220:235], a[12:15], a[244:247], v[220:235]
  v_exp_f32 v175, v175
  v_exp_f32 v176, v176
  v_exp_f32 v177, v177
  v_mfma_f32_32x32x16_bf16 v[236:251], a[32:35], a[240:243], v[236:251]
  ds_read_b64_tr_b16 a[240:241], v0 offset:18432
  ds_read_b64_tr_b16 a[242:243], v0 offset:18688
  v_exp_f32 v178, v178
  v_cvt_pk_bf16_f32 v172, v172, v173
  s_waitcnt lgkmcnt(4)
  v_mfma_f32_32x32x16_bf16 v[220:235], a[16:19], a[248:251], v[220:235]
  v_exp_f32 v179, v179
  v_cvt_pk_bf16_f32 v173, v174, v175
  v_cvt_pk_bf16_f32 v174, v176, v177
  v_cvt_pk_bf16_f32 v175, v178, v179
  v_mfma_f32_32x32x16_bf16 v[236:251], a[36:39], a[244:247], v[236:251]
  ds_read_b64_tr_b16 a[244:245], v0 offset:19456
  ds_read_b64_tr_b16 a[246:247], v0 offset:19712
  v_exp_f32 v180, v180
  v_exp_f32 v181, v181
  v_mfma_f32_32x32x16_bf16 v[204:219], v[108:111], v[172:175], 0
  ds_read_b128 v[172:175], v3 offset:1408
  v_exp_f32 v182, v182
  v_exp_f32 v183, v183
  s_waitcnt lgkmcnt(5)
  v_mfma_f32_32x32x16_bf16 v[220:235], a[20:23], a[252:255], v[220:235]
  v_exp_f32 v184, v184
  v_exp_f32 v185, v185
  v_exp_f32 v186, v186
  v_mfma_f32_32x32x16_bf16 v[236:251], a[40:43], a[248:251], v[236:251]
  ds_read_b64_tr_b16 a[248:249], v0 offset:20480
  ds_read_b64_tr_b16 a[250:251], v0 offset:20736
  v_exp_f32 v187, v187
  v_cvt_pk_bf16_f32 v176, v180, v181
  v_cvt_pk_bf16_f32 v177, v182, v183
  v_mfma_f32_32x32x16_bf16 v[236:251], a[44:47], a[252:255], v[236:251]
  ds_read_b64_tr_b16 a[252:253], v0 offset:21504
  ds_read_b64_tr_b16 a[254:255], v0 offset:21760
  buffer_load_dwordx4 v8, s[8:11], s38 offen offset:1024 nt lds
  v_cvt_pk_bf16_f32 v178, v184, v185
  v_cvt_pk_bf16_f32 v179, v186, v187
  v_exp_f32 v188, v188
  v_mfma_f32_32x32x16_bf16 v[204:219], v[112:115], v[176:179], v[204:219]
  ds_read_b128 v[176:179], v3 offset:1280
  v_exp_f32 v189, v189
  v_exp_f32 v190, v190
  v_exp_f32 v191, v191
  v_exp_f32 v192, v192
  v_exp_f32 v193, v193
  v_exp_f32 v194, v194
  v_exp_f32 v195, v195
  v_cvt_pk_bf16_f32 v180, v188, v189
  v_cvt_pk_bf16_f32 v181, v190, v191
  v_cvt_pk_bf16_f32 v182, v192, v193
  v_cvt_pk_bf16_f32 v183, v194, v195
  v_exp_f32 v196, v196
  v_mfma_f32_32x32x16_bf16 v[204:219], v[116:119], v[180:183], v[204:219]
  ds_read_b128 v[180:183], v3 offset:1152
  ds_read_b128 v[188:191], v2 offset:896
  ds_read_b128 v[192:195], v2 offset:768
  v_exp_f32 v197, v197
  v_exp_f32 v198, v198
  v_exp_f32 v199, v199
  v_exp_f32 v200, v200
  v_exp_f32 v201, v201
  v_exp_f32 v202, v202
  v_exp_f32 v203, v203
  v_cvt_pk_bf16_f32 v184, v196, v197
  v_cvt_pk_bf16_f32 v185, v198, v199
  v_cvt_pk_bf16_f32 v186, v200, v201
  v_cvt_pk_bf16_f32 v187, v202, v203
  s_mov_b64 exec, s[62:63]
  v_cvt_pk_bf16_f32 v124, v220, v221
  v_mfma_f32_32x32x16_bf16 v[204:219], v[120:123], v[184:187], v[204:219]
  v_cvt_pk_bf16_f32 v125, v222, v223
  v_cvt_pk_bf16_f32 v126, v224, v225
  v_cvt_pk_bf16_f32 v127, v226, v227
  v_cvt_pk_bf16_f32 v128, v228, v229
  v_cvt_pk_bf16_f32 v129, v230, v231
  v_cvt_pk_bf16_f32 v130, v232, v233
  v_cvt_pk_bf16_f32 v131, v234, v235
  s_mov_b64 exec, -1
  s_mov_b64 exec, s[62:63]
  v_cvt_pk_bf16_f32 v132, v236, v237
  v_cvt_pk_bf16_f32 v133, v238, v239
  v_cvt_pk_bf16_f32 v134, v240, v241
  v_cvt_pk_bf16_f32 v135, v242, v243
  v_cvt_pk_bf16_f32 v136, v244, v245
  v_cvt_pk_bf16_f32 v137, v246, v247
  v_cvt_pk_bf16_f32 v138, v248, v249
  v_cvt_pk_bf16_f32 v139, v250, v251
  s_mov_b64 exec, -1
  ds_read_b128 v[196:199], v2 offset:640
  ds_read_b128 v[184:187], v3 offset:1024
  ds_read_b128 v[200:203], v2 offset:512
  buffer_load_dwordx4 v9, s[8:11], s38 offen offset:2048 nt lds
  s_add_u32 m0, s50, 9216
  v_rcp_f32 v217, v216
  s_mov_b64 exec, s[64:65]
  v_cvt_pk_bf16_f32 v140, v220, v221
  v_cvt_pk_bf16_f32 v141, v222, v223
  v_cvt_pk_bf16_f32 v142, v224, v225
  v_cvt_pk_bf16_f32 v143, v226, v227
  v_cvt_pk_bf16_f32 v144, v228, v229
  v_cvt_pk_bf16_f32 v145, v230, v231
  v_cvt_pk_bf16_f32 v146, v232, v233
  v_cvt_pk_bf16_f32 v147, v234, v235
  v_mfma_f32_32x32x16_bf16 v[220:235], a[120:123], a[0:3], 0
  s_mov_b64 exec, -1
  v_mul_f32 v204, v204, v217
  v_mul_f32 v205, v205, v217
  v_mul_f32 v206, v206, v217
  v_mul_f32 v207, v207, v217
  v_mul_f32 v208, v208, v217
  v_mfma_f32_32x32x16_bf16 v[220:235], a[124:127], a[4:7], v[220:235]
  v_mul_f32 v209, v209, v217
  v_mul_f32 v210, v210, v217
  v_mul_f32 v211, v211, v217
  v_mul_f32 v212, v212, v217
  v_mul_f32 v213, v213, v217
  v_mul_f32 v214, v214, v217
  v_mfma_f32_32x32x16_bf16 v[220:235], a[128:131], a[8:11], v[220:235]
  v_mul_f32 v215, v215, v217
  v_cvt_pk_bf16_f32 v12, v204, v205
  v_cvt_pk_bf16_f32 v13, v206, v207
  v_cvt_pk_bf16_f32 v14, v208, v209
  v_cvt_pk_bf16_f32 v15, v210, v211
  s_waitcnt lgkmcnt(0)
  v_mfma_f32_32x32x16_bf16 v[172:187], v[84:87], v[24:27], v[172:187]
  v_cvt_pk_bf16_f32 v16, v212, v213
  v_cvt_pk_bf16_f32 v17, v214, v215
  s_mov_b64 exec, s[64:65]
  v_cvt_pk_bf16_f32 v148, v236, v237
  v_cvt_pk_bf16_f32 v149, v238, v239
  v_cvt_pk_bf16_f32 v150, v240, v241
  v_mfma_f32_32x32x16_bf16 v[188:203], v[90:93], v[24:27], v[188:203]
  v_cvt_pk_bf16_f32 v151, v242, v243
  v_cvt_pk_bf16_f32 v152, v244, v245
  v_cvt_pk_bf16_f32 v153, v246, v247
  v_cvt_pk_bf16_f32 v154, v248, v249
  v_cvt_pk_bf16_f32 v155, v250, v251
  s_mov_b64 exec, -1
  v_mfma_f32_32x32x8_bf16 v[172:187], v[88:89], v[28:29], v[172:187]
  v_mfma_f32_32x32x16_bf16 v[236:251], a[120:123], a[24:27], 0
  v_mfma_f32_32x32x16_bf16 v[236:251], a[124:127], a[28:31], v[236:251]
  v_mfma_f32_32x32x8_bf16 v[188:203], v[94:95], v[28:29], v[188:203]
  buffer_load_dwordx4 v7, s[8:11], s39 offen offset:0 nt lds
  v_mfma_f32_32x32x16_bf16 v[236:251], a[128:131], a[32:35], v[236:251]
  v_mfma_f32_32x32x16_bf16 v[220:235], a[132:135], a[12:15], v[220:235]
  v_mfma_f32_32x32x16_bf16 v[236:251], a[132:135], a[36:39], v[236:251]
  v_max3_f32 v26, v172, v173, v174
  v_mfma_f32_32x32x16_bf16 v[220:235], a[136:139], a[16:19], v[220:235]
  v_max3_f32 v26, v26, v175, v176
  v_mfma_f32_32x32x16_bf16 v[236:251], a[136:139], a[40:43], v[236:251]
  v_max3_f32 v27, v188, v189, v190
  v_max3_f32 v26, v26, v177, v178
  v_max3_f32 v27, v27, v191, v192
  v_max3_f32 v26, v26, v179, v180
  v_max3_f32 v27, v27, v193, v194
  v_max3_f32 v26, v26, v181, v182
  v_mfma_f32_32x32x16_bf16 v[220:235], a[140:143], a[20:23], v[220:235]
  v_max3_f32 v27, v27, v195, v196
  v_max3_f32 v26, v26, v183, v184
  v_max3_f32 v27, v27, v197, v198
  v_max3_f32 v26, v26, v185, v186
  v_max3_f32 v27, v27, v199, v200
  v_max3_f32 v26, v26, v187, v203
  v_mfma_f32_32x32x16_bf16 v[236:251], a[140:143], a[44:47], v[236:251]
  v_max3_f32 v27, v27, v201, v202
  v_max_f32 v26, v26, v27
  s_nop 1
  v_cvt_pk_bf16_f32 v36, v220, v221
  v_permlane32_swap_b32 v26, v27
  v_cvt_pk_bf16_f32 v37, v222, v223
  v_max_f32 v26, v26, v27
  v_cvt_pk_bf16_f32 v38, v224, v225
  v_and_b32 v27, 0xffff0000, v26
  v_cvt_pk_bf16_f32 v39, v226, v227
  v_sub_f32 v27, v26, v27
  v_cvt_pk_bf16_f32 v40, v228, v229
  v_perm_b32 v24, v27, v26, s53
  v_and_b32 v26, 0xffff0000, v27
  v_cvt_pk_bf16_f32 v41, v230, v231
  v_sub_f32 v25, v27, v26
  v_cvt_pk_bf16_f32 v84, v232, v233
  v_cvt_pk_bf16_f32 v85, v234, v235
  v_mfma_f32_32x32x8_bf16 v[172:187], v[10:11], v[24:25], v[172:187]
  v_cvt_pk_bf16_f32 v48, v236, v237
  v_cvt_pk_bf16_f32 v49, v238, v239
  v_cvt_pk_bf16_f32 v50, v240, v241
  v_cvt_pk_bf16_f32 v51, v242, v243
  v_cvt_pk_bf16_f32 v52, v244, v245
  v_cvt_pk_bf16_f32 v53, v246, v247
  v_cvt_pk_bf16_f32 v90, v248, v249
  v_mfma_f32_32x32x8_bf16 v[188:203], v[10:11], v[24:25], v[188:203]
  v_cvt_pk_bf16_f32 v91, v250, v251
  buffer_load_dwordx4 v8, s[8:11], s39 offen offset:1024 nt lds
  v_mfma_f32_32x32x16_bf16 v[220:235], a[144:147], a[0:3], 0
  v_exp_f32 v172, v172
  v_exp_f32 v173, v173
  v_exp_f32 v174, v174
  v_mfma_f32_32x32x16_bf16 v[236:251], a[144:147], a[24:27], 0
  v_exp_f32 v175, v175
  v_exp_f32 v176, v176
  v_exp_f32 v177, v177
  v_mfma_f32_32x32x16_bf16 v[220:235], a[148:151], a[4:7], v[220:235]
  v_exp_f32 v178, v178
  v_exp_f32 v179, v179
  v_cvt_pk_bf16_f32 v172, v172, v173
  v_cvt_pk_bf16_f32 v173, v174, v175
  v_mfma_f32_32x32x16_bf16 v[236:251], a[148:151], a[28:31], v[236:251]
  v_cvt_pk_bf16_f32 v174, v176, v177
  v_cvt_pk_bf16_f32 v175, v178, v179
  v_exp_f32 v180, v180
  v_exp_f32 v181, v181
  v_mfma_f32_32x32x16_bf16 v[204:219], v[108:111], v[172:175], 0
  ds_read_b128 v[172:175], v2 offset:4736
  v_exp_f32 v182, v182
  v_exp_f32 v183, v183
  v_cvt_pk_bf16_f32 v176, v180, v181
  v_mfma_f32_32x32x16_bf16 v[220:235], a[152:155], a[8:11], v[220:235]
  v_exp_f32 v184, v184
  v_exp_f32 v185, v185
  v_exp_f32 v186, v186
  v_mfma_f32_32x32x16_bf16 v[236:251], a[152:155], a[32:35], v[236:251]
  v_exp_f32 v187, v187
  v_cvt_pk_bf16_f32 v177, v182, v183
  v_cvt_pk_bf16_f32 v178, v184, v185
  v_cvt_pk_bf16_f32 v179, v186, v187
  v_mfma_f32_32x32x16_bf16 v[220:235], a[156:159], a[12:15], v[220:235]
  v_exp_f32 v188, v188
  v_exp_f32 v189, v189
  v_exp_f32 v190, v190
  v_mfma_f32_32x32x16_bf16 v[204:219], v[112:115], v[176:179], v[204:219]
  ds_read_b128 v[176:179], v2 offset:4608
  v_exp_f32 v191, v191
  v_exp_f32 v192, v192
  v_cvt_pk_bf16_f32 v180, v188, v189
  v_mfma_f32_32x32x16_bf16 v[236:251], a[156:159], a[36:39], v[236:251]
  buffer_load_dwordx4 v9, s[8:11], s39 offen offset:2048 nt lds
  s_add_u32 m0, s50, 0
  v_exp_f32 v193, v193
  v_cvt_pk_bf16_f32 v181, v190, v191
  v_mfma_f32_32x32x16_bf16 v[220:235], a[160:163], a[16:19], v[220:235]
  ds_read_b128 v[188:191], v3 offset:4224
  v_exp_f32 v194, v194
  v_exp_f32 v195, v195
  v_cvt_pk_bf16_f32 v182, v192, v193
  v_mfma_f32_32x32x16_bf16 v[236:251], a[160:163], a[40:43], v[236:251]
  v_cvt_pk_bf16_f32 v183, v194, v195
  v_exp_f32 v196, v196
  v_exp_f32 v197, v197
  v_mfma_f32_32x32x16_bf16 v[204:219], v[116:119], v[180:183], v[204:219]
  ds_read_b128 v[180:183], v2 offset:4480
  ds_read_b128 v[192:195], v3 offset:4096
  v_exp_f32 v198, v198
  v_exp_f32 v199, v199
  v_mfma_f32_32x32x16_bf16 v[220:235], a[164:167], a[20:23], v[220:235]
  v_exp_f32 v200, v200
  v_exp_f32 v201, v201
  v_exp_f32 v202, v202
  v_mfma_f32_32x32x16_bf16 v[236:251], a[164:167], a[44:47], v[236:251]
  v_exp_f32 v203, v203
  v_cvt_pk_bf16_f32 v184, v196, v197
  v_cvt_pk_bf16_f32 v185, v198, v199
  v_cvt_pk_bf16_f32 v186, v200, v201
  v_cvt_pk_bf16_f32 v187, v202, v203
  v_cvt_pk_bf16_f32 v86, v220, v221
  v_cvt_pk_bf16_f32 v87, v222, v223
  v_mfma_f32_32x32x16_bf16 v[204:219], v[120:123], v[184:187], v[204:219]
  ds_read_b128 v[184:187], v2 offset:4352
  ds_read_b128 v[196:199], v3 offset:3968
  ds_read_b128 v[200:203], v3 offset:3840
  v_cvt_pk_bf16_f32 v92, v236, v237
  v_cvt_pk_bf16_f32 v93, v238, v239
  v_cvt_pk_bf16_f32 v88, v224, v225
  v_cvt_pk_bf16_f32 v89, v226, v227
  v_cvt_pk_bf16_f32 v94, v240, v241
  v_cvt_pk_bf16_f32 v95, v242, v243
  v_cvt_pk_bf16_f32 v42, v228, v229
  v_cvt_pk_bf16_f32 v43, v230, v231
  v_cvt_pk_bf16_f32 v44, v232, v233
  v_rcp_f32 v217, v216
  v_cvt_pk_bf16_f32 v45, v234, v235
  v_mfma_f32_32x32x16_bf16 v[220:235], a[0:3], a[240:243], 0
  v_mul_f32 v204, v204, v217
  v_mul_f32 v205, v205, v217
  v_mul_f32 v206, v206, v217
  v_mul_f32 v207, v207, v217
  v_mul_f32 v208, v208, v217
  v_mul_f32 v209, v209, v217
  v_mfma_f32_32x32x16_bf16 v[220:235], a[4:7], a[244:247], v[220:235]
  v_mul_f32 v210, v210, v217
  v_mul_f32 v211, v211, v217
  v_mul_f32 v212, v212, v217
  v_mul_f32 v213, v213, v217
  v_mul_f32 v214, v214, v217
  v_mul_f32 v215, v215, v217
  v_mfma_f32_32x32x16_bf16 v[220:235], a[8:11], a[248:251], v[220:235]
  v_cvt_pk_bf16_f32 v24, v204, v205
  v_cvt_pk_bf16_f32 v25, v206, v207
  v_cvt_pk_bf16_f32 v26, v208, v209
  v_cvt_pk_bf16_f32 v27, v210, v211
  v_cvt_pk_bf16_f32 v28, v212, v213
  s_waitcnt lgkmcnt(0)
  v_mfma_f32_32x32x16_bf16 v[172:187], v[96:99], v[18:21], v[172:187]
  v_cvt_pk_bf16_f32 v29, v214, v215
  v_cvt_pk_bf16_f32 v54, v244, v245
  v_cvt_pk_bf16_f32 v55, v246, v247
  v_cvt_pk_bf16_f32 v56, v248, v249
  v_cvt_pk_bf16_f32 v57, v250, v251
  v_mfma_f32_32x32x16_bf16 v[188:203], v[102:105], v[18:21], v[188:203]
  v_mfma_f32_32x32x16_bf16 v[236:251], a[24:27], a[240:243], 0
  ds_read_b64_tr_b16 a[240:241], v0 offset:22528
  ds_read_b64_tr_b16 a[242:243], v0 offset:22784
  v_mfma_f32_32x32x8_bf16 v[172:187], v[100:101], v[22:23], v[172:187]
  v_mfma_f32_32x32x16_bf16 v[236:251], a[28:31], a[244:247], v[236:251]
  ds_read_b64_tr_b16 a[244:245], v0 offset:23552
  ds_read_b64_tr_b16 a[246:247], v0 offset:23808
  v_mfma_f32_32x32x16_bf16 v[220:235], a[12:15], a[252:255], v[220:235]
  v_mfma_f32_32x32x8_bf16 v[188:203], v[106:107], v[22:23], v[188:203]
  v_mfma_f32_32x32x16_bf16 v[236:251], a[32:35], a[248:251], v[236:251]
  ds_read_b64_tr_b16 a[248:249], v0 offset:0
  ds_read_b64_tr_b16 a[250:251], v0 offset:256
  s_waitcnt lgkmcnt(4)
  v_mfma_f32_32x32x16_bf16 v[220:235], a[16:19], a[240:243], v[220:235]
  v_max3_f32 v20, v172, v173, v174
  v_mfma_f32_32x32x16_bf16 v[236:251], a[36:39], a[252:255], v[236:251]
  ds_read_b64_tr_b16 a[252:253], v0 offset:1024
  ds_read_b64_tr_b16 a[254:255], v0 offset:1280
  v_max3_f32 v21, v188, v189, v190
  v_max3_f32 v20, v20, v175, v176
  v_max3_f32 v21, v21, v191, v192
  s_waitcnt lgkmcnt(4)
  v_mfma_f32_32x32x16_bf16 v[220:235], a[20:23], a[244:247], v[220:235]
  v_max3_f32 v20, v20, v177, v178
  v_max3_f32 v21, v21, v193, v194
  v_max3_f32 v20, v20, v179, v180
  v_max3_f32 v21, v21, v195, v196
  v_max3_f32 v20, v20, v181, v182
  v_max3_f32 v21, v21, v197, v198
  v_mfma_f32_32x32x16_bf16 v[236:251], a[40:43], a[240:243], v[236:251]
  ds_read_b64_tr_b16 a[240:241], v0 offset:2048
  ds_read_b64_tr_b16 a[242:243], v0 offset:2304
  v_max3_f32 v20, v20, v183, v184
  v_max3_f32 v21, v21, v199, v200
  v_max3_f32 v20, v20, v185, v186
  v_max3_f32 v21, v21, v201, v202
  v_mfma_f32_32x32x16_bf16 v[236:251], a[44:47], a[244:247], v[236:251]
  ds_read_b64_tr_b16 a[244:245], v0 offset:3072
  ds_read_b64_tr_b16 a[246:247], v0 offset:3328
  v_max3_f32 v20, v20, v187, v203
  s_mov_b64 exec, s[66:67]
  v_cvt_pk_bf16_f32 v140, v220, v221
  v_cvt_pk_bf16_f32 v141, v222, v223
  v_cvt_pk_bf16_f32 v142, v224, v225
  v_cvt_pk_bf16_f32 v143, v226, v227
  v_cvt_pk_bf16_f32 v144, v228, v229
  v_cvt_pk_bf16_f32 v145, v230, v231
  v_cvt_pk_bf16_f32 v146, v232, v233
  v_cvt_pk_bf16_f32 v147, v234, v235
  s_mov_b64 exec, -1
  v_max_f32 v20, v20, v21
  s_mov_b64 exec, s[66:67]
  v_cvt_pk_bf16_f32 v148, v236, v237
  v_cvt_pk_bf16_f32 v149, v238, v239
  v_cvt_pk_bf16_f32 v150, v240, v241
  v_cvt_pk_bf16_f32 v151, v242, v243
  v_cvt_pk_bf16_f32 v152, v244, v245
  v_cvt_pk_bf16_f32 v153, v246, v247
  v_cvt_pk_bf16_f32 v154, v248, v249
  v_cvt_pk_bf16_f32 v155, v250, v251
  s_mov_b64 exec, -1
  v_permlane32_swap_b32 v20, v21
  s_mov_b64 exec, s[68:69]
  v_cvt_pk_bf16_f32 v156, v220, v221
  v_cvt_pk_bf16_f32 v157, v222, v223
  v_cvt_pk_bf16_f32 v158, v224, v225
  v_cvt_pk_bf16_f32 v159, v226, v227
  v_cvt_pk_bf16_f32 v160, v228, v229
  v_cvt_pk_bf16_f32 v161, v230, v231
  v_cvt_pk_bf16_f32 v162, v232, v233
  v_cvt_pk_bf16_f32 v163, v234, v235
  s_waitcnt lgkmcnt(0)
  v_mfma_f32_32x32x16_bf16 v[220:235], a[248:251], a[0:3], 0
  s_mov_b64 exec, -1
  s_waitcnt vmcnt(6)
  ds_read_b128 a[0:3], v4 offset:49152
  v_max_f32 v20, v20, v21
  s_mov_b64 exec, s[68:69]
  v_cvt_pk_bf16_f32 v164, v236, v237
  v_mfma_f32_32x32x16_bf16 v[220:235], a[252:255], a[4:7], v[220:235]
  v_cvt_pk_bf16_f32 v165, v238, v239
  v_cvt_pk_bf16_f32 v166, v240, v241
  v_cvt_pk_bf16_f32 v167, v242, v243
  v_cvt_pk_bf16_f32 v168, v244, v245
  v_cvt_pk_bf16_f32 v169, v246, v247
  v_cvt_pk_bf16_f32 v170, v248, v249
  v_mfma_f32_32x32x16_bf16 v[220:235], a[240:243], a[8:11], v[220:235]
  v_cvt_pk_bf16_f32 v171, v250, v251
  s_mov_b64 exec, -1
  v_and_b32 v21, 0xffff0000, v20
  ds_read_b128 a[4:7], v5 offset:49152
  v_mfma_f32_32x32x16_bf16 v[236:251], a[248:251], a[24:27], 0
  ds_read_b64_tr_b16 a[248:249], v0 offset:4096
  ds_read_b64_tr_b16 a[250:251], v0 offset:4352
  ds_read_b128 a[8:11], v4 offset:49216
  v_sub_f32 v21, v20, v21
  v_mfma_f32_32x32x16_bf16 v[236:251], a[252:255], a[28:31], v[236:251]
  ds_read_b64_tr_b16 a[252:253], v0 offset:5120
  ds_read_b64_tr_b16 a[254:255], v0 offset:5376
  v_perm_b32 v18, v21, v20, s53
  v_and_b32 v20, 0xffff0000, v21
  v_mfma_f32_32x32x16_bf16 v[236:251], a[240:243], a[32:35], v[236:251]
  ds_read_b64_tr_b16 a[240:241], v0 offset:6144
  ds_read_b64_tr_b16 a[242:243], v0 offset:6400
  v_sub_f32 v19, v21, v20
  v_mfma_f32_32x32x16_bf16 v[220:235], a[244:247], a[12:15], v[220:235]
  ds_read_b128 a[12:15], v5 offset:49216
  v_mfma_f32_32x32x8_bf16 v[172:187], v[10:11], v[18:19], v[172:187]
  v_mfma_f32_32x32x8_bf16 v[188:203], v[10:11], v[18:19], v[188:203]
  v_mfma_f32_32x32x16_bf16 v[236:251], a[244:247], a[36:39], v[236:251]
  ds_read_b64_tr_b16 a[244:245], v0 offset:7168
  ds_read_b64_tr_b16 a[246:247], v0 offset:7424
  s_waitcnt lgkmcnt(3)
  v_mfma_f32_32x32x16_bf16 v[220:235], a[248:251], a[16:19], v[220:235]
  ds_read_b128 a[16:19], v4 offset:49280
  v_mfma_f32_32x32x16_bf16 v[236:251], a[248:251], a[40:43], v[236:251]
  ds_read_b64_tr_b16 a[248:249], v0 offset:8192
  ds_read_b64_tr_b16 a[250:251], v0 offset:8448
  v_exp_f32 v172, v172
  v_exp_f32 v173, v173
  v_mfma_f32_32x32x16_bf16 v[220:235], a[252:255], a[20:23], v[220:235]
  ds_read_b128 a[20:23], v5 offset:49280
  v_exp_f32 v174, v174
  v_exp_f32 v175, v175
  v_cvt_pk_bf16_f32 v172, v172, v173
  v_mfma_f32_32x32x16_bf16 v[236:251], a[252:255], a[44:47], v[236:251]
  ds_read_b64_tr_b16 a[252:253], v0 offset:9216
  ds_read_b64_tr_b16 a[254:255], v0 offset:9472
  v_exp_f32 v176, v176
  v_exp_f32 v177, v177
  v_exp_f32 v178, v178
  v_exp_f32 v179, v179
  v_cvt_pk_bf16_f32 v173, v174, v175
  v_cvt_pk_bf16_f32 v174, v176, v177
  v_cvt_pk_bf16_f32 v175, v178, v179
  v_exp_f32 v180, v180
  v_mfma_f32_32x32x16_bf16 v[204:219], v[124:127], v[172:175], 0
  ds_read_b128 v[172:175], v3 offset:5248
  v_exp_f32 v181, v181
  v_exp_f32 v182, v182
  v_exp_f32 v183, v183
  v_exp_f32 v184, v184
  v_exp_f32 v185, v185
  v_exp_f32 v186, v186
  v_exp_f32 v187, v187
  v_cvt_pk_bf16_f32 v176, v180, v181
  v_cvt_pk_bf16_f32 v177, v182, v183
  v_cvt_pk_bf16_f32 v178, v184, v185
  v_cvt_pk_bf16_f32 v179, v186, v187
  v_exp_f32 v188, v188
  v_mfma_f32_32x32x16_bf16 v[204:219], v[128:131], v[176:179], v[204:219]
  ds_read_b128 v[176:179], v3 offset:5120
  s_waitcnt vmcnt(0)
  ds_read_b128 a[24:27], v4 offset:55296
  ds_read_b128 a[28:31], v5 offset:55296
  s_waitcnt lgkmcnt(4)
  buffer_load_dwordx4 v7, s[8:11], s40 offen offset:0 nt lds
  ds_read_b128 a[32:35], v4 offset:55360
  v_exp_f32 v189, v189
  v_exp_f32 v190, v190
  v_exp_f32 v191, v191
  v_exp_f32 v192, v192
  v_exp_f32 v193, v193
  v_exp_f32 v194, v194
  v_exp_f32 v195, v195
  v_cvt_pk_bf16_f32 v180, v188, v189
  v_cvt_pk_bf16_f32 v181, v190, v191
  v_cvt_pk_bf16_f32 v182, v192, v193
  v_cvt_pk_bf16_f32 v183, v194, v195
  v_exp_f32 v196, v196
  v_mfma_f32_32x32x16_bf16 v[204:219], v[132:135], v[180:183], v[204:219]
  ds_read_b128 v[180:183], v3 offset:4992
  ds_read_b128 v[188:191], v2 offset:4736
  ds_read_b128 v[192:195], v2 offset:4608
  v_exp_f32 v197, v197
  v_exp_f32 v198, v198
  v_exp_f32 v199, v199
  v_exp_f32 v200, v200
  v_exp_f32 v201, v201
  v_exp_f32 v202, v202
  v_exp_f32 v203, v203
  v_cvt_pk_bf16_f32 v184, v196, v197
  v_cvt_pk_bf16_f32 v185, v198, v199
  v_cvt_pk_bf16_f32 v186, v200, v201
  v_cvt_pk_bf16_f32 v187, v202, v203
  v_cvt_pk_bf16_f32 v46, v220, v221
  v_cvt_pk_bf16_f32 v47, v222, v223
  v_mfma_f32_32x32x16_bf16 v[204:219], v[136:139], v[184:187], v[204:219]
  ds_read_b128 v[184:187], v3 offset:4864
  ds_read_b128 v[196:199], v2 offset:4480
  ds_read_b128 v[200:203], v2 offset:4352
  v_cvt_pk_bf16_f32 v58, v236, v237
  v_cvt_pk_bf16_f32 v59, v238, v239
  ds_read_b128 a[36:39], v5 offset:55360
  ds_read_b128 a[40:43], v4 offset:55424
  s_nop 4
  v_rcp_f32 v213, v212
  ds_read_b128 a[44:47], v5 offset:55424
  buffer_load_dwordx4 v8, s[8:11], s40 offen offset:1024 nt lds
  v_mul_f32 v216, v216, v213
  v_mul_f32 v217, v217, v213
  v_mul_f32 v218, v218, v213
  v_mul_f32 v219, v219, v213
  v_mul_f32 v204, v204, v213
  v_mul_f32 v205, v205, v213
  v_mul_f32 v206, v206, v213
  v_mul_f32 v207, v207, v213
  v_mul_f32 v208, v208, v213
  v_mul_f32 v209, v209, v213
  v_mul_f32 v210, v210, v213
  v_mul_f32 v211, v211, v213
  v_cvt_pk_bf16_f32 v18, v216, v217
  v_cvt_pk_bf16_f32 v19, v218, v219
  s_waitcnt lgkmcnt(5)
  v_mfma_f32_32x32x16_bf16 v[172:187], v[96:99], v[30:33], v[172:187]
  v_cvt_pk_bf16_f32 v20, v204, v205
  v_cvt_pk_bf16_f32 v21, v206, v207
  v_cvt_pk_bf16_f32 v22, v208, v209
  v_cvt_pk_bf16_f32 v23, v210, v211
  v_cvt_pk_bf16_f32 v96, v224, v225
  s_waitcnt lgkmcnt(2)
  v_mfma_f32_32x32x16_bf16 v[188:203], v[102:105], v[30:33], v[188:203]
  v_cvt_pk_bf16_f32 v97, v226, v227
  v_cvt_pk_bf16_f32 v98, v228, v229
  v_cvt_pk_bf16_f32 v99, v230, v231
  v_cvt_pk_bf16_f32 v102, v240, v241
  v_cvt_pk_bf16_f32 v103, v242, v243
  v_cvt_pk_bf16_f32 v104, v244, v245
  v_cvt_pk_bf16_f32 v105, v246, v247
  v_mfma_f32_32x32x8_bf16 v[172:187], v[100:101], v[34:35], v[172:187]
  v_cvt_pk_bf16_f32 v100, v232, v233
  v_cvt_pk_bf16_f32 v101, v234, v235
  v_mfma_f32_32x32x8_bf16 v[188:203], v[106:107], v[34:35], v[188:203]
  v_cvt_pk_bf16_f32 v106, v248, v249
  v_cvt_pk_bf16_f32 v107, v250, v251
  v_mfma_f32_32x32x16_bf16 v[220:235], a[0:3], a[240:243], 0
  v_mfma_f32_32x32x16_bf16 v[236:251], a[24:27], a[240:243], 0
  ds_read_b64_tr_b16 a[240:241], v0 offset:10240
  ds_read_b64_tr_b16 a[242:243], v0 offset:10496
  v_mfma_f32_32x32x16_bf16 v[220:235], a[4:7], a[244:247], v[220:235]
  buffer_load_dwordx4 v9, s[8:11], s40 offen offset:2048 nt lds
  s_add_u32 m0, s50, 3072
  v_max3_f32 v32, v172, v173, v174
  v_max3_f32 v33, v188, v189, v190
  v_max3_f32 v32, v32, v175, v176
  v_mfma_f32_32x32x16_bf16 v[236:251], a[28:31], a[244:247], v[236:251]
  ds_read_b64_tr_b16 a[244:245], v0 offset:11264
  ds_read_b64_tr_b16 a[246:247], v0 offset:11520
  v_max3_f32 v33, v33, v191, v192
  v_max3_f32 v32, v32, v177, v178
  v_max3_f32 v33, v33, v193, v194
  v_max3_f32 v32, v32, v179, v180
  v_mfma_f32_32x32x16_bf16 v[220:235], a[8:11], a[248:251], v[220:235]
  v_max3_f32 v33, v33, v195, v196
  v_max3_f32 v32, v32, v181, v182
  v_max3_f32 v33, v33, v197, v198
  v_max3_f32 v32, v32, v183, v184
  v_max3_f32 v33, v33, v199, v200
  v_max3_f32 v32, v32, v185, v186
  v_mfma_f32_32x32x16_bf16 v[220:235], a[12:15], a[252:255], v[220:235]
  v_max3_f32 v33, v33, v201, v202
  v_max3_f32 v32, v32, v187, v203
  v_mfma_f32_32x32x16_bf16 v[236:251], a[32:35], a[248:251], v[236:251]
  ds_read_b64_tr_b16 a[248:249], v0 offset:12288
  ds_read_b64_tr_b16 a[250:251], v0 offset:12544
  v_max_f32 v32, v32, v33
  s_waitcnt lgkmcnt(4)
  v_mfma_f32_32x32x16_bf16 v[220:235], a[16:19], a[240:243], v[220:235]
  v_permlane32_swap_b32 v32, v33
  v_mfma_f32_32x32x16_bf16 v[236:251], a[36:39], a[252:255], v[236:251]
  ds_read_b64_tr_b16 a[252:253], v0 offset:13312
  ds_read_b64_tr_b16 a[254:255], v0 offset:13568
  v_max_f32 v32, v32, v33
  s_waitcnt lgkmcnt(4)
  v_mfma_f32_32x32x16_bf16 v[220:235], a[20:23], a[244:247], v[220:235]
  v_and_b32 v33, 0xffff0000, v32
  v_mfma_f32_32x32x16_bf16 v[236:251], a[40:43], a[240:243], v[236:251]
  ds_read_b64_tr_b16 a[240:241], v0 offset:14336
  ds_read_b64_tr_b16 a[242:243], v0 offset:14592
  buffer_load_dwordx4 v7, s[8:11], s41 offen offset:0 nt lds
  v_sub_f32 v33, v32, v33
  v_mfma_f32_32x32x16_bf16 v[236:251], a[44:47], a[244:247], v[236:251]
  ds_read_b64_tr_b16 a[244:245], v0 offset:15360
  ds_read_b64_tr_b16 a[246:247], v0 offset:15616
  v_perm_b32 v30, v33, v32, s53
  v_and_b32 v32, 0xffff0000, v33
  s_mov_b64 exec, s[48:49]
  v_cvt_pk_bf16_f32 v108, v220, v221
  v_cvt_pk_bf16_f32 v109, v222, v223
  v_cvt_pk_bf16_f32 v110, v224, v225
  v_cvt_pk_bf16_f32 v111, v226, v227
  v_cvt_pk_bf16_f32 v112, v228, v229
  v_cvt_pk_bf16_f32 v113, v230, v231
  v_cvt_pk_bf16_f32 v114, v232, v233
  v_cvt_pk_bf16_f32 v115, v234, v235
  s_mov_b64 exec, -1
  v_sub_f32 v31, v33, v32
  s_mov_b64 exec, s[48:49]
  v_cvt_pk_bf16_f32 v116, v236, v237
  v_cvt_pk_bf16_f32 v117, v238, v239
  v_cvt_pk_bf16_f32 v118, v240, v241
  v_cvt_pk_bf16_f32 v119, v242, v243
  v_cvt_pk_bf16_f32 v120, v244, v245
  v_cvt_pk_bf16_f32 v121, v246, v247
  v_cvt_pk_bf16_f32 v122, v248, v249
  v_cvt_pk_bf16_f32 v123, v250, v251
  s_mov_b64 exec, -1
  v_mfma_f32_32x32x8_bf16 v[172:187], v[10:11], v[30:31], v[172:187]
  v_mfma_f32_32x32x8_bf16 v[188:203], v[10:11], v[30:31], v[188:203]
  s_nop 10
  v_exp_f32 v172, v172
  v_exp_f32 v173, v173
  v_exp_f32 v174, v174
  v_cvt_pk_bf16_f32 v172, v172, v173
  v_exp_f32 v175, v175
  v_exp_f32 v176, v176
  v_exp_f32 v177, v177
  v_exp_f32 v178, v178
  v_exp_f32 v179, v179
  v_cvt_pk_bf16_f32 v173, v174, v175
  v_cvt_pk_bf16_f32 v174, v176, v177
  v_cvt_pk_bf16_f32 v175, v178, v179
  v_exp_f32 v180, v180
  v_mfma_f32_32x32x16_bf16 v[204:219], v[124:127], v[172:175], 0
  ds_read_b128 v[172:175], v2 offset:8576
  buffer_load_dwordx4 v8, s[8:11], s41 offen offset:1024 nt lds
  v_exp_f32 v181, v181
  v_exp_f32 v182, v182
  v_exp_f32 v183, v183
  v_exp_f32 v184, v184
  v_exp_f32 v185, v185
  v_exp_f32 v186, v186
  v_exp_f32 v187, v187
  v_cvt_pk_bf16_f32 v176, v180, v181
  v_cvt_pk_bf16_f32 v177, v182, v183
  v_cvt_pk_bf16_f32 v178, v184, v185
  v_cvt_pk_bf16_f32 v179, v186, v187
  v_exp_f32 v188, v188
  v_mfma_f32_32x32x16_bf16 v[204:219], v[128:131], v[176:179], v[204:219]
  ds_read_b128 v[176:179], v2 offset:8448
  v_exp_f32 v189, v189
  v_exp_f32 v190, v190
  v_exp_f32 v191, v191
  v_exp_f32 v192, v192
  v_exp_f32 v193, v193
  v_exp_f32 v194, v194
  v_exp_f32 v195, v195
  v_cvt_pk_bf16_f32 v180, v188, v189
  v_cvt_pk_bf16_f32 v181, v190, v191
  v_cvt_pk_bf16_f32 v182, v192, v193
  v_cvt_pk_bf16_f32 v183, v194, v195
  v_exp_f32 v196, v196
  v_mfma_f32_32x32x16_bf16 v[204:219], v[132:135], v[180:183], v[204:219]
  ds_read_b128 v[180:183], v2 offset:8320
  ds_read_b128 v[188:191], v3 offset:8064
  ds_read_b128 v[192:195], v3 offset:7936
  v_exp_f32 v197, v197
  v_exp_f32 v198, v198
  v_exp_f32 v199, v199
  v_exp_f32 v200, v200
  v_exp_f32 v201, v201
  v_exp_f32 v202, v202
  v_exp_f32 v203, v203
  v_cvt_pk_bf16_f32 v184, v196, v197
  v_cvt_pk_bf16_f32 v185, v198, v199
  v_cvt_pk_bf16_f32 v186, v200, v201
  v_cvt_pk_bf16_f32 v187, v202, v203
  s_mov_b64 exec, s[60:61]
  v_cvt_pk_bf16_f32 v124, v220, v221
  v_mfma_f32_32x32x16_bf16 v[204:219], v[136:139], v[184:187], v[204:219]
  v_cvt_pk_bf16_f32 v125, v222, v223
  v_cvt_pk_bf16_f32 v126, v224, v225
  v_cvt_pk_bf16_f32 v127, v226, v227
  v_cvt_pk_bf16_f32 v128, v228, v229
  v_cvt_pk_bf16_f32 v129, v230, v231
  v_cvt_pk_bf16_f32 v130, v232, v233
  v_cvt_pk_bf16_f32 v131, v234, v235
  v_mfma_f32_32x32x16_bf16 v[220:235], a[48:51], a[0:3], 0
  s_mov_b64 exec, -1
  ds_read_b128 v[184:187], v2 offset:8192
  ds_read_b128 v[196:199], v3 offset:7808
  ds_read_b128 v[200:203], v3 offset:7680
  buffer_load_dwordx4 v9, s[8:11], s41 offen offset:2048 nt lds
  v_mfma_f32_32x32x16_bf16 v[220:235], a[52:55], a[4:7], v[220:235]
  s_add_u32 m0, s50, 6144
  v_rcp_f32 v213, v212
  s_mov_b64 exec, s[60:61]
  v_cvt_pk_bf16_f32 v132, v236, v237
  v_cvt_pk_bf16_f32 v133, v238, v239
  v_mfma_f32_32x32x16_bf16 v[220:235], a[56:59], a[8:11], v[220:235]
  v_cvt_pk_bf16_f32 v134, v240, v241
  v_cvt_pk_bf16_f32 v135, v242, v243
  v_cvt_pk_bf16_f32 v136, v244, v245
  v_cvt_pk_bf16_f32 v137, v246, v247
  v_cvt_pk_bf16_f32 v138, v248, v249
  v_cvt_pk_bf16_f32 v139, v250, v251
  v_mfma_f32_32x32x16_bf16 v[236:251], a[48:51], a[24:27], 0
  s_mov_b64 exec, -1
  v_mul_f32 v216, v216, v213
  v_mul_f32 v217, v217, v213
  v_mul_f32 v218, v218, v213
  v_mul_f32 v219, v219, v213
  v_mul_f32 v204, v204, v213
  v_mfma_f32_32x32x16_bf16 v[236:251], a[52:55], a[28:31], v[236:251]
  v_mul_f32 v205, v205, v213
  v_mul_f32 v206, v206, v213
  v_mul_f32 v207, v207, v213
  v_mul_f32 v208, v208, v213
  v_mul_f32 v209, v209, v213
  s_waitcnt lgkmcnt(0)
  v_mfma_f32_32x32x16_bf16 v[172:187], v[84:87], v[36:39], v[172:187]
  v_mul_f32 v210, v210, v213
  v_mul_f32 v211, v211, v213
  v_cvt_pk_bf16_f32 v30, v216, v217
  v_cvt_pk_bf16_f32 v31, v218, v219
  v_cvt_pk_bf16_f32 v32, v204, v205
  v_cvt_pk_bf16_f32 v33, v206, v207
  v_mfma_f32_32x32x16_bf16 v[188:203], v[90:93], v[36:39], v[188:203]
  v_cvt_pk_bf16_f32 v34, v208, v209
  v_cvt_pk_bf16_f32 v35, v210, v211
  v_mfma_f32_32x32x8_bf16 v[172:187], v[88:89], v[40:41], v[172:187]
  v_mfma_f32_32x32x16_bf16 v[220:235], a[60:63], a[12:15], v[220:235]
  v_mfma_f32_32x32x16_bf16 v[236:251], a[56:59], a[32:35], v[236:251]
  buffer_load_dwordx4 v7, s[8:11], s42 offen offset:0 nt lds
  v_mfma_f32_32x32x16_bf16 v[220:235], a[64:67], a[16:19], v[220:235]
  v_mfma_f32_32x32x8_bf16 v[188:203], v[94:95], v[40:41], v[188:203]
  v_mfma_f32_32x32x16_bf16 v[236:251], a[60:63], a[36:39], v[236:251]
  v_mfma_f32_32x32x16_bf16 v[220:235], a[68:71], a[20:23], v[220:235]
  v_max3_f32 v38, v172, v173, v174
  v_mfma_f32_32x32x16_bf16 v[236:251], a[64:67], a[40:43], v[236:251]
  v_max3_f32 v38, v38, v175, v176
  v_mfma_f32_32x32x16_bf16 v[236:251], a[68:71], a[44:47], v[236:251]
  v_max3_f32 v38, v38, v177, v178
  s_nop 0
  v_max3_f32 v39, v188, v189, v190
  v_max3_f32 v38, v38, v179, v180
  v_max3_f32 v39, v39, v191, v192
  v_max3_f32 v38, v38, v181, v182
  v_max3_f32 v39, v39, v193, v194
  v_max3_f32 v38, v38, v183, v184
  v_max3_f32 v39, v39, v195, v196
  v_max3_f32 v38, v38, v185, v186
  v_max3_f32 v39, v39, v197, v198
  v_max3_f32 v38, v38, v187, v203
  v_max3_f32 v39, v39, v199, v200
  v_cvt_pk_bf16_f32 v60, v220, v221
  v_max3_f32 v39, v39, v201, v202
  v_cvt_pk_bf16_f32 v61, v222, v223
  v_max_f32 v38, v38, v39
  v_cvt_pk_bf16_f32 v62, v224, v225
  v_cvt_pk_bf16_f32 v63, v226, v227
  v_permlane32_swap_b32 v38, v39
  v_cvt_pk_bf16_f32 v64, v228, v229
  v_max_f32 v38, v38, v39
  v_cvt_pk_bf16_f32 v65, v230, v231
  v_and_b32 v39, 0xffff0000, v38
  v_cvt_pk_bf16_f32 v72, v236, v237
  v_sub_f32 v39, v38, v39
  v_cvt_pk_bf16_f32 v73, v238, v239
  v_perm_b32 v36, v39, v38, s53
  v_and_b32 v38, 0xffff0000, v39
  v_cvt_pk_bf16_f32 v74, v240, v241
  v_sub_f32 v37, v39, v38
  v_cvt_pk_bf16_f32 v75, v242, v243
  v_cvt_pk_bf16_f32 v76, v244, v245
  v_mfma_f32_32x32x8_bf16 v[172:187], v[10:11], v[36:37], v[172:187]
  v_cvt_pk_bf16_f32 v77, v246, v247
  buffer_load_dwordx4 v8, s[8:11], s42 offen offset:1024 nt lds
  v_mfma_f32_32x32x8_bf16 v[188:203], v[10:11], v[36:37], v[188:203]
  s_nop 8
  v_exp_f32 v172, v172
  v_exp_f32 v173, v173
  v_exp_f32 v174, v174
  v_cvt_pk_bf16_f32 v172, v172, v173
  v_exp_f32 v175, v175
  v_exp_f32 v176, v176
  v_exp_f32 v177, v177
  v_exp_f32 v178, v178
  v_exp_f32 v179, v179
  v_cvt_pk_bf16_f32 v173, v174, v175
  v_cvt_pk_bf16_f32 v174, v176, v177
  v_cvt_pk_bf16_f32 v175, v178, v179
  v_exp_f32 v180, v180
  v_mfma_f32_32x32x16_bf16 v[204:219], v[140:143], v[172:175], 0
  ds_read_b128 v[172:175], v3 offset:9088
  v_exp_f32 v181, v181
  v_exp_f32 v182, v182
  v_exp_f32 v183, v183
  v_exp_f32 v184, v184
  v_exp_f32 v185, v185
  v_exp_f32 v186, v186
  v_exp_f32 v187, v187
  v_cvt_pk_bf16_f32 v176, v180, v181
  v_cvt_pk_bf16_f32 v177, v182, v183
  v_cvt_pk_bf16_f32 v178, v184, v185
  v_cvt_pk_bf16_f32 v179, v186, v187
  v_exp_f32 v188, v188
  v_mfma_f32_32x32x16_bf16 v[204:219], v[144:147], v[176:179], v[204:219]
  ds_read_b128 v[176:179], v3 offset:8960
  v_exp_f32 v189, v189
  v_exp_f32 v190, v190
  v_exp_f32 v191, v191
  v_exp_f32 v192, v192
  v_exp_f32 v193, v193
  v_exp_f32 v194, v194
  v_exp_f32 v195, v195
  v_cvt_pk_bf16_f32 v180, v188, v189
  v_cvt_pk_bf16_f32 v181, v190, v191
  v_cvt_pk_bf16_f32 v182, v192, v193
  v_cvt_pk_bf16_f32 v183, v194, v195
  v_exp_f32 v196, v196
  v_mfma_f32_32x32x16_bf16 v[204:219], v[148:151], v[180:183], v[204:219]
  ds_read_b128 v[180:183], v3 offset:8832
  ds_read_b128 v[188:191], v2 offset:8576
  ds_read_b128 v[192:195], v2 offset:8448
  buffer_load_dwordx4 v9, s[8:11], s42 offen offset:2048 nt lds
  s_add_u32 m0, s50, 9216
  v_exp_f32 v197, v197
  v_exp_f32 v198, v198
  v_exp_f32 v199, v199
  v_exp_f32 v200, v200
  v_exp_f32 v201, v201
  v_exp_f32 v202, v202
  v_exp_f32 v203, v203
  v_cvt_pk_bf16_f32 v184, v196, v197
  v_cvt_pk_bf16_f32 v185, v198, v199
  v_cvt_pk_bf16_f32 v186, v200, v201
  v_cvt_pk_bf16_f32 v187, v202, v203
  ds_read_b128 v[196:199], v2 offset:8320
  ds_read_b128 v[200:203], v2 offset:8192
  v_mfma_f32_32x32x16_bf16 v[204:219], v[152:155], v[184:187], v[204:219]
  ds_read_b128 v[184:187], v3 offset:8704
  s_nop 10
  v_rcp_f32 v209, v208
  s_nop 0
  v_mul_f32 v212, v212, v209
  v_mul_f32 v213, v213, v209
  v_mul_f32 v214, v214, v209
  v_cvt_pk_bf16_f32 v36, v212, v213
  v_mul_f32 v215, v215, v209
  v_mul_f32 v216, v216, v209
  v_cvt_pk_bf16_f32 v37, v214, v215
  v_mul_f32 v217, v217, v209
  v_mul_f32 v218, v218, v209
  v_mul_f32 v219, v219, v209
  v_mul_f32 v204, v204, v209
  v_mul_f32 v205, v205, v209
  v_mul_f32 v206, v206, v209
  v_mul_f32 v207, v207, v209
  v_cvt_pk_bf16_f32 v38, v216, v217
  s_waitcnt lgkmcnt(1)
  v_mfma_f32_32x32x16_bf16 v[188:203], v[90:93], v[48:51], v[188:203]
  v_cvt_pk_bf16_f32 v39, v218, v219
  v_cvt_pk_bf16_f32 v40, v204, v205
  v_cvt_pk_bf16_f32 v41, v206, v207
  v_cvt_pk_bf16_f32 v90, v248, v249
  v_cvt_pk_bf16_f32 v91, v250, v251
  s_waitcnt lgkmcnt(0)
  v_mfma_f32_32x32x16_bf16 v[172:187], v[84:87], v[48:51], v[172:187]
  buffer_load_dwordx4 v7, s[8:11], s43 offen offset:0 nt lds
  v_cvt_pk_bf16_f32 v84, v232, v233
  v_cvt_pk_bf16_f32 v85, v234, v235
  v_mfma_f32_32x32x8_bf16 v[188:203], v[94:95], v[52:53], v[188:203]
  v_mfma_f32_32x32x16_bf16 v[220:235], a[72:75], a[0:3], 0
  v_mfma_f32_32x32x16_bf16 v[220:235], a[76:79], a[4:7], v[220:235]
  v_mfma_f32_32x32x16_bf16 v[236:251], a[72:75], a[24:27], 0
  v_mfma_f32_32x32x8_bf16 v[172:187], v[88:89], v[52:53], v[172:187]
  v_mfma_f32_32x32x16_bf16 v[220:235], a[80:83], a[8:11], v[220:235]
  v_mfma_f32_32x32x16_bf16 v[236:251], a[76:79], a[28:31], v[236:251]
  v_mfma_f32_32x32x16_bf16 v[220:235], a[84:87], a[12:15], v[220:235]
  buffer_load_dwordx4 v8, s[8:11], s43 offen offset:1024 nt lds
  v_max3_f32 v51, v188, v189, v190
  v_mfma_f32_32x32x16_bf16 v[236:251], a[80:83], a[32:35], v[236:251]
  v_max3_f32 v51, v51, v191, v192
  v_mfma_f32_32x32x16_bf16 v[220:235], a[88:91], a[16:19], v[220:235]
  v_max3_f32 v50, v172, v173, v174
  v_max3_f32 v51, v51, v193, v194
  v_max3_f32 v50, v50, v175, v176
  v_max3_f32 v51, v51, v195, v196
  v_max3_f32 v50, v50, v177, v178
  v_max3_f32 v51, v51, v197, v198
  v_mfma_f32_32x32x16_bf16 v[236:251], a[84:87], a[36:39], v[236:251]
  v_max3_f32 v50, v50, v179, v180
  v_max3_f32 v51, v51, v199, v200
  v_max3_f32 v50, v50, v181, v182
  v_max3_f32 v51, v51, v201, v202
  v_max3_f32 v50, v50, v183, v184
  v_mfma_f32_32x32x16_bf16 v[220:235], a[92:95], a[20:23], v[220:235]
  v_max3_f32 v50, v50, v185, v186
  v_mfma_f32_32x32x16_bf16 v[236:251], a[88:91], a[40:43], v[236:251]
  v_max3_f32 v50, v50, v187, v203
  v_mfma_f32_32x32x16_bf16 v[236:251], a[92:95], a[44:47], v[236:251]
  v_max_f32 v50, v50, v51
  s_nop 4
  v_cvt_pk_bf16_f32 v86, v220, v221
  v_cvt_pk_bf16_f32 v87, v222, v223
  v_permlane32_swap_b32 v50, v51
  v_cvt_pk_bf16_f32 v88, v224, v225
  v_max_f32 v50, v50, v51
  v_cvt_pk_bf16_f32 v89, v226, v227
  v_and_b32 v51, 0xffff0000, v50
  v_cvt_pk_bf16_f32 v66, v228, v229
  v_sub_f32 v51, v50, v51
  v_cvt_pk_bf16_f32 v67, v230, v231
  v_perm_b32 v48, v51, v50, s53
  v_and_b32 v50, 0xffff0000, v51
  v_cvt_pk_bf16_f32 v68, v232, v233
  v_sub_f32 v49, v51, v50
  v_cvt_pk_bf16_f32 v69, v234, v235
  v_mfma_f32_32x32x16_bf16 v[220:235], a[168:171], v[12:15], 0
  buffer_load_dwordx4 v9, s[8:11], s43 offen offset:2048 nt lds
  s_add_u32 m0, s50, 0
  v_cvt_pk_bf16_f32 v92, v236, v237
  v_cvt_pk_bf16_f32 v93, v238, v239
  v_cvt_pk_bf16_f32 v94, v240, v241
  v_cvt_pk_bf16_f32 v95, v242, v243
  v_mfma_f32_32x32x8_bf16 v[172:187], v[10:11], v[48:49], v[172:187]
  v_cvt_pk_bf16_f32 v78, v244, v245
  v_cvt_pk_bf16_f32 v79, v246, v247
  v_cvt_pk_bf16_f32 v80, v248, v249
  v_cvt_pk_bf16_f32 v81, v250, v251
  v_mfma_f32_32x32x8_bf16 v[188:203], v[10:11], v[48:49], v[188:203]
  v_mfma_f32_32x32x16_bf16 v[220:235], a[172:175], v[16:19], v[220:235]
  v_mfma_f32_32x32x16_bf16 v[236:251], a[192:195], v[12:15], 0
  v_mfma_f32_32x32x16_bf16 v[220:235], a[176:179], v[20:23], v[220:235]
  v_mfma_f32_32x32x16_bf16 v[236:251], a[196:199], v[16:19], v[236:251]
  v_exp_f32 v172, v172
  v_exp_f32 v173, v173
  v_exp_f32 v174, v174
  v_mfma_f32_32x32x16_bf16 v[220:235], a[180:183], v[36:39], v[220:235]
  v_exp_f32 v175, v175
  v_exp_f32 v176, v176
  v_exp_f32 v177, v177
  v_mfma_f32_32x32x16_bf16 v[236:251], a[200:203], v[20:23], v[236:251]
  v_exp_f32 v178, v178
  v_exp_f32 v179, v179
  v_cvt_pk_bf16_f32 v172, v172, v173
  v_cvt_pk_bf16_f32 v173, v174, v175
  v_mfma_f32_32x32x16_bf16 v[236:251], a[204:207], v[36:39], v[236:251]
  v_cvt_pk_bf16_f32 v174, v176, v177
  v_cvt_pk_bf16_f32 v175, v178, v179
  v_exp_f32 v180, v180
  v_exp_f32 v181, v181
  v_mfma_f32_32x32x16_bf16 v[204:219], v[140:143], v[172:175], 0
  ds_read_b128 v[172:175], v2 offset:12416
  v_exp_f32 v182, v182
  v_exp_f32 v183, v183
  v_exp_f32 v184, v184
  v_exp_f32 v185, v185
  v_exp_f32 v186, v186
  v_exp_f32 v187, v187
  v_cvt_pk_bf16_f32 v176, v180, v181
  v_cvt_pk_bf16_f32 v177, v182, v183
  v_cvt_pk_bf16_f32 v178, v184, v185
  v_cvt_pk_bf16_f32 v179, v186, v187
  v_exp_f32 v188, v188
  v_mfma_f32_32x32x16_bf16 v[204:219], v[144:147], v[176:179], v[204:219]
  ds_read_b128 v[176:179], v2 offset:12288
  v_exp_f32 v189, v189
  v_exp_f32 v190, v190
  v_exp_f32 v191, v191
  v_exp_f32 v192, v192
  v_exp_f32 v193, v193
  v_exp_f32 v194, v194
  v_exp_f32 v195, v195
  v_cvt_pk_bf16_f32 v180, v188, v189
  v_cvt_pk_bf16_f32 v181, v190, v191
  v_cvt_pk_bf16_f32 v182, v192, v193
  v_cvt_pk_bf16_f32 v183, v194, v195
  v_exp_f32 v196, v196
  v_mfma_f32_32x32x16_bf16 v[204:219], v[148:151], v[180:183], v[204:219]
  ds_read_b128 v[180:183], v2 offset:12160
  ds_read_b128 v[188:191], v3 offset:11904
  ds_read_b128 v[192:195], v3 offset:11776
  v_exp_f32 v197, v197
  v_exp_f32 v198, v198
  v_exp_f32 v199, v199
  v_exp_f32 v200, v200
  v_exp_f32 v201, v201
  v_exp_f32 v202, v202
  v_exp_f32 v203, v203
  v_cvt_pk_bf16_f32 v184, v196, v197
  v_cvt_pk_bf16_f32 v185, v198, v199
  v_cvt_pk_bf16_f32 v186, v200, v201
  v_cvt_pk_bf16_f32 v187, v202, v203
  ds_read_b128 v[196:199], v3 offset:11648
  ds_read_b128 v[200:203], v3 offset:11520
  v_mfma_f32_32x32x16_bf16 v[204:219], v[152:155], v[184:187], v[204:219]
  ds_read_b128 v[184:187], v2 offset:12032
  s_nop 10
  v_rcp_f32 v209, v208
  s_nop 0
  v_mul_f32 v212, v212, v209
  v_mul_f32 v213, v213, v209
  v_mul_f32 v214, v214, v209
  v_cvt_pk_bf16_f32 v48, v212, v213
  v_mul_f32 v215, v215, v209
  v_mul_f32 v216, v216, v209
  v_cvt_pk_bf16_f32 v49, v214, v215
  v_mul_f32 v217, v217, v209
  v_mul_f32 v218, v218, v209
  v_mul_f32 v219, v219, v209
  v_mul_f32 v204, v204, v209
  v_mul_f32 v205, v205, v209
  v_mul_f32 v206, v206, v209
  v_mul_f32 v207, v207, v209
  v_cvt_pk_bf16_f32 v50, v216, v217
  s_waitcnt lgkmcnt(1)
  v_mfma_f32_32x32x16_bf16 v[188:203], v[102:105], v[42:45], v[188:203]
  v_cvt_pk_bf16_f32 v51, v218, v219
  v_cvt_pk_bf16_f32 v52, v204, v205
  v_cvt_pk_bf16_f32 v53, v206, v207
  s_waitcnt lgkmcnt(0)
  v_mfma_f32_32x32x16_bf16 v[172:187], v[96:99], v[42:45], v[172:187]
  s_nop 3
  v_mfma_f32_32x32x8_bf16 v[188:203], v[106:107], v[46:47], v[188:203]
  s_nop 4
  v_mfma_f32_32x32x8_bf16 v[172:187], v[100:101], v[46:47], v[172:187]
  s_nop 5
  v_max3_f32 v45, v188, v189, v190
  v_max3_f32 v45, v45, v191, v192
  v_max3_f32 v45, v45, v193, v194
  v_max3_f32 v45, v45, v195, v196
  v_max3_f32 v45, v45, v197, v198
  v_max3_f32 v45, v45, v199, v200
  v_max3_f32 v44, v172, v173, v174
  v_max3_f32 v45, v45, v201, v202
  v_max3_f32 v44, v44, v175, v176
  v_max3_f32 v44, v44, v177, v178
  v_max3_f32 v44, v44, v179, v180
  v_max3_f32 v44, v44, v181, v182
  v_max3_f32 v44, v44, v183, v184
  v_max3_f32 v44, v44, v185, v186
  v_max3_f32 v44, v44, v187, v203
  v_max_f32 v44, v44, v45
  s_nop 1
  v_permlane32_swap_b32 v44, v45
  v_max_f32 v44, v44, v45
  v_and_b32 v45, 0xffff0000, v44
  v_sub_f32 v45, v44, v45
  v_perm_b32 v42, v45, v44, s53
  v_and_b32 v44, 0xffff0000, v45
  v_sub_f32 v43, v45, v44
  s_nop 1
  v_mfma_f32_32x32x8_bf16 v[172:187], v[10:11], v[42:43], v[172:187]
  v_mfma_f32_32x32x8_bf16 v[188:203], v[10:11], v[42:43], v[188:203]
  s_nop 10
  v_exp_f32 v172, v172
  v_exp_f32 v173, v173
  v_exp_f32 v174, v174
  v_cvt_pk_bf16_f32 v172, v172, v173
  v_exp_f32 v175, v175
  v_exp_f32 v176, v176
  v_exp_f32 v177, v177
  v_exp_f32 v178, v178
  v_exp_f32 v179, v179
  v_cvt_pk_bf16_f32 v173, v174, v175
  v_cvt_pk_bf16_f32 v174, v176, v177
  v_cvt_pk_bf16_f32 v175, v178, v179
  v_exp_f32 v180, v180
  v_mfma_f32_32x32x16_bf16 v[204:219], v[156:159], v[172:175], 0
  ds_read_b128 v[172:175], v3 offset:12928
  v_exp_f32 v181, v181
  v_exp_f32 v182, v182
  v_exp_f32 v183, v183
  v_exp_f32 v184, v184
  v_exp_f32 v185, v185
  v_exp_f32 v186, v186
  v_exp_f32 v187, v187
  v_cvt_pk_bf16_f32 v176, v180, v181
  v_cvt_pk_bf16_f32 v177, v182, v183
  v_cvt_pk_bf16_f32 v178, v184, v185
  v_cvt_pk_bf16_f32 v179, v186, v187
  v_exp_f32 v188, v188
  v_mfma_f32_32x32x16_bf16 v[204:219], v[160:163], v[176:179], v[204:219]
  ds_read_b128 v[176:179], v3 offset:12800
  v_exp_f32 v189, v189
  v_exp_f32 v190, v190
  v_exp_f32 v191, v191
  v_exp_f32 v192, v192
  v_exp_f32 v193, v193
  v_exp_f32 v194, v194
  v_exp_f32 v195, v195
  v_cvt_pk_bf16_f32 v180, v188, v189
  v_cvt_pk_bf16_f32 v181, v190, v191
  v_cvt_pk_bf16_f32 v182, v192, v193
  v_cvt_pk_bf16_f32 v183, v194, v195
  v_exp_f32 v196, v196
  v_mfma_f32_32x32x16_bf16 v[204:219], v[164:167], v[180:183], v[204:219]
  ds_read_b128 v[180:183], v3 offset:12672
  ds_read_b128 v[188:191], v2 offset:12416
  ds_read_b128 v[192:195], v2 offset:12288
  v_exp_f32 v197, v197
  v_exp_f32 v198, v198
  v_exp_f32 v199, v199
  v_exp_f32 v200, v200
  v_exp_f32 v201, v201
  v_exp_f32 v202, v202
  v_exp_f32 v203, v203
  v_cvt_pk_bf16_f32 v184, v196, v197
  v_cvt_pk_bf16_f32 v185, v198, v199
  v_cvt_pk_bf16_f32 v186, v200, v201
  v_cvt_pk_bf16_f32 v187, v202, v203
  ds_read_b128 v[196:199], v2 offset:12160
  ds_read_b128 v[200:203], v2 offset:12032
  v_mfma_f32_32x32x16_bf16 v[204:219], v[168:171], v[184:187], v[204:219]
  ds_read_b128 v[184:187], v3 offset:12544
  s_nop 10
  v_rcp_f32 v205, v204
  s_nop 0
  v_mul_f32 v208, v208, v205
  v_mul_f32 v209, v209, v205
  v_mul_f32 v210, v210, v205
  v_cvt_pk_bf16_f32 v42, v208, v209
  v_mul_f32 v211, v211, v205
  v_mul_f32 v212, v212, v205
  v_cvt_pk_bf16_f32 v43, v210, v211
  v_mul_f32 v213, v213, v205
  v_mul_f32 v214, v214, v205
  v_mfma_f32_32x32x16_bf16 v[220:235], a[184:187], v[40:43], v[220:235]
  v_mul_f32 v215, v215, v205
  v_mul_f32 v216, v216, v205
  v_mul_f32 v217, v217, v205
  v_mul_f32 v218, v218, v205
  v_mul_f32 v219, v219, v205
  s_waitcnt lgkmcnt(1)
  v_mfma_f32_32x32x16_bf16 v[188:203], v[102:105], v[54:57], v[188:203]
  v_cvt_pk_bf16_f32 v44, v212, v213
  v_cvt_pk_bf16_f32 v45, v214, v215
  v_cvt_pk_bf16_f32 v46, v216, v217
  v_cvt_pk_bf16_f32 v47, v218, v219
  s_waitcnt lgkmcnt(0)
  v_mfma_f32_32x32x16_bf16 v[172:187], v[96:99], v[54:57], v[172:187]
  v_mfma_f32_32x32x16_bf16 v[220:235], a[188:191], v[44:47], v[220:235]
  v_mfma_f32_32x32x16_bf16 v[236:251], a[208:211], v[40:43], v[236:251]
  v_mfma_f32_32x32x8_bf16 v[188:203], v[106:107], v[58:59], v[188:203]
  v_mfma_f32_32x32x16_bf16 v[236:251], a[212:215], v[44:47], v[236:251]
  s_nop 6
  v_cvt_pk_bf16_f32 v220, v220, v221
  v_cvt_pk_bf16_f32 v221, v222, v223
  v_cvt_pk_bf16_f32 v222, v224, v225
  v_mfma_f32_32x32x8_bf16 v[172:187], v[100:101], v[58:59], v[172:187]
  v_max3_f32 v57, v188, v189, v190
  v_cvt_pk_bf16_f32 v223, v226, v227
  v_max3_f32 v57, v57, v191, v192
  v_cvt_pk_bf16_f32 v224, v228, v229
  v_cvt_pk_bf16_f32 v225, v230, v231
  v_cvt_pk_bf16_f32 v226, v232, v233
  v_max3_f32 v57, v57, v193, v194
  v_cvt_pk_bf16_f32 v227, v234, v235
  v_max3_f32 v57, v57, v195, v196
  v_cvt_pk_bf16_f32 v236, v236, v237
  v_max3_f32 v57, v57, v197, v198
  v_cvt_pk_bf16_f32 v237, v238, v239
  v_max3_f32 v57, v57, v199, v200
  v_max3_f32 v56, v172, v173, v174
  v_max3_f32 v57, v57, v201, v202
  v_max3_f32 v56, v56, v175, v176
  v_cvt_pk_bf16_f32 v238, v240, v241
  v_max3_f32 v56, v56, v177, v178
  v_cvt_pk_bf16_f32 v239, v242, v243
  v_max3_f32 v56, v56, v179, v180
  v_cvt_pk_bf16_f32 v240, v244, v245
  v_max3_f32 v56, v56, v181, v182
  v_cvt_pk_bf16_f32 v241, v246, v247
  v_max3_f32 v56, v56, v183, v184
  v_cvt_pk_bf16_f32 v242, v248, v249
  v_max3_f32 v56, v56, v185, v186
  ds_write_b128 v4, v[220:223] offset:0
  v_max3_f32 v56, v56, v187, v203
  v_cvt_pk_bf16_f32 v243, v250, v251
  v_max_f32 v56, v56, v57
  ds_write_b128 v5, v[224:227] offset:0
  v_mfma_f32_32x32x16_bf16 v[220:235], a[216:219], v[12:15], 0
  v_permlane32_swap_b32 v56, v57
  v_mfma_f32_32x32x16_bf16 v[220:235], a[220:223], v[16:19], v[220:235]
  ds_write_b128 v4, v[236:239] offset:64
  v_max_f32 v56, v56, v57
  v_mfma_f32_32x32x16_bf16 v[220:235], a[224:227], v[20:23], v[220:235]
  v_and_b32 v57, 0xffff0000, v56
  ds_write_b128 v5, v[240:243] offset:64
  v_mfma_f32_32x32x16_bf16 v[236:251], a[168:171], v[24:27], 0
  v_sub_f32 v57, v56, v57
  v_mfma_f32_32x32x16_bf16 v[236:251], a[172:175], v[28:31], v[236:251]
  v_perm_b32 v54, v57, v56, s53
  v_and_b32 v56, 0xffff0000, v57
  v_mfma_f32_32x32x16_bf16 v[220:235], a[228:231], v[36:39], v[220:235]
  v_sub_f32 v55, v57, v56
  v_mfma_f32_32x32x16_bf16 v[236:251], a[176:179], v[32:35], v[236:251]
  v_mfma_f32_32x32x8_bf16 v[172:187], v[10:11], v[54:55], v[172:187]
  v_mfma_f32_32x32x8_bf16 v[188:203], v[10:11], v[54:55], v[188:203]
  v_mfma_f32_32x32x16_bf16 v[220:235], a[232:235], v[40:43], v[220:235]
  v_mfma_f32_32x32x16_bf16 v[236:251], a[180:183], v[48:51], v[236:251]
  v_mfma_f32_32x32x16_bf16 v[220:235], a[236:239], v[44:47], v[220:235]
  s_nop 4
  v_exp_f32 v172, v172
  v_exp_f32 v173, v173
  v_exp_f32 v174, v174
  v_exp_f32 v175, v175
  v_exp_f32 v176, v176
  v_exp_f32 v177, v177
  v_exp_f32 v178, v178
  v_exp_f32 v179, v179
  v_cvt_pk_bf16_f32 v172, v172, v173
  v_cvt_pk_bf16_f32 v173, v174, v175
  v_cvt_pk_bf16_f32 v174, v176, v177
  v_cvt_pk_bf16_f32 v175, v178, v179
  v_exp_f32 v180, v180
  v_mfma_f32_32x32x16_bf16 v[204:219], v[156:159], v[172:175], 0
  ds_read_b128 v[172:175], v2 offset:896
  v_exp_f32 v181, v181
  v_exp_f32 v182, v182
  v_exp_f32 v183, v183
  v_exp_f32 v184, v184
  v_exp_f32 v185, v185
  v_exp_f32 v186, v186
  v_exp_f32 v187, v187
  v_cvt_pk_bf16_f32 v176, v180, v181
  v_cvt_pk_bf16_f32 v177, v182, v183
  v_cvt_pk_bf16_f32 v178, v184, v185
  v_cvt_pk_bf16_f32 v179, v186, v187
  v_exp_f32 v188, v188
  v_mfma_f32_32x32x16_bf16 v[204:219], v[160:163], v[176:179], v[204:219]
  ds_read_b128 v[176:179], v2 offset:768
  v_exp_f32 v189, v189
  v_exp_f32 v190, v190
  v_exp_f32 v191, v191
  v_exp_f32 v192, v192
  v_exp_f32 v193, v193
  v_exp_f32 v194, v194
  v_exp_f32 v195, v195
  v_cvt_pk_bf16_f32 v180, v188, v189
  v_cvt_pk_bf16_f32 v181, v190, v191
  v_cvt_pk_bf16_f32 v182, v192, v193
  v_cvt_pk_bf16_f32 v183, v194, v195
  v_exp_f32 v196, v196
  v_mfma_f32_32x32x16_bf16 v[204:219], v[164:167], v[180:183], v[204:219]
  ds_read_b128 v[180:183], v2 offset:640
  ds_read_b128 v[188:191], v3 offset:384
  ds_read_b128 v[192:195], v3 offset:256
  v_exp_f32 v197, v197
  v_exp_f32 v198, v198
  v_exp_f32 v199, v199
  v_exp_f32 v200, v200
  v_exp_f32 v201, v201
  v_exp_f32 v202, v202
  v_exp_f32 v203, v203
  v_cvt_pk_bf16_f32 v184, v196, v197
  v_cvt_pk_bf16_f32 v185, v198, v199
  v_cvt_pk_bf16_f32 v186, v200, v201
  v_cvt_pk_bf16_f32 v187, v202, v203
  v_cvt_pk_bf16_f32 v220, v220, v221
  v_cvt_pk_bf16_f32 v221, v222, v223
  v_mfma_f32_32x32x16_bf16 v[204:219], v[168:171], v[184:187], v[204:219]
  ds_read_b128 v[184:187], v2 offset:512
  ds_read_b128 v[196:199], v3 offset:128
  ds_read_b128 v[200:203], v3 offset:0
  v_cvt_pk_bf16_f32 v222, v224, v225
  v_cvt_pk_bf16_f32 v223, v226, v227
  v_cvt_pk_bf16_f32 v224, v228, v229
  v_cvt_pk_bf16_f32 v225, v230, v231
  v_cvt_pk_bf16_f32 v226, v232, v233
  v_cvt_pk_bf16_f32 v227, v234, v235
  ds_write_b128 v4, v[220:223] offset:128
  s_nop 1
  v_rcp_f32 v205, v204
  s_nop 0
  v_mul_f32 v208, v208, v205
  v_mul_f32 v209, v209, v205
  v_mul_f32 v210, v210, v205
  v_mul_f32 v211, v211, v205
  v_mul_f32 v212, v212, v205
  v_mul_f32 v213, v213, v205
  v_mul_f32 v214, v214, v205
  v_mul_f32 v215, v215, v205
  v_mul_f32 v216, v216, v205
  v_mul_f32 v217, v217, v205
  v_mul_f32 v218, v218, v205
  v_mul_f32 v219, v219, v205
  v_cvt_pk_bf16_f32 v54, v208, v209
  v_cvt_pk_bf16_f32 v55, v210, v211
  s_waitcnt lgkmcnt(3)
  v_mfma_f32_32x32x16_bf16 v[172:187], v[84:87], v[60:63], v[172:187]
  ds_write_b128 v5, v[224:227] offset:128
  s_waitcnt lgkmcnt(2)
  v_mfma_f32_32x32x16_bf16 v[188:203], v[90:93], v[60:63], v[188:203]
  v_cvt_pk_bf16_f32 v56, v212, v213
  v_cvt_pk_bf16_f32 v57, v214, v215
  v_cvt_pk_bf16_f32 v58, v216, v217
  v_cvt_pk_bf16_f32 v59, v218, v219
  v_mfma_f32_32x32x16_bf16 v[236:251], a[184:187], v[52:55], v[236:251]
  v_mfma_f32_32x32x8_bf16 v[172:187], v[88:89], v[64:65], v[172:187]
  v_mfma_f32_32x32x16_bf16 v[236:251], a[188:191], v[56:59], v[236:251]
  v_mfma_f32_32x32x16_bf16 v[220:235], a[192:195], v[24:27], 0
  v_mfma_f32_32x32x8_bf16 v[188:203], v[94:95], v[64:65], v[188:203]
  v_mfma_f32_32x32x16_bf16 v[220:235], a[196:199], v[28:31], v[220:235]
  v_mfma_f32_32x32x16_bf16 v[220:235], a[200:203], v[32:35], v[220:235]
  v_mfma_f32_32x32x16_bf16 v[220:235], a[204:207], v[48:51], v[220:235]
  v_mfma_f32_32x32x16_bf16 v[220:235], a[208:211], v[52:55], v[220:235]
  v_max3_f32 v62, v172, v173, v174
  v_cvt_pk_bf16_f32 v236, v236, v237
  v_max3_f32 v62, v62, v175, v176
  v_cvt_pk_bf16_f32 v237, v238, v239
  v_max3_f32 v63, v188, v189, v190
  v_max3_f32 v62, v62, v177, v178
  v_mfma_f32_32x32x16_bf16 v[220:235], a[212:215], v[56:59], v[220:235]
  v_max3_f32 v63, v63, v191, v192
  v_max3_f32 v62, v62, v179, v180
  v_max3_f32 v63, v63, v193, v194
  v_max3_f32 v62, v62, v181, v182
  v_max3_f32 v63, v63, v195, v196
  v_max3_f32 v62, v62, v183, v184
  v_max3_f32 v63, v63, v197, v198
  v_max3_f32 v62, v62, v185, v186
  v_max3_f32 v63, v63, v199, v200
  v_max3_f32 v62, v62, v187, v203
  v_max3_f32 v63, v63, v201, v202
  v_cvt_pk_bf16_f32 v238, v240, v241
  v_max_f32 v62, v62, v63
  v_cvt_pk_bf16_f32 v239, v242, v243
  v_cvt_pk_bf16_f32 v240, v244, v245
  v_permlane32_swap_b32 v62, v63
  v_cvt_pk_bf16_f32 v241, v246, v247
  v_max_f32 v62, v62, v63
  v_cvt_pk_bf16_f32 v242, v248, v249
  v_and_b32 v63, 0xffff0000, v62
  v_cvt_pk_bf16_f32 v243, v250, v251
  v_sub_f32 v63, v62, v63
  v_cvt_pk_bf16_f32 v220, v220, v221
  v_perm_b32 v60, v63, v62, s53
  v_and_b32 v62, 0xffff0000, v63
  v_cvt_pk_bf16_f32 v221, v222, v223
  v_sub_f32 v61, v63, v62
  v_cvt_pk_bf16_f32 v222, v224, v225
  v_cvt_pk_bf16_f32 v223, v226, v227
  v_mfma_f32_32x32x8_bf16 v[172:187], v[10:11], v[60:61], v[172:187]
  v_cvt_pk_bf16_f32 v224, v228, v229
  v_cvt_pk_bf16_f32 v225, v230, v231
  v_cvt_pk_bf16_f32 v226, v232, v233
  v_cvt_pk_bf16_f32 v227, v234, v235
  v_mfma_f32_32x32x8_bf16 v[188:203], v[10:11], v[60:61], v[188:203]
  ds_write_b128 v4, v[236:239] offset:6144
  s_nop 5
  v_exp_f32 v172, v172
  ds_write_b128 v5, v[240:243] offset:6144
  v_mfma_f32_32x32x16_bf16 v[236:251], a[216:219], v[24:27], 0
  v_mfma_f32_32x32x16_bf16 v[236:251], a[220:223], v[28:31], v[236:251]
  ds_write_b128 v4, v[220:223] offset:6208
  v_exp_f32 v173, v173
  v_mfma_f32_32x32x16_bf16 v[236:251], a[224:227], v[32:35], v[236:251]
  v_exp_f32 v174, v174
  v_exp_f32 v175, v175
  v_exp_f32 v176, v176
  v_mfma_f32_32x32x16_bf16 v[236:251], a[228:231], v[48:51], v[236:251]
  ds_write_b128 v5, v[224:227] offset:6208
  v_cvt_pk_bf16_f32 v172, v172, v173
  v_mfma_f32_32x32x16_bf16 v[236:251], a[232:235], v[52:55], v[236:251]
  v_exp_f32 v177, v177
  v_exp_f32 v178, v178
  v_exp_f32 v179, v179
  v_mfma_f32_32x32x16_bf16 v[236:251], a[236:239], v[56:59], v[236:251]
  v_cvt_pk_bf16_f32 v173, v174, v175
  v_cvt_pk_bf16_f32 v174, v176, v177
  v_cvt_pk_bf16_f32 v175, v178, v179
  v_exp_f32 v180, v180
  v_mfma_f32_32x32x16_bf16 v[204:219], v[108:111], v[172:175], 0
  ds_read_b128 v[172:175], v3 offset:1408
  ds_read_b128 v[252:255], v6 offset:0
  v_exp_f32 v181, v181
  v_exp_f32 v182, v182
  v_mfma_f32_32x32x16_bf16 v[220:235], a[96:99], a[0:3], 0
  v_exp_f32 v183, v183
  v_exp_f32 v184, v184
  v_exp_f32 v185, v185
  v_mfma_f32_32x32x16_bf16 v[220:235], a[100:103], a[4:7], v[220:235]
  v_exp_f32 v186, v186
  v_exp_f32 v187, v187
  v_cvt_pk_bf16_f32 v176, v180, v181
  v_cvt_pk_bf16_f32 v177, v182, v183
  v_mfma_f32_32x32x16_bf16 v[220:235], a[104:107], a[8:11], v[220:235]
  v_cvt_pk_bf16_f32 v178, v184, v185
  v_cvt_pk_bf16_f32 v179, v186, v187
  v_exp_f32 v188, v188
  v_exp_f32 v189, v189
  v_mfma_f32_32x32x16_bf16 v[204:219], v[112:115], v[176:179], v[204:219]
  ds_read_b128 v[176:179], v3 offset:1280
  v_exp_f32 v190, v190
  v_exp_f32 v191, v191
  v_cvt_pk_bf16_f32 v180, v188, v189
  v_mfma_f32_32x32x16_bf16 v[220:235], a[108:111], a[12:15], v[220:235]
  s_waitcnt vmcnt(0) lgkmcnt(1)
  buffer_store_dwordx4 v[252:255], v7, s[12:15], s32 offen offset:0 sc1
  v_mfma_f32_32x32x16_bf16 v[220:235], a[112:115], a[16:19], v[220:235]
  ds_read_b128 v[252:255], v6 offset:1024
  v_exp_f32 v192, v192
  v_exp_f32 v193, v193
  v_cvt_pk_bf16_f32 v181, v190, v191
  v_mfma_f32_32x32x16_bf16 v[220:235], a[116:119], a[20:23], v[220:235]
  ds_read_b128 v[188:191], v2 offset:896
  v_exp_f32 v194, v194
  v_exp_f32 v195, v195
  v_cvt_pk_bf16_f32 v182, v192, v193
  v_cvt_pk_bf16_f32 v183, v194, v195
  v_exp_f32 v196, v196
  v_mfma_f32_32x32x16_bf16 v[204:219], v[116:119], v[180:183], v[204:219]
  ds_read_b128 v[180:183], v3 offset:1152
  ds_read_b128 v[192:195], v2 offset:768
  v_exp_f32 v197, v197
  v_exp_f32 v198, v198
  v_exp_f32 v199, v199
  v_exp_f32 v200, v200
  v_exp_f32 v201, v201
  v_exp_f32 v202, v202
  v_exp_f32 v203, v203
  v_cvt_pk_bf16_f32 v184, v196, v197
  v_cvt_pk_bf16_f32 v185, v198, v199
  v_cvt_pk_bf16_f32 v186, v200, v201
  v_cvt_pk_bf16_f32 v187, v202, v203
  v_cvt_pk_bf16_f32 v236, v236, v237
  v_cvt_pk_bf16_f32 v237, v238, v239
  v_mfma_f32_32x32x16_bf16 v[204:219], v[120:123], v[184:187], v[204:219]
  ds_read_b128 v[184:187], v3 offset:1024
  ds_read_b128 v[196:199], v2 offset:640
  ds_read_b128 v[200:203], v2 offset:512
  v_cvt_pk_bf16_f32 v238, v240, v241
  v_cvt_pk_bf16_f32 v239, v242, v243
  v_cvt_pk_bf16_f32 v240, v244, v245
  v_cvt_pk_bf16_f32 v241, v246, v247
  v_cvt_pk_bf16_f32 v242, v248, v249
  v_cvt_pk_bf16_f32 v243, v250, v251
  v_cvt_pk_bf16_f32 v96, v224, v225
  v_cvt_pk_bf16_f32 v97, v226, v227
  v_cvt_pk_bf16_f32 v98, v228, v229
  v_rcp_f32 v217, v216
  v_cvt_pk_bf16_f32 v99, v230, v231
  v_mul_f32 v204, v204, v217
  v_mul_f32 v205, v205, v217
  v_mul_f32 v206, v206, v217
  v_mul_f32 v207, v207, v217
  v_mul_f32 v208, v208, v217
  v_mul_f32 v209, v209, v217
  v_mul_f32 v210, v210, v217
  v_mul_f32 v211, v211, v217
  v_mul_f32 v212, v212, v217
  v_mul_f32 v213, v213, v217
  v_mul_f32 v214, v214, v217
  v_mul_f32 v215, v215, v217
  v_cvt_pk_bf16_f32 v60, v204, v205
  v_cvt_pk_bf16_f32 v61, v206, v207
  ds_write_b128 v4, v[236:239] offset:6272
  s_waitcnt lgkmcnt(1)
  v_mfma_f32_32x32x16_bf16 v[172:187], v[84:87], v[72:75], v[172:187]
  ds_write_b128 v5, v[240:243] offset:6272
  v_cvt_pk_bf16_f32 v62, v208, v209
  v_mfma_f32_32x32x16_bf16 v[188:203], v[90:93], v[72:75], v[188:203]
  buffer_store_dwordx4 v[252:255], v8, s[12:15], s32 offen offset:1024 sc1
  v_cvt_pk_bf16_f32 v63, v210, v211
  v_mfma_f32_32x32x16_bf16 v[236:251], a[96:99], a[24:27], 0
  ds_read_b128 v[252:255], v6 offset:2048
  v_cvt_pk_bf16_f32 v64, v212, v213
  v_cvt_pk_bf16_f32 v65, v214, v215
  v_cvt_pk_bf16_f32 v70, v220, v221
  v_cvt_pk_bf16_f32 v71, v222, v223
  v_cvt_pk_bf16_f32 v100, v232, v233
  v_cvt_pk_bf16_f32 v101, v234, v235
  v_mfma_f32_32x32x8_bf16 v[172:187], v[88:89], v[76:77], v[172:187]
  v_mfma_f32_32x32x8_bf16 v[188:203], v[94:95], v[76:77], v[188:203]
  v_mfma_f32_32x32x16_bf16 v[236:251], a[100:103], a[28:31], v[236:251]
  v_mfma_f32_32x32x16_bf16 v[236:251], a[104:107], a[32:35], v[236:251]
  v_mfma_f32_32x32x16_bf16 v[236:251], a[108:111], a[36:39], v[236:251]
  v_mfma_f32_32x32x16_bf16 v[236:251], a[112:115], a[40:43], v[236:251]
  v_mfma_f32_32x32x16_bf16 v[236:251], a[116:119], a[44:47], v[236:251]
  v_mfma_f32_32x32x16_bf16 v[220:235], a[0:3], a[248:251], 0
  s_waitcnt lgkmcnt(0)
  buffer_store_dwordx4 v[252:255], v9, s[12:15], s32 offen offset:2048 sc1
  v_mfma_f32_32x32x16_bf16 v[220:235], a[4:7], a[252:255], v[220:235]
  ds_read_b128 v[252:255], v6 offset:3072
  v_max3_f32 v74, v172, v173, v174
  v_max3_f32 v75, v188, v189, v190
  v_max3_f32 v74, v74, v175, v176
  v_max3_f32 v75, v75, v191, v192
  v_max3_f32 v74, v74, v177, v178
  v_mfma_f32_32x32x16_bf16 v[220:235], a[8:11], a[240:243], v[220:235]
  v_max3_f32 v75, v75, v193, v194
  v_max3_f32 v74, v74, v179, v180
  v_max3_f32 v75, v75, v195, v196
  v_max3_f32 v74, v74, v181, v182
  v_max3_f32 v75, v75, v197, v198
  v_max3_f32 v74, v74, v183, v184
  v_mfma_f32_32x32x16_bf16 v[220:235], a[12:15], a[244:247], v[220:235]
  v_max3_f32 v75, v75, v199, v200
  v_max3_f32 v74, v74, v185, v186
  v_max3_f32 v75, v75, v201, v202
  v_max3_f32 v74, v74, v187, v203
  v_cvt_pk_bf16_f32 v102, v240, v241
  v_max_f32 v74, v74, v75
  v_cvt_pk_bf16_f32 v103, v242, v243
  v_cvt_pk_bf16_f32 v104, v244, v245
  v_permlane32_swap_b32 v74, v75
  v_cvt_pk_bf16_f32 v105, v246, v247
  v_max_f32 v74, v74, v75
  v_cvt_pk_bf16_f32 v106, v248, v249
  v_and_b32 v75, 0xffff0000, v74
  v_cvt_pk_bf16_f32 v107, v250, v251
  v_sub_f32 v75, v74, v75
  v_cvt_pk_bf16_f32 v82, v236, v237
  v_perm_b32 v72, v75, v74, s53
  v_and_b32 v74, 0xffff0000, v75
  v_cvt_pk_bf16_f32 v83, v238, v239
  v_mfma_f32_32x32x16_bf16 v[236:251], a[24:27], a[248:251], 0
  ds_read_b64_tr_b16 a[248:249], v0 offset:16384
  ds_read_b64_tr_b16 a[250:251], v0 offset:16640
  v_sub_f32 v73, v75, v74
  v_mfma_f32_32x32x16_bf16 v[236:251], a[28:31], a[252:255], v[236:251]
  ds_read_b64_tr_b16 a[252:253], v0 offset:17408
  ds_read_b64_tr_b16 a[254:255], v0 offset:17664
  v_mfma_f32_32x32x8_bf16 v[172:187], v[10:11], v[72:73], v[172:187]
  v_mfma_f32_32x32x8_bf16 v[188:203], v[10:11], v[72:73], v[188:203]
  v_mfma_f32_32x32x16_bf16 v[236:251], a[32:35], a[240:243], v[236:251]
  ds_read_b64_tr_b16 a[240:241], v0 offset:18432
  ds_read_b64_tr_b16 a[242:243], v0 offset:18688
  s_waitcnt lgkmcnt(4)
  v_mfma_f32_32x32x16_bf16 v[220:235], a[16:19], a[248:251], v[220:235]
  buffer_store_dwordx4 v[252:255], v7, s[12:15], s33 offen offset:0 sc1
  v_mfma_f32_32x32x16_bf16 v[236:251], a[36:39], a[244:247], v[236:251]
  ds_read_b64_tr_b16 a[244:245], v0 offset:19456
  ds_read_b64_tr_b16 a[246:247], v0 offset:19712
  ds_read_b128 v[252:255], v6 offset:4096
  v_exp_f32 v172, v172
  s_waitcnt lgkmcnt(5)
  v_mfma_f32_32x32x16_bf16 v[220:235], a[20:23], a[252:255], v[220:235]
  v_exp_f32 v173, v173
  v_exp_f32 v174, v174
  v_exp_f32 v175, v175
  v_mfma_f32_32x32x16_bf16 v[236:251], a[40:43], a[248:251], v[236:251]
  ds_read_b64_tr_b16 a[248:249], v0 offset:20480
  ds_read_b64_tr_b16 a[250:251], v0 offset:20736
  v_exp_f32 v176, v176
  v_exp_f32 v177, v177
  v_mfma_f32_32x32x16_bf16 v[236:251], a[44:47], a[252:255], v[236:251]
  ds_read_b64_tr_b16 a[252:253], v0 offset:21504
  ds_read_b64_tr_b16 a[254:255], v0 offset:21760
  v_exp_f32 v178, v178
  v_exp_f32 v179, v179
  v_cvt_pk_bf16_f32 v172, v172, v173
  v_cvt_pk_bf16_f32 v173, v174, v175
  v_cvt_pk_bf16_f32 v174, v176, v177
  v_cvt_pk_bf16_f32 v175, v178, v179
  v_exp_f32 v180, v180
  v_mfma_f32_32x32x16_bf16 v[204:219], v[108:111], v[172:175], 0
  ds_read_b128 v[172:175], v2 offset:4736
  v_exp_f32 v181, v181
  v_exp_f32 v182, v182
  v_exp_f32 v183, v183
  v_exp_f32 v184, v184
  v_exp_f32 v185, v185
  v_exp_f32 v186, v186
  v_exp_f32 v187, v187
  v_cvt_pk_bf16_f32 v176, v180, v181
  v_cvt_pk_bf16_f32 v177, v182, v183
  v_cvt_pk_bf16_f32 v178, v184, v185
  v_cvt_pk_bf16_f32 v179, v186, v187
  v_exp_f32 v188, v188
  v_mfma_f32_32x32x16_bf16 v[204:219], v[112:115], v[176:179], v[204:219]
  ds_read_b128 v[176:179], v2 offset:4608
  s_waitcnt lgkmcnt(2)
  buffer_store_dwordx4 v[252:255], v8, s[12:15], s33 offen offset:1024 sc1
  v_exp_f32 v189, v189
  v_exp_f32 v190, v190
  v_exp_f32 v191, v191
  v_exp_f32 v192, v192
  v_exp_f32 v193, v193
  v_exp_f32 v194, v194
  v_exp_f32 v195, v195
  v_cvt_pk_bf16_f32 v180, v188, v189
  v_cvt_pk_bf16_f32 v181, v190, v191
  v_cvt_pk_bf16_f32 v182, v192, v193
  v_cvt_pk_bf16_f32 v183, v194, v195
  v_exp_f32 v196, v196
  v_mfma_f32_32x32x16_bf16 v[204:219], v[116:119], v[180:183], v[204:219]
  ds_read_b128 v[180:183], v2 offset:4480
  ds_read_b128 v[188:191], v3 offset:4224
  ds_read_b128 v[192:195], v3 offset:4096
  v_exp_f32 v197, v197
  v_exp_f32 v198, v198
  v_exp_f32 v199, v199
  v_exp_f32 v200, v200
  v_exp_f32 v201, v201
  v_exp_f32 v202, v202
  v_exp_f32 v203, v203
  v_cvt_pk_bf16_f32 v184, v196, v197
  v_cvt_pk_bf16_f32 v185, v198, v199
  v_cvt_pk_bf16_f32 v186, v200, v201
  v_cvt_pk_bf16_f32 v187, v202, v203
  s_mov_b64 exec, s[62:63]
  v_cvt_pk_bf16_f32 v124, v220, v221
  v_mfma_f32_32x32x16_bf16 v[204:219], v[120:123], v[184:187], v[204:219]
  v_cvt_pk_bf16_f32 v125, v222, v223
  v_cvt_pk_bf16_f32 v126, v224, v225
  v_cvt_pk_bf16_f32 v127, v226, v227
  v_cvt_pk_bf16_f32 v128, v228, v229
  v_cvt_pk_bf16_f32 v129, v230, v231
  v_cvt_pk_bf16_f32 v130, v232, v233
  v_cvt_pk_bf16_f32 v131, v234, v235
  s_mov_b64 exec, -1
  ds_read_b128 v[252:255], v6 offset:5120
  ds_read_b128 v[184:187], v2 offset:4352
  ds_read_b128 v[196:199], v3 offset:3968
  s_mov_b64 exec, s[62:63]
  v_cvt_pk_bf16_f32 v132, v236, v237
  v_cvt_pk_bf16_f32 v133, v238, v239
  v_cvt_pk_bf16_f32 v134, v240, v241
  v_cvt_pk_bf16_f32 v135, v242, v243
  v_cvt_pk_bf16_f32 v136, v244, v245
  v_cvt_pk_bf16_f32 v137, v246, v247
  v_cvt_pk_bf16_f32 v138, v248, v249
  v_cvt_pk_bf16_f32 v139, v250, v251
  s_mov_b64 exec, -1
  v_rcp_f32 v217, v216
  s_mov_b64 exec, s[64:65]
  v_cvt_pk_bf16_f32 v140, v220, v221
  v_cvt_pk_bf16_f32 v141, v222, v223
  v_cvt_pk_bf16_f32 v142, v224, v225
  v_cvt_pk_bf16_f32 v143, v226, v227
  v_cvt_pk_bf16_f32 v144, v228, v229
  v_cvt_pk_bf16_f32 v145, v230, v231
  v_cvt_pk_bf16_f32 v146, v232, v233
  v_cvt_pk_bf16_f32 v147, v234, v235
  v_mfma_f32_32x32x16_bf16 v[220:235], a[120:123], a[0:3], 0
  s_mov_b64 exec, -1
  ds_read_b128 v[200:203], v3 offset:3840
  v_mul_f32 v204, v204, v217
  v_mul_f32 v205, v205, v217
  v_mul_f32 v206, v206, v217
  v_mul_f32 v207, v207, v217
  v_mfma_f32_32x32x16_bf16 v[220:235], a[124:127], a[4:7], v[220:235]
  v_mul_f32 v208, v208, v217
  v_mul_f32 v209, v209, v217
  v_mul_f32 v210, v210, v217
  v_mul_f32 v211, v211, v217
  v_mul_f32 v212, v212, v217
  s_waitcnt lgkmcnt(1)
  v_mfma_f32_32x32x16_bf16 v[172:187], v[96:99], v[66:69], v[172:187]
  buffer_store_dwordx4 v[252:255], v9, s[12:15], s33 offen offset:2048 sc1
  v_mul_f32 v213, v213, v217
  v_mfma_f32_32x32x16_bf16 v[220:235], a[128:131], a[8:11], v[220:235]
  ds_read_b128 v[252:255], v6 offset:6144
  v_mul_f32 v214, v214, v217
  v_mul_f32 v215, v215, v217
  v_cvt_pk_bf16_f32 v72, v204, v205
  v_cvt_pk_bf16_f32 v73, v206, v207
  v_cvt_pk_bf16_f32 v74, v208, v209
  v_cvt_pk_bf16_f32 v75, v210, v211
  v_mfma_f32_32x32x8_bf16 v[172:187], v[100:101], v[70:71], v[172:187]
  v_cvt_pk_bf16_f32 v76, v212, v213
  v_cvt_pk_bf16_f32 v77, v214, v215
  s_mov_b64 exec, s[64:65]
  v_cvt_pk_bf16_f32 v148, v236, v237
  v_cvt_pk_bf16_f32 v149, v238, v239
  v_cvt_pk_bf16_f32 v150, v240, v241
  v_cvt_pk_bf16_f32 v151, v242, v243
  s_waitcnt lgkmcnt(1)
  v_mfma_f32_32x32x16_bf16 v[188:203], v[102:105], v[66:69], v[188:203]
  v_cvt_pk_bf16_f32 v152, v244, v245
  v_cvt_pk_bf16_f32 v153, v246, v247
  v_cvt_pk_bf16_f32 v154, v248, v249
  v_cvt_pk_bf16_f32 v155, v250, v251
  s_mov_b64 exec, -1
  v_max3_f32 v68, v172, v173, v174
  v_mfma_f32_32x32x16_bf16 v[236:251], a[120:123], a[24:27], 0
  v_max3_f32 v68, v68, v175, v176
  v_mfma_f32_32x32x16_bf16 v[236:251], a[124:127], a[28:31], v[236:251]
  v_max3_f32 v68, v68, v177, v178
  v_mfma_f32_32x32x8_bf16 v[188:203], v[106:107], v[70:71], v[188:203]
  v_max3_f32 v68, v68, v179, v180
  v_mfma_f32_32x32x16_bf16 v[236:251], a[128:131], a[32:35], v[236:251]
  v_max3_f32 v68, v68, v181, v182
  v_mfma_f32_32x32x16_bf16 v[220:235], a[132:135], a[12:15], v[220:235]
  v_max3_f32 v68, v68, v183, v184
  v_mfma_f32_32x32x16_bf16 v[236:251], a[132:135], a[36:39], v[236:251]
  s_waitcnt lgkmcnt(0)
  buffer_store_dwordx4 v[252:255], v7, s[12:15], s34 offen offset:0 sc1
  v_mfma_f32_32x32x16_bf16 v[220:235], a[136:139], a[16:19], v[220:235]
  ds_read_b128 v[252:255], v6 offset:7168
  v_max3_f32 v69, v188, v189, v190
  v_max3_f32 v68, v68, v185, v186
  v_max3_f32 v69, v69, v191, v192
  v_max3_f32 v68, v68, v187, v203
  v_max3_f32 v69, v69, v193, v194
  v_mfma_f32_32x32x16_bf16 v[236:251], a[136:139], a[40:43], v[236:251]
  v_max3_f32 v69, v69, v195, v196
  v_mfma_f32_32x32x16_bf16 v[220:235], a[140:143], a[20:23], v[220:235]
  v_max3_f32 v69, v69, v197, v198
  v_mfma_f32_32x32x16_bf16 v[236:251], a[140:143], a[44:47], v[236:251]
  v_max3_f32 v69, v69, v199, v200
  v_max3_f32 v69, v69, v201, v202
  v_max_f32 v68, v68, v69
  s_nop 5
  v_cvt_pk_bf16_f32 v12, v220, v221
  v_cvt_pk_bf16_f32 v13, v222, v223
  v_permlane32_swap_b32 v68, v69
  v_cvt_pk_bf16_f32 v14, v224, v225
  v_max_f32 v68, v68, v69
  v_cvt_pk_bf16_f32 v15, v226, v227
  v_and_b32 v69, 0xffff0000, v68
  v_cvt_pk_bf16_f32 v16, v228, v229
  v_sub_f32 v69, v68, v69
  v_cvt_pk_bf16_f32 v17, v230, v231
  v_perm_b32 v66, v69, v68, s53
  v_and_b32 v68, 0xffff0000, v69
  v_cvt_pk_bf16_f32 v84, v232, v233
  v_sub_f32 v67, v69, v68
  v_cvt_pk_bf16_f32 v85, v234, v235
  v_mfma_f32_32x32x16_bf16 v[220:235], a[144:147], a[0:3], 0
  v_cvt_pk_bf16_f32 v24, v236, v237
  v_cvt_pk_bf16_f32 v25, v238, v239
  v_cvt_pk_bf16_f32 v26, v240, v241
  v_cvt_pk_bf16_f32 v27, v242, v243
  v_cvt_pk_bf16_f32 v28, v244, v245
  v_cvt_pk_bf16_f32 v29, v246, v247
  v_cvt_pk_bf16_f32 v90, v248, v249
  v_mfma_f32_32x32x8_bf16 v[172:187], v[10:11], v[66:67], v[172:187]
  v_cvt_pk_bf16_f32 v91, v250, v251
  v_mfma_f32_32x32x8_bf16 v[188:203], v[10:11], v[66:67], v[188:203]
  v_mfma_f32_32x32x16_bf16 v[236:251], a[144:147], a[24:27], 0
  s_waitcnt lgkmcnt(0)
  buffer_store_dwordx4 v[252:255], v8, s[12:15], s34 offen offset:1024 sc1
  v_mfma_f32_32x32x16_bf16 v[220:235], a[148:151], a[4:7], v[220:235]
  ds_read_b128 v[252:255], v6 offset:8192
  v_mfma_f32_32x32x16_bf16 v[236:251], a[148:151], a[28:31], v[236:251]
  v_mfma_f32_32x32x16_bf16 v[220:235], a[152:155], a[8:11], v[220:235]
  v_exp_f32 v172, v172
  v_exp_f32 v173, v173
  v_exp_f32 v174, v174
  v_mfma_f32_32x32x16_bf16 v[236:251], a[152:155], a[32:35], v[236:251]
  v_exp_f32 v175, v175
  v_exp_f32 v176, v176
  v_exp_f32 v177, v177
  v_mfma_f32_32x32x16_bf16 v[220:235], a[156:159], a[12:15], v[220:235]
  v_exp_f32 v178, v178
  v_exp_f32 v179, v179
  v_cvt_pk_bf16_f32 v172, v172, v173
  v_cvt_pk_bf16_f32 v173, v174, v175
  v_mfma_f32_32x32x16_bf16 v[236:251], a[156:159], a[36:39], v[236:251]
  v_cvt_pk_bf16_f32 v174, v176, v177
  v_cvt_pk_bf16_f32 v175, v178, v179
  v_exp_f32 v180, v180
  v_exp_f32 v181, v181
  v_mfma_f32_32x32x16_bf16 v[204:219], v[124:127], v[172:175], 0
  ds_read_b128 v[172:175], v3 offset:5248
  v_exp_f32 v182, v182
  v_exp_f32 v183, v183
  v_cvt_pk_bf16_f32 v176, v180, v181
  v_mfma_f32_32x32x16_bf16 v[220:235], a[160:163], a[16:19], v[220:235]
  v_exp_f32 v184, v184
  v_exp_f32 v185, v185
  v_exp_f32 v186, v186
  v_mfma_f32_32x32x16_bf16 v[236:251], a[160:163], a[40:43], v[236:251]
  s_waitcnt lgkmcnt(1)
  buffer_store_dwordx4 v[252:255], v9, s[12:15], s34 offen offset:2048 sc1
  v_mfma_f32_32x32x16_bf16 v[220:235], a[164:167], a[20:23], v[220:235]
  ds_read_b128 v[252:255], v6 offset:9216
  v_exp_f32 v187, v187
  v_cvt_pk_bf16_f32 v177, v182, v183
  v_cvt_pk_bf16_f32 v178, v184, v185
  v_cvt_pk_bf16_f32 v179, v186, v187
  v_mfma_f32_32x32x16_bf16 v[236:251], a[164:167], a[44:47], v[236:251]
  v_exp_f32 v188, v188
  v_exp_f32 v189, v189
  v_exp_f32 v190, v190
  v_mfma_f32_32x32x16_bf16 v[204:219], v[128:131], v[176:179], v[204:219]
  ds_read_b128 v[176:179], v3 offset:5120
  v_exp_f32 v191, v191
  v_exp_f32 v192, v192
  v_exp_f32 v193, v193
  v_exp_f32 v194, v194
  v_exp_f32 v195, v195
  v_cvt_pk_bf16_f32 v180, v188, v189
  v_cvt_pk_bf16_f32 v181, v190, v191
  v_cvt_pk_bf16_f32 v182, v192, v193
  v_cvt_pk_bf16_f32 v183, v194, v195
  v_exp_f32 v196, v196
  v_mfma_f32_32x32x16_bf16 v[204:219], v[132:135], v[180:183], v[204:219]
  ds_read_b128 v[180:183], v3 offset:4992
  ds_read_b128 v[188:191], v2 offset:4736
  ds_read_b128 v[192:195], v2 offset:4608
  v_exp_f32 v197, v197
  v_exp_f32 v198, v198
  v_exp_f32 v199, v199
  v_exp_f32 v200, v200
  v_exp_f32 v201, v201
  v_exp_f32 v202, v202
  v_exp_f32 v203, v203
  v_cvt_pk_bf16_f32 v184, v196, v197
  v_cvt_pk_bf16_f32 v185, v198, v199
  v_cvt_pk_bf16_f32 v186, v200, v201
  v_cvt_pk_bf16_f32 v187, v202, v203
  v_cvt_pk_bf16_f32 v86, v220, v221
  v_cvt_pk_bf16_f32 v87, v222, v223
  v_mfma_f32_32x32x16_bf16 v[204:219], v[136:139], v[184:187], v[204:219]
  ds_read_b128 v[184:187], v3 offset:4864
  ds_read_b128 v[196:199], v2 offset:4480
  ds_read_b128 v[200:203], v2 offset:4352
  s_waitcnt lgkmcnt(6)
  buffer_store_dwordx4 v[252:255], v7, s[12:15], s35 offen offset:0 sc1
  v_cvt_pk_bf16_f32 v92, v236, v237
  v_cvt_pk_bf16_f32 v93, v238, v239
  v_cvt_pk_bf16_f32 v88, v224, v225
  v_cvt_pk_bf16_f32 v89, v226, v227
  v_cvt_pk_bf16_f32 v94, v240, v241
  v_cvt_pk_bf16_f32 v95, v242, v243
  v_cvt_pk_bf16_f32 v18, v228, v229
  v_rcp_f32 v213, v212
  v_cvt_pk_bf16_f32 v19, v230, v231
  v_mul_f32 v216, v216, v213
  v_mul_f32 v217, v217, v213
  v_mul_f32 v218, v218, v213
  v_mul_f32 v219, v219, v213
  v_mul_f32 v204, v204, v213
  v_mul_f32 v205, v205, v213
  v_mul_f32 v206, v206, v213
  v_mul_f32 v207, v207, v213
  v_mul_f32 v208, v208, v213
  v_mul_f32 v209, v209, v213
  v_mul_f32 v210, v210, v213
  ds_read_b128 v[252:255], v6 offset:10240
  s_waitcnt lgkmcnt(3)
  v_mfma_f32_32x32x16_bf16 v[172:187], v[96:99], v[78:81], v[172:187]
  v_mul_f32 v211, v211, v213
  v_cvt_pk_bf16_f32 v66, v216, v217
  v_cvt_pk_bf16_f32 v67, v218, v219
  v_cvt_pk_bf16_f32 v68, v204, v205
  v_cvt_pk_bf16_f32 v69, v206, v207
  s_waitcnt lgkmcnt(1)
  v_mfma_f32_32x32x16_bf16 v[188:203], v[102:105], v[78:81], v[188:203]
  v_cvt_pk_bf16_f32 v70, v208, v209
  v_cvt_pk_bf16_f32 v71, v210, v211
  v_cvt_pk_bf16_f32 v20, v232, v233
  v_cvt_pk_bf16_f32 v21, v234, v235
  v_cvt_pk_bf16_f32 v30, v244, v245
  v_cvt_pk_bf16_f32 v31, v246, v247
  v_cvt_pk_bf16_f32 v32, v248, v249
  v_mfma_f32_32x32x8_bf16 v[172:187], v[100:101], v[82:83], v[172:187]
  v_cvt_pk_bf16_f32 v33, v250, v251
  v_mfma_f32_32x32x16_bf16 v[220:235], a[0:3], a[240:243], 0
  v_mfma_f32_32x32x8_bf16 v[188:203], v[106:107], v[82:83], v[188:203]
  v_mfma_f32_32x32x16_bf16 v[236:251], a[24:27], a[240:243], 0
  ds_read_b64_tr_b16 a[240:241], v0 offset:22528
  ds_read_b64_tr_b16 a[242:243], v0 offset:22784
  s_waitcnt lgkmcnt(2)
  buffer_store_dwordx4 v[252:255], v8, s[12:15], s35 offen offset:1024 sc1
  v_mfma_f32_32x32x16_bf16 v[220:235], a[4:7], a[244:247], v[220:235]
  ds_read_b128 v[252:255], v6 offset:11264
  v_max3_f32 v80, v172, v173, v174
  v_mfma_f32_32x32x16_bf16 v[236:251], a[28:31], a[244:247], v[236:251]
  ds_read_b64_tr_b16 a[244:245], v0 offset:23552
  ds_read_b64_tr_b16 a[246:247], v0 offset:23808
  v_max3_f32 v81, v188, v189, v190
  v_max3_f32 v80, v80, v175, v176
  v_max3_f32 v81, v81, v191, v192
  v_max3_f32 v80, v80, v177, v178
  v_mfma_f32_32x32x16_bf16 v[220:235], a[8:11], a[248:251], v[220:235]
  v_max3_f32 v81, v81, v193, v194
  v_max3_f32 v80, v80, v179, v180
  v_max3_f32 v81, v81, v195, v196
  v_max3_f32 v80, v80, v181, v182
  v_max3_f32 v81, v81, v197, v198
  v_max3_f32 v80, v80, v183, v184
  v_mfma_f32_32x32x16_bf16 v[220:235], a[12:15], a[252:255], v[220:235]
  v_max3_f32 v81, v81, v199, v200
  v_max3_f32 v80, v80, v185, v186
  v_max3_f32 v81, v81, v201, v202
  v_max3_f32 v80, v80, v187, v203
  v_mfma_f32_32x32x16_bf16 v[236:251], a[32:35], a[248:251], v[236:251]
  ds_read_b64_tr_b16 a[248:249], v0 offset:0
  ds_read_b64_tr_b16 a[250:251], v0 offset:256
  v_max_f32 v80, v80, v81
  s_waitcnt lgkmcnt(4)
  v_mfma_f32_32x32x16_bf16 v[220:235], a[16:19], a[240:243], v[220:235]
  v_permlane32_swap_b32 v80, v81
  v_mfma_f32_32x32x16_bf16 v[236:251], a[36:39], a[252:255], v[236:251]
  ds_read_b64_tr_b16 a[252:253], v0 offset:1024
  ds_read_b64_tr_b16 a[254:255], v0 offset:1280
  v_max_f32 v80, v80, v81
  s_waitcnt lgkmcnt(4)
  v_mfma_f32_32x32x16_bf16 v[220:235], a[20:23], a[244:247], v[220:235]
  v_and_b32 v81, 0xffff0000, v80
  v_mfma_f32_32x32x16_bf16 v[236:251], a[40:43], a[240:243], v[236:251]
  ds_read_b64_tr_b16 a[240:241], v0 offset:2048
  ds_read_b64_tr_b16 a[242:243], v0 offset:2304
  v_sub_f32 v81, v80, v81
  v_mfma_f32_32x32x16_bf16 v[236:251], a[44:47], a[244:247], v[236:251]
  ds_read_b64_tr_b16 a[244:245], v0 offset:3072
  ds_read_b64_tr_b16 a[246:247], v0 offset:3328
  buffer_store_dwordx4 v[252:255], v9, s[12:15], s35 offen offset:2048 sc1
  v_perm_b32 v78, v81, v80, s53
  v_and_b32 v80, 0xffff0000, v81
  s_mov_b64 exec, s[66:67]
  v_cvt_pk_bf16_f32 v140, v220, v221
  v_cvt_pk_bf16_f32 v141, v222, v223
  v_cvt_pk_bf16_f32 v142, v224, v225
  v_cvt_pk_bf16_f32 v143, v226, v227
  v_cvt_pk_bf16_f32 v144, v228, v229
  v_cvt_pk_bf16_f32 v145, v230, v231
  v_cvt_pk_bf16_f32 v146, v232, v233
  v_cvt_pk_bf16_f32 v147, v234, v235
  s_mov_b64 exec, -1
  v_sub_f32 v79, v81, v80
  s_mov_b64 exec, s[66:67]
  v_cvt_pk_bf16_f32 v148, v236, v237
  v_cvt_pk_bf16_f32 v149, v238, v239
  v_cvt_pk_bf16_f32 v150, v240, v241
  v_cvt_pk_bf16_f32 v151, v242, v243
  v_cvt_pk_bf16_f32 v152, v244, v245
  v_cvt_pk_bf16_f32 v153, v246, v247
  v_cvt_pk_bf16_f32 v154, v248, v249
  v_cvt_pk_bf16_f32 v155, v250, v251
  s_mov_b64 exec, -1
  v_mfma_f32_32x32x8_bf16 v[172:187], v[10:11], v[78:79], v[172:187]
  s_mov_b64 exec, s[68:69]
  v_cvt_pk_bf16_f32 v156, v220, v221
  v_cvt_pk_bf16_f32 v157, v222, v223
  v_cvt_pk_bf16_f32 v158, v224, v225
  v_cvt_pk_bf16_f32 v159, v226, v227
  v_cvt_pk_bf16_f32 v160, v228, v229
  v_cvt_pk_bf16_f32 v161, v230, v231
  v_cvt_pk_bf16_f32 v162, v232, v233
  v_cvt_pk_bf16_f32 v163, v234, v235
  s_waitcnt lgkmcnt(0)
  v_mfma_f32_32x32x16_bf16 v[220:235], a[248:251], a[0:3], 0
  s_mov_b64 exec, -1
  ds_read_b128 a[0:3], v4 offset:49152
  v_exp_f32 v172, v172
  v_exp_f32 v173, v173
  s_mov_b64 exec, s[68:69]
  v_mfma_f32_32x32x16_bf16 v[220:235], a[252:255], a[4:7], v[220:235]
  v_cvt_pk_bf16_f32 v164, v236, v237
  v_cvt_pk_bf16_f32 v165, v238, v239
  v_cvt_pk_bf16_f32 v166, v240, v241
  v_cvt_pk_bf16_f32 v167, v242, v243
  v_cvt_pk_bf16_f32 v168, v244, v245
  v_cvt_pk_bf16_f32 v169, v246, v247
  v_mfma_f32_32x32x16_bf16 v[220:235], a[240:243], a[8:11], v[220:235]
  v_cvt_pk_bf16_f32 v170, v248, v249
  v_cvt_pk_bf16_f32 v171, v250, v251
  s_mov_b64 exec, -1
  v_exp_f32 v174, v174
  v_exp_f32 v175, v175
  v_mfma_f32_32x32x8_bf16 v[188:203], v[10:11], v[78:79], v[188:203]
  v_exp_f32 v176, v176
  v_exp_f32 v177, v177
  v_exp_f32 v178, v178
  v_exp_f32 v179, v179
  v_mfma_f32_32x32x16_bf16 v[236:251], a[248:251], a[24:27], 0
  ds_read_b64_tr_b16 a[248:249], v0 offset:4096
  ds_read_b64_tr_b16 a[250:251], v0 offset:4352
  ds_read_b128 a[24:27], v4 offset:55296
  ds_read_b128 a[4:7], v5 offset:49152
  v_cvt_pk_bf16_f32 v172, v172, v173
  v_cvt_pk_bf16_f32 v173, v174, v175
  v_mfma_f32_32x32x16_bf16 v[236:251], a[252:255], a[28:31], v[236:251]
  ds_read_b64_tr_b16 a[252:253], v0 offset:5120
  ds_read_b64_tr_b16 a[254:255], v0 offset:5376
  ds_read_b128 a[28:31], v5 offset:55296
  v_cvt_pk_bf16_f32 v174, v176, v177
  v_cvt_pk_bf16_f32 v175, v178, v179
  v_mfma_f32_32x32x16_bf16 v[236:251], a[240:243], a[32:35], v[236:251]
  ds_read_b64_tr_b16 a[240:241], v0 offset:6144
  ds_read_b64_tr_b16 a[242:243], v0 offset:6400
  ds_read_b128 a[8:11], v4 offset:49216
  v_exp_f32 v180, v180
  v_mfma_f32_32x32x16_bf16 v[204:219], v[124:127], v[172:175], 0
  ds_read_b128 v[172:175], v2 offset:8576
  v_exp_f32 v181, v181
  v_exp_f32 v182, v182
  v_cvt_pk_bf16_f32 v176, v180, v181
  v_mfma_f32_32x32x16_bf16 v[220:235], a[244:247], a[12:15], v[220:235]
  ds_read_b128 a[12:15], v5 offset:49216
  ds_read_b128 a[32:35], v4 offset:55360
  v_exp_f32 v183, v183
  v_exp_f32 v184, v184
  v_mfma_f32_32x32x16_bf16 v[236:251], a[244:247], a[36:39], v[236:251]
  ds_read_b64_tr_b16 a[244:245], v0 offset:7168
  ds_read_b64_tr_b16 a[246:247], v0 offset:7424
  ds_read_b128 a[36:39], v5 offset:55360
  v_exp_f32 v185, v185
  s_waitcnt lgkmcnt(9)
  v_mfma_f32_32x32x16_bf16 v[220:235], a[248:251], a[16:19], v[220:235]
  ds_read_b128 a[16:19], v4 offset:49280
  v_exp_f32 v186, v186
  v_exp_f32 v187, v187
  v_cvt_pk_bf16_f32 v177, v182, v183
  v_mfma_f32_32x32x16_bf16 v[236:251], a[248:251], a[40:43], v[236:251]
  ds_read_b64_tr_b16 a[248:249], v0 offset:8192
  ds_read_b64_tr_b16 a[250:251], v0 offset:8448
  ds_read_b128 a[40:43], v4 offset:55424
  v_cvt_pk_bf16_f32 v178, v184, v185
  v_cvt_pk_bf16_f32 v179, v186, v187
  v_mfma_f32_32x32x16_bf16 v[220:235], a[252:255], a[20:23], v[220:235]
  ds_read_b128 a[20:23], v5 offset:49280
  v_exp_f32 v188, v188
  v_exp_f32 v189, v189
  v_mfma_f32_32x32x16_bf16 v[204:219], v[128:131], v[176:179], v[204:219]
  ds_read_b128 v[176:179], v2 offset:8448
  v_exp_f32 v190, v190
  v_exp_f32 v191, v191
  v_cvt_pk_bf16_f32 v180, v188, v189
  v_mfma_f32_32x32x16_bf16 v[236:251], a[252:255], a[44:47], v[236:251]
  ds_read_b64_tr_b16 a[252:253], v0 offset:9216
  ds_read_b64_tr_b16 a[254:255], v0 offset:9472
  ds_read_b128 a[44:47], v5 offset:55424
  v_exp_f32 v192, v192
  v_exp_f32 v193, v193
  v_exp_f32 v194, v194
  v_exp_f32 v195, v195
  v_cvt_pk_bf16_f32 v181, v190, v191
  v_cvt_pk_bf16_f32 v182, v192, v193
  v_cvt_pk_bf16_f32 v183, v194, v195
  v_exp_f32 v196, v196
  v_mfma_f32_32x32x16_bf16 v[204:219], v[132:135], v[180:183], v[204:219]
  ds_read_b128 v[180:183], v2 offset:8320
  ds_read_b128 v[188:191], v3 offset:8064
  ds_read_b128 v[192:195], v3 offset:7936
  s_waitcnt lgkmcnt(7)
  buffer_load_dwordx4 v7, s[8:11], s44 offen offset:0 nt lds
  v_exp_f32 v197, v197
  v_exp_f32 v198, v198
  v_exp_f32 v199, v199
  v_exp_f32 v200, v200
  v_exp_f32 v201, v201
  v_exp_f32 v202, v202
  v_exp_f32 v203, v203
  v_cvt_pk_bf16_f32 v184, v196, v197
  v_cvt_pk_bf16_f32 v185, v198, v199
  v_cvt_pk_bf16_f32 v186, v200, v201
  v_cvt_pk_bf16_f32 v187, v202, v203
  v_cvt_pk_bf16_f32 v96, v224, v225
  v_cvt_pk_bf16_f32 v97, v226, v227
  v_mfma_f32_32x32x16_bf16 v[204:219], v[136:139], v[184:187], v[204:219]
  ds_read_b128 v[184:187], v2 offset:8192
  ds_read_b128 v[196:199], v3 offset:7808
  ds_read_b128 v[200:203], v3 offset:7680
  v_cvt_pk_bf16_f32 v98, v228, v229
  v_cvt_pk_bf16_f32 v99, v230, v231
  v_cvt_pk_bf16_f32 v102, v240, v241
  v_cvt_pk_bf16_f32 v103, v242, v243
  v_cvt_pk_bf16_f32 v104, v244, v245
  v_cvt_pk_bf16_f32 v105, v246, v247
  v_cvt_pk_bf16_f32 v22, v220, v221
  v_cvt_pk_bf16_f32 v23, v222, v223
  v_cvt_pk_bf16_f32 v100, v232, v233
  v_rcp_f32 v213, v212
  v_cvt_pk_bf16_f32 v101, v234, v235
  v_mfma_f32_32x32x16_bf16 v[220:235], a[0:3], a[240:243], 0
  v_mul_f32 v216, v216, v213
  v_mul_f32 v217, v217, v213
  v_mul_f32 v218, v218, v213
  v_mul_f32 v219, v219, v213
  v_mul_f32 v204, v204, v213
  v_mul_f32 v205, v205, v213
  v_mfma_f32_32x32x16_bf16 v[220:235], a[4:7], a[244:247], v[220:235]
  v_mul_f32 v206, v206, v213
  v_mul_f32 v207, v207, v213
  v_mul_f32 v208, v208, v213
  v_mul_f32 v209, v209, v213
  v_mul_f32 v210, v210, v213
  v_mul_f32 v211, v211, v213
  v_mfma_f32_32x32x16_bf16 v[220:235], a[8:11], a[248:251], v[220:235]
  v_cvt_pk_bf16_f32 v78, v216, v217
  v_cvt_pk_bf16_f32 v79, v218, v219
  v_cvt_pk_bf16_f32 v80, v204, v205
  v_cvt_pk_bf16_f32 v81, v206, v207
  v_cvt_pk_bf16_f32 v82, v208, v209
  s_waitcnt lgkmcnt(0)
  v_mfma_f32_32x32x16_bf16 v[172:187], v[84:87], v[12:15], v[172:187]
  v_cvt_pk_bf16_f32 v83, v210, v211
  v_cvt_pk_bf16_f32 v106, v248, v249
  v_cvt_pk_bf16_f32 v107, v250, v251
  v_cvt_pk_bf16_f32 v34, v236, v237
  v_cvt_pk_bf16_f32 v35, v238, v239
  v_mfma_f32_32x32x16_bf16 v[188:203], v[90:93], v[12:15], v[188:203]
  v_mfma_f32_32x32x16_bf16 v[236:251], a[24:27], a[240:243], 0
  ds_read_b64_tr_b16 a[240:241], v0 offset:10240
  ds_read_b64_tr_b16 a[242:243], v0 offset:10496
  buffer_load_dwordx4 v8, s[8:11], s44 offen offset:1024 nt lds
  v_mfma_f32_32x32x8_bf16 v[172:187], v[88:89], v[16:17], v[172:187]
  v_mfma_f32_32x32x16_bf16 v[236:251], a[28:31], a[244:247], v[236:251]
  ds_read_b64_tr_b16 a[244:245], v0 offset:11264
  ds_read_b64_tr_b16 a[246:247], v0 offset:11520
  v_mfma_f32_32x32x8_bf16 v[188:203], v[94:95], v[16:17], v[188:203]
  v_mfma_f32_32x32x16_bf16 v[220:235], a[12:15], a[252:255], v[220:235]
  v_mfma_f32_32x32x16_bf16 v[236:251], a[32:35], a[248:251], v[236:251]
  ds_read_b64_tr_b16 a[248:249], v0 offset:12288
  ds_read_b64_tr_b16 a[250:251], v0 offset:12544
  s_waitcnt lgkmcnt(4)
  v_mfma_f32_32x32x16_bf16 v[220:235], a[16:19], a[240:243], v[220:235]
  v_max3_f32 v14, v172, v173, v174
  v_mfma_f32_32x32x16_bf16 v[236:251], a[36:39], a[252:255], v[236:251]
  ds_read_b64_tr_b16 a[252:253], v0 offset:13312
  ds_read_b64_tr_b16 a[254:255], v0 offset:13568
  v_max3_f32 v15, v188, v189, v190
  v_max3_f32 v14, v14, v175, v176
  v_max3_f32 v15, v15, v191, v192
  s_waitcnt lgkmcnt(4)
  v_mfma_f32_32x32x16_bf16 v[220:235], a[20:23], a[244:247], v[220:235]
  v_max3_f32 v14, v14, v177, v178
  v_max3_f32 v15, v15, v193, v194
  v_max3_f32 v14, v14, v179, v180
  v_max3_f32 v15, v15, v195, v196
  v_max3_f32 v14, v14, v181, v182
  v_max3_f32 v15, v15, v197, v198
  v_mfma_f32_32x32x16_bf16 v[236:251], a[40:43], a[240:243], v[236:251]
  ds_read_b64_tr_b16 a[240:241], v0 offset:14336
  ds_read_b64_tr_b16 a[242:243], v0 offset:14592
  buffer_load_dwordx4 v9, s[8:11], s44 offen offset:2048 nt lds
  s_add_u32 m0, s50, 3072
  v_max3_f32 v14, v14, v183, v184
  v_mfma_f32_32x32x16_bf16 v[236:251], a[44:47], a[244:247], v[236:251]
  ds_read_b64_tr_b16 a[244:245], v0 offset:15360
  ds_read_b64_tr_b16 a[246:247], v0 offset:15616
  v_max3_f32 v15, v15, v199, v200
  v_max3_f32 v14, v14, v185, v186
  v_max3_f32 v15, v15, v201, v202
  v_max3_f32 v14, v14, v187, v203
  s_mov_b64 exec, s[48:49]
  v_cvt_pk_bf16_f32 v108, v220, v221
  v_cvt_pk_bf16_f32 v109, v222, v223
  v_cvt_pk_bf16_f32 v110, v224, v225
  v_cvt_pk_bf16_f32 v111, v226, v227
  v_cvt_pk_bf16_f32 v112, v228, v229
  v_cvt_pk_bf16_f32 v113, v230, v231
  v_cvt_pk_bf16_f32 v114, v232, v233
  v_cvt_pk_bf16_f32 v115, v234, v235
  s_mov_b64 exec, -1
  v_max_f32 v14, v14, v15
  s_mov_b64 exec, s[60:61]
  v_cvt_pk_bf16_f32 v124, v220, v221
  v_cvt_pk_bf16_f32 v125, v222, v223
  v_cvt_pk_bf16_f32 v126, v224, v225
  v_cvt_pk_bf16_f32 v127, v226, v227
  v_cvt_pk_bf16_f32 v128, v228, v229
  v_cvt_pk_bf16_f32 v129, v230, v231
  v_cvt_pk_bf16_f32 v130, v232, v233
  v_cvt_pk_bf16_f32 v131, v234, v235
  v_mfma_f32_32x32x16_bf16 v[220:235], a[48:51], a[0:3], 0
  s_mov_b64 exec, -1
  v_permlane32_swap_b32 v14, v15
  s_mov_b64 exec, s[48:49]
  v_cvt_pk_bf16_f32 v116, v236, v237
  v_cvt_pk_bf16_f32 v117, v238, v239
  v_mfma_f32_32x32x16_bf16 v[220:235], a[52:55], a[4:7], v[220:235]
  v_cvt_pk_bf16_f32 v118, v240, v241
  v_cvt_pk_bf16_f32 v119, v242, v243
  v_cvt_pk_bf16_f32 v120, v244, v245
  v_cvt_pk_bf16_f32 v121, v246, v247
  v_cvt_pk_bf16_f32 v122, v248, v249
  v_cvt_pk_bf16_f32 v123, v250, v251
  v_mfma_f32_32x32x16_bf16 v[220:235], a[56:59], a[8:11], v[220:235]
  s_mov_b64 exec, -1
  v_max_f32 v14, v14, v15
  s_mov_b64 exec, s[60:61]
  v_cvt_pk_bf16_f32 v132, v236, v237
  v_cvt_pk_bf16_f32 v133, v238, v239
  v_cvt_pk_bf16_f32 v134, v240, v241
  v_mfma_f32_32x32x16_bf16 v[220:235], a[60:63], a[12:15], v[220:235]
  v_cvt_pk_bf16_f32 v135, v242, v243
  v_cvt_pk_bf16_f32 v136, v244, v245
  v_cvt_pk_bf16_f32 v137, v246, v247
  v_cvt_pk_bf16_f32 v138, v248, v249
  v_cvt_pk_bf16_f32 v139, v250, v251
  s_mov_b64 exec, -1
  v_mfma_f32_32x32x16_bf16 v[236:251], a[48:51], a[24:27], 0
  v_and_b32 v15, 0xffff0000, v14
  v_mfma_f32_32x32x16_bf16 v[236:251], a[52:55], a[28:31], v[236:251]
  v_sub_f32 v15, v14, v15
  buffer_load_dwordx4 v7, s[8:11], s45 offen offset:0 nt lds
  v_perm_b32 v12, v15, v14, s53
  v_mfma_f32_32x32x16_bf16 v[236:251], a[56:59], a[32:35], v[236:251]
  v_and_b32 v14, 0xffff0000, v15
  v_mfma_f32_32x32x16_bf16 v[220:235], a[64:67], a[16:19], v[220:235]
  v_sub_f32 v13, v15, v14
  v_mfma_f32_32x32x16_bf16 v[236:251], a[60:63], a[36:39], v[236:251]
  v_mfma_f32_32x32x8_bf16 v[172:187], v[10:11], v[12:13], v[172:187]
  v_mfma_f32_32x32x8_bf16 v[188:203], v[10:11], v[12:13], v[188:203]
  v_mfma_f32_32x32x16_bf16 v[220:235], a[68:71], a[20:23], v[220:235]
  v_mfma_f32_32x32x16_bf16 v[236:251], a[64:67], a[40:43], v[236:251]
  v_mfma_f32_32x32x16_bf16 v[236:251], a[68:71], a[44:47], v[236:251]
  s_nop 4
  v_exp_f32 v172, v172
  v_exp_f32 v173, v173
  v_exp_f32 v174, v174
  v_exp_f32 v175, v175
  v_exp_f32 v176, v176
  v_exp_f32 v177, v177
  v_exp_f32 v178, v178
  v_exp_f32 v179, v179
  v_cvt_pk_bf16_f32 v172, v172, v173
  v_cvt_pk_bf16_f32 v173, v174, v175
  v_cvt_pk_bf16_f32 v174, v176, v177
  v_cvt_pk_bf16_f32 v175, v178, v179
  v_exp_f32 v180, v180
  v_mfma_f32_32x32x16_bf16 v[204:219], v[140:143], v[172:175], 0
  ds_read_b128 v[172:175], v3 offset:9088
  buffer_load_dwordx4 v8, s[8:11], s45 offen offset:1024 nt lds
  v_exp_f32 v181, v181
  v_exp_f32 v182, v182
  v_exp_f32 v183, v183
  v_exp_f32 v184, v184
  v_exp_f32 v185, v185
  v_exp_f32 v186, v186
  v_exp_f32 v187, v187
  v_cvt_pk_bf16_f32 v176, v180, v181
  v_cvt_pk_bf16_f32 v177, v182, v183
  v_cvt_pk_bf16_f32 v178, v184, v185
  v_cvt_pk_bf16_f32 v179, v186, v187
  v_exp_f32 v188, v188
  v_mfma_f32_32x32x16_bf16 v[204:219], v[144:147], v[176:179], v[204:219]
  ds_read_b128 v[176:179], v3 offset:8960
  v_exp_f32 v189, v189
  v_exp_f32 v190, v190
  v_exp_f32 v191, v191
  v_exp_f32 v192, v192
  v_exp_f32 v193, v193
  v_exp_f32 v194, v194
  v_exp_f32 v195, v195
  v_cvt_pk_bf16_f32 v180, v188, v189
  v_cvt_pk_bf16_f32 v181, v190, v191
  v_cvt_pk_bf16_f32 v182, v192, v193
  v_cvt_pk_bf16_f32 v183, v194, v195
  v_exp_f32 v196, v196
  v_mfma_f32_32x32x16_bf16 v[204:219], v[148:151], v[180:183], v[204:219]
  ds_read_b128 v[180:183], v3 offset:8832
  ds_read_b128 v[188:191], v2 offset:8576
  ds_read_b128 v[192:195], v2 offset:8448
  v_exp_f32 v197, v197
  v_exp_f32 v198, v198
  v_exp_f32 v199, v199
  v_exp_f32 v200, v200
  v_exp_f32 v201, v201
  v_exp_f32 v202, v202
  v_exp_f32 v203, v203
  v_cvt_pk_bf16_f32 v184, v196, v197
  v_cvt_pk_bf16_f32 v185, v198, v199
  v_cvt_pk_bf16_f32 v186, v200, v201
  v_cvt_pk_bf16_f32 v187, v202, v203
  v_cvt_pk_bf16_f32 v36, v220, v221
  v_cvt_pk_bf16_f32 v37, v222, v223
  v_mfma_f32_32x32x16_bf16 v[204:219], v[152:155], v[184:187], v[204:219]
  ds_read_b128 v[184:187], v3 offset:8704
  ds_read_b128 v[196:199], v2 offset:8320
  ds_read_b128 v[200:203], v2 offset:8192
  buffer_load_dwordx4 v9, s[8:11], s45 offen offset:2048 nt lds
  s_add_u32 m0, s50, 6144
  v_cvt_pk_bf16_f32 v38, v224, v225
  v_cvt_pk_bf16_f32 v39, v226, v227
  v_cvt_pk_bf16_f32 v40, v228, v229
  v_cvt_pk_bf16_f32 v41, v230, v231
  v_cvt_pk_bf16_f32 v48, v236, v237
  v_cvt_pk_bf16_f32 v49, v238, v239
  v_cvt_pk_bf16_f32 v50, v240, v241
  v_rcp_f32 v209, v208
  v_cvt_pk_bf16_f32 v51, v242, v243
  v_mul_f32 v212, v212, v209
  v_mul_f32 v213, v213, v209
  v_mul_f32 v214, v214, v209
  v_mul_f32 v215, v215, v209
  v_mul_f32 v216, v216, v209
  v_mul_f32 v217, v217, v209
  v_mul_f32 v218, v218, v209
  v_mul_f32 v219, v219, v209
  v_mul_f32 v204, v204, v209
  v_mul_f32 v205, v205, v209
  v_mul_f32 v206, v206, v209
  v_mul_f32 v207, v207, v209
  v_cvt_pk_bf16_f32 v12, v212, v213
  v_cvt_pk_bf16_f32 v13, v214, v215
  v_cvt_pk_bf16_f32 v14, v216, v217
  v_cvt_pk_bf16_f32 v15, v218, v219
  v_cvt_pk_bf16_f32 v16, v204, v205
  s_waitcnt lgkmcnt(2)
  v_mfma_f32_32x32x16_bf16 v[172:187], v[84:87], v[24:27], v[172:187]
  v_cvt_pk_bf16_f32 v17, v206, v207
  v_cvt_pk_bf16_f32 v84, v232, v233
  v_cvt_pk_bf16_f32 v85, v234, v235
  v_cvt_pk_bf16_f32 v52, v244, v245
  v_cvt_pk_bf16_f32 v53, v246, v247
  s_waitcnt lgkmcnt(0)
  v_mfma_f32_32x32x16_bf16 v[188:203], v[90:93], v[24:27], v[188:203]
  v_cvt_pk_bf16_f32 v90, v248, v249
  v_cvt_pk_bf16_f32 v91, v250, v251
  v_mfma_f32_32x32x8_bf16 v[172:187], v[88:89], v[28:29], v[172:187]
  v_mfma_f32_32x32x16_bf16 v[220:235], a[72:75], a[0:3], 0
  v_mfma_f32_32x32x16_bf16 v[220:235], a[76:79], a[4:7], v[220:235]
  v_mfma_f32_32x32x16_bf16 v[236:251], a[72:75], a[24:27], 0
  buffer_load_dwordx4 v7, s[8:11], s46 offen offset:0 nt lds
  v_mfma_f32_32x32x8_bf16 v[188:203], v[94:95], v[28:29], v[188:203]
  v_mfma_f32_32x32x16_bf16 v[220:235], a[80:83], a[8:11], v[220:235]
  v_mfma_f32_32x32x16_bf16 v[236:251], a[76:79], a[28:31], v[236:251]
  v_max3_f32 v26, v172, v173, v174
  v_mfma_f32_32x32x16_bf16 v[220:235], a[84:87], a[12:15], v[220:235]
  v_max3_f32 v26, v26, v175, v176
  v_mfma_f32_32x32x16_bf16 v[236:251], a[80:83], a[32:35], v[236:251]
  v_max3_f32 v26, v26, v177, v178
  v_mfma_f32_32x32x16_bf16 v[220:235], a[88:91], a[16:19], v[220:235]
  v_max3_f32 v27, v188, v189, v190
  v_max3_f32 v26, v26, v179, v180
  v_max3_f32 v27, v27, v191, v192
  v_max3_f32 v26, v26, v181, v182
  v_max3_f32 v27, v27, v193, v194
  v_max3_f32 v26, v26, v183, v184
  v_mfma_f32_32x32x16_bf16 v[236:251], a[84:87], a[36:39], v[236:251]
  v_max3_f32 v27, v27, v195, v196
  v_max3_f32 v26, v26, v185, v186
  v_max3_f32 v27, v27, v197, v198
  v_max3_f32 v26, v26, v187, v203
  v_max3_f32 v27, v27, v199, v200
  v_mfma_f32_32x32x16_bf16 v[220:235], a[92:95], a[20:23], v[220:235]
  v_max3_f32 v27, v27, v201, v202
  v_mfma_f32_32x32x16_bf16 v[236:251], a[88:91], a[40:43], v[236:251]
  v_max_f32 v26, v26, v27
  buffer_load_dwordx4 v8, s[8:11], s46 offen offset:1024 nt lds
  v_mfma_f32_32x32x16_bf16 v[236:251], a[92:95], a[44:47], v[236:251]
  v_permlane32_swap_b32 v26, v27
  s_nop 2
  v_cvt_pk_bf16_f32 v86, v220, v221
  v_max_f32 v26, v26, v27
  v_cvt_pk_bf16_f32 v87, v222, v223
  v_and_b32 v27, 0xffff0000, v26
  v_cvt_pk_bf16_f32 v88, v224, v225
  v_sub_f32 v27, v26, v27
  v_cvt_pk_bf16_f32 v89, v226, v227
  v_perm_b32 v24, v27, v26, s53
  v_and_b32 v26, 0xffff0000, v27
  v_cvt_pk_bf16_f32 v42, v228, v229
  v_sub_f32 v25, v27, v26
  v_cvt_pk_bf16_f32 v43, v230, v231
  v_cvt_pk_bf16_f32 v44, v232, v233
  v_mfma_f32_32x32x8_bf16 v[172:187], v[10:11], v[24:25], v[172:187]
  v_cvt_pk_bf16_f32 v45, v234, v235
  v_cvt_pk_bf16_f32 v92, v236, v237
  v_cvt_pk_bf16_f32 v93, v238, v239
  v_cvt_pk_bf16_f32 v94, v240, v241
  v_cvt_pk_bf16_f32 v95, v242, v243
  v_cvt_pk_bf16_f32 v54, v244, v245
  v_cvt_pk_bf16_f32 v55, v246, v247
  v_mfma_f32_32x32x8_bf16 v[188:203], v[10:11], v[24:25], v[188:203]
  v_cvt_pk_bf16_f32 v56, v248, v249
  v_cvt_pk_bf16_f32 v57, v250, v251
  v_mfma_f32_32x32x16_bf16 v[220:235], a[168:171], v[60:63], 0
  v_exp_f32 v172, v172
  v_exp_f32 v173, v173
  v_exp_f32 v174, v174
  v_mfma_f32_32x32x16_bf16 v[220:235], a[172:175], v[64:67], v[220:235]
  v_exp_f32 v175, v175
  v_exp_f32 v176, v176
  v_exp_f32 v177, v177
  v_mfma_f32_32x32x16_bf16 v[236:251], a[192:195], v[60:63], 0
  v_exp_f32 v178, v178
  v_exp_f32 v179, v179
  v_cvt_pk_bf16_f32 v172, v172, v173
  v_cvt_pk_bf16_f32 v173, v174, v175
  v_mfma_f32_32x32x16_bf16 v[220:235], a[176:179], v[68:71], v[220:235]
  v_cvt_pk_bf16_f32 v174, v176, v177
  v_cvt_pk_bf16_f32 v175, v178, v179
  v_exp_f32 v180, v180
  v_exp_f32 v181, v181
  v_mfma_f32_32x32x16_bf16 v[204:219], v[140:143], v[172:175], 0
  ds_read_b128 v[172:175], v2 offset:12416
  v_exp_f32 v182, v182
  v_exp_f32 v183, v183
  v_cvt_pk_bf16_f32 v176, v180, v181
  v_mfma_f32_32x32x16_bf16 v[236:251], a[196:199], v[64:67], v[236:251]
  buffer_load_dwordx4 v9, s[8:11], s46 offen offset:2048 nt lds
  s_add_u32 m0, s50, 9216
  v_exp_f32 v184, v184
  v_cvt_pk_bf16_f32 v177, v182, v183
  v_mfma_f32_32x32x16_bf16 v[220:235], a[180:183], v[12:15], v[220:235]
  v_exp_f32 v185, v185
  v_exp_f32 v186, v186
  v_exp_f32 v187, v187
  v_mfma_f32_32x32x16_bf16 v[236:251], a[200:203], v[68:71], v[236:251]
  v_cvt_pk_bf16_f32 v178, v184, v185
  v_cvt_pk_bf16_f32 v179, v186, v187
  v_exp_f32 v188, v188
  v_exp_f32 v189, v189
  v_mfma_f32_32x32x16_bf16 v[204:219], v[144:147], v[176:179], v[204:219]
  ds_read_b128 v[176:179], v2 offset:12288
  v_exp_f32 v190, v190
  v_exp_f32 v191, v191
  v_cvt_pk_bf16_f32 v180, v188, v189
  v_mfma_f32_32x32x16_bf16 v[236:251], a[204:207], v[12:15], v[236:251]
  v_exp_f32 v192, v192
  v_exp_f32 v193, v193
  v_exp_f32 v194, v194
  v_exp_f32 v195, v195
  v_cvt_pk_bf16_f32 v181, v190, v191
  v_cvt_pk_bf16_f32 v182, v192, v193
  v_cvt_pk_bf16_f32 v183, v194, v195
  v_exp_f32 v196, v196
  v_mfma_f32_32x32x16_bf16 v[204:219], v[148:151], v[180:183], v[204:219]
  ds_read_b128 v[180:183], v2 offset:12160
  ds_read_b128 v[188:191], v3 offset:11904
  ds_read_b128 v[192:195], v3 offset:11776
  v_exp_f32 v197, v197
  v_exp_f32 v198, v198
  v_exp_f32 v199, v199
  v_exp_f32 v200, v200
  v_exp_f32 v201, v201
  v_exp_f32 v202, v202
  v_exp_f32 v203, v203
  v_cvt_pk_bf16_f32 v184, v196, v197
  v_cvt_pk_bf16_f32 v185, v198, v199
  v_cvt_pk_bf16_f32 v186, v200, v201
  v_cvt_pk_bf16_f32 v187, v202, v203
  ds_read_b128 v[196:199], v3 offset:11648
  ds_read_b128 v[200:203], v3 offset:11520
  v_mfma_f32_32x32x16_bf16 v[204:219], v[152:155], v[184:187], v[204:219]
  ds_read_b128 v[184:187], v2 offset:12032
  buffer_load_dwordx4 v7, s[8:11], s47 offen offset:0 nt lds
  s_nop 9
  v_rcp_f32 v209, v208
  s_nop 0
  v_mul_f32 v212, v212, v209
  v_mul_f32 v213, v213, v209
  v_mul_f32 v214, v214, v209
  v_cvt_pk_bf16_f32 v24, v212, v213
  v_mul_f32 v215, v215, v209
  v_mul_f32 v216, v216, v209
  v_cvt_pk_bf16_f32 v25, v214, v215
  v_mul_f32 v217, v217, v209
  v_mul_f32 v218, v218, v209
  v_mul_f32 v219, v219, v209
  v_mul_f32 v204, v204, v209
  v_mul_f32 v205, v205, v209
  v_mul_f32 v206, v206, v209
  v_mul_f32 v207, v207, v209
  v_cvt_pk_bf16_f32 v26, v216, v217
  s_waitcnt lgkmcnt(1)
  v_mfma_f32_32x32x16_bf16 v[188:203], v[102:105], v[18:21], v[188:203]
  v_cvt_pk_bf16_f32 v27, v218, v219
  v_cvt_pk_bf16_f32 v28, v204, v205
  v_cvt_pk_bf16_f32 v29, v206, v207
  s_waitcnt lgkmcnt(0)
  v_mfma_f32_32x32x16_bf16 v[172:187], v[96:99], v[18:21], v[172:187]
  s_nop 3
  v_mfma_f32_32x32x8_bf16 v[188:203], v[106:107], v[22:23], v[188:203]
  s_nop 4
  v_mfma_f32_32x32x8_bf16 v[172:187], v[100:101], v[22:23], v[172:187]
  s_nop 5
  v_max3_f32 v21, v188, v189, v190
  v_max3_f32 v21, v21, v191, v192
  v_max3_f32 v21, v21, v193, v194
  v_max3_f32 v21, v21, v195, v196
  v_max3_f32 v21, v21, v197, v198
  v_max3_f32 v21, v21, v199, v200
  v_max3_f32 v20, v172, v173, v174
  v_max3_f32 v21, v21, v201, v202
  v_max3_f32 v20, v20, v175, v176
  v_max3_f32 v20, v20, v177, v178
  v_max3_f32 v20, v20, v179, v180
  buffer_load_dwordx4 v8, s[8:11], s47 offen offset:1024 nt lds
  v_max3_f32 v20, v20, v181, v182
  v_max3_f32 v20, v20, v183, v184
  v_max3_f32 v20, v20, v185, v186
  v_max3_f32 v20, v20, v187, v203
  v_max_f32 v20, v20, v21
  s_nop 1
  v_permlane32_swap_b32 v20, v21
  v_max_f32 v20, v20, v21
  v_and_b32 v21, 0xffff0000, v20
  v_sub_f32 v21, v20, v21
  v_perm_b32 v18, v21, v20, s53
  v_and_b32 v20, 0xffff0000, v21
  v_sub_f32 v19, v21, v20
  s_nop 1
  v_mfma_f32_32x32x8_bf16 v[172:187], v[10:11], v[18:19], v[172:187]
  v_mfma_f32_32x32x8_bf16 v[188:203], v[10:11], v[18:19], v[188:203]
  s_nop 10
  v_exp_f32 v172, v172
  v_exp_f32 v173, v173
  v_exp_f32 v174, v174
  v_cvt_pk_bf16_f32 v172, v172, v173
  v_exp_f32 v175, v175
  v_exp_f32 v176, v176
  v_exp_f32 v177, v177
  v_exp_f32 v178, v178
  v_exp_f32 v179, v179
  v_cvt_pk_bf16_f32 v173, v174, v175
  v_cvt_pk_bf16_f32 v174, v176, v177
  v_cvt_pk_bf16_f32 v175, v178, v179
  v_exp_f32 v180, v180
  v_mfma_f32_32x32x16_bf16 v[204:219], v[156:159], v[172:175], 0
  ds_read_b128 v[172:175], v3 offset:12928
  v_exp_f32 v181, v181
  v_exp_f32 v182, v182
  v_exp_f32 v183, v183
  v_exp_f32 v184, v184
  v_exp_f32 v185, v185
  v_exp_f32 v186, v186
  v_exp_f32 v187, v187
  v_cvt_pk_bf16_f32 v176, v180, v181
  v_cvt_pk_bf16_f32 v177, v182, v183
  v_cvt_pk_bf16_f32 v178, v184, v185
  v_cvt_pk_bf16_f32 v179, v186, v187
  v_exp_f32 v188, v188
  v_mfma_f32_32x32x16_bf16 v[204:219], v[160:163], v[176:179], v[204:219]
  ds_read_b128 v[176:179], v3 offset:12800
  buffer_load_dwordx4 v9, s[8:11], s47 offen offset:2048 nt lds
  v_exp_f32 v189, v189
  v_exp_f32 v190, v190
  v_exp_f32 v191, v191
  v_exp_f32 v192, v192
  v_exp_f32 v193, v193
  v_exp_f32 v194, v194
  v_exp_f32 v195, v195
  v_cvt_pk_bf16_f32 v180, v188, v189
  v_cvt_pk_bf16_f32 v181, v190, v191
  v_cvt_pk_bf16_f32 v182, v192, v193
  v_cvt_pk_bf16_f32 v183, v194, v195
  v_exp_f32 v196, v196
  v_mfma_f32_32x32x16_bf16 v[204:219], v[164:167], v[180:183], v[204:219]
  ds_read_b128 v[180:183], v3 offset:12672
  ds_read_b128 v[188:191], v2 offset:12416
  ds_read_b128 v[192:195], v2 offset:12288
  v_exp_f32 v197, v197
  v_exp_f32 v198, v198
  v_exp_f32 v199, v199
  v_exp_f32 v200, v200
  v_exp_f32 v201, v201
  v_exp_f32 v202, v202
  v_exp_f32 v203, v203
  v_cvt_pk_bf16_f32 v184, v196, v197
  v_cvt_pk_bf16_f32 v185, v198, v199
  v_cvt_pk_bf16_f32 v186, v200, v201
  v_cvt_pk_bf16_f32 v187, v202, v203
  ds_read_b128 v[196:199], v2 offset:12160
  ds_read_b128 v[200:203], v2 offset:12032
  v_mfma_f32_32x32x16_bf16 v[204:219], v[168:171], v[184:187], v[204:219]
  ds_read_b128 v[184:187], v3 offset:12544
  s_nop 10
  v_rcp_f32 v205, v204
  s_nop 0
  v_mul_f32 v208, v208, v205
  v_mul_f32 v209, v209, v205
  v_mul_f32 v210, v210, v205
  v_cvt_pk_bf16_f32 v18, v208, v209
  v_mul_f32 v211, v211, v205
  v_mul_f32 v212, v212, v205
  v_cvt_pk_bf16_f32 v19, v210, v211
  v_mul_f32 v213, v213, v205
  v_mul_f32 v214, v214, v205
  v_mfma_f32_32x32x16_bf16 v[220:235], a[184:187], v[16:19], v[220:235]
  v_mul_f32 v215, v215, v205
  v_mul_f32 v216, v216, v205
  v_mul_f32 v217, v217, v205
  v_mul_f32 v218, v218, v205
  v_mul_f32 v219, v219, v205
  s_waitcnt lgkmcnt(1)
  v_mfma_f32_32x32x16_bf16 v[188:203], v[102:105], v[30:33], v[188:203]
  v_cvt_pk_bf16_f32 v20, v212, v213
  v_cvt_pk_bf16_f32 v21, v214, v215
  v_cvt_pk_bf16_f32 v22, v216, v217
  v_cvt_pk_bf16_f32 v23, v218, v219
  s_waitcnt lgkmcnt(0)
  v_mfma_f32_32x32x16_bf16 v[172:187], v[96:99], v[30:33], v[172:187]
  v_mfma_f32_32x32x16_bf16 v[220:235], a[188:191], v[20:23], v[220:235]
  v_mfma_f32_32x32x16_bf16 v[236:251], a[208:211], v[16:19], v[236:251]
  v_mfma_f32_32x32x8_bf16 v[188:203], v[106:107], v[34:35], v[188:203]
  v_mfma_f32_32x32x16_bf16 v[236:251], a[212:215], v[20:23], v[236:251]
  s_nop 6
  v_cvt_pk_bf16_f32 v220, v220, v221
  v_cvt_pk_bf16_f32 v221, v222, v223
  v_cvt_pk_bf16_f32 v222, v224, v225
  v_mfma_f32_32x32x8_bf16 v[172:187], v[100:101], v[34:35], v[172:187]
  v_max3_f32 v33, v188, v189, v190
  v_cvt_pk_bf16_f32 v223, v226, v227
  v_max3_f32 v33, v33, v191, v192
  v_cvt_pk_bf16_f32 v224, v228, v229
  v_cvt_pk_bf16_f32 v225, v230, v231
  v_cvt_pk_bf16_f32 v226, v232, v233
  v_max3_f32 v33, v33, v193, v194
  v_cvt_pk_bf16_f32 v227, v234, v235
  v_max3_f32 v33, v33, v195, v196
  v_cvt_pk_bf16_f32 v236, v236, v237
  v_max3_f32 v33, v33, v197, v198
  v_cvt_pk_bf16_f32 v237, v238, v239
  v_max3_f32 v33, v33, v199, v200
  v_max3_f32 v32, v172, v173, v174
  v_max3_f32 v33, v33, v201, v202
  v_max3_f32 v32, v32, v175, v176
  v_cvt_pk_bf16_f32 v238, v240, v241
  v_max3_f32 v32, v32, v177, v178
  v_cvt_pk_bf16_f32 v239, v242, v243
  v_max3_f32 v32, v32, v179, v180
  v_cvt_pk_bf16_f32 v240, v244, v245
  v_max3_f32 v32, v32, v181, v182
  v_cvt_pk_bf16_f32 v241, v246, v247
  v_max3_f32 v32, v32, v183, v184
  v_cvt_pk_bf16_f32 v242, v248, v249
  v_max3_f32 v32, v32, v185, v186
  ds_write_b128 v4, v[220:223] offset:0
  v_max3_f32 v32, v32, v187, v203
  v_cvt_pk_bf16_f32 v243, v250, v251
  v_max_f32 v32, v32, v33
  ds_write_b128 v5, v[224:227] offset:0
  v_mfma_f32_32x32x16_bf16 v[220:235], a[216:219], v[60:63], 0
  v_permlane32_swap_b32 v32, v33
  v_mfma_f32_32x32x16_bf16 v[220:235], a[220:223], v[64:67], v[220:235]
  ds_write_b128 v4, v[236:239] offset:64
  v_max_f32 v32, v32, v33
  v_mfma_f32_32x32x16_bf16 v[220:235], a[224:227], v[68:71], v[220:235]
  v_and_b32 v33, 0xffff0000, v32
  ds_write_b128 v5, v[240:243] offset:64
  v_mfma_f32_32x32x16_bf16 v[236:251], a[168:171], v[72:75], 0
  v_sub_f32 v33, v32, v33
  v_mfma_f32_32x32x16_bf16 v[236:251], a[172:175], v[76:79], v[236:251]
  v_perm_b32 v30, v33, v32, s53
  v_and_b32 v32, 0xffff0000, v33
  v_mfma_f32_32x32x16_bf16 v[220:235], a[228:231], v[12:15], v[220:235]
  v_sub_f32 v31, v33, v32
  v_mfma_f32_32x32x16_bf16 v[236:251], a[176:179], v[80:83], v[236:251]
  v_mfma_f32_32x32x8_bf16 v[172:187], v[10:11], v[30:31], v[172:187]
  v_mfma_f32_32x32x8_bf16 v[188:203], v[10:11], v[30:31], v[188:203]
  v_mfma_f32_32x32x16_bf16 v[220:235], a[232:235], v[16:19], v[220:235]
  v_mfma_f32_32x32x16_bf16 v[236:251], a[180:183], v[24:27], v[236:251]
  v_mfma_f32_32x32x16_bf16 v[220:235], a[236:239], v[20:23], v[220:235]
  s_nop 4
  v_exp_f32 v172, v172
  v_exp_f32 v173, v173
  v_exp_f32 v174, v174
  v_exp_f32 v175, v175
  v_exp_f32 v176, v176
  v_exp_f32 v177, v177
  v_exp_f32 v178, v178
  v_exp_f32 v179, v179
  v_cvt_pk_bf16_f32 v172, v172, v173
  v_cvt_pk_bf16_f32 v173, v174, v175
  v_cvt_pk_bf16_f32 v174, v176, v177
  v_cvt_pk_bf16_f32 v175, v178, v179
  v_exp_f32 v180, v180
  v_mfma_f32_32x32x16_bf16 v[204:219], v[156:159], v[172:175], 0
  ds_read_b128 v[172:175], v2 offset:896
  v_exp_f32 v181, v181
  v_exp_f32 v182, v182
  v_exp_f32 v183, v183
  v_exp_f32 v184, v184
  v_exp_f32 v185, v185
  v_exp_f32 v186, v186
  v_exp_f32 v187, v187
  v_cvt_pk_bf16_f32 v176, v180, v181
  v_cvt_pk_bf16_f32 v177, v182, v183
  v_cvt_pk_bf16_f32 v178, v184, v185
  v_cvt_pk_bf16_f32 v179, v186, v187
  v_exp_f32 v188, v188
  v_mfma_f32_32x32x16_bf16 v[204:219], v[160:163], v[176:179], v[204:219]
  ds_read_b128 v[176:179], v2 offset:768
  v_exp_f32 v189, v189
  v_exp_f32 v190, v190
  v_exp_f32 v191, v191
  v_exp_f32 v192, v192
  v_exp_f32 v193, v193
  v_exp_f32 v194, v194
  v_exp_f32 v195, v195
  v_cvt_pk_bf16_f32 v180, v188, v189
  v_cvt_pk_bf16_f32 v181, v190, v191
  v_cvt_pk_bf16_f32 v182, v192, v193
  v_cvt_pk_bf16_f32 v183, v194, v195
  v_exp_f32 v196, v196
  v_mfma_f32_32x32x16_bf16 v[204:219], v[164:167], v[180:183], v[204:219]
  ds_read_b128 v[180:183], v2 offset:640
  ds_read_b128 v[188:191], v3 offset:384
  ds_read_b128 v[192:195], v3 offset:256
  v_exp_f32 v197, v197
  v_exp_f32 v198, v198
  v_exp_f32 v199, v199
  v_exp_f32 v200, v200
  v_exp_f32 v201, v201
  v_exp_f32 v202, v202
  v_exp_f32 v203, v203
  v_cvt_pk_bf16_f32 v184, v196, v197
  v_cvt_pk_bf16_f32 v185, v198, v199
  v_cvt_pk_bf16_f32 v186, v200, v201
  v_cvt_pk_bf16_f32 v187, v202, v203
  v_cvt_pk_bf16_f32 v220, v220, v221
  v_cvt_pk_bf16_f32 v221, v222, v223
  v_mfma_f32_32x32x16_bf16 v[204:219], v[168:171], v[184:187], v[204:219]
  ds_read_b128 v[184:187], v2 offset:512
  ds_read_b128 v[196:199], v3 offset:128
  ds_read_b128 v[200:203], v3 offset:0
  v_cvt_pk_bf16_f32 v222, v224, v225
  v_cvt_pk_bf16_f32 v223, v226, v227
  v_cvt_pk_bf16_f32 v224, v228, v229
  v_cvt_pk_bf16_f32 v225, v230, v231
  v_cvt_pk_bf16_f32 v226, v232, v233
  v_cvt_pk_bf16_f32 v227, v234, v235
  ds_write_b128 v4, v[220:223] offset:128
  s_nop 1
  v_rcp_f32 v205, v204
  s_nop 0
  v_mul_f32 v208, v208, v205
  v_mul_f32 v209, v209, v205
  v_mul_f32 v210, v210, v205
  v_mul_f32 v211, v211, v205
  v_mul_f32 v212, v212, v205
  v_mul_f32 v213, v213, v205
  v_mul_f32 v214, v214, v205
  v_mul_f32 v215, v215, v205
  v_mul_f32 v216, v216, v205
  v_mul_f32 v217, v217, v205
  v_mul_f32 v218, v218, v205
  v_mul_f32 v219, v219, v205
  v_cvt_pk_bf16_f32 v30, v208, v209
  v_cvt_pk_bf16_f32 v31, v210, v211
  s_waitcnt lgkmcnt(3)
  v_mfma_f32_32x32x16_bf16 v[172:187], v[84:87], v[36:39], v[172:187]
  ds_write_b128 v5, v[224:227] offset:128
  s_waitcnt lgkmcnt(2)
  v_mfma_f32_32x32x16_bf16 v[188:203], v[90:93], v[36:39], v[188:203]
  v_cvt_pk_bf16_f32 v32, v212, v213
  v_cvt_pk_bf16_f32 v33, v214, v215
  v_cvt_pk_bf16_f32 v34, v216, v217
  v_cvt_pk_bf16_f32 v35, v218, v219
  v_mfma_f32_32x32x16_bf16 v[236:251], a[184:187], v[28:31], v[236:251]
  v_mfma_f32_32x32x8_bf16 v[172:187], v[88:89], v[40:41], v[172:187]
  v_mfma_f32_32x32x16_bf16 v[236:251], a[188:191], v[32:35], v[236:251]
  v_mfma_f32_32x32x16_bf16 v[220:235], a[192:195], v[72:75], 0
  v_mfma_f32_32x32x8_bf16 v[188:203], v[94:95], v[40:41], v[188:203]
  v_mfma_f32_32x32x16_bf16 v[220:235], a[196:199], v[76:79], v[220:235]
  v_mfma_f32_32x32x16_bf16 v[220:235], a[200:203], v[80:83], v[220:235]
  v_mfma_f32_32x32x16_bf16 v[220:235], a[204:207], v[24:27], v[220:235]
  v_mfma_f32_32x32x16_bf16 v[220:235], a[208:211], v[28:31], v[220:235]
  v_max3_f32 v38, v172, v173, v174
  v_cvt_pk_bf16_f32 v236, v236, v237
  v_max3_f32 v38, v38, v175, v176
  v_cvt_pk_bf16_f32 v237, v238, v239
  v_max3_f32 v39, v188, v189, v190
  v_max3_f32 v38, v38, v177, v178
  v_mfma_f32_32x32x16_bf16 v[220:235], a[212:215], v[32:35], v[220:235]
  v_max3_f32 v39, v39, v191, v192
  v_max3_f32 v38, v38, v179, v180
  v_max3_f32 v39, v39, v193, v194
  v_max3_f32 v38, v38, v181, v182
  v_max3_f32 v39, v39, v195, v196
  v_max3_f32 v38, v38, v183, v184
  v_max3_f32 v39, v39, v197, v198
  v_max3_f32 v38, v38, v185, v186
  v_max3_f32 v39, v39, v199, v200
  v_max3_f32 v38, v38, v187, v203
  v_max3_f32 v39, v39, v201, v202
  v_cvt_pk_bf16_f32 v238, v240, v241
  v_max_f32 v38, v38, v39
  v_cvt_pk_bf16_f32 v239, v242, v243
  v_cvt_pk_bf16_f32 v240, v244, v245
  v_permlane32_swap_b32 v38, v39
  v_cvt_pk_bf16_f32 v241, v246, v247
  v_max_f32 v38, v38, v39
  v_cvt_pk_bf16_f32 v242, v248, v249
  v_and_b32 v39, 0xffff0000, v38
  v_cvt_pk_bf16_f32 v243, v250, v251
  v_sub_f32 v39, v38, v39
  v_cvt_pk_bf16_f32 v220, v220, v221
  v_perm_b32 v36, v39, v38, s53
  v_and_b32 v38, 0xffff0000, v39
  v_cvt_pk_bf16_f32 v221, v222, v223
  v_sub_f32 v37, v39, v38
  v_cvt_pk_bf16_f32 v222, v224, v225
  v_cvt_pk_bf16_f32 v223, v226, v227
  v_mfma_f32_32x32x8_bf16 v[172:187], v[10:11], v[36:37], v[172:187]
  v_cvt_pk_bf16_f32 v224, v228, v229
  v_cvt_pk_bf16_f32 v225, v230, v231
  v_cvt_pk_bf16_f32 v226, v232, v233
  v_cvt_pk_bf16_f32 v227, v234, v235
  v_mfma_f32_32x32x8_bf16 v[188:203], v[10:11], v[36:37], v[188:203]
  ds_write_b128 v4, v[236:239] offset:6144
  s_nop 5
  v_exp_f32 v172, v172
  ds_write_b128 v5, v[240:243] offset:6144
  v_mfma_f32_32x32x16_bf16 v[236:251], a[216:219], v[72:75], 0
  v_mfma_f32_32x32x16_bf16 v[236:251], a[220:223], v[76:79], v[236:251]
  ds_write_b128 v4, v[220:223] offset:6208
  v_exp_f32 v173, v173
  v_mfma_f32_32x32x16_bf16 v[236:251], a[224:227], v[80:83], v[236:251]
  v_exp_f32 v174, v174
  v_exp_f32 v175, v175
  v_exp_f32 v176, v176
  v_mfma_f32_32x32x16_bf16 v[236:251], a[228:231], v[24:27], v[236:251]
  ds_write_b128 v5, v[224:227] offset:6208
  v_cvt_pk_bf16_f32 v172, v172, v173
  v_mfma_f32_32x32x16_bf16 v[236:251], a[232:235], v[28:31], v[236:251]
  v_exp_f32 v177, v177
  v_exp_f32 v178, v178
  v_exp_f32 v179, v179
  v_mfma_f32_32x32x16_bf16 v[236:251], a[236:239], v[32:35], v[236:251]
  v_cvt_pk_bf16_f32 v173, v174, v175
  v_cvt_pk_bf16_f32 v174, v176, v177
  v_cvt_pk_bf16_f32 v175, v178, v179
  v_exp_f32 v180, v180
  v_mfma_f32_32x32x16_bf16 v[204:219], v[108:111], v[172:175], 0
  ds_read_b128 v[172:175], v3 offset:1408
  ds_read_b128 v[252:255], v6 offset:0
  v_exp_f32 v181, v181
  v_exp_f32 v182, v182
  v_mfma_f32_32x32x16_bf16 v[220:235], a[96:99], a[0:3], 0
  v_exp_f32 v183, v183
  v_exp_f32 v184, v184
  v_exp_f32 v185, v185
  v_mfma_f32_32x32x16_bf16 v[220:235], a[100:103], a[4:7], v[220:235]
  v_exp_f32 v186, v186
  v_exp_f32 v187, v187
  v_cvt_pk_bf16_f32 v176, v180, v181
  v_cvt_pk_bf16_f32 v177, v182, v183
  v_mfma_f32_32x32x16_bf16 v[220:235], a[104:107], a[8:11], v[220:235]
  v_cvt_pk_bf16_f32 v178, v184, v185
  v_cvt_pk_bf16_f32 v179, v186, v187
  v_exp_f32 v188, v188
  v_exp_f32 v189, v189
  v_mfma_f32_32x32x16_bf16 v[204:219], v[112:115], v[176:179], v[204:219]
  ds_read_b128 v[176:179], v3 offset:1280
  v_exp_f32 v190, v190
  v_exp_f32 v191, v191
  v_cvt_pk_bf16_f32 v180, v188, v189
  v_mfma_f32_32x32x16_bf16 v[220:235], a[108:111], a[12:15], v[220:235]
  s_waitcnt vmcnt(0) lgkmcnt(1)
  buffer_store_dwordx4 v[252:255], v7, s[12:15], s36 offen offset:0 sc1
  v_mfma_f32_32x32x16_bf16 v[220:235], a[112:115], a[16:19], v[220:235]
  ds_read_b128 v[252:255], v6 offset:1024
  v_exp_f32 v192, v192
  v_exp_f32 v193, v193
  v_cvt_pk_bf16_f32 v181, v190, v191
  v_mfma_f32_32x32x16_bf16 v[220:235], a[116:119], a[20:23], v[220:235]
  ds_read_b128 v[188:191], v2 offset:896
  v_exp_f32 v194, v194
  v_exp_f32 v195, v195
  v_cvt_pk_bf16_f32 v182, v192, v193
  v_cvt_pk_bf16_f32 v183, v194, v195
  v_exp_f32 v196, v196
  v_mfma_f32_32x32x16_bf16 v[204:219], v[116:119], v[180:183], v[204:219]
  ds_read_b128 v[180:183], v3 offset:1152
  ds_read_b128 v[192:195], v2 offset:768
  v_exp_f32 v197, v197
  v_exp_f32 v198, v198
  v_exp_f32 v199, v199
  v_exp_f32 v200, v200
  v_exp_f32 v201, v201
  v_exp_f32 v202, v202
  v_exp_f32 v203, v203
  v_cvt_pk_bf16_f32 v184, v196, v197
  v_cvt_pk_bf16_f32 v185, v198, v199
  v_cvt_pk_bf16_f32 v186, v200, v201
  v_cvt_pk_bf16_f32 v187, v202, v203
  v_cvt_pk_bf16_f32 v236, v236, v237
  v_cvt_pk_bf16_f32 v237, v238, v239
  v_mfma_f32_32x32x16_bf16 v[204:219], v[120:123], v[184:187], v[204:219]
  ds_read_b128 v[184:187], v3 offset:1024
  ds_read_b128 v[196:199], v2 offset:640
  ds_read_b128 v[200:203], v2 offset:512
  v_cvt_pk_bf16_f32 v238, v240, v241
  v_cvt_pk_bf16_f32 v239, v242, v243
  v_cvt_pk_bf16_f32 v240, v244, v245
  v_cvt_pk_bf16_f32 v241, v246, v247
  v_cvt_pk_bf16_f32 v242, v248, v249
  v_cvt_pk_bf16_f32 v243, v250, v251
  v_cvt_pk_bf16_f32 v96, v224, v225
  v_cvt_pk_bf16_f32 v97, v226, v227
  v_cvt_pk_bf16_f32 v98, v228, v229
  v_rcp_f32 v217, v216
  v_cvt_pk_bf16_f32 v99, v230, v231
  v_mul_f32 v204, v204, v217
  v_mul_f32 v205, v205, v217
  v_mul_f32 v206, v206, v217
  v_mul_f32 v207, v207, v217
  v_mul_f32 v208, v208, v217
  v_mul_f32 v209, v209, v217
  v_mul_f32 v210, v210, v217
  v_mul_f32 v211, v211, v217
  v_mul_f32 v212, v212, v217
  v_mul_f32 v213, v213, v217
  v_mul_f32 v214, v214, v217
  v_mul_f32 v215, v215, v217
  v_cvt_pk_bf16_f32 v36, v204, v205
  v_cvt_pk_bf16_f32 v37, v206, v207
  ds_write_b128 v4, v[236:239] offset:6272
  s_waitcnt lgkmcnt(1)
  v_mfma_f32_32x32x16_bf16 v[172:187], v[84:87], v[48:51], v[172:187]
  ds_write_b128 v5, v[240:243] offset:6272
  v_cvt_pk_bf16_f32 v38, v208, v209
  v_mfma_f32_32x32x16_bf16 v[188:203], v[90:93], v[48:51], v[188:203]
  buffer_store_dwordx4 v[252:255], v8, s[12:15], s36 offen offset:1024 sc1
  v_cvt_pk_bf16_f32 v39, v210, v211
  v_mfma_f32_32x32x16_bf16 v[236:251], a[96:99], a[24:27], 0
  ds_read_b128 v[252:255], v6 offset:2048
  v_cvt_pk_bf16_f32 v40, v212, v213
  v_cvt_pk_bf16_f32 v41, v214, v215
  v_cvt_pk_bf16_f32 v46, v220, v221
  v_cvt_pk_bf16_f32 v47, v222, v223
  v_cvt_pk_bf16_f32 v100, v232, v233
  v_cvt_pk_bf16_f32 v101, v234, v235
  v_mfma_f32_32x32x8_bf16 v[172:187], v[88:89], v[52:53], v[172:187]
  v_mfma_f32_32x32x8_bf16 v[188:203], v[94:95], v[52:53], v[188:203]
  v_mfma_f32_32x32x16_bf16 v[236:251], a[100:103], a[28:31], v[236:251]
  v_mfma_f32_32x32x16_bf16 v[236:251], a[104:107], a[32:35], v[236:251]
  v_mfma_f32_32x32x16_bf16 v[236:251], a[108:111], a[36:39], v[236:251]
  v_mfma_f32_32x32x16_bf16 v[236:251], a[112:115], a[40:43], v[236:251]
  v_mfma_f32_32x32x16_bf16 v[236:251], a[116:119], a[44:47], v[236:251]
  v_mfma_f32_32x32x16_bf16 v[220:235], a[0:3], a[248:251], 0
  v_max3_f32 v50, v172, v173, v174
  v_max3_f32 v51, v188, v189, v190
  v_max3_f32 v50, v50, v175, v176
  v_max3_f32 v51, v51, v191, v192
  v_max3_f32 v50, v50, v177, v178
  v_max3_f32 v51, v51, v193, v194
  v_mfma_f32_32x32x16_bf16 v[220:235], a[4:7], a[252:255], v[220:235]
  s_waitcnt lgkmcnt(0)
  buffer_store_dwordx4 v[252:255], v9, s[12:15], s36 offen offset:2048 sc1
  v_mfma_f32_32x32x16_bf16 v[220:235], a[8:11], a[240:243], v[220:235]
  ds_read_b128 v[252:255], v6 offset:3072
  v_max3_f32 v50, v50, v179, v180
  v_max3_f32 v51, v51, v195, v196
  v_max3_f32 v50, v50, v181, v182
  v_max3_f32 v51, v51, v197, v198
  v_max3_f32 v50, v50, v183, v184
  v_mfma_f32_32x32x16_bf16 v[220:235], a[12:15], a[244:247], v[220:235]
  v_max3_f32 v51, v51, v199, v200
  v_max3_f32 v50, v50, v185, v186
  v_max3_f32 v51, v51, v201, v202
  v_max3_f32 v50, v50, v187, v203
  v_cvt_pk_bf16_f32 v102, v240, v241
  v_max_f32 v50, v50, v51
  v_cvt_pk_bf16_f32 v103, v242, v243
  v_cvt_pk_bf16_f32 v104, v244, v245
  v_permlane32_swap_b32 v50, v51
  v_cvt_pk_bf16_f32 v105, v246, v247
  v_max_f32 v50, v50, v51
  v_cvt_pk_bf16_f32 v106, v248, v249
  v_and_b32 v51, 0xffff0000, v50
  v_cvt_pk_bf16_f32 v107, v250, v251
  v_sub_f32 v51, v50, v51
  v_cvt_pk_bf16_f32 v58, v236, v237
  v_perm_b32 v48, v51, v50, s53
  v_and_b32 v50, 0xffff0000, v51
  v_cvt_pk_bf16_f32 v59, v238, v239
  v_mfma_f32_32x32x16_bf16 v[236:251], a[24:27], a[248:251], 0
  ds_read_b64_tr_b16 a[248:249], v0 offset:16384
  ds_read_b64_tr_b16 a[250:251], v0 offset:16640
  v_sub_f32 v49, v51, v50
  v_mfma_f32_32x32x16_bf16 v[236:251], a[28:31], a[252:255], v[236:251]
  ds_read_b64_tr_b16 a[252:253], v0 offset:17408
  ds_read_b64_tr_b16 a[254:255], v0 offset:17664
  v_mfma_f32_32x32x8_bf16 v[172:187], v[10:11], v[48:49], v[172:187]
  v_mfma_f32_32x32x8_bf16 v[188:203], v[10:11], v[48:49], v[188:203]
  v_mfma_f32_32x32x16_bf16 v[236:251], a[32:35], a[240:243], v[236:251]
  ds_read_b64_tr_b16 a[240:241], v0 offset:18432
  ds_read_b64_tr_b16 a[242:243], v0 offset:18688
  s_waitcnt lgkmcnt(4)
  v_mfma_f32_32x32x16_bf16 v[220:235], a[16:19], a[248:251], v[220:235]
  buffer_store_dwordx4 v[252:255], v7, s[12:15], s37 offen offset:0 sc1
  v_mfma_f32_32x32x16_bf16 v[236:251], a[36:39], a[244:247], v[236:251]
  ds_read_b64_tr_b16 a[244:245], v0 offset:19456
  ds_read_b64_tr_b16 a[246:247], v0 offset:19712
  ds_read_b128 v[252:255], v6 offset:4096
  v_exp_f32 v172, v172
  s_waitcnt lgkmcnt(5)
  v_mfma_f32_32x32x16_bf16 v[220:235], a[20:23], a[252:255], v[220:235]
  v_exp_f32 v173, v173
  v_exp_f32 v174, v174
  v_exp_f32 v175, v175
  v_mfma_f32_32x32x16_bf16 v[236:251], a[40:43], a[248:251], v[236:251]
  ds_read_b64_tr_b16 a[248:249], v0 offset:20480
  ds_read_b64_tr_b16 a[250:251], v0 offset:20736
  v_exp_f32 v176, v176
  v_exp_f32 v177, v177
  v_mfma_f32_32x32x16_bf16 v[236:251], a[44:47], a[252:255], v[236:251]
  ds_read_b64_tr_b16 a[252:253], v0 offset:21504
  ds_read_b64_tr_b16 a[254:255], v0 offset:21760
  v_exp_f32 v178, v178
  v_exp_f32 v179, v179
  v_cvt_pk_bf16_f32 v172, v172, v173
  v_cvt_pk_bf16_f32 v173, v174, v175
  v_cvt_pk_bf16_f32 v174, v176, v177
  v_cvt_pk_bf16_f32 v175, v178, v179
  v_exp_f32 v180, v180
  v_mfma_f32_32x32x16_bf16 v[204:219], v[108:111], v[172:175], 0
  ds_read_b128 v[172:175], v2 offset:4736
  v_exp_f32 v181, v181
  v_exp_f32 v182, v182
  v_exp_f32 v183, v183
  v_exp_f32 v184, v184
  v_exp_f32 v185, v185
  v_exp_f32 v186, v186
  v_exp_f32 v187, v187
  v_cvt_pk_bf16_f32 v176, v180, v181
  v_cvt_pk_bf16_f32 v177, v182, v183
  v_cvt_pk_bf16_f32 v178, v184, v185
  v_cvt_pk_bf16_f32 v179, v186, v187
  v_exp_f32 v188, v188
  v_mfma_f32_32x32x16_bf16 v[204:219], v[112:115], v[176:179], v[204:219]
  ds_read_b128 v[176:179], v2 offset:4608
  v_exp_f32 v189, v189
  v_exp_f32 v190, v190
  v_exp_f32 v191, v191
  v_exp_f32 v192, v192
  v_exp_f32 v193, v193
  v_exp_f32 v194, v194
  v_exp_f32 v195, v195
  v_cvt_pk_bf16_f32 v180, v188, v189
  v_cvt_pk_bf16_f32 v181, v190, v191
  v_cvt_pk_bf16_f32 v182, v192, v193
  v_cvt_pk_bf16_f32 v183, v194, v195
  v_exp_f32 v196, v196
  v_mfma_f32_32x32x16_bf16 v[204:219], v[116:119], v[180:183], v[204:219]
  ds_read_b128 v[180:183], v2 offset:4480
  ds_read_b128 v[188:191], v3 offset:4224
  ds_read_b128 v[192:195], v3 offset:4096
  s_waitcnt lgkmcnt(4)
  buffer_store_dwordx4 v[252:255], v8, s[12:15], s37 offen offset:1024 sc1
  v_exp_f32 v197, v197
  v_exp_f32 v198, v198
  v_exp_f32 v199, v199
  v_exp_f32 v200, v200
  v_exp_f32 v201, v201
  v_exp_f32 v202, v202
  v_exp_f32 v203, v203
  v_cvt_pk_bf16_f32 v184, v196, v197
  v_cvt_pk_bf16_f32 v185, v198, v199
  v_cvt_pk_bf16_f32 v186, v200, v201
  v_cvt_pk_bf16_f32 v187, v202, v203
  s_mov_b64 exec, s[62:63]
  v_cvt_pk_bf16_f32 v124, v220, v221
  v_mfma_f32_32x32x16_bf16 v[204:219], v[120:123], v[184:187], v[204:219]
  v_cvt_pk_bf16_f32 v125, v222, v223
  v_cvt_pk_bf16_f32 v126, v224, v225
  v_cvt_pk_bf16_f32 v127, v226, v227
  v_cvt_pk_bf16_f32 v128, v228, v229
  v_cvt_pk_bf16_f32 v129, v230, v231
  v_cvt_pk_bf16_f32 v130, v232, v233
  v_cvt_pk_bf16_f32 v131, v234, v235
  s_mov_b64 exec, -1
  ds_read_b128 v[252:255], v6 offset:5120
  ds_read_b128 v[184:187], v2 offset:4352
  ds_read_b128 v[196:199], v3 offset:3968
  s_mov_b64 exec, s[62:63]
  v_cvt_pk_bf16_f32 v132, v236, v237
  v_cvt_pk_bf16_f32 v133, v238, v239
  v_cvt_pk_bf16_f32 v134, v240, v241
  v_cvt_pk_bf16_f32 v135, v242, v243
  v_cvt_pk_bf16_f32 v136, v244, v245
  v_cvt_pk_bf16_f32 v137, v246, v247
  v_cvt_pk_bf16_f32 v138, v248, v249
  v_cvt_pk_bf16_f32 v139, v250, v251
  s_mov_b64 exec, -1
  v_rcp_f32 v217, v216
  s_mov_b64 exec, s[64:65]
  v_cvt_pk_bf16_f32 v140, v220, v221
  v_cvt_pk_bf16_f32 v141, v222, v223
  v_cvt_pk_bf16_f32 v142, v224, v225
  v_cvt_pk_bf16_f32 v143, v226, v227
  v_cvt_pk_bf16_f32 v144, v228, v229
  v_cvt_pk_bf16_f32 v145, v230, v231
  v_cvt_pk_bf16_f32 v146, v232, v233
  v_cvt_pk_bf16_f32 v147, v234, v235
  v_mfma_f32_32x32x16_bf16 v[220:235], a[120:123], a[0:3], 0
  s_mov_b64 exec, -1
  ds_read_b128 v[200:203], v3 offset:3840
  v_mul_f32 v204, v204, v217
  v_mul_f32 v205, v205, v217
  v_mul_f32 v206, v206, v217
  v_mul_f32 v207, v207, v217
  v_mfma_f32_32x32x16_bf16 v[220:235], a[124:127], a[4:7], v[220:235]
  v_mul_f32 v208, v208, v217
  v_mul_f32 v209, v209, v217
  v_mul_f32 v210, v210, v217
  v_mul_f32 v211, v211, v217
  v_mul_f32 v212, v212, v217
  s_waitcnt lgkmcnt(1)
  v_mfma_f32_32x32x16_bf16 v[172:187], v[96:99], v[42:45], v[172:187]
  buffer_store_dwordx4 v[252:255], v9, s[12:15], s37 offen offset:2048 sc1
  v_mul_f32 v213, v213, v217
  v_mfma_f32_32x32x16_bf16 v[220:235], a[128:131], a[8:11], v[220:235]
  ds_read_b128 v[252:255], v6 offset:6144
  v_mul_f32 v214, v214, v217
  v_mul_f32 v215, v215, v217
  v_cvt_pk_bf16_f32 v48, v204, v205
  v_cvt_pk_bf16_f32 v49, v206, v207
  v_cvt_pk_bf16_f32 v50, v208, v209
  v_cvt_pk_bf16_f32 v51, v210, v211
  v_mfma_f32_32x32x8_bf16 v[172:187], v[100:101], v[46:47], v[172:187]
  v_cvt_pk_bf16_f32 v52, v212, v213
  v_cvt_pk_bf16_f32 v53, v214, v215
  s_mov_b64 exec, s[64:65]
  v_cvt_pk_bf16_f32 v148, v236, v237
  v_cvt_pk_bf16_f32 v149, v238, v239
  v_cvt_pk_bf16_f32 v150, v240, v241
  v_cvt_pk_bf16_f32 v151, v242, v243
  s_waitcnt lgkmcnt(1)
  v_mfma_f32_32x32x16_bf16 v[188:203], v[102:105], v[42:45], v[188:203]
  v_cvt_pk_bf16_f32 v152, v244, v245
  v_cvt_pk_bf16_f32 v153, v246, v247
  v_cvt_pk_bf16_f32 v154, v248, v249
  v_cvt_pk_bf16_f32 v155, v250, v251
  s_mov_b64 exec, -1
  v_max3_f32 v44, v172, v173, v174
  v_mfma_f32_32x32x16_bf16 v[236:251], a[120:123], a[24:27], 0
  v_max3_f32 v44, v44, v175, v176
  v_mfma_f32_32x32x16_bf16 v[236:251], a[124:127], a[28:31], v[236:251]
  v_max3_f32 v44, v44, v177, v178
  v_mfma_f32_32x32x8_bf16 v[188:203], v[106:107], v[46:47], v[188:203]
  v_max3_f32 v44, v44, v179, v180
  v_mfma_f32_32x32x16_bf16 v[236:251], a[128:131], a[32:35], v[236:251]
  v_max3_f32 v44, v44, v181, v182
  v_mfma_f32_32x32x16_bf16 v[220:235], a[132:135], a[12:15], v[220:235]
  v_max3_f32 v44, v44, v183, v184
  v_mfma_f32_32x32x16_bf16 v[236:251], a[132:135], a[36:39], v[236:251]
  s_waitcnt lgkmcnt(0)
  buffer_store_dwordx4 v[252:255], v7, s[12:15], s38 offen offset:0 sc1
  v_mfma_f32_32x32x16_bf16 v[220:235], a[136:139], a[16:19], v[220:235]
  ds_read_b128 v[252:255], v6 offset:7168
  v_max3_f32 v45, v188, v189, v190
  v_max3_f32 v44, v44, v185, v186
  v_max3_f32 v45, v45, v191, v192
  v_max3_f32 v44, v44, v187, v203
  v_max3_f32 v45, v45, v193, v194
  v_mfma_f32_32x32x16_bf16 v[236:251], a[136:139], a[40:43], v[236:251]
  v_max3_f32 v45, v45, v195, v196
  v_mfma_f32_32x32x16_bf16 v[220:235], a[140:143], a[20:23], v[220:235]
  v_max3_f32 v45, v45, v197, v198
  v_mfma_f32_32x32x16_bf16 v[236:251], a[140:143], a[44:47], v[236:251]
  v_max3_f32 v45, v45, v199, v200
  v_max3_f32 v45, v45, v201, v202
  v_max_f32 v44, v44, v45
  s_nop 5
  v_cvt_pk_bf16_f32 v60, v220, v221
  v_cvt_pk_bf16_f32 v61, v222, v223
  v_permlane32_swap_b32 v44, v45
  v_cvt_pk_bf16_f32 v62, v224, v225
  v_max_f32 v44, v44, v45
  v_cvt_pk_bf16_f32 v63, v226, v227
  v_and_b32 v45, 0xffff0000, v44
  v_cvt_pk_bf16_f32 v64, v228, v229
  v_sub_f32 v45, v44, v45
  v_cvt_pk_bf16_f32 v65, v230, v231
  v_perm_b32 v42, v45, v44, s53
  v_and_b32 v44, 0xffff0000, v45
  v_cvt_pk_bf16_f32 v84, v232, v233
  v_sub_f32 v43, v45, v44
  v_cvt_pk_bf16_f32 v85, v234, v235
  v_mfma_f32_32x32x16_bf16 v[220:235], a[144:147], a[0:3], 0
  v_cvt_pk_bf16_f32 v72, v236, v237
  v_cvt_pk_bf16_f32 v73, v238, v239
  v_cvt_pk_bf16_f32 v74, v240, v241
  v_cvt_pk_bf16_f32 v75, v242, v243
  v_cvt_pk_bf16_f32 v76, v244, v245
  v_cvt_pk_bf16_f32 v77, v246, v247
  v_cvt_pk_bf16_f32 v90, v248, v249
  v_mfma_f32_32x32x8_bf16 v[172:187], v[10:11], v[42:43], v[172:187]
  v_cvt_pk_bf16_f32 v91, v250, v251
  v_mfma_f32_32x32x8_bf16 v[188:203], v[10:11], v[42:43], v[188:203]
  v_mfma_f32_32x32x16_bf16 v[236:251], a[144:147], a[24:27], 0
  s_waitcnt lgkmcnt(0)
  buffer_store_dwordx4 v[252:255], v8, s[12:15], s38 offen offset:1024 sc1
  v_mfma_f32_32x32x16_bf16 v[220:235], a[148:151], a[4:7], v[220:235]
  ds_read_b128 v[252:255], v6 offset:8192
  v_mfma_f32_32x32x16_bf16 v[236:251], a[148:151], a[28:31], v[236:251]
  v_mfma_f32_32x32x16_bf16 v[220:235], a[152:155], a[8:11], v[220:235]
  v_exp_f32 v172, v172
  v_exp_f32 v173, v173
  v_exp_f32 v174, v174
  v_mfma_f32_32x32x16_bf16 v[236:251], a[152:155], a[32:35], v[236:251]
  v_exp_f32 v175, v175
  v_exp_f32 v176, v176
  v_exp_f32 v177, v177
  v_mfma_f32_32x32x16_bf16 v[220:235], a[156:159], a[12:15], v[220:235]
  v_exp_f32 v178, v178
  v_exp_f32 v179, v179
  v_cvt_pk_bf16_f32 v172, v172, v173
  v_cvt_pk_bf16_f32 v173, v174, v175
  v_mfma_f32_32x32x16_bf16 v[236:251], a[156:159], a[36:39], v[236:251]
  v_cvt_pk_bf16_f32 v174, v176, v177
  v_cvt_pk_bf16_f32 v175, v178, v179
  v_exp_f32 v180, v180
  v_exp_f32 v181, v181
  v_mfma_f32_32x32x16_bf16 v[204:219], v[124:127], v[172:175], 0
  ds_read_b128 v[172:175], v3 offset:5248
  v_exp_f32 v182, v182
  v_exp_f32 v183, v183
  v_cvt_pk_bf16_f32 v176, v180, v181
  v_mfma_f32_32x32x16_bf16 v[220:235], a[160:163], a[16:19], v[220:235]
  v_exp_f32 v184, v184
  v_exp_f32 v185, v185
  v_exp_f32 v186, v186
  v_mfma_f32_32x32x16_bf16 v[236:251], a[160:163], a[40:43], v[236:251]
  v_exp_f32 v187, v187
  v_cvt_pk_bf16_f32 v177, v182, v183
  v_cvt_pk_bf16_f32 v178, v184, v185
  v_cvt_pk_bf16_f32 v179, v186, v187
  v_mfma_f32_32x32x16_bf16 v[220:235], a[164:167], a[20:23], v[220:235]
  s_waitcnt lgkmcnt(1)
  buffer_store_dwordx4 v[252:255], v9, s[12:15], s38 offen offset:2048 sc1
  v_mfma_f32_32x32x16_bf16 v[204:219], v[128:131], v[176:179], v[204:219]
  ds_read_b128 v[176:179], v3 offset:5120
  ds_read_b128 v[252:255], v6 offset:9216
  v_exp_f32 v188, v188
  v_exp_f32 v189, v189
  v_mfma_f32_32x32x16_bf16 v[236:251], a[164:167], a[44:47], v[236:251]
  v_exp_f32 v190, v190
  v_exp_f32 v191, v191
  v_exp_f32 v192, v192
  v_exp_f32 v193, v193
  v_exp_f32 v194, v194
  v_exp_f32 v195, v195
  v_cvt_pk_bf16_f32 v180, v188, v189
  v_cvt_pk_bf16_f32 v181, v190, v191
  v_cvt_pk_bf16_f32 v182, v192, v193
  v_cvt_pk_bf16_f32 v183, v194, v195
  v_exp_f32 v196, v196
  v_mfma_f32_32x32x16_bf16 v[204:219], v[132:135], v[180:183], v[204:219]
  ds_read_b128 v[180:183], v3 offset:4992
  ds_read_b128 v[188:191], v2 offset:4736
  ds_read_b128 v[192:195], v2 offset:4608
  v_exp_f32 v197, v197
  v_exp_f32 v198, v198
  v_exp_f32 v199, v199
  v_exp_f32 v200, v200
  v_exp_f32 v201, v201
  v_exp_f32 v202, v202
  v_exp_f32 v203, v203
  v_cvt_pk_bf16_f32 v184, v196, v197
  v_cvt_pk_bf16_f32 v185, v198, v199
  v_cvt_pk_bf16_f32 v186, v200, v201
  v_cvt_pk_bf16_f32 v187, v202, v203
  v_cvt_pk_bf16_f32 v86, v220, v221
  v_cvt_pk_bf16_f32 v87, v222, v223
  v_mfma_f32_32x32x16_bf16 v[204:219], v[136:139], v[184:187], v[204:219]
  ds_read_b128 v[184:187], v3 offset:4864
  ds_read_b128 v[196:199], v2 offset:4480
  ds_read_b128 v[200:203], v2 offset:4352
  v_cvt_pk_bf16_f32 v92, v236, v237
  v_cvt_pk_bf16_f32 v93, v238, v239
  v_cvt_pk_bf16_f32 v88, v224, v225
  v_cvt_pk_bf16_f32 v89, v226, v227
  v_cvt_pk_bf16_f32 v94, v240, v241
  v_cvt_pk_bf16_f32 v95, v242, v243
  v_cvt_pk_bf16_f32 v66, v228, v229
  v_cvt_pk_bf16_f32 v67, v230, v231
  v_cvt_pk_bf16_f32 v68, v232, v233
  v_rcp_f32 v213, v212
  v_cvt_pk_bf16_f32 v69, v234, v235
  v_mfma_f32_32x32x16_bf16 v[220:235], a[0:3], a[240:243], 0
  s_waitcnt lgkmcnt(3)
  buffer_store_dwordx4 v[252:255], v7, s[12:15], s39 offen offset:0 sc1
  v_mfma_f32_32x32x16_bf16 v[220:235], a[4:7], a[244:247], v[220:235]
  ds_read_b128 v[252:255], v6 offset:10240
  v_mul_f32 v216, v216, v213
  v_mul_f32 v217, v217, v213
  v_mul_f32 v218, v218, v213
  v_mul_f32 v219, v219, v213
  v_mul_f32 v204, v204, v213
  v_mfma_f32_32x32x16_bf16 v[220:235], a[8:11], a[248:251], v[220:235]
  v_mul_f32 v205, v205, v213
  v_mul_f32 v206, v206, v213
  v_mul_f32 v207, v207, v213
  v_mul_f32 v208, v208, v213
  v_mul_f32 v209, v209, v213
  s_waitcnt lgkmcnt(1)
  v_mfma_f32_32x32x16_bf16 v[172:187], v[96:99], v[54:57], v[172:187]
  v_mul_f32 v210, v210, v213
  v_mul_f32 v211, v211, v213
  v_cvt_pk_bf16_f32 v42, v216, v217
  v_cvt_pk_bf16_f32 v43, v218, v219
  v_cvt_pk_bf16_f32 v44, v204, v205
  v_cvt_pk_bf16_f32 v45, v206, v207
  v_mfma_f32_32x32x16_bf16 v[188:203], v[102:105], v[54:57], v[188:203]
  v_cvt_pk_bf16_f32 v46, v208, v209
  v_cvt_pk_bf16_f32 v47, v210, v211
  v_cvt_pk_bf16_f32 v78, v244, v245
  v_cvt_pk_bf16_f32 v79, v246, v247
  v_cvt_pk_bf16_f32 v80, v248, v249
  v_cvt_pk_bf16_f32 v81, v250, v251
  v_mfma_f32_32x32x8_bf16 v[172:187], v[100:101], v[58:59], v[172:187]
  v_mfma_f32_32x32x16_bf16 v[236:251], a[24:27], a[240:243], 0
  ds_read_b64_tr_b16 a[240:241], v0 offset:22528
  ds_read_b64_tr_b16 a[242:243], v0 offset:22784
  v_mfma_f32_32x32x8_bf16 v[188:203], v[106:107], v[58:59], v[188:203]
  v_mfma_f32_32x32x16_bf16 v[236:251], a[28:31], a[244:247], v[236:251]
  ds_read_b64_tr_b16 a[244:245], v0 offset:23552
  ds_read_b64_tr_b16 a[246:247], v0 offset:23808
  v_mfma_f32_32x32x16_bf16 v[220:235], a[12:15], a[252:255], v[220:235]
  s_waitcnt lgkmcnt(4)
  buffer_store_dwordx4 v[252:255], v8, s[12:15], s39 offen offset:1024 sc1
  v_mfma_f32_32x32x16_bf16 v[236:251], a[32:35], a[248:251], v[236:251]
  ds_read_b64_tr_b16 a[248:249], v0 offset:0
  ds_read_b64_tr_b16 a[250:251], v0 offset:256
  ds_read_b128 v[252:255], v6 offset:11264
  v_max3_f32 v56, v172, v173, v174
  v_max3_f32 v57, v188, v189, v190
  s_waitcnt lgkmcnt(5)
  v_mfma_f32_32x32x16_bf16 v[220:235], a[16:19], a[240:243], v[220:235]
  v_max3_f32 v56, v56, v175, v176
  v_max3_f32 v57, v57, v191, v192
  v_max3_f32 v56, v56, v177, v178
  v_max3_f32 v57, v57, v193, v194
  v_max3_f32 v56, v56, v179, v180
  v_max3_f32 v57, v57, v195, v196
  v_mfma_f32_32x32x16_bf16 v[236:251], a[36:39], a[252:255], v[236:251]
  ds_read_b64_tr_b16 a[252:253], v0 offset:1024
  ds_read_b64_tr_b16 a[254:255], v0 offset:1280
  v_max3_f32 v56, v56, v181, v182
  v_max3_f32 v57, v57, v197, v198
  v_max3_f32 v56, v56, v183, v184
  s_waitcnt lgkmcnt(5)
  v_mfma_f32_32x32x16_bf16 v[220:235], a[20:23], a[244:247], v[220:235]
  v_max3_f32 v57, v57, v199, v200
  v_max3_f32 v56, v56, v185, v186
  v_max3_f32 v57, v57, v201, v202
  v_max3_f32 v56, v56, v187, v203
  v_mfma_f32_32x32x16_bf16 v[236:251], a[40:43], a[240:243], v[236:251]
  ds_read_b64_tr_b16 a[240:241], v0 offset:2048
  ds_read_b64_tr_b16 a[242:243], v0 offset:2304
  v_max_f32 v56, v56, v57
  v_mfma_f32_32x32x16_bf16 v[236:251], a[44:47], a[244:247], v[236:251]
  ds_read_b64_tr_b16 a[244:245], v0 offset:3072
  ds_read_b64_tr_b16 a[246:247], v0 offset:3328
  v_permlane32_swap_b32 v56, v57
  s_mov_b64 exec, s[66:67]
  v_cvt_pk_bf16_f32 v140, v220, v221
  v_cvt_pk_bf16_f32 v141, v222, v223
  v_cvt_pk_bf16_f32 v142, v224, v225
  v_cvt_pk_bf16_f32 v143, v226, v227
  v_cvt_pk_bf16_f32 v144, v228, v229
  v_cvt_pk_bf16_f32 v145, v230, v231
  v_cvt_pk_bf16_f32 v146, v232, v233
  v_cvt_pk_bf16_f32 v147, v234, v235
  s_mov_b64 exec, -1
  v_max_f32 v56, v56, v57
  s_mov_b64 exec, s[66:67]
  v_cvt_pk_bf16_f32 v148, v236, v237
  v_cvt_pk_bf16_f32 v149, v238, v239
  v_cvt_pk_bf16_f32 v150, v240, v241
  v_cvt_pk_bf16_f32 v151, v242, v243
  v_cvt_pk_bf16_f32 v152, v244, v245
  v_cvt_pk_bf16_f32 v153, v246, v247
  v_cvt_pk_bf16_f32 v154, v248, v249
  v_cvt_pk_bf16_f32 v155, v250, v251
  s_mov_b64 exec, -1
  v_and_b32 v57, 0xffff0000, v56
  s_mov_b64 exec, s[68:69]
  v_cvt_pk_bf16_f32 v156, v220, v221
  v_cvt_pk_bf16_f32 v157, v222, v223
  v_cvt_pk_bf16_f32 v158, v224, v225
  v_cvt_pk_bf16_f32 v159, v226, v227
  v_cvt_pk_bf16_f32 v160, v228, v229
  v_cvt_pk_bf16_f32 v161, v230, v231
  v_cvt_pk_bf16_f32 v162, v232, v233
  v_cvt_pk_bf16_f32 v163, v234, v235
  s_waitcnt lgkmcnt(0)
  v_mfma_f32_32x32x16_bf16 v[220:235], a[248:251], a[0:3], 0
  s_mov_b64 exec, -1
  ds_read_b128 a[0:3], v4 offset:49152
  v_sub_f32 v57, v56, v57
  s_mov_b64 exec, s[68:69]
  v_cvt_pk_bf16_f32 v164, v236, v237
  v_cvt_pk_bf16_f32 v165, v238, v239
  v_mfma_f32_32x32x16_bf16 v[220:235], a[252:255], a[4:7], v[220:235]
  v_cvt_pk_bf16_f32 v166, v240, v241
  v_cvt_pk_bf16_f32 v167, v242, v243
  v_cvt_pk_bf16_f32 v168, v244, v245
  v_cvt_pk_bf16_f32 v169, v246, v247
  v_cvt_pk_bf16_f32 v170, v248, v249
  v_cvt_pk_bf16_f32 v171, v250, v251
  v_mfma_f32_32x32x16_bf16 v[236:251], a[248:251], a[24:27], 0
  s_mov_b64 exec, -1
  ds_read_b64_tr_b16 a[248:249], v0 offset:4096
  ds_read_b64_tr_b16 a[250:251], v0 offset:4352
  ds_read_b128 a[24:27], v4 offset:55296
  ds_read_b128 a[4:7], v5 offset:49152
  v_perm_b32 v54, v57, v56, s53
  v_mfma_f32_32x32x16_bf16 v[236:251], a[252:255], a[28:31], v[236:251]
  ds_read_b64_tr_b16 a[252:253], v0 offset:5120
  ds_read_b64_tr_b16 a[254:255], v0 offset:5376
  v_and_b32 v56, 0xffff0000, v57
  ds_read_b128 a[28:31], v5 offset:55296
  v_mfma_f32_32x32x16_bf16 v[220:235], a[240:243], a[8:11], v[220:235]
  ds_read_b128 a[8:11], v4 offset:49216
  buffer_store_dwordx4 v[252:255], v9, s[12:15], s39 offen offset:2048 sc1
  v_mfma_f32_32x32x16_bf16 v[236:251], a[240:243], a[32:35], v[236:251]
  ds_read_b64_tr_b16 a[240:241], v0 offset:6144
  ds_read_b64_tr_b16 a[242:243], v0 offset:6400
  ds_read_b128 a[32:35], v4 offset:55360
  v_sub_f32 v55, v57, v56
  v_mfma_f32_32x32x16_bf16 v[220:235], a[244:247], a[12:15], v[220:235]
  ds_read_b128 a[12:15], v5 offset:49216
  v_mfma_f32_32x32x8_bf16 v[172:187], v[10:11], v[54:55], v[172:187]
  v_mfma_f32_32x32x8_bf16 v[188:203], v[10:11], v[54:55], v[188:203]
  v_mfma_f32_32x32x16_bf16 v[236:251], a[244:247], a[36:39], v[236:251]
  ds_read_b64_tr_b16 a[244:245], v0 offset:7168
  ds_read_b64_tr_b16 a[246:247], v0 offset:7424
  ds_read_b128 a[36:39], v5 offset:55360
  s_waitcnt lgkmcnt(4)
  v_mfma_f32_32x32x16_bf16 v[220:235], a[248:251], a[16:19], v[220:235]
  ds_read_b128 a[16:19], v4 offset:49280
  v_mfma_f32_32x32x16_bf16 v[236:251], a[248:251], a[40:43], v[236:251]
  ds_read_b64_tr_b16 a[248:249], v0 offset:8192
  ds_read_b64_tr_b16 a[250:251], v0 offset:8448
  ds_read_b128 a[40:43], v4 offset:55424
  v_exp_f32 v172, v172
  v_mfma_f32_32x32x16_bf16 v[220:235], a[252:255], a[20:23], v[220:235]
  ds_read_b128 a[20:23], v5 offset:49280
  v_exp_f32 v173, v173
  v_exp_f32 v174, v174
  v_cvt_pk_bf16_f32 v172, v172, v173
  v_mfma_f32_32x32x16_bf16 v[236:251], a[252:255], a[44:47], v[236:251]
  ds_read_b64_tr_b16 a[252:253], v0 offset:9216
  ds_read_b64_tr_b16 a[254:255], v0 offset:9472
  ds_read_b128 a[44:47], v5 offset:55424
  v_exp_f32 v175, v175
  v_exp_f32 v176, v176
  v_exp_f32 v177, v177
  v_exp_f32 v178, v178
  v_exp_f32 v179, v179
  v_cvt_pk_bf16_f32 v173, v174, v175
  v_cvt_pk_bf16_f32 v174, v176, v177
  v_cvt_pk_bf16_f32 v175, v178, v179
  v_exp_f32 v180, v180
  v_mfma_f32_32x32x16_bf16 v[204:219], v[124:127], v[172:175], 0
  ds_read_b128 v[172:175], v2 offset:8576
  v_exp_f32 v181, v181
  v_exp_f32 v182, v182
  v_exp_f32 v183, v183
  v_exp_f32 v184, v184
  v_exp_f32 v185, v185
  v_exp_f32 v186, v186
  v_exp_f32 v187, v187
  v_cvt_pk_bf16_f32 v176, v180, v181
  v_cvt_pk_bf16_f32 v177, v182, v183
  v_cvt_pk_bf16_f32 v178, v184, v185
  v_cvt_pk_bf16_f32 v179, v186, v187
  v_exp_f32 v188, v188
  v_mfma_f32_32x32x16_bf16 v[204:219], v[128:131], v[176:179], v[204:219]
  ds_read_b128 v[176:179], v2 offset:8448
  v_exp_f32 v189, v189
  v_exp_f32 v190, v190
  v_exp_f32 v191, v191
  v_exp_f32 v192, v192
  v_exp_f32 v193, v193
  v_exp_f32 v194, v194
  v_exp_f32 v195, v195
  v_cvt_pk_bf16_f32 v180, v188, v189
  v_cvt_pk_bf16_f32 v181, v190, v191
  v_cvt_pk_bf16_f32 v182, v192, v193
  v_cvt_pk_bf16_f32 v183, v194, v195
  v_exp_f32 v196, v196
  v_mfma_f32_32x32x16_bf16 v[204:219], v[132:135], v[180:183], v[204:219]
  ds_read_b128 v[180:183], v2 offset:8320
  ds_read_b128 v[188:191], v3 offset:8064
  ds_read_b128 v[192:195], v3 offset:7936
  v_exp_f32 v197, v197
  v_exp_f32 v198, v198
  v_exp_f32 v199, v199
  v_exp_f32 v200, v200
  v_exp_f32 v201, v201
  v_exp_f32 v202, v202
  v_exp_f32 v203, v203
  v_cvt_pk_bf16_f32 v184, v196, v197
  v_cvt_pk_bf16_f32 v185, v198, v199
  v_cvt_pk_bf16_f32 v186, v200, v201
  v_cvt_pk_bf16_f32 v187, v202, v203
  v_cvt_pk_bf16_f32 v96, v224, v225
  v_cvt_pk_bf16_f32 v97, v226, v227
  v_mfma_f32_32x32x16_bf16 v[204:219], v[136:139], v[184:187], v[204:219]
  ds_read_b128 v[184:187], v2 offset:8192
  ds_read_b128 v[196:199], v3 offset:7808
  ds_read_b128 v[200:203], v3 offset:7680
  v_cvt_pk_bf16_f32 v98, v228, v229
  v_cvt_pk_bf16_f32 v99, v230, v231
  v_cvt_pk_bf16_f32 v102, v240, v241
  v_cvt_pk_bf16_f32 v103, v242, v243
  v_cvt_pk_bf16_f32 v104, v244, v245
  v_cvt_pk_bf16_f32 v105, v246, v247
  v_cvt_pk_bf16_f32 v70, v220, v221
  v_cvt_pk_bf16_f32 v71, v222, v223
  v_cvt_pk_bf16_f32 v100, v232, v233
  v_rcp_f32 v213, v212
  v_cvt_pk_bf16_f32 v101, v234, v235
  v_mfma_f32_32x32x16_bf16 v[220:235], a[0:3], a[240:243], 0
  v_mul_f32 v216, v216, v213
  v_mul_f32 v217, v217, v213
  v_mul_f32 v218, v218, v213
  v_mul_f32 v219, v219, v213
  v_mul_f32 v204, v204, v213
  s_waitcnt lgkmcnt(3)
  v_mfma_f32_32x32x16_bf16 v[220:235], a[4:7], a[244:247], v[220:235]
  v_mul_f32 v205, v205, v213
  v_mul_f32 v206, v206, v213
  v_mul_f32 v207, v207, v213
  v_mul_f32 v208, v208, v213
  v_mul_f32 v209, v209, v213
  v_mul_f32 v210, v210, v213
  v_mfma_f32_32x32x16_bf16 v[220:235], a[8:11], a[248:251], v[220:235]
  v_mul_f32 v211, v211, v213
  v_cvt_pk_bf16_f32 v54, v216, v217
  v_cvt_pk_bf16_f32 v55, v218, v219
  v_cvt_pk_bf16_f32 v56, v204, v205
  v_cvt_pk_bf16_f32 v57, v206, v207
  s_waitcnt lgkmcnt(0)
  v_mfma_f32_32x32x16_bf16 v[172:187], v[84:87], v[60:63], v[172:187]
  v_cvt_pk_bf16_f32 v58, v208, v209
  v_cvt_pk_bf16_f32 v59, v210, v211
  v_cvt_pk_bf16_f32 v106, v248, v249
  v_cvt_pk_bf16_f32 v107, v250, v251
  v_cvt_pk_bf16_f32 v82, v236, v237
  v_cvt_pk_bf16_f32 v83, v238, v239
  v_mfma_f32_32x32x16_bf16 v[188:203], v[90:93], v[60:63], v[188:203]
  v_mfma_f32_32x32x16_bf16 v[236:251], a[24:27], a[240:243], 0
  ds_read_b64_tr_b16 a[240:241], v0 offset:10240
  ds_read_b64_tr_b16 a[242:243], v0 offset:10496
  v_mfma_f32_32x32x8_bf16 v[172:187], v[88:89], v[64:65], v[172:187]
  v_mfma_f32_32x32x16_bf16 v[236:251], a[28:31], a[244:247], v[236:251]
  ds_read_b64_tr_b16 a[244:245], v0 offset:11264
  ds_read_b64_tr_b16 a[246:247], v0 offset:11520
  v_mfma_f32_32x32x16_bf16 v[220:235], a[12:15], a[252:255], v[220:235]
  v_mfma_f32_32x32x8_bf16 v[188:203], v[94:95], v[64:65], v[188:203]
  v_mfma_f32_32x32x16_bf16 v[236:251], a[32:35], a[248:251], v[236:251]
  ds_read_b64_tr_b16 a[248:249], v0 offset:12288
  ds_read_b64_tr_b16 a[250:251], v0 offset:12544
  s_waitcnt lgkmcnt(4)
  v_mfma_f32_32x32x16_bf16 v[220:235], a[16:19], a[240:243], v[220:235]
  v_max3_f32 v62, v172, v173, v174
  v_mfma_f32_32x32x16_bf16 v[236:251], a[36:39], a[252:255], v[236:251]
  ds_read_b64_tr_b16 a[252:253], v0 offset:13312
  ds_read_b64_tr_b16 a[254:255], v0 offset:13568
  v_max3_f32 v63, v188, v189, v190
  v_max3_f32 v62, v62, v175, v176
  v_max3_f32 v63, v63, v191, v192
  s_waitcnt lgkmcnt(4)
  v_mfma_f32_32x32x16_bf16 v[220:235], a[20:23], a[244:247], v[220:235]
  v_max3_f32 v62, v62, v177, v178
  v_max3_f32 v63, v63, v193, v194
  v_max3_f32 v62, v62, v179, v180
  v_max3_f32 v63, v63, v195, v196
  v_max3_f32 v62, v62, v181, v182
  v_max3_f32 v63, v63, v197, v198
  v_mfma_f32_32x32x16_bf16 v[236:251], a[40:43], a[240:243], v[236:251]
  ds_read_b64_tr_b16 a[240:241], v0 offset:14336
  ds_read_b64_tr_b16 a[242:243], v0 offset:14592
  v_max3_f32 v62, v62, v183, v184
  v_max3_f32 v63, v63, v199, v200
  v_max3_f32 v62, v62, v185, v186
  v_max3_f32 v63, v63, v201, v202
  v_mfma_f32_32x32x16_bf16 v[236:251], a[44:47], a[244:247], v[236:251]
  ds_read_b64_tr_b16 a[244:245], v0 offset:15360
  ds_read_b64_tr_b16 a[246:247], v0 offset:15616
  v_max3_f32 v62, v62, v187, v203
  s_mov_b64 exec, s[48:49]
  v_cvt_pk_bf16_f32 v108, v220, v221
  v_cvt_pk_bf16_f32 v109, v222, v223
  v_cvt_pk_bf16_f32 v110, v224, v225
  v_cvt_pk_bf16_f32 v111, v226, v227
  v_cvt_pk_bf16_f32 v112, v228, v229
  v_cvt_pk_bf16_f32 v113, v230, v231
  v_cvt_pk_bf16_f32 v114, v232, v233
  v_cvt_pk_bf16_f32 v115, v234, v235
  s_mov_b64 exec, -1
  v_max_f32 v62, v62, v63
  s_mov_b64 exec, s[60:61]
  v_cvt_pk_bf16_f32 v124, v220, v221
  v_cvt_pk_bf16_f32 v125, v222, v223
  v_cvt_pk_bf16_f32 v126, v224, v225
  v_cvt_pk_bf16_f32 v127, v226, v227
  v_cvt_pk_bf16_f32 v128, v228, v229
  v_cvt_pk_bf16_f32 v129, v230, v231
  v_cvt_pk_bf16_f32 v130, v232, v233
  v_cvt_pk_bf16_f32 v131, v234, v235
  v_mfma_f32_32x32x16_bf16 v[220:235], a[48:51], a[0:3], 0
  s_mov_b64 exec, -1
  v_permlane32_swap_b32 v62, v63
  s_mov_b64 exec, s[48:49]
  v_cvt_pk_bf16_f32 v116, v236, v237
  v_cvt_pk_bf16_f32 v117, v238, v239
  v_mfma_f32_32x32x16_bf16 v[220:235], a[52:55], a[4:7], v[220:235]
  v_cvt_pk_bf16_f32 v118, v240, v241
  v_cvt_pk_bf16_f32 v119, v242, v243
  v_cvt_pk_bf16_f32 v120, v244, v245
  v_cvt_pk_bf16_f32 v121, v246, v247
  v_cvt_pk_bf16_f32 v122, v248, v249
  v_cvt_pk_bf16_f32 v123, v250, v251
  v_mfma_f32_32x32x16_bf16 v[220:235], a[56:59], a[8:11], v[220:235]
  s_mov_b64 exec, -1
  v_max_f32 v62, v62, v63
  s_mov_b64 exec, s[60:61]
  v_cvt_pk_bf16_f32 v132, v236, v237
  v_cvt_pk_bf16_f32 v133, v238, v239
  v_cvt_pk_bf16_f32 v134, v240, v241
  v_mfma_f32_32x32x16_bf16 v[220:235], a[60:63], a[12:15], v[220:235]
  v_cvt_pk_bf16_f32 v135, v242, v243
  v_cvt_pk_bf16_f32 v136, v244, v245
  v_cvt_pk_bf16_f32 v137, v246, v247
  v_cvt_pk_bf16_f32 v138, v248, v249
  v_cvt_pk_bf16_f32 v139, v250, v251
  s_mov_b64 exec, -1
  v_mfma_f32_32x32x16_bf16 v[236:251], a[48:51], a[24:27], 0
  v_and_b32 v63, 0xffff0000, v62
  v_mfma_f32_32x32x16_bf16 v[236:251], a[52:55], a[28:31], v[236:251]
  v_sub_f32 v63, v62, v63
  v_mfma_f32_32x32x16_bf16 v[236:251], a[56:59], a[32:35], v[236:251]
  v_perm_b32 v60, v63, v62, s53
  v_and_b32 v62, 0xffff0000, v63
  v_mfma_f32_32x32x16_bf16 v[220:235], a[64:67], a[16:19], v[220:235]
  v_sub_f32 v61, v63, v62
  v_mfma_f32_32x32x16_bf16 v[236:251], a[60:63], a[36:39], v[236:251]
  v_mfma_f32_32x32x8_bf16 v[172:187], v[10:11], v[60:61], v[172:187]
  v_mfma_f32_32x32x8_bf16 v[188:203], v[10:11], v[60:61], v[188:203]
  v_mfma_f32_32x32x16_bf16 v[220:235], a[68:71], a[20:23], v[220:235]
  v_mfma_f32_32x32x16_bf16 v[236:251], a[64:67], a[40:43], v[236:251]
  v_mfma_f32_32x32x16_bf16 v[236:251], a[68:71], a[44:47], v[236:251]
  s_nop 4
  v_exp_f32 v172, v172
  v_exp_f32 v173, v173
  v_exp_f32 v174, v174
  v_exp_f32 v175, v175
  v_exp_f32 v176, v176
  v_exp_f32 v177, v177
  v_exp_f32 v178, v178
  v_exp_f32 v179, v179
  v_cvt_pk_bf16_f32 v172, v172, v173
  v_cvt_pk_bf16_f32 v173, v174, v175
  v_cvt_pk_bf16_f32 v174, v176, v177
  v_cvt_pk_bf16_f32 v175, v178, v179
  v_exp_f32 v180, v180
  v_mfma_f32_32x32x16_bf16 v[204:219], v[140:143], v[172:175], 0
  ds_read_b128 v[172:175], v3 offset:9088
  v_exp_f32 v181, v181
  v_exp_f32 v182, v182
  v_exp_f32 v183, v183
  v_exp_f32 v184, v184
  v_exp_f32 v185, v185
  v_exp_f32 v186, v186
  v_exp_f32 v187, v187
  v_cvt_pk_bf16_f32 v176, v180, v181
  v_cvt_pk_bf16_f32 v177, v182, v183
  v_cvt_pk_bf16_f32 v178, v184, v185
  v_cvt_pk_bf16_f32 v179, v186, v187
  v_exp_f32 v188, v188
  v_mfma_f32_32x32x16_bf16 v[204:219], v[144:147], v[176:179], v[204:219]
  ds_read_b128 v[176:179], v3 offset:8960
  v_exp_f32 v189, v189
  v_exp_f32 v190, v190
  v_exp_f32 v191, v191
  v_exp_f32 v192, v192
  v_exp_f32 v193, v193
  v_exp_f32 v194, v194
  v_exp_f32 v195, v195
  v_cvt_pk_bf16_f32 v180, v188, v189
  v_cvt_pk_bf16_f32 v181, v190, v191
  v_cvt_pk_bf16_f32 v182, v192, v193
  v_cvt_pk_bf16_f32 v183, v194, v195
  v_exp_f32 v196, v196
  v_mfma_f32_32x32x16_bf16 v[204:219], v[148:151], v[180:183], v[204:219]
  ds_read_b128 v[180:183], v3 offset:8832
  ds_read_b128 v[188:191], v2 offset:8576
  ds_read_b128 v[192:195], v2 offset:8448
  v_exp_f32 v197, v197
  v_exp_f32 v198, v198
  v_exp_f32 v199, v199
  v_exp_f32 v200, v200
  v_exp_f32 v201, v201
  v_exp_f32 v202, v202
  v_exp_f32 v203, v203
  v_cvt_pk_bf16_f32 v184, v196, v197
  v_cvt_pk_bf16_f32 v185, v198, v199
  v_cvt_pk_bf16_f32 v186, v200, v201
  v_cvt_pk_bf16_f32 v187, v202, v203
  v_cvt_pk_bf16_f32 v12, v220, v221
  v_cvt_pk_bf16_f32 v13, v222, v223
  v_mfma_f32_32x32x16_bf16 v[204:219], v[152:155], v[184:187], v[204:219]
  ds_read_b128 v[184:187], v3 offset:8704
  ds_read_b128 v[196:199], v2 offset:8320
  ds_read_b128 v[200:203], v2 offset:8192
  v_cvt_pk_bf16_f32 v14, v224, v225
  v_cvt_pk_bf16_f32 v15, v226, v227
  v_cvt_pk_bf16_f32 v16, v228, v229
  v_cvt_pk_bf16_f32 v17, v230, v231
  v_cvt_pk_bf16_f32 v24, v236, v237
  v_cvt_pk_bf16_f32 v25, v238, v239
  v_cvt_pk_bf16_f32 v26, v240, v241
  v_cvt_pk_bf16_f32 v27, v242, v243
  v_cvt_pk_bf16_f32 v28, v244, v245
  v_rcp_f32 v209, v208
  v_cvt_pk_bf16_f32 v29, v246, v247
  v_mul_f32 v212, v212, v209
  v_mul_f32 v213, v213, v209
  v_mul_f32 v214, v214, v209
  v_mul_f32 v215, v215, v209
  v_mul_f32 v216, v216, v209
  v_mul_f32 v217, v217, v209
  v_mul_f32 v218, v218, v209
  v_mul_f32 v219, v219, v209
  v_mul_f32 v204, v204, v209
  v_mul_f32 v205, v205, v209
  v_mul_f32 v206, v206, v209
  v_mul_f32 v207, v207, v209
  v_cvt_pk_bf16_f32 v60, v212, v213
  v_cvt_pk_bf16_f32 v61, v214, v215
  v_cvt_pk_bf16_f32 v62, v216, v217
  v_cvt_pk_bf16_f32 v63, v218, v219
  v_cvt_pk_bf16_f32 v64, v204, v205
  v_cvt_pk_bf16_f32 v65, v206, v207
  s_waitcnt lgkmcnt(2)
  v_mfma_f32_32x32x16_bf16 v[172:187], v[84:87], v[72:75], v[172:187]
  v_cvt_pk_bf16_f32 v84, v232, v233
  v_cvt_pk_bf16_f32 v85, v234, v235
  s_waitcnt lgkmcnt(0)
  v_mfma_f32_32x32x16_bf16 v[188:203], v[90:93], v[72:75], v[188:203]
  v_cvt_pk_bf16_f32 v90, v248, v249
  v_cvt_pk_bf16_f32 v91, v250, v251
  v_mfma_f32_32x32x16_bf16 v[220:235], a[72:75], a[0:3], 0
  v_mfma_f32_32x32x16_bf16 v[220:235], a[76:79], a[4:7], v[220:235]
  v_mfma_f32_32x32x8_bf16 v[172:187], v[88:89], v[76:77], v[172:187]
  v_mfma_f32_32x32x16_bf16 v[236:251], a[72:75], a[24:27], 0
  v_mfma_f32_32x32x16_bf16 v[220:235], a[80:83], a[8:11], v[220:235]
  v_mfma_f32_32x32x8_bf16 v[188:203], v[94:95], v[76:77], v[188:203]
  v_mfma_f32_32x32x16_bf16 v[236:251], a[76:79], a[28:31], v[236:251]
  v_mfma_f32_32x32x16_bf16 v[220:235], a[84:87], a[12:15], v[220:235]
  v_mfma_f32_32x32x16_bf16 v[236:251], a[80:83], a[32:35], v[236:251]
  v_mfma_f32_32x32x16_bf16 v[220:235], a[88:91], a[16:19], v[220:235]
  v_max3_f32 v74, v172, v173, v174
  v_mfma_f32_32x32x16_bf16 v[236:251], a[84:87], a[36:39], v[236:251]
  v_max3_f32 v74, v74, v175, v176
  v_max3_f32 v75, v188, v189, v190
  v_max3_f32 v74, v74, v177, v178
  v_max3_f32 v75, v75, v191, v192
  v_max3_f32 v74, v74, v179, v180
  v_max3_f32 v75, v75, v193, v194
  v_mfma_f32_32x32x16_bf16 v[220:235], a[92:95], a[20:23], v[220:235]
  v_max3_f32 v75, v75, v195, v196
  v_max3_f32 v74, v74, v181, v182
  v_max3_f32 v75, v75, v197, v198
  v_max3_f32 v74, v74, v183, v184
  v_max3_f32 v75, v75, v199, v200
  v_max3_f32 v74, v74, v185, v186
  v_mfma_f32_32x32x16_bf16 v[236:251], a[88:91], a[40:43], v[236:251]
  v_max3_f32 v75, v75, v201, v202
  v_max3_f32 v74, v74, v187, v203
  v_mfma_f32_32x32x16_bf16 v[236:251], a[92:95], a[44:47], v[236:251]
  v_max_f32 v74, v74, v75
  v_cvt_pk_bf16_f32 v86, v220, v221
  v_cvt_pk_bf16_f32 v87, v222, v223
  v_permlane32_swap_b32 v74, v75
  v_cvt_pk_bf16_f32 v88, v224, v225
  v_max_f32 v74, v74, v75
  v_cvt_pk_bf16_f32 v89, v226, v227
  v_and_b32 v75, 0xffff0000, v74
  v_cvt_pk_bf16_f32 v18, v228, v229
  v_sub_f32 v75, v74, v75
  v_cvt_pk_bf16_f32 v19, v230, v231
  v_perm_b32 v72, v75, v74, s53
  v_and_b32 v74, 0xffff0000, v75
  v_cvt_pk_bf16_f32 v20, v232, v233
  v_sub_f32 v73, v75, v74
  v_cvt_pk_bf16_f32 v21, v234, v235
  v_mfma_f32_32x32x16_bf16 v[220:235], a[168:171], v[36:39], 0
  v_cvt_pk_bf16_f32 v92, v236, v237
  v_cvt_pk_bf16_f32 v93, v238, v239
  v_cvt_pk_bf16_f32 v94, v240, v241
  v_cvt_pk_bf16_f32 v95, v242, v243
  v_cvt_pk_bf16_f32 v30, v244, v245
  v_cvt_pk_bf16_f32 v31, v246, v247
  v_cvt_pk_bf16_f32 v32, v248, v249
  v_mfma_f32_32x32x8_bf16 v[172:187], v[10:11], v[72:73], v[172:187]
  v_cvt_pk_bf16_f32 v33, v250, v251
  v_mfma_f32_32x32x8_bf16 v[188:203], v[10:11], v[72:73], v[188:203]
  v_mfma_f32_32x32x16_bf16 v[220:235], a[172:175], v[40:43], v[220:235]
  v_mfma_f32_32x32x16_bf16 v[236:251], a[192:195], v[36:39], 0
  v_mfma_f32_32x32x16_bf16 v[220:235], a[176:179], v[44:47], v[220:235]
  v_mfma_f32_32x32x16_bf16 v[236:251], a[196:199], v[40:43], v[236:251]
  v_mfma_f32_32x32x16_bf16 v[220:235], a[180:183], v[60:63], v[220:235]
  v_exp_f32 v172, v172
  v_exp_f32 v173, v173
  v_exp_f32 v174, v174
  v_mfma_f32_32x32x16_bf16 v[236:251], a[200:203], v[44:47], v[236:251]
  v_exp_f32 v175, v175
  v_exp_f32 v176, v176
  v_exp_f32 v177, v177
  v_mfma_f32_32x32x16_bf16 v[236:251], a[204:207], v[60:63], v[236:251]
  v_exp_f32 v178, v178
  v_exp_f32 v179, v179
  v_cvt_pk_bf16_f32 v172, v172, v173
  v_cvt_pk_bf16_f32 v173, v174, v175
  v_cvt_pk_bf16_f32 v174, v176, v177
  v_cvt_pk_bf16_f32 v175, v178, v179
  v_exp_f32 v180, v180
  v_mfma_f32_32x32x16_bf16 v[204:219], v[140:143], v[172:175], 0
  ds_read_b128 v[172:175], v2 offset:12416
  v_exp_f32 v181, v181
  v_exp_f32 v182, v182
  v_exp_f32 v183, v183
  v_exp_f32 v184, v184
  v_exp_f32 v185, v185
  v_exp_f32 v186, v186
  v_exp_f32 v187, v187
  v_cvt_pk_bf16_f32 v176, v180, v181
  v_cvt_pk_bf16_f32 v177, v182, v183
  v_cvt_pk_bf16_f32 v178, v184, v185
  v_cvt_pk_bf16_f32 v179, v186, v187
  v_exp_f32 v188, v188
  v_mfma_f32_32x32x16_bf16 v[204:219], v[144:147], v[176:179], v[204:219]
  ds_read_b128 v[176:179], v2 offset:12288
  v_exp_f32 v189, v189
  v_exp_f32 v190, v190
  v_exp_f32 v191, v191
  v_exp_f32 v192, v192
  v_exp_f32 v193, v193
  v_exp_f32 v194, v194
  v_exp_f32 v195, v195
  v_cvt_pk_bf16_f32 v180, v188, v189
  v_cvt_pk_bf16_f32 v181, v190, v191
  v_cvt_pk_bf16_f32 v182, v192, v193
  v_cvt_pk_bf16_f32 v183, v194, v195
  v_exp_f32 v196, v196
  v_mfma_f32_32x32x16_bf16 v[204:219], v[148:151], v[180:183], v[204:219]
  ds_read_b128 v[180:183], v2 offset:12160
  ds_read_b128 v[188:191], v3 offset:11904
  ds_read_b128 v[192:195], v3 offset:11776
  v_exp_f32 v197, v197
  v_exp_f32 v198, v198
  v_exp_f32 v199, v199
  v_exp_f32 v200, v200
  v_exp_f32 v201, v201
  v_exp_f32 v202, v202
  v_exp_f32 v203, v203
  v_cvt_pk_bf16_f32 v184, v196, v197
  v_cvt_pk_bf16_f32 v185, v198, v199
  v_cvt_pk_bf16_f32 v186, v200, v201
  v_cvt_pk_bf16_f32 v187, v202, v203
  ds_read_b128 v[196:199], v3 offset:11648
  ds_read_b128 v[200:203], v3 offset:11520
  v_mfma_f32_32x32x16_bf16 v[204:219], v[152:155], v[184:187], v[204:219]
  ds_read_b128 v[184:187], v2 offset:12032
  s_nop 10
  v_rcp_f32 v209, v208
  s_nop 0
  v_mul_f32 v212, v212, v209
  v_mul_f32 v213, v213, v209
  v_mul_f32 v214, v214, v209
  v_cvt_pk_bf16_f32 v72, v212, v213
  v_mul_f32 v215, v215, v209
  v_mul_f32 v216, v216, v209
  v_cvt_pk_bf16_f32 v73, v214, v215
  v_mul_f32 v217, v217, v209
  v_mul_f32 v218, v218, v209
  v_mul_f32 v219, v219, v209
  v_mul_f32 v204, v204, v209
  v_mul_f32 v205, v205, v209
  v_mul_f32 v206, v206, v209
  v_mul_f32 v207, v207, v209
  v_cvt_pk_bf16_f32 v74, v216, v217
  s_waitcnt lgkmcnt(1)
  v_mfma_f32_32x32x16_bf16 v[188:203], v[102:105], v[66:69], v[188:203]
  v_cvt_pk_bf16_f32 v75, v218, v219
  v_cvt_pk_bf16_f32 v76, v204, v205
  v_cvt_pk_bf16_f32 v77, v206, v207
  s_waitcnt lgkmcnt(0)
  v_mfma_f32_32x32x16_bf16 v[172:187], v[96:99], v[66:69], v[172:187]
  s_nop 3
  v_mfma_f32_32x32x8_bf16 v[188:203], v[106:107], v[70:71], v[188:203]
  s_nop 4
  v_mfma_f32_32x32x8_bf16 v[172:187], v[100:101], v[70:71], v[172:187]
  s_nop 5
  v_max3_f32 v69, v188, v189, v190
  v_max3_f32 v69, v69, v191, v192
  v_max3_f32 v69, v69, v193, v194
  v_max3_f32 v69, v69, v195, v196
  v_max3_f32 v69, v69, v197, v198
  v_max3_f32 v69, v69, v199, v200
  v_max3_f32 v68, v172, v173, v174
  v_max3_f32 v69, v69, v201, v202
  v_max3_f32 v68, v68, v175, v176
  v_max3_f32 v68, v68, v177, v178
  v_max3_f32 v68, v68, v179, v180
  v_max3_f32 v68, v68, v181, v182
  v_max3_f32 v68, v68, v183, v184
  v_max3_f32 v68, v68, v185, v186
  v_max3_f32 v68, v68, v187, v203
  v_max_f32 v68, v68, v69
  s_nop 1
  v_permlane32_swap_b32 v68, v69
  v_max_f32 v68, v68, v69
  v_and_b32 v69, 0xffff0000, v68
  v_sub_f32 v69, v68, v69
  v_perm_b32 v66, v69, v68, s53
  v_and_b32 v68, 0xffff0000, v69
  v_sub_f32 v67, v69, v68
  s_nop 1
  v_mfma_f32_32x32x8_bf16 v[172:187], v[10:11], v[66:67], v[172:187]
  v_mfma_f32_32x32x8_bf16 v[188:203], v[10:11], v[66:67], v[188:203]
  s_nop 10
  v_exp_f32 v172, v172
  v_exp_f32 v173, v173
  v_exp_f32 v174, v174
  v_cvt_pk_bf16_f32 v172, v172, v173
  v_exp_f32 v175, v175
  v_exp_f32 v176, v176
  v_exp_f32 v177, v177
  v_exp_f32 v178, v178
  v_exp_f32 v179, v179
  v_cvt_pk_bf16_f32 v173, v174, v175
  v_cvt_pk_bf16_f32 v174, v176, v177
  v_cvt_pk_bf16_f32 v175, v178, v179
  v_exp_f32 v180, v180
  v_mfma_f32_32x32x16_bf16 v[204:219], v[156:159], v[172:175], 0
  ds_read_b128 v[172:175], v3 offset:12928
  v_exp_f32 v181, v181
  v_exp_f32 v182, v182
  v_exp_f32 v183, v183
  v_exp_f32 v184, v184
  v_exp_f32 v185, v185
  v_exp_f32 v186, v186
  v_exp_f32 v187, v187
  v_cvt_pk_bf16_f32 v176, v180, v181
  v_cvt_pk_bf16_f32 v177, v182, v183
  v_cvt_pk_bf16_f32 v178, v184, v185
  v_cvt_pk_bf16_f32 v179, v186, v187
  v_exp_f32 v188, v188
  v_mfma_f32_32x32x16_bf16 v[204:219], v[160:163], v[176:179], v[204:219]
  ds_read_b128 v[176:179], v3 offset:12800
  v_exp_f32 v189, v189
  v_exp_f32 v190, v190
  v_exp_f32 v191, v191
  v_exp_f32 v192, v192
  v_exp_f32 v193, v193
  v_exp_f32 v194, v194
  v_exp_f32 v195, v195
  v_cvt_pk_bf16_f32 v180, v188, v189
  v_cvt_pk_bf16_f32 v181, v190, v191
  v_cvt_pk_bf16_f32 v182, v192, v193
  v_cvt_pk_bf16_f32 v183, v194, v195
  v_exp_f32 v196, v196
  v_mfma_f32_32x32x16_bf16 v[204:219], v[164:167], v[180:183], v[204:219]
  ds_read_b128 v[180:183], v3 offset:12672
  ds_read_b128 v[188:191], v2 offset:12416
  ds_read_b128 v[192:195], v2 offset:12288
  v_exp_f32 v197, v197
  v_exp_f32 v198, v198
  v_exp_f32 v199, v199
  v_exp_f32 v200, v200
  v_exp_f32 v201, v201
  v_exp_f32 v202, v202
  v_exp_f32 v203, v203
  v_cvt_pk_bf16_f32 v184, v196, v197
  v_cvt_pk_bf16_f32 v185, v198, v199
  v_cvt_pk_bf16_f32 v186, v200, v201
  v_cvt_pk_bf16_f32 v187, v202, v203
  ds_read_b128 v[196:199], v2 offset:12160
  ds_read_b128 v[200:203], v2 offset:12032
  v_mfma_f32_32x32x16_bf16 v[204:219], v[168:171], v[184:187], v[204:219]
  ds_read_b128 v[184:187], v3 offset:12544
  v_mov_b32 v3, s51
  v_cndmask_b32 v3, 0, v3, vcc
  v_add_u32 v3, v3, v2
  s_nop 7
  v_rcp_f32 v205, v204
  s_nop 0
  v_mul_f32 v208, v208, v205
  v_mul_f32 v209, v209, v205
  v_mul_f32 v210, v210, v205
  v_cvt_pk_bf16_f32 v66, v208, v209
  v_mul_f32 v211, v211, v205
  v_mul_f32 v212, v212, v205
  v_mul_f32 v213, v213, v205
  v_mul_f32 v214, v214, v205
  v_mul_f32 v215, v215, v205
  v_mul_f32 v216, v216, v205
  v_mul_f32 v217, v217, v205
  v_mul_f32 v218, v218, v205
  v_mul_f32 v219, v219, v205
  v_cvt_pk_bf16_f32 v67, v210, v211
  v_cvt_pk_bf16_f32 v68, v212, v213
  s_waitcnt lgkmcnt(1)
  v_mfma_f32_32x32x16_bf16 v[188:203], v[102:105], v[78:81], v[188:203]
  v_cvt_pk_bf16_f32 v69, v214, v215
  v_cvt_pk_bf16_f32 v70, v216, v217
  v_cvt_pk_bf16_f32 v71, v218, v219
  s_waitcnt lgkmcnt(0)
  v_mfma_f32_32x32x16_bf16 v[172:187], v[96:99], v[78:81], v[172:187]
  v_mfma_f32_32x32x16_bf16 v[220:235], a[184:187], v[64:67], v[220:235]
  v_mfma_f32_32x32x16_bf16 v[220:235], a[188:191], v[68:71], v[220:235]
  v_mfma_f32_32x32x8_bf16 v[188:203], v[106:107], v[82:83], v[188:203]
  v_mfma_f32_32x32x16_bf16 v[236:251], a[208:211], v[64:67], v[236:251]
  v_mfma_f32_32x32x16_bf16 v[236:251], a[212:215], v[68:71], v[236:251]
  s_nop 7
  v_max3_f32 v81, v188, v189, v190
  v_mfma_f32_32x32x8_bf16 v[172:187], v[100:101], v[82:83], v[172:187]
  v_max3_f32 v81, v81, v191, v192
  v_cvt_pk_bf16_f32 v220, v220, v221
  v_max3_f32 v81, v81, v193, v194
  v_cvt_pk_bf16_f32 v221, v222, v223
  v_max3_f32 v81, v81, v195, v196
  v_cvt_pk_bf16_f32 v222, v224, v225
  v_max3_f32 v81, v81, v197, v198
  v_cvt_pk_bf16_f32 v223, v226, v227
  v_max3_f32 v81, v81, v199, v200
  v_cvt_pk_bf16_f32 v224, v228, v229
  v_max3_f32 v81, v81, v201, v202
  v_cvt_pk_bf16_f32 v225, v230, v231
  v_cvt_pk_bf16_f32 v226, v232, v233
  v_max3_f32 v80, v172, v173, v174
  v_cvt_pk_bf16_f32 v227, v234, v235
  v_max3_f32 v80, v80, v175, v176
  v_cvt_pk_bf16_f32 v236, v236, v237
  v_max3_f32 v80, v80, v177, v178
  v_cvt_pk_bf16_f32 v237, v238, v239
  v_max3_f32 v80, v80, v179, v180
  v_cvt_pk_bf16_f32 v238, v240, v241
  v_max3_f32 v80, v80, v181, v182
  v_cvt_pk_bf16_f32 v239, v242, v243
  v_max3_f32 v80, v80, v183, v184
  v_cvt_pk_bf16_f32 v240, v244, v245
  v_max3_f32 v80, v80, v185, v186
  v_cvt_pk_bf16_f32 v241, v246, v247
  v_max3_f32 v80, v80, v187, v203
  v_cvt_pk_bf16_f32 v242, v248, v249
  v_max_f32 v80, v80, v81
  v_cvt_pk_bf16_f32 v243, v250, v251
  ds_write_b128 v4, v[220:223] offset:0
  v_permlane32_swap_b32 v80, v81
  v_max_f32 v80, v80, v81
  ds_write_b128 v5, v[224:227] offset:0
  v_mfma_f32_32x32x16_bf16 v[220:235], a[216:219], v[36:39], 0
  v_and_b32 v81, 0xffff0000, v80
  v_mfma_f32_32x32x16_bf16 v[220:235], a[220:223], v[40:43], v[220:235]
  ds_write_b128 v4, v[236:239] offset:64
  v_sub_f32 v81, v80, v81
  v_mfma_f32_32x32x16_bf16 v[220:235], a[224:227], v[44:47], v[220:235]
  v_perm_b32 v78, v81, v80, s53
  v_and_b32 v80, 0xffff0000, v81
  ds_write_b128 v5, v[240:243] offset:64
  v_mfma_f32_32x32x16_bf16 v[236:251], a[168:171], v[48:51], 0
  v_sub_f32 v79, v81, v80
  v_mfma_f32_32x32x16_bf16 v[236:251], a[172:175], v[52:55], v[236:251]
  v_mfma_f32_32x32x8_bf16 v[172:187], v[10:11], v[78:79], v[172:187]
  v_mfma_f32_32x32x8_bf16 v[188:203], v[10:11], v[78:79], v[188:203]
  v_mfma_f32_32x32x16_bf16 v[220:235], a[228:231], v[60:63], v[220:235]
  v_mfma_f32_32x32x16_bf16 v[236:251], a[176:179], v[56:59], v[236:251]
  v_mfma_f32_32x32x16_bf16 v[220:235], a[232:235], v[64:67], v[220:235]
  v_mfma_f32_32x32x16_bf16 v[236:251], a[180:183], v[72:75], v[236:251]
  v_mfma_f32_32x32x16_bf16 v[220:235], a[236:239], v[68:71], v[220:235]
  s_nop 0
  v_exp_f32 v172, v172
  v_exp_f32 v173, v173
  v_exp_f32 v174, v174
  v_exp_f32 v175, v175
  v_exp_f32 v176, v176
  v_exp_f32 v177, v177
  v_exp_f32 v178, v178
  v_exp_f32 v179, v179
  v_cvt_pk_bf16_f32 v172, v172, v173
  v_cvt_pk_bf16_f32 v173, v174, v175
  v_cvt_pk_bf16_f32 v174, v176, v177
  v_cvt_pk_bf16_f32 v175, v178, v179
  v_exp_f32 v180, v180
  v_mfma_f32_32x32x16_bf16 v[204:219], v[156:159], v[172:175], 0
  ds_read_b128 v[172:175], v2 offset:896
  v_exp_f32 v181, v181
  v_exp_f32 v182, v182
  v_exp_f32 v183, v183
  v_exp_f32 v184, v184
  v_exp_f32 v185, v185
  v_exp_f32 v186, v186
  v_exp_f32 v187, v187
  v_cvt_pk_bf16_f32 v176, v180, v181
  v_cvt_pk_bf16_f32 v177, v182, v183
  v_cvt_pk_bf16_f32 v178, v184, v185
  v_cvt_pk_bf16_f32 v179, v186, v187
  v_exp_f32 v188, v188
  v_mfma_f32_32x32x16_bf16 v[204:219], v[160:163], v[176:179], v[204:219]
  ds_read_b128 v[176:179], v2 offset:768
  v_exp_f32 v189, v189
  v_exp_f32 v190, v190
  v_exp_f32 v191, v191
  v_exp_f32 v192, v192
  v_exp_f32 v193, v193
  v_exp_f32 v194, v194
  v_exp_f32 v195, v195
  v_cvt_pk_bf16_f32 v180, v188, v189
  v_cvt_pk_bf16_f32 v181, v190, v191
  v_cvt_pk_bf16_f32 v182, v192, v193
  v_cvt_pk_bf16_f32 v183, v194, v195
  v_exp_f32 v196, v196
  v_mfma_f32_32x32x16_bf16 v[204:219], v[164:167], v[180:183], v[204:219]
  ds_read_b128 v[180:183], v2 offset:640
  ds_read_b128 v[188:191], v3 offset:384
  ds_read_b128 v[192:195], v3 offset:256
  v_exp_f32 v197, v197
  v_exp_f32 v198, v198
  v_exp_f32 v199, v199
  v_exp_f32 v200, v200
  v_exp_f32 v201, v201
  v_exp_f32 v202, v202
  v_exp_f32 v203, v203
  v_cvt_pk_bf16_f32 v184, v196, v197
  v_cvt_pk_bf16_f32 v185, v198, v199
  v_cvt_pk_bf16_f32 v186, v200, v201
  v_cvt_pk_bf16_f32 v187, v202, v203
  v_cvt_pk_bf16_f32 v220, v220, v221
  v_cvt_pk_bf16_f32 v221, v222, v223
  v_mfma_f32_32x32x16_bf16 v[204:219], v[168:171], v[184:187], v[204:219]
  ds_read_b128 v[184:187], v2 offset:512
  ds_read_b128 v[196:199], v3 offset:128
  ds_read_b128 v[200:203], v3 offset:0
  v_cvt_pk_bf16_f32 v222, v224, v225
  v_cvt_pk_bf16_f32 v223, v226, v227
  v_cvt_pk_bf16_f32 v224, v228, v229
  v_cvt_pk_bf16_f32 v225, v230, v231
  v_cvt_pk_bf16_f32 v226, v232, v233
  v_cvt_pk_bf16_f32 v227, v234, v235
  ds_write_b128 v4, v[220:223] offset:128
  s_nop 1
  v_rcp_f32 v205, v204
  s_nop 0
  v_mul_f32 v208, v208, v205
  v_mul_f32 v209, v209, v205
  v_mul_f32 v210, v210, v205
  v_mul_f32 v211, v211, v205
  v_mul_f32 v212, v212, v205
  v_mul_f32 v213, v213, v205
  v_mul_f32 v214, v214, v205
  v_mul_f32 v215, v215, v205
  v_mul_f32 v216, v216, v205
  v_mul_f32 v217, v217, v205
  v_mul_f32 v218, v218, v205
  v_mul_f32 v219, v219, v205
  v_cvt_pk_bf16_f32 v78, v208, v209
  v_cvt_pk_bf16_f32 v79, v210, v211
  s_waitcnt lgkmcnt(3)
  v_mfma_f32_32x32x16_bf16 v[172:187], v[84:87], v[12:15], v[172:187]
  ds_write_b128 v5, v[224:227] offset:128
  s_waitcnt lgkmcnt(2)
  v_mfma_f32_32x32x16_bf16 v[188:203], v[90:93], v[12:15], v[188:203]
  v_cvt_pk_bf16_f32 v80, v212, v213
  v_cvt_pk_bf16_f32 v81, v214, v215
  v_cvt_pk_bf16_f32 v82, v216, v217
  v_cvt_pk_bf16_f32 v83, v218, v219
  v_mfma_f32_32x32x16_bf16 v[236:251], a[184:187], v[76:79], v[236:251]
  v_mfma_f32_32x32x8_bf16 v[172:187], v[88:89], v[16:17], v[172:187]
  v_mfma_f32_32x32x16_bf16 v[236:251], a[188:191], v[80:83], v[236:251]
  v_mfma_f32_32x32x16_bf16 v[220:235], a[192:195], v[48:51], 0
  v_mfma_f32_32x32x8_bf16 v[188:203], v[94:95], v[16:17], v[188:203]
  v_mfma_f32_32x32x16_bf16 v[220:235], a[196:199], v[52:55], v[220:235]
  v_mfma_f32_32x32x16_bf16 v[220:235], a[200:203], v[56:59], v[220:235]
  v_mfma_f32_32x32x16_bf16 v[220:235], a[204:207], v[72:75], v[220:235]
  v_mfma_f32_32x32x16_bf16 v[220:235], a[208:211], v[76:79], v[220:235]
  v_max3_f32 v14, v172, v173, v174
  v_cvt_pk_bf16_f32 v236, v236, v237
  v_max3_f32 v14, v14, v175, v176
  v_cvt_pk_bf16_f32 v237, v238, v239
  v_max3_f32 v15, v188, v189, v190
  v_max3_f32 v14, v14, v177, v178
  v_mfma_f32_32x32x16_bf16 v[220:235], a[212:215], v[80:83], v[220:235]
  v_max3_f32 v15, v15, v191, v192
  v_max3_f32 v14, v14, v179, v180
  v_max3_f32 v15, v15, v193, v194
  v_max3_f32 v14, v14, v181, v182
  v_max3_f32 v15, v15, v195, v196
  v_max3_f32 v14, v14, v183, v184
  v_max3_f32 v15, v15, v197, v198
  v_max3_f32 v14, v14, v185, v186
  v_max3_f32 v15, v15, v199, v200
  v_max3_f32 v14, v14, v187, v203
  v_max3_f32 v15, v15, v201, v202
  v_cvt_pk_bf16_f32 v238, v240, v241
  v_max_f32 v14, v14, v15
  v_cvt_pk_bf16_f32 v239, v242, v243
  v_cvt_pk_bf16_f32 v240, v244, v245
  v_permlane32_swap_b32 v14, v15
  v_cvt_pk_bf16_f32 v241, v246, v247
  v_max_f32 v14, v14, v15
  v_cvt_pk_bf16_f32 v242, v248, v249
  v_and_b32 v15, 0xffff0000, v14
  v_cvt_pk_bf16_f32 v243, v250, v251
  v_sub_f32 v15, v14, v15
  v_cvt_pk_bf16_f32 v220, v220, v221
  v_perm_b32 v12, v15, v14, s53
  v_and_b32 v14, 0xffff0000, v15
  v_cvt_pk_bf16_f32 v221, v222, v223
  v_sub_f32 v13, v15, v14
  v_cvt_pk_bf16_f32 v222, v224, v225
  v_cvt_pk_bf16_f32 v223, v226, v227
  v_mfma_f32_32x32x8_bf16 v[172:187], v[10:11], v[12:13], v[172:187]
  v_cvt_pk_bf16_f32 v224, v228, v229
  v_cvt_pk_bf16_f32 v225, v230, v231
  v_cvt_pk_bf16_f32 v226, v232, v233
  v_cvt_pk_bf16_f32 v227, v234, v235
  v_mfma_f32_32x32x8_bf16 v[188:203], v[10:11], v[12:13], v[188:203]
  ds_write_b128 v4, v[236:239] offset:6144
  s_nop 5
  v_exp_f32 v172, v172
  ds_write_b128 v5, v[240:243] offset:6144
  v_mfma_f32_32x32x16_bf16 v[236:251], a[216:219], v[48:51], 0
  v_mfma_f32_32x32x16_bf16 v[236:251], a[220:223], v[52:55], v[236:251]
  ds_write_b128 v4, v[220:223] offset:6208
  v_exp_f32 v173, v173
  v_mfma_f32_32x32x16_bf16 v[236:251], a[224:227], v[56:59], v[236:251]
  v_exp_f32 v174, v174
  v_exp_f32 v175, v175
  v_exp_f32 v176, v176
  v_mfma_f32_32x32x16_bf16 v[236:251], a[228:231], v[72:75], v[236:251]
  ds_write_b128 v5, v[224:227] offset:6208
  v_cvt_pk_bf16_f32 v172, v172, v173
  v_mfma_f32_32x32x16_bf16 v[236:251], a[232:235], v[76:79], v[236:251]
  v_exp_f32 v177, v177
  v_exp_f32 v178, v178
  v_exp_f32 v179, v179
  v_mfma_f32_32x32x16_bf16 v[236:251], a[236:239], v[80:83], v[236:251]
  v_cvt_pk_bf16_f32 v173, v174, v175
  v_cvt_pk_bf16_f32 v174, v176, v177
  v_cvt_pk_bf16_f32 v175, v178, v179
  v_exp_f32 v180, v180
  v_mfma_f32_32x32x16_bf16 v[204:219], v[108:111], v[172:175], 0
  ds_read_b128 v[172:175], v3 offset:1408
  ds_read_b128 v[252:255], v6 offset:0
  v_exp_f32 v181, v181
  v_exp_f32 v182, v182
  v_mfma_f32_32x32x16_bf16 v[220:235], a[96:99], a[0:3], 0
  v_exp_f32 v183, v183
  v_exp_f32 v184, v184
  v_exp_f32 v185, v185
  v_mfma_f32_32x32x16_bf16 v[220:235], a[100:103], a[4:7], v[220:235]
  v_exp_f32 v186, v186
  v_exp_f32 v187, v187
  v_cvt_pk_bf16_f32 v176, v180, v181
  v_cvt_pk_bf16_f32 v177, v182, v183
  v_mfma_f32_32x32x16_bf16 v[220:235], a[104:107], a[8:11], v[220:235]
  v_cvt_pk_bf16_f32 v178, v184, v185
  v_cvt_pk_bf16_f32 v179, v186, v187
  v_exp_f32 v188, v188
  v_exp_f32 v189, v189
  v_mfma_f32_32x32x16_bf16 v[204:219], v[112:115], v[176:179], v[204:219]
  ds_read_b128 v[176:179], v3 offset:1280
  v_exp_f32 v190, v190
  v_exp_f32 v191, v191
  v_cvt_pk_bf16_f32 v180, v188, v189
  v_mfma_f32_32x32x16_bf16 v[220:235], a[108:111], a[12:15], v[220:235]
  s_waitcnt lgkmcnt(1)
  buffer_store_dwordx4 v[252:255], v7, s[12:15], s40 offen offset:0 sc1
  v_mfma_f32_32x32x16_bf16 v[220:235], a[112:115], a[16:19], v[220:235]
  ds_read_b128 v[252:255], v6 offset:1024
  v_exp_f32 v192, v192
  v_exp_f32 v193, v193
  v_cvt_pk_bf16_f32 v181, v190, v191
  v_mfma_f32_32x32x16_bf16 v[220:235], a[116:119], a[20:23], v[220:235]
  ds_read_b128 v[188:191], v2 offset:896
  v_exp_f32 v194, v194
  v_exp_f32 v195, v195
  v_cvt_pk_bf16_f32 v182, v192, v193
  v_cvt_pk_bf16_f32 v183, v194, v195
  v_exp_f32 v196, v196
  v_mfma_f32_32x32x16_bf16 v[204:219], v[116:119], v[180:183], v[204:219]
  ds_read_b128 v[180:183], v3 offset:1152
  ds_read_b128 v[192:195], v2 offset:768
  v_exp_f32 v197, v197
  v_exp_f32 v198, v198
  v_exp_f32 v199, v199
  v_exp_f32 v200, v200
  v_exp_f32 v201, v201
  v_exp_f32 v202, v202
  v_exp_f32 v203, v203
  v_cvt_pk_bf16_f32 v184, v196, v197
  v_cvt_pk_bf16_f32 v185, v198, v199
  v_cvt_pk_bf16_f32 v186, v200, v201
  v_cvt_pk_bf16_f32 v187, v202, v203
  v_cvt_pk_bf16_f32 v236, v236, v237
  v_cvt_pk_bf16_f32 v237, v238, v239
  v_mfma_f32_32x32x16_bf16 v[204:219], v[120:123], v[184:187], v[204:219]
  ds_read_b128 v[184:187], v3 offset:1024
  ds_read_b128 v[196:199], v2 offset:640
  ds_read_b128 v[200:203], v2 offset:512
  v_cvt_pk_bf16_f32 v238, v240, v241
  v_cvt_pk_bf16_f32 v239, v242, v243
  v_cvt_pk_bf16_f32 v240, v244, v245
  v_cvt_pk_bf16_f32 v241, v246, v247
  v_cvt_pk_bf16_f32 v242, v248, v249
  v_cvt_pk_bf16_f32 v243, v250, v251
  v_cvt_pk_bf16_f32 v96, v224, v225
  v_cvt_pk_bf16_f32 v97, v226, v227
  v_cvt_pk_bf16_f32 v98, v228, v229
  v_rcp_f32 v217, v216
  v_cvt_pk_bf16_f32 v99, v230, v231
  v_mul_f32 v204, v204, v217
  v_mul_f32 v205, v205, v217
  v_mul_f32 v206, v206, v217
  v_mul_f32 v207, v207, v217
  v_mul_f32 v208, v208, v217
  v_mul_f32 v209, v209, v217
  v_mul_f32 v210, v210, v217
  v_mul_f32 v211, v211, v217
  v_mul_f32 v212, v212, v217
  v_mul_f32 v213, v213, v217
  v_mul_f32 v214, v214, v217
  v_mul_f32 v215, v215, v217
  v_cvt_pk_bf16_f32 v12, v204, v205
  v_cvt_pk_bf16_f32 v13, v206, v207
  ds_write_b128 v4, v[236:239] offset:6272
  s_waitcnt lgkmcnt(1)
  v_mfma_f32_32x32x16_bf16 v[172:187], v[84:87], v[24:27], v[172:187]
  ds_write_b128 v5, v[240:243] offset:6272
  v_cvt_pk_bf16_f32 v14, v208, v209
  v_mfma_f32_32x32x16_bf16 v[188:203], v[90:93], v[24:27], v[188:203]
  buffer_store_dwordx4 v[252:255], v8, s[12:15], s40 offen offset:1024 sc1
  v_cvt_pk_bf16_f32 v15, v210, v211
  v_mfma_f32_32x32x16_bf16 v[236:251], a[96:99], a[24:27], 0
  ds_read_b128 v[252:255], v6 offset:2048
  v_cvt_pk_bf16_f32 v16, v212, v213
  v_cvt_pk_bf16_f32 v17, v214, v215
  v_cvt_pk_bf16_f32 v22, v220, v221
  v_cvt_pk_bf16_f32 v23, v222, v223
  v_cvt_pk_bf16_f32 v100, v232, v233
  v_cvt_pk_bf16_f32 v101, v234, v235
  v_mfma_f32_32x32x8_bf16 v[172:187], v[88:89], v[28:29], v[172:187]
  v_mfma_f32_32x32x8_bf16 v[188:203], v[94:95], v[28:29], v[188:203]
  v_mfma_f32_32x32x16_bf16 v[236:251], a[100:103], a[28:31], v[236:251]
  v_mfma_f32_32x32x16_bf16 v[236:251], a[104:107], a[32:35], v[236:251]
  v_mfma_f32_32x32x16_bf16 v[236:251], a[108:111], a[36:39], v[236:251]
  v_mfma_f32_32x32x16_bf16 v[236:251], a[112:115], a[40:43], v[236:251]
  v_mfma_f32_32x32x16_bf16 v[236:251], a[116:119], a[44:47], v[236:251]
  v_mfma_f32_32x32x16_bf16 v[220:235], a[0:3], a[248:251], 0
  v_max3_f32 v26, v172, v173, v174
  v_max3_f32 v27, v188, v189, v190
  v_max3_f32 v26, v26, v175, v176
  v_max3_f32 v27, v27, v191, v192
  v_max3_f32 v26, v26, v177, v178
  v_max3_f32 v27, v27, v193, v194
  v_mfma_f32_32x32x16_bf16 v[220:235], a[4:7], a[252:255], v[220:235]
  v_max3_f32 v26, v26, v179, v180
  v_max3_f32 v27, v27, v195, v196
  v_max3_f32 v26, v26, v181, v182
  v_max3_f32 v27, v27, v197, v198
  v_max3_f32 v26, v26, v183, v184
  v_max3_f32 v27, v27, v199, v200
  v_mfma_f32_32x32x16_bf16 v[220:235], a[8:11], a[240:243], v[220:235]
  s_waitcnt lgkmcnt(0)
  buffer_store_dwordx4 v[252:255], v9, s[12:15], s40 offen offset:2048 sc1
  v_mfma_f32_32x32x16_bf16 v[220:235], a[12:15], a[244:247], v[220:235]
  ds_read_b128 v[252:255], v6 offset:3072
  v_max3_f32 v26, v26, v185, v186
  v_max3_f32 v27, v27, v201, v202
  v_max3_f32 v26, v26, v187, v203
  v_cvt_pk_bf16_f32 v102, v240, v241
  v_max_f32 v26, v26, v27
  v_mfma_f32_32x32x16_bf16 v[60:75], a[216:219], v[12:15], 0
  v_permlane32_swap_b32 v26, v27
  v_cvt_pk_bf16_f32 v103, v242, v243
  v_max_f32 v26, v26, v27
  v_cvt_pk_bf16_f32 v104, v244, v245
  v_and_b32 v27, 0xffff0000, v26
  v_cvt_pk_bf16_f32 v105, v246, v247
  v_sub_f32 v27, v26, v27
  v_cvt_pk_bf16_f32 v106, v248, v249
  v_perm_b32 v24, v27, v26, s53
  v_and_b32 v26, 0xffff0000, v27
  v_cvt_pk_bf16_f32 v107, v250, v251
  v_sub_f32 v25, v27, v26
  v_cvt_pk_bf16_f32 v34, v236, v237
  v_cvt_pk_bf16_f32 v35, v238, v239
  v_mfma_f32_32x32x8_bf16 v[172:187], v[10:11], v[24:25], v[172:187]
  v_mfma_f32_32x32x8_bf16 v[188:203], v[10:11], v[24:25], v[188:203]
  v_mfma_f32_32x32x16_bf16 v[236:251], a[24:27], a[248:251], 0
  ds_read_b64_tr_b16 a[248:249], v0 offset:16384
  ds_read_b64_tr_b16 a[250:251], v0 offset:16640
  v_mfma_f32_32x32x16_bf16 v[236:251], a[28:31], a[252:255], v[236:251]
  ds_read_b64_tr_b16 a[252:253], v0 offset:17408
  ds_read_b64_tr_b16 a[254:255], v0 offset:17664
  v_mfma_f32_32x32x16_bf16 v[236:251], a[32:35], a[240:243], v[236:251]
  ds_read_b64_tr_b16 a[240:241], v0 offset:18432
  ds_read_b64_tr_b16 a[242:243], v0 offset:18688
  v_exp_f32 v172, v172
  v_exp_f32 v173, v173
  v_mfma_f32_32x32x16_bf16 v[236:251], a[36:39], a[244:247], v[236:251]
  ds_read_b64_tr_b16 a[244:245], v0 offset:19456
  ds_read_b64_tr_b16 a[246:247], v0 offset:19712
  v_exp_f32 v174, v174
  v_exp_f32 v175, v175
  v_exp_f32 v176, v176
  v_exp_f32 v177, v177
  s_waitcnt lgkmcnt(6)
  v_mfma_f32_32x32x16_bf16 v[220:235], a[16:19], a[248:251], v[220:235]
  buffer_store_dwordx4 v[252:255], v7, s[12:15], s41 offen offset:0 sc1
  s_waitcnt lgkmcnt(4)
  v_mfma_f32_32x32x16_bf16 v[220:235], a[20:23], a[252:255], v[220:235]
  ds_read_b128 v[252:255], v6 offset:4096
  v_exp_f32 v178, v178
  v_exp_f32 v179, v179
  v_cvt_pk_bf16_f32 v172, v172, v173
  v_mfma_f32_32x32x16_bf16 v[236:251], a[40:43], a[248:251], v[236:251]
  ds_read_b64_tr_b16 a[248:249], v0 offset:20480
  ds_read_b64_tr_b16 a[250:251], v0 offset:20736
  v_cvt_pk_bf16_f32 v173, v174, v175
  v_cvt_pk_bf16_f32 v174, v176, v177
  v_cvt_pk_bf16_f32 v175, v178, v179
  s_mov_b64 exec, s[62:63]
  v_mfma_f32_32x32x16_bf16 v[236:251], a[44:47], a[252:255], v[236:251]
  v_cvt_pk_bf16_f32 v124, v220, v221
  v_cvt_pk_bf16_f32 v125, v222, v223
  v_cvt_pk_bf16_f32 v126, v224, v225
  v_cvt_pk_bf16_f32 v127, v226, v227
  v_cvt_pk_bf16_f32 v128, v228, v229
  v_cvt_pk_bf16_f32 v129, v230, v231
  v_mfma_f32_32x32x16_bf16 v[204:219], v[108:111], v[172:175], 0
  v_cvt_pk_bf16_f32 v130, v232, v233
  v_cvt_pk_bf16_f32 v131, v234, v235
  s_mov_b64 exec, -1
  v_exp_f32 v180, v180
  v_exp_f32 v181, v181
  v_exp_f32 v182, v182
  v_exp_f32 v183, v183
  v_exp_f32 v184, v184
  v_exp_f32 v185, v185
  ds_read_b64_tr_b16 a[252:253], v0 offset:21504
  ds_read_b128 v[172:175], v2 offset:4736
  ds_read_b64_tr_b16 a[254:255], v0 offset:21760
  v_exp_f32 v186, v186
  v_exp_f32 v187, v187
  v_cvt_pk_bf16_f32 v176, v180, v181
  v_cvt_pk_bf16_f32 v177, v182, v183
  v_cvt_pk_bf16_f32 v178, v184, v185
  v_cvt_pk_bf16_f32 v179, v186, v187
  v_exp_f32 v188, v188
  v_mfma_f32_32x32x16_bf16 v[204:219], v[112:115], v[176:179], v[204:219]
  ds_read_b128 v[176:179], v2 offset:4608
  v_exp_f32 v189, v189
  v_exp_f32 v190, v190
  v_exp_f32 v191, v191
  v_exp_f32 v192, v192
  v_exp_f32 v193, v193
  v_exp_f32 v194, v194
  v_exp_f32 v195, v195
  v_cvt_pk_bf16_f32 v180, v188, v189
  v_cvt_pk_bf16_f32 v181, v190, v191
  v_cvt_pk_bf16_f32 v182, v192, v193
  v_cvt_pk_bf16_f32 v183, v194, v195
  v_exp_f32 v196, v196
  v_mfma_f32_32x32x16_bf16 v[204:219], v[116:119], v[180:183], v[204:219]
  ds_read_b128 v[180:183], v2 offset:4480
  ds_read_b128 v[188:191], v3 offset:4224
  ds_read_b128 v[192:195], v3 offset:4096
  s_waitcnt lgkmcnt(4)
  buffer_store_dwordx4 v[252:255], v8, s[12:15], s41 offen offset:1024 sc1
  v_exp_f32 v197, v197
  v_exp_f32 v198, v198
  v_exp_f32 v199, v199
  v_exp_f32 v200, v200
  v_exp_f32 v201, v201
  v_exp_f32 v202, v202
  v_exp_f32 v203, v203
  v_cvt_pk_bf16_f32 v184, v196, v197
  v_cvt_pk_bf16_f32 v185, v198, v199
  v_cvt_pk_bf16_f32 v186, v200, v201
  v_cvt_pk_bf16_f32 v187, v202, v203
  s_mov_b64 exec, s[62:63]
  v_cvt_pk_bf16_f32 v132, v236, v237
  v_mfma_f32_32x32x16_bf16 v[204:219], v[120:123], v[184:187], v[204:219]
  v_cvt_pk_bf16_f32 v133, v238, v239
  v_cvt_pk_bf16_f32 v134, v240, v241
  v_cvt_pk_bf16_f32 v135, v242, v243
  v_cvt_pk_bf16_f32 v136, v244, v245
  v_cvt_pk_bf16_f32 v137, v246, v247
  v_cvt_pk_bf16_f32 v138, v248, v249
  v_cvt_pk_bf16_f32 v139, v250, v251
  s_mov_b64 exec, -1
  ds_read_b128 v[252:255], v6 offset:5120
  ds_read_b128 v[184:187], v2 offset:4352
  ds_read_b128 v[196:199], v3 offset:3968
  s_mov_b64 exec, s[64:65]
  v_cvt_pk_bf16_f32 v140, v220, v221
  v_cvt_pk_bf16_f32 v141, v222, v223
  v_cvt_pk_bf16_f32 v142, v224, v225
  v_cvt_pk_bf16_f32 v143, v226, v227
  v_cvt_pk_bf16_f32 v144, v228, v229
  v_cvt_pk_bf16_f32 v145, v230, v231
  v_cvt_pk_bf16_f32 v146, v232, v233
  v_cvt_pk_bf16_f32 v147, v234, v235
  v_mfma_f32_32x32x16_bf16 v[220:235], a[120:123], a[0:3], 0
  s_mov_b64 exec, -1
  ds_read_b128 v[200:203], v3 offset:3840
  v_rcp_f32 v217, v216
  s_mov_b64 exec, s[64:65]
  v_cvt_pk_bf16_f32 v148, v236, v237
  v_mfma_f32_32x32x16_bf16 v[220:235], a[124:127], a[4:7], v[220:235]
  v_cvt_pk_bf16_f32 v149, v238, v239
  v_cvt_pk_bf16_f32 v150, v240, v241
  v_cvt_pk_bf16_f32 v151, v242, v243
  v_cvt_pk_bf16_f32 v152, v244, v245
  v_cvt_pk_bf16_f32 v153, v246, v247
  v_cvt_pk_bf16_f32 v154, v248, v249
  v_mfma_f32_32x32x16_bf16 v[220:235], a[128:131], a[8:11], v[220:235]
  v_cvt_pk_bf16_f32 v155, v250, v251
  s_mov_b64 exec, -1
  v_mul_f32 v204, v204, v217
  v_mul_f32 v205, v205, v217
  v_mul_f32 v206, v206, v217
  s_waitcnt lgkmcnt(1)
  v_mfma_f32_32x32x16_bf16 v[172:187], v[96:99], v[18:21], v[172:187]
  v_mul_f32 v207, v207, v217
  v_mul_f32 v208, v208, v217
  v_mul_f32 v209, v209, v217
  v_mul_f32 v210, v210, v217
  v_mul_f32 v211, v211, v217
  v_mul_f32 v212, v212, v217
  v_mfma_f32_32x32x16_bf16 v[236:251], a[120:123], a[24:27], 0
  v_mul_f32 v213, v213, v217
  v_mul_f32 v214, v214, v217
  v_mul_f32 v215, v215, v217
  v_cvt_pk_bf16_f32 v24, v204, v205
  v_cvt_pk_bf16_f32 v25, v206, v207
  s_waitcnt lgkmcnt(0)
  v_mfma_f32_32x32x16_bf16 v[188:203], v[102:105], v[18:21], v[188:203]
  buffer_store_dwordx4 v[252:255], v9, s[12:15], s41 offen offset:2048 sc1
  v_cvt_pk_bf16_f32 v26, v208, v209
  v_cvt_pk_bf16_f32 v27, v210, v211
  v_mfma_f32_32x32x8_bf16 v[172:187], v[100:101], v[22:23], v[172:187]
  v_cvt_pk_bf16_f32 v28, v212, v213
  v_cvt_pk_bf16_f32 v29, v214, v215
  ds_read_b128 v[252:255], v6 offset:6144
  v_mfma_f32_32x32x16_bf16 v[236:251], a[124:127], a[28:31], v[236:251]
  v_mfma_f32_32x32x16_bf16 v[236:251], a[128:131], a[32:35], v[236:251]
  v_mfma_f32_32x32x8_bf16 v[188:203], v[106:107], v[22:23], v[188:203]
  v_mfma_f32_32x32x16_bf16 v[220:235], a[132:135], a[12:15], v[220:235]
  v_mfma_f32_32x32x16_bf16 v[236:251], a[132:135], a[36:39], v[236:251]
  v_max3_f32 v20, v172, v173, v174
  v_mfma_f32_32x32x16_bf16 v[220:235], a[136:139], a[16:19], v[220:235]
  v_max3_f32 v20, v20, v175, v176
  v_mfma_f32_32x32x16_bf16 v[236:251], a[136:139], a[40:43], v[236:251]
  v_max3_f32 v20, v20, v177, v178
  v_mfma_f32_32x32x16_bf16 v[220:235], a[140:143], a[20:23], v[220:235]
  v_max3_f32 v21, v188, v189, v190
  v_max3_f32 v20, v20, v179, v180
  v_max3_f32 v21, v21, v191, v192
  v_max3_f32 v20, v20, v181, v182
  v_max3_f32 v21, v21, v193, v194
  v_max3_f32 v20, v20, v183, v184
  v_mfma_f32_32x32x16_bf16 v[236:251], a[140:143], a[44:47], v[236:251]
  s_waitcnt lgkmcnt(0)
  buffer_store_dwordx4 v[252:255], v7, s[12:15], s42 offen offset:0 sc1
  v_max3_f32 v21, v21, v195, v196
  v_max3_f32 v20, v20, v185, v186
  v_max3_f32 v21, v21, v197, v198
  v_max3_f32 v20, v20, v187, v203
  v_max3_f32 v21, v21, v199, v200
  v_cvt_pk_bf16_f32 v36, v220, v221
  v_max3_f32 v21, v21, v201, v202
  v_cvt_pk_bf16_f32 v37, v222, v223
  v_max_f32 v20, v20, v21
  v_cvt_pk_bf16_f32 v38, v224, v225
  v_cvt_pk_bf16_f32 v39, v226, v227
  v_permlane32_swap_b32 v20, v21
  v_cvt_pk_bf16_f32 v40, v228, v229
  v_max_f32 v20, v20, v21
  v_cvt_pk_bf16_f32 v41, v230, v231
  v_and_b32 v21, 0xffff0000, v20
  v_cvt_pk_bf16_f32 v84, v232, v233
  v_sub_f32 v21, v20, v21
  v_cvt_pk_bf16_f32 v85, v234, v235
  v_mfma_f32_32x32x16_bf16 v[220:235], a[144:147], a[0:3], 0
  ds_read_b128 v[252:255], v6 offset:7168
  v_perm_b32 v18, v21, v20, s53
  v_and_b32 v20, 0xffff0000, v21
  v_cvt_pk_bf16_f32 v48, v236, v237
  v_sub_f32 v19, v21, v20
  v_cvt_pk_bf16_f32 v49, v238, v239
  v_mfma_f32_32x32x16_bf16 v[220:235], a[148:151], a[4:7], v[220:235]
  v_cvt_pk_bf16_f32 v50, v240, v241
  v_cvt_pk_bf16_f32 v51, v242, v243
  v_cvt_pk_bf16_f32 v52, v244, v245
  v_cvt_pk_bf16_f32 v53, v246, v247
  v_cvt_pk_bf16_f32 v90, v248, v249
  v_cvt_pk_bf16_f32 v91, v250, v251
  v_mfma_f32_32x32x8_bf16 v[172:187], v[10:11], v[18:19], v[172:187]
  v_mfma_f32_32x32x8_bf16 v[188:203], v[10:11], v[18:19], v[188:203]
  v_mfma_f32_32x32x16_bf16 v[236:251], a[144:147], a[24:27], 0
  v_mfma_f32_32x32x16_bf16 v[236:251], a[148:151], a[28:31], v[236:251]
  v_mfma_f32_32x32x16_bf16 v[220:235], a[152:155], a[8:11], v[220:235]
  v_mfma_f32_32x32x16_bf16 v[236:251], a[152:155], a[32:35], v[236:251]
  s_waitcnt lgkmcnt(0)
  buffer_store_dwordx4 v[252:255], v8, s[12:15], s42 offen offset:1024 sc1
  v_mfma_f32_32x32x16_bf16 v[220:235], a[156:159], a[12:15], v[220:235]
  ds_read_b128 v[252:255], v6 offset:8192
  v_exp_f32 v172, v172
  v_exp_f32 v173, v173
  v_mfma_f32_32x32x16_bf16 v[236:251], a[156:159], a[36:39], v[236:251]
  v_exp_f32 v174, v174
  v_exp_f32 v175, v175
  v_exp_f32 v176, v176
  v_mfma_f32_32x32x16_bf16 v[220:235], a[160:163], a[16:19], v[220:235]
  v_exp_f32 v177, v177
  v_exp_f32 v178, v178
  v_exp_f32 v179, v179
  v_mfma_f32_32x32x16_bf16 v[236:251], a[160:163], a[40:43], v[236:251]
  v_cvt_pk_bf16_f32 v172, v172, v173
  v_cvt_pk_bf16_f32 v173, v174, v175
  v_cvt_pk_bf16_f32 v174, v176, v177
  v_cvt_pk_bf16_f32 v175, v178, v179
  v_exp_f32 v180, v180
  v_mfma_f32_32x32x16_bf16 v[204:219], v[124:127], v[172:175], 0
  ds_read_b128 v[172:175], v3 offset:5248
  v_exp_f32 v181, v181
  v_exp_f32 v182, v182
  v_cvt_pk_bf16_f32 v176, v180, v181
  v_mfma_f32_32x32x16_bf16 v[220:235], a[164:167], a[20:23], v[220:235]
  v_exp_f32 v183, v183
  v_exp_f32 v184, v184
  v_exp_f32 v185, v185
  v_mfma_f32_32x32x16_bf16 v[236:251], a[164:167], a[44:47], v[236:251]
  v_exp_f32 v186, v186
  v_exp_f32 v187, v187
  v_cvt_pk_bf16_f32 v177, v182, v183
  v_cvt_pk_bf16_f32 v178, v184, v185
  v_cvt_pk_bf16_f32 v179, v186, v187
  v_exp_f32 v188, v188
  v_mfma_f32_32x32x16_bf16 v[204:219], v[128:131], v[176:179], v[204:219]
  ds_read_b128 v[176:179], v3 offset:5120
  v_exp_f32 v189, v189
  v_exp_f32 v190, v190
  v_exp_f32 v191, v191
  v_exp_f32 v192, v192
  v_exp_f32 v193, v193
  v_exp_f32 v194, v194
  v_exp_f32 v195, v195
  v_cvt_pk_bf16_f32 v180, v188, v189
  v_cvt_pk_bf16_f32 v181, v190, v191
  v_cvt_pk_bf16_f32 v182, v192, v193
  v_cvt_pk_bf16_f32 v183, v194, v195
  v_exp_f32 v196, v196
  v_mfma_f32_32x32x16_bf16 v[204:219], v[132:135], v[180:183], v[204:219]
  ds_read_b128 v[180:183], v3 offset:4992
  ds_read_b128 v[188:191], v2 offset:4736
  ds_read_b128 v[192:195], v2 offset:4608
  s_waitcnt lgkmcnt(4)
  buffer_store_dwordx4 v[252:255], v9, s[12:15], s42 offen offset:2048 sc1
  v_exp_f32 v197, v197
  v_exp_f32 v198, v198
  v_exp_f32 v199, v199
  v_exp_f32 v200, v200
  v_exp_f32 v201, v201
  v_exp_f32 v202, v202
  v_exp_f32 v203, v203
  v_cvt_pk_bf16_f32 v184, v196, v197
  v_cvt_pk_bf16_f32 v185, v198, v199
  v_cvt_pk_bf16_f32 v186, v200, v201
  v_cvt_pk_bf16_f32 v187, v202, v203
  v_cvt_pk_bf16_f32 v86, v220, v221
  v_cvt_pk_bf16_f32 v87, v222, v223
  v_mfma_f32_32x32x16_bf16 v[204:219], v[136:139], v[184:187], v[204:219]
  ds_read_b128 v[184:187], v3 offset:4864
  ds_read_b128 v[196:199], v2 offset:4480
  ds_read_b128 v[200:203], v2 offset:4352
  v_cvt_pk_bf16_f32 v92, v236, v237
  v_cvt_pk_bf16_f32 v93, v238, v239
  v_cvt_pk_bf16_f32 v88, v224, v225
  v_cvt_pk_bf16_f32 v89, v226, v227
  v_cvt_pk_bf16_f32 v94, v240, v241
  v_cvt_pk_bf16_f32 v95, v242, v243
  v_cvt_pk_bf16_f32 v42, v228, v229
  v_cvt_pk_bf16_f32 v43, v230, v231
  v_cvt_pk_bf16_f32 v44, v232, v233
  v_rcp_f32 v213, v212
  v_cvt_pk_bf16_f32 v45, v234, v235
  v_mfma_f32_32x32x16_bf16 v[220:235], a[0:3], a[240:243], 0
  ds_read_b128 v[252:255], v6 offset:9216
  v_mul_f32 v216, v216, v213
  v_mul_f32 v217, v217, v213
  v_mul_f32 v218, v218, v213
  v_mul_f32 v219, v219, v213
  v_mul_f32 v204, v204, v213
  v_mfma_f32_32x32x16_bf16 v[220:235], a[4:7], a[244:247], v[220:235]
  v_mul_f32 v205, v205, v213
  v_mul_f32 v206, v206, v213
  v_mul_f32 v207, v207, v213
  v_mul_f32 v208, v208, v213
  v_mul_f32 v209, v209, v213
  v_mul_f32 v210, v210, v213
  v_mfma_f32_32x32x16_bf16 v[220:235], a[8:11], a[248:251], v[220:235]
  v_mul_f32 v211, v211, v213
  v_cvt_pk_bf16_f32 v18, v216, v217
  v_cvt_pk_bf16_f32 v19, v218, v219
  v_cvt_pk_bf16_f32 v20, v204, v205
  v_cvt_pk_bf16_f32 v21, v206, v207
  s_waitcnt lgkmcnt(1)
  v_mfma_f32_32x32x16_bf16 v[172:187], v[96:99], v[30:33], v[172:187]
  v_cvt_pk_bf16_f32 v22, v208, v209
  v_cvt_pk_bf16_f32 v23, v210, v211
  v_cvt_pk_bf16_f32 v54, v244, v245
  v_cvt_pk_bf16_f32 v55, v246, v247
  v_cvt_pk_bf16_f32 v56, v248, v249
  v_cvt_pk_bf16_f32 v57, v250, v251
  v_mfma_f32_32x32x16_bf16 v[188:203], v[102:105], v[30:33], v[188:203]
  v_mfma_f32_32x32x16_bf16 v[236:251], a[24:27], a[240:243], 0
  ds_read_b64_tr_b16 a[240:241], v0 offset:22528
  ds_read_b64_tr_b16 a[242:243], v0 offset:22784
  s_waitcnt lgkmcnt(2)
  buffer_store_dwordx4 v[252:255], v7, s[12:15], s43 offen offset:0 sc1
  v_mfma_f32_32x32x8_bf16 v[172:187], v[100:101], v[34:35], v[172:187]
  v_mfma_f32_32x32x16_bf16 v[236:251], a[28:31], a[244:247], v[236:251]
  ds_read_b64_tr_b16 a[244:245], v0 offset:23552
  ds_read_b64_tr_b16 a[246:247], v0 offset:23808
  ds_read_b128 v[252:255], v6 offset:10240
  v_mfma_f32_32x32x8_bf16 v[188:203], v[106:107], v[34:35], v[188:203]
  v_mfma_f32_32x32x16_bf16 v[236:251], a[32:35], a[248:251], v[236:251]
  ds_read_b64_tr_b16 a[248:249], v0 offset:0
  ds_read_b64_tr_b16 a[250:251], v0 offset:256
  v_mfma_f32_32x32x16_bf16 v[220:235], a[12:15], a[252:255], v[220:235]
  v_max3_f32 v32, v172, v173, v174
  v_mfma_f32_32x32x16_bf16 v[236:251], a[36:39], a[252:255], v[236:251]
  ds_read_b64_tr_b16 a[252:253], v0 offset:1024
  ds_read_b64_tr_b16 a[254:255], v0 offset:1280
  v_max3_f32 v32, v32, v175, v176
  v_max3_f32 v33, v188, v189, v190
  v_max3_f32 v32, v32, v177, v178
  s_waitcnt lgkmcnt(4)
  v_mfma_f32_32x32x16_bf16 v[220:235], a[16:19], a[240:243], v[220:235]
  v_max3_f32 v33, v33, v191, v192
  v_max3_f32 v32, v32, v179, v180
  v_max3_f32 v33, v33, v193, v194
  v_max3_f32 v32, v32, v181, v182
  v_max3_f32 v33, v33, v195, v196
  v_max3_f32 v32, v32, v183, v184
  v_mfma_f32_32x32x16_bf16 v[236:251], a[40:43], a[240:243], v[236:251]
  ds_read_b64_tr_b16 a[240:241], v0 offset:2048
  ds_read_b64_tr_b16 a[242:243], v0 offset:2304
  v_max3_f32 v33, v33, v197, v198
  v_max3_f32 v32, v32, v185, v186
  v_max3_f32 v33, v33, v199, v200
  v_max3_f32 v32, v32, v187, v203
  v_mfma_f32_32x32x16_bf16 v[220:235], a[20:23], a[244:247], v[220:235]
  v_max3_f32 v33, v33, v201, v202
  v_mfma_f32_32x32x16_bf16 v[236:251], a[44:47], a[244:247], v[236:251]
  ds_read_b64_tr_b16 a[244:245], v0 offset:3072
  ds_read_b64_tr_b16 a[246:247], v0 offset:3328
  v_max_f32 v32, v32, v33
  v_mfma_f32_32x32x16_bf16 v[60:75], a[220:223], v[16:19], v[60:75]
  buffer_store_dwordx4 v[252:255], v8, s[12:15], s43 offen offset:1024 sc1
  v_mfma_f32_32x32x16_bf16 v[60:75], a[224:227], v[20:23], v[60:75]
  ds_read_b128 v[252:255], v6 offset:11264
  v_permlane32_swap_b32 v32, v33
  s_mov_b64 exec, s[66:67]
  v_cvt_pk_bf16_f32 v140, v220, v221
  v_cvt_pk_bf16_f32 v141, v222, v223
  v_cvt_pk_bf16_f32 v142, v224, v225
  v_cvt_pk_bf16_f32 v143, v226, v227
  v_cvt_pk_bf16_f32 v144, v228, v229
  v_cvt_pk_bf16_f32 v145, v230, v231
  v_cvt_pk_bf16_f32 v146, v232, v233
  v_cvt_pk_bf16_f32 v147, v234, v235
  s_mov_b64 exec, -1
  v_max_f32 v32, v32, v33
  s_mov_b64 exec, s[68:69]
  v_cvt_pk_bf16_f32 v156, v220, v221
  v_cvt_pk_bf16_f32 v157, v222, v223
  v_cvt_pk_bf16_f32 v158, v224, v225
  v_cvt_pk_bf16_f32 v159, v226, v227
  v_cvt_pk_bf16_f32 v160, v228, v229
  v_cvt_pk_bf16_f32 v161, v230, v231
  v_cvt_pk_bf16_f32 v162, v232, v233
  v_cvt_pk_bf16_f32 v163, v234, v235
  s_waitcnt lgkmcnt(1)
  v_mfma_f32_32x32x16_bf16 v[220:235], a[248:251], a[0:3], 0
  s_mov_b64 exec, -1
  v_and_b32 v33, 0xffff0000, v32
  s_mov_b64 exec, s[66:67]
  v_cvt_pk_bf16_f32 v148, v236, v237
  v_cvt_pk_bf16_f32 v149, v238, v239
  v_cvt_pk_bf16_f32 v150, v240, v241
  v_mfma_f32_32x32x16_bf16 v[220:235], a[252:255], a[4:7], v[220:235]
  v_cvt_pk_bf16_f32 v151, v242, v243
  v_cvt_pk_bf16_f32 v152, v244, v245
  v_cvt_pk_bf16_f32 v153, v246, v247
  v_cvt_pk_bf16_f32 v154, v248, v249
  v_cvt_pk_bf16_f32 v155, v250, v251
  s_mov_b64 exec, -1
  v_mfma_f32_32x32x16_bf16 v[220:235], a[240:243], a[8:11], v[220:235]
  v_sub_f32 v33, v32, v33
  s_mov_b64 exec, s[68:69]
  v_cvt_pk_bf16_f32 v164, v236, v237
  v_cvt_pk_bf16_f32 v165, v238, v239
  v_cvt_pk_bf16_f32 v166, v240, v241
  v_cvt_pk_bf16_f32 v167, v242, v243
  v_mfma_f32_32x32x16_bf16 v[220:235], a[244:247], a[12:15], v[220:235]
  v_cvt_pk_bf16_f32 v168, v244, v245
  v_cvt_pk_bf16_f32 v169, v246, v247
  v_cvt_pk_bf16_f32 v170, v248, v249
  v_cvt_pk_bf16_f32 v171, v250, v251
  s_mov_b64 exec, -1
  v_perm_b32 v30, v33, v32, s53
  v_mfma_f32_32x32x16_bf16 v[236:251], a[248:251], a[24:27], 0
  ds_read_b64_tr_b16 a[248:249], v0 offset:4096
  ds_read_b64_tr_b16 a[250:251], v0 offset:4352
  v_and_b32 v32, 0xffff0000, v33
  v_mfma_f32_32x32x16_bf16 v[236:251], a[252:255], a[28:31], v[236:251]
  ds_read_b64_tr_b16 a[252:253], v0 offset:5120
  ds_read_b64_tr_b16 a[254:255], v0 offset:5376
  v_sub_f32 v31, v33, v32
  v_mfma_f32_32x32x16_bf16 v[236:251], a[240:243], a[32:35], v[236:251]
  v_mfma_f32_32x32x8_bf16 v[172:187], v[10:11], v[30:31], v[172:187]
  s_waitcnt lgkmcnt(4)
  buffer_store_dwordx4 v[252:255], v9, s[12:15], s43 offen offset:2048 sc1
  v_mfma_f32_32x32x8_bf16 v[188:203], v[10:11], v[30:31], v[188:203]
  v_mfma_f32_32x32x16_bf16 v[236:251], a[244:247], a[36:39], v[236:251]
  s_waitcnt lgkmcnt(0)
  v_mfma_f32_32x32x16_bf16 v[220:235], a[248:251], a[16:19], v[220:235]
  v_mfma_f32_32x32x16_bf16 v[236:251], a[248:251], a[40:43], v[236:251]
  v_mfma_f32_32x32x16_bf16 v[220:235], a[252:255], a[20:23], v[220:235]
  v_exp_f32 v172, v172
  v_exp_f32 v173, v173
  v_exp_f32 v174, v174
  v_mfma_f32_32x32x16_bf16 v[236:251], a[252:255], a[44:47], v[236:251]
  v_exp_f32 v175, v175
  v_exp_f32 v176, v176
  v_exp_f32 v177, v177
  v_exp_f32 v178, v178
  v_exp_f32 v179, v179
  v_cvt_pk_bf16_f32 v172, v172, v173
  v_cvt_pk_bf16_f32 v173, v174, v175
  v_cvt_pk_bf16_f32 v174, v176, v177
  v_cvt_pk_bf16_f32 v175, v178, v179
  v_exp_f32 v180, v180
  v_mfma_f32_32x32x16_bf16 v[204:219], v[124:127], v[172:175], 0
  ds_read_b128 v[172:175], v2 offset:8576
  v_exp_f32 v181, v181
  v_exp_f32 v182, v182
  v_exp_f32 v183, v183
  v_exp_f32 v184, v184
  v_exp_f32 v185, v185
  v_exp_f32 v186, v186
  v_exp_f32 v187, v187
  v_cvt_pk_bf16_f32 v176, v180, v181
  v_cvt_pk_bf16_f32 v177, v182, v183
  v_cvt_pk_bf16_f32 v178, v184, v185
  v_cvt_pk_bf16_f32 v179, v186, v187
  v_exp_f32 v188, v188
  v_mfma_f32_32x32x16_bf16 v[204:219], v[128:131], v[176:179], v[204:219]
  ds_read_b128 v[176:179], v2 offset:8448
  v_exp_f32 v189, v189
  v_exp_f32 v190, v190
  v_exp_f32 v191, v191
  v_exp_f32 v192, v192
  v_exp_f32 v193, v193
  v_exp_f32 v194, v194
  v_exp_f32 v195, v195
  v_cvt_pk_bf16_f32 v180, v188, v189
  v_cvt_pk_bf16_f32 v181, v190, v191
  v_cvt_pk_bf16_f32 v182, v192, v193
  v_cvt_pk_bf16_f32 v183, v194, v195
  v_exp_f32 v196, v196
  v_mfma_f32_32x32x16_bf16 v[204:219], v[132:135], v[180:183], v[204:219]
  ds_read_b128 v[180:183], v2 offset:8320
  ds_read_b128 v[188:191], v3 offset:8064
  ds_read_b128 v[192:195], v3 offset:7936
  v_exp_f32 v197, v197
  v_exp_f32 v198, v198
  v_exp_f32 v199, v199
  v_exp_f32 v200, v200
  v_exp_f32 v201, v201
  v_exp_f32 v202, v202
  v_exp_f32 v203, v203
  v_cvt_pk_bf16_f32 v184, v196, v197
  v_cvt_pk_bf16_f32 v185, v198, v199
  v_cvt_pk_bf16_f32 v186, v200, v201
  v_cvt_pk_bf16_f32 v187, v202, v203
  v_cvt_pk_bf16_f32 v96, v224, v225
  v_cvt_pk_bf16_f32 v97, v226, v227
  v_mfma_f32_32x32x16_bf16 v[204:219], v[136:139], v[184:187], v[204:219]
  ds_read_b128 v[184:187], v2 offset:8192
  ds_read_b128 v[196:199], v3 offset:7808
  ds_read_b128 v[200:203], v3 offset:7680
  v_cvt_pk_bf16_f32 v98, v228, v229
  v_cvt_pk_bf16_f32 v99, v230, v231
  v_cvt_pk_bf16_f32 v102, v240, v241
  v_cvt_pk_bf16_f32 v103, v242, v243
  v_cvt_pk_bf16_f32 v104, v244, v245
  v_cvt_pk_bf16_f32 v105, v246, v247
  v_cvt_pk_bf16_f32 v46, v220, v221
  v_cvt_pk_bf16_f32 v47, v222, v223
  v_cvt_pk_bf16_f32 v100, v232, v233
  v_rcp_f32 v213, v212
  v_cvt_pk_bf16_f32 v101, v234, v235
  v_mfma_f32_32x32x16_bf16 v[220:235], a[168:171], v[12:15], 0
  v_mul_f32 v216, v216, v213
  v_mul_f32 v217, v217, v213
  v_mul_f32 v218, v218, v213
  v_mul_f32 v219, v219, v213
  v_mul_f32 v204, v204, v213
  v_mul_f32 v205, v205, v213
  v_mfma_f32_32x32x16_bf16 v[220:235], a[172:175], v[16:19], v[220:235]
  v_mul_f32 v206, v206, v213
  v_mul_f32 v207, v207, v213
  v_mul_f32 v208, v208, v213
  v_mul_f32 v209, v209, v213
  v_mul_f32 v210, v210, v213
  v_mul_f32 v211, v211, v213
  v_mfma_f32_32x32x16_bf16 v[220:235], a[176:179], v[20:23], v[220:235]
  v_cvt_pk_bf16_f32 v30, v216, v217
  v_cvt_pk_bf16_f32 v31, v218, v219
  v_cvt_pk_bf16_f32 v32, v204, v205
  v_cvt_pk_bf16_f32 v33, v206, v207
  v_cvt_pk_bf16_f32 v34, v208, v209
  s_waitcnt lgkmcnt(0)
  v_mfma_f32_32x32x16_bf16 v[172:187], v[84:87], v[36:39], v[172:187]
  v_cvt_pk_bf16_f32 v35, v210, v211
  v_cvt_pk_bf16_f32 v106, v248, v249
  v_cvt_pk_bf16_f32 v107, v250, v251
  v_cvt_pk_bf16_f32 v58, v236, v237
  v_cvt_pk_bf16_f32 v59, v238, v239
  v_mfma_f32_32x32x16_bf16 v[188:203], v[90:93], v[36:39], v[188:203]
  v_mfma_f32_32x32x16_bf16 v[236:251], a[192:195], v[12:15], 0
  v_mfma_f32_32x32x16_bf16 v[236:251], a[196:199], v[16:19], v[236:251]
  v_mfma_f32_32x32x8_bf16 v[172:187], v[88:89], v[40:41], v[172:187]
  v_mfma_f32_32x32x16_bf16 v[236:251], a[200:203], v[20:23], v[236:251]
  s_nop 9
  v_max3_f32 v38, v172, v173, v174
  v_max3_f32 v38, v38, v175, v176
  v_mfma_f32_32x32x8_bf16 v[188:203], v[94:95], v[40:41], v[188:203]
  v_max3_f32 v38, v38, v177, v178
  v_max3_f32 v38, v38, v179, v180
  v_max3_f32 v38, v38, v181, v182
  v_max3_f32 v38, v38, v183, v184
  v_max3_f32 v38, v38, v185, v186
  s_nop 6
  v_max3_f32 v39, v188, v189, v190
  v_max3_f32 v38, v38, v187, v203
  v_max3_f32 v39, v39, v191, v192
  v_max3_f32 v39, v39, v193, v194
  v_max3_f32 v39, v39, v195, v196
  v_max3_f32 v39, v39, v197, v198
  v_max3_f32 v39, v39, v199, v200
  v_max3_f32 v39, v39, v201, v202
  v_max_f32 v38, v38, v39
  s_nop 1
  v_permlane32_swap_b32 v38, v39
  v_max_f32 v38, v38, v39
  v_and_b32 v39, 0xffff0000, v38
  v_sub_f32 v39, v38, v39
  v_perm_b32 v36, v39, v38, s53
  v_and_b32 v38, 0xffff0000, v39
  v_sub_f32 v37, v39, v38
  s_nop 1
  v_mfma_f32_32x32x8_bf16 v[172:187], v[10:11], v[36:37], v[172:187]
  v_mfma_f32_32x32x8_bf16 v[188:203], v[10:11], v[36:37], v[188:203]
  s_nop 10
  v_exp_f32 v172, v172
  v_exp_f32 v173, v173
  v_exp_f32 v174, v174
  v_cvt_pk_bf16_f32 v172, v172, v173
  v_exp_f32 v175, v175
  v_exp_f32 v176, v176
  v_exp_f32 v177, v177
  v_exp_f32 v178, v178
  v_exp_f32 v179, v179
  v_cvt_pk_bf16_f32 v173, v174, v175
  v_cvt_pk_bf16_f32 v174, v176, v177
  v_cvt_pk_bf16_f32 v175, v178, v179
  v_exp_f32 v180, v180
  v_mfma_f32_32x32x16_bf16 v[204:219], v[140:143], v[172:175], 0
  ds_read_b128 v[172:175], v2 offset:12416
  v_exp_f32 v181, v181
  v_exp_f32 v182, v182
  v_exp_f32 v183, v183
  v_exp_f32 v184, v184
  v_exp_f32 v185, v185
  v_exp_f32 v186, v186
  v_exp_f32 v187, v187
  v_cvt_pk_bf16_f32 v176, v180, v181
  v_cvt_pk_bf16_f32 v177, v182, v183
  v_cvt_pk_bf16_f32 v178, v184, v185
  v_cvt_pk_bf16_f32 v179, v186, v187
  v_exp_f32 v188, v188
  v_mfma_f32_32x32x16_bf16 v[204:219], v[144:147], v[176:179], v[204:219]
  ds_read_b128 v[176:179], v2 offset:12288
  v_exp_f32 v189, v189
  v_exp_f32 v190, v190
  v_exp_f32 v191, v191
  v_exp_f32 v192, v192
  v_exp_f32 v193, v193
  v_exp_f32 v194, v194
  v_exp_f32 v195, v195
  v_cvt_pk_bf16_f32 v180, v188, v189
  v_cvt_pk_bf16_f32 v181, v190, v191
  v_cvt_pk_bf16_f32 v182, v192, v193
  v_cvt_pk_bf16_f32 v183, v194, v195
  v_exp_f32 v196, v196
  v_mfma_f32_32x32x16_bf16 v[204:219], v[148:151], v[180:183], v[204:219]
  ds_read_b128 v[180:183], v2 offset:12160
  ds_read_b128 v[188:191], v3 offset:11904
  ds_read_b128 v[192:195], v3 offset:11776
  v_exp_f32 v197, v197
  v_exp_f32 v198, v198
  v_exp_f32 v199, v199
  v_exp_f32 v200, v200
  v_exp_f32 v201, v201
  v_exp_f32 v202, v202
  v_exp_f32 v203, v203
  v_cvt_pk_bf16_f32 v184, v196, v197
  v_cvt_pk_bf16_f32 v185, v198, v199
  v_cvt_pk_bf16_f32 v186, v200, v201
  v_cvt_pk_bf16_f32 v187, v202, v203
  ds_read_b128 v[196:199], v3 offset:11648
  ds_read_b128 v[200:203], v3 offset:11520
  v_mfma_f32_32x32x16_bf16 v[204:219], v[152:155], v[184:187], v[204:219]
  ds_read_b128 v[184:187], v2 offset:12032
  s_nop 10
  v_rcp_f32 v209, v208
  s_nop 0
  v_mul_f32 v212, v212, v209
  v_mul_f32 v213, v213, v209
  v_mul_f32 v214, v214, v209
  v_cvt_pk_bf16_f32 v36, v212, v213
  v_mul_f32 v215, v215, v209
  v_mul_f32 v216, v216, v209
  v_cvt_pk_bf16_f32 v37, v214, v215
  v_mul_f32 v217, v217, v209
  v_mul_f32 v218, v218, v209
  v_mul_f32 v219, v219, v209
  v_mul_f32 v204, v204, v209
  v_mul_f32 v205, v205, v209
  v_mul_f32 v206, v206, v209
  v_mul_f32 v207, v207, v209
  v_cvt_pk_bf16_f32 v38, v216, v217
  s_waitcnt lgkmcnt(1)
  v_mfma_f32_32x32x16_bf16 v[188:203], v[102:105], v[42:45], v[188:203]
  v_cvt_pk_bf16_f32 v39, v218, v219
  v_cvt_pk_bf16_f32 v40, v204, v205
  v_cvt_pk_bf16_f32 v41, v206, v207
  s_waitcnt lgkmcnt(0)
  v_mfma_f32_32x32x16_bf16 v[172:187], v[96:99], v[42:45], v[172:187]
  v_mfma_f32_32x32x16_bf16 v[220:235], a[180:183], v[36:39], v[220:235]
  v_mfma_f32_32x32x16_bf16 v[236:251], a[204:207], v[36:39], v[236:251]
  v_mfma_f32_32x32x8_bf16 v[188:203], v[106:107], v[46:47], v[188:203]
  v_mfma_f32_32x32x16_bf16 v[60:75], a[228:231], v[36:39], v[60:75]
  s_nop 9
  v_max3_f32 v45, v188, v189, v190
  v_max3_f32 v45, v45, v191, v192
  v_mfma_f32_32x32x8_bf16 v[172:187], v[100:101], v[46:47], v[172:187]
  v_max3_f32 v45, v45, v193, v194
  v_max3_f32 v45, v45, v195, v196
  v_max3_f32 v45, v45, v197, v198
  v_max3_f32 v45, v45, v199, v200
  v_max3_f32 v45, v45, v201, v202
  s_nop 6
  v_max3_f32 v44, v172, v173, v174
  v_max3_f32 v44, v44, v175, v176
  v_max3_f32 v44, v44, v177, v178
  v_max3_f32 v44, v44, v179, v180
  v_max3_f32 v44, v44, v181, v182
  v_max3_f32 v44, v44, v183, v184
  v_max3_f32 v44, v44, v185, v186
  v_max3_f32 v44, v44, v187, v203
  v_max_f32 v44, v44, v45
  s_nop 1
  v_permlane32_swap_b32 v44, v45
  v_max_f32 v44, v44, v45
  v_and_b32 v45, 0xffff0000, v44
  v_sub_f32 v45, v44, v45
  v_perm_b32 v42, v45, v44, s53
  v_and_b32 v44, 0xffff0000, v45
  v_sub_f32 v43, v45, v44
  s_nop 1
  v_mfma_f32_32x32x8_bf16 v[172:187], v[10:11], v[42:43], v[172:187]
  v_mfma_f32_32x32x8_bf16 v[188:203], v[10:11], v[42:43], v[188:203]
  s_nop 10
  v_exp_f32 v172, v172
  v_exp_f32 v173, v173
  v_exp_f32 v174, v174
  v_cvt_pk_bf16_f32 v172, v172, v173
  v_exp_f32 v175, v175
  v_exp_f32 v176, v176
  v_exp_f32 v177, v177
  v_exp_f32 v178, v178
  v_exp_f32 v179, v179
  v_cvt_pk_bf16_f32 v173, v174, v175
  v_cvt_pk_bf16_f32 v174, v176, v177
  v_cvt_pk_bf16_f32 v175, v178, v179
  v_exp_f32 v180, v180
  v_mfma_f32_32x32x16_bf16 v[204:219], v[156:159], v[172:175], 0
  ds_read_b128 v[172:175], v3 offset:9088
  v_exp_f32 v181, v181
  v_exp_f32 v182, v182
  v_exp_f32 v183, v183
  v_exp_f32 v184, v184
  v_exp_f32 v185, v185
  v_exp_f32 v186, v186
  v_exp_f32 v187, v187
  v_cvt_pk_bf16_f32 v176, v180, v181
  v_cvt_pk_bf16_f32 v177, v182, v183
  v_cvt_pk_bf16_f32 v178, v184, v185
  v_cvt_pk_bf16_f32 v179, v186, v187
  v_exp_f32 v188, v188
  v_mfma_f32_32x32x16_bf16 v[204:219], v[160:163], v[176:179], v[204:219]
  ds_read_b128 v[176:179], v3 offset:8960
  v_exp_f32 v189, v189
  v_exp_f32 v190, v190
  v_exp_f32 v191, v191
  v_exp_f32 v192, v192
  v_exp_f32 v193, v193
  v_exp_f32 v194, v194
  v_exp_f32 v195, v195
  v_cvt_pk_bf16_f32 v180, v188, v189
  v_cvt_pk_bf16_f32 v181, v190, v191
  v_cvt_pk_bf16_f32 v182, v192, v193
  v_cvt_pk_bf16_f32 v183, v194, v195
  v_exp_f32 v196, v196
  v_mfma_f32_32x32x16_bf16 v[204:219], v[164:167], v[180:183], v[204:219]
  ds_read_b128 v[180:183], v3 offset:8832
  ds_read_b128 v[188:191], v2 offset:8576
  ds_read_b128 v[192:195], v2 offset:8448
  v_exp_f32 v197, v197
  v_exp_f32 v198, v198
  v_exp_f32 v199, v199
  v_exp_f32 v200, v200
  v_exp_f32 v201, v201
  v_exp_f32 v202, v202
  v_exp_f32 v203, v203
  v_cvt_pk_bf16_f32 v184, v196, v197
  v_cvt_pk_bf16_f32 v185, v198, v199
  v_cvt_pk_bf16_f32 v186, v200, v201
  v_cvt_pk_bf16_f32 v187, v202, v203
  ds_read_b128 v[196:199], v2 offset:8320
  ds_read_b128 v[200:203], v2 offset:8192
  v_mfma_f32_32x32x16_bf16 v[204:219], v[168:171], v[184:187], v[204:219]
  ds_read_b128 v[184:187], v3 offset:8704
  s_nop 10
  v_rcp_f32 v205, v204
  s_nop 0
  v_mul_f32 v208, v208, v205
  v_mul_f32 v209, v209, v205
  v_mul_f32 v210, v210, v205
  v_cvt_pk_bf16_f32 v42, v208, v209
  v_mul_f32 v211, v211, v205
  v_mul_f32 v212, v212, v205
  v_cvt_pk_bf16_f32 v43, v210, v211
  v_mul_f32 v213, v213, v205
  v_mul_f32 v214, v214, v205
  v_mfma_f32_32x32x16_bf16 v[220:235], a[184:187], v[40:43], v[220:235]
  v_mul_f32 v215, v215, v205
  v_mul_f32 v216, v216, v205
  v_mul_f32 v217, v217, v205
  v_mul_f32 v218, v218, v205
  v_mul_f32 v219, v219, v205
  s_waitcnt lgkmcnt(1)
  v_mfma_f32_32x32x16_bf16 v[188:203], v[90:93], v[48:51], v[188:203]
  v_cvt_pk_bf16_f32 v44, v212, v213
  v_cvt_pk_bf16_f32 v45, v214, v215
  v_cvt_pk_bf16_f32 v46, v216, v217
  v_cvt_pk_bf16_f32 v47, v218, v219
  s_waitcnt lgkmcnt(0)
  v_mfma_f32_32x32x16_bf16 v[172:187], v[84:87], v[48:51], v[172:187]
  v_mfma_f32_32x32x16_bf16 v[220:235], a[188:191], v[44:47], v[220:235]
  v_mfma_f32_32x32x16_bf16 v[236:251], a[208:211], v[40:43], v[236:251]
  v_mfma_f32_32x32x8_bf16 v[188:203], v[94:95], v[52:53], v[188:203]
  v_mfma_f32_32x32x16_bf16 v[236:251], a[212:215], v[44:47], v[236:251]
  v_mfma_f32_32x32x16_bf16 v[60:75], a[232:235], v[40:43], v[60:75]
  v_mfma_f32_32x32x16_bf16 v[60:75], a[236:239], v[44:47], v[60:75]
  v_mfma_f32_32x32x8_bf16 v[172:187], v[88:89], v[52:53], v[172:187]
  s_nop 1
  v_cvt_pk_bf16_f32 v220, v220, v221
  v_cvt_pk_bf16_f32 v221, v222, v223
  v_cvt_pk_bf16_f32 v222, v224, v225
  v_cvt_pk_bf16_f32 v223, v226, v227
  v_cvt_pk_bf16_f32 v224, v228, v229
  v_cvt_pk_bf16_f32 v225, v230, v231
  v_cvt_pk_bf16_f32 v226, v232, v233
  v_cvt_pk_bf16_f32 v227, v234, v235
  v_cvt_pk_bf16_f32 v236, v236, v237
  v_cvt_pk_bf16_f32 v237, v238, v239
  v_cvt_pk_bf16_f32 v238, v240, v241
  v_cvt_pk_bf16_f32 v239, v242, v243
  v_cvt_pk_bf16_f32 v240, v244, v245
  v_cvt_pk_bf16_f32 v241, v246, v247
  v_cvt_pk_bf16_f32 v242, v248, v249
  v_cvt_pk_bf16_f32 v243, v250, v251
  v_cvt_pk_bf16_f32 v60, v60, v61
  v_cvt_pk_bf16_f32 v61, v62, v63
  v_cvt_pk_bf16_f32 v62, v64, v65
  v_cvt_pk_bf16_f32 v63, v66, v67
  v_cvt_pk_bf16_f32 v64, v68, v69
  v_cvt_pk_bf16_f32 v65, v70, v71
  v_cvt_pk_bf16_f32 v66, v72, v73
  v_cvt_pk_bf16_f32 v67, v74, v75
  v_max3_f32 v50, v172, v173, v174
  v_max3_f32 v51, v188, v189, v190
  v_max3_f32 v50, v50, v175, v176
  v_max3_f32 v51, v51, v191, v192
  ds_write_b128 v4, v[220:223] offset:0
  v_max3_f32 v50, v50, v177, v178
  v_max3_f32 v51, v51, v193, v194
  v_max3_f32 v50, v50, v179, v180
  v_max3_f32 v51, v51, v195, v196
  v_max3_f32 v50, v50, v181, v182
  v_max3_f32 v51, v51, v197, v198
  v_max3_f32 v50, v50, v183, v184
  v_max3_f32 v51, v51, v199, v200
  v_max3_f32 v50, v50, v185, v186
  v_max3_f32 v51, v51, v201, v202
  v_max3_f32 v50, v50, v187, v203
  ds_write_b128 v5, v[224:227] offset:0
  v_mfma_f32_32x32x16_bf16 v[220:235], a[168:171], v[24:27], 0
  v_max_f32 v50, v50, v51
  ds_write_b128 v4, v[236:239] offset:64
  v_mfma_f32_32x32x16_bf16 v[220:235], a[172:175], v[28:31], v[220:235]
  v_permlane32_swap_b32 v50, v51
  v_mfma_f32_32x32x16_bf16 v[220:235], a[176:179], v[32:35], v[220:235]
  ds_write_b128 v5, v[240:243] offset:64
  v_max_f32 v50, v50, v51
  v_mfma_f32_32x32x16_bf16 v[236:251], a[192:195], v[24:27], 0
  v_and_b32 v51, 0xffff0000, v50
  ds_write_b128 v4, v[60:63] offset:128
  v_mfma_f32_32x32x16_bf16 v[236:251], a[196:199], v[28:31], v[236:251]
  v_sub_f32 v51, v50, v51
  v_mfma_f32_32x32x16_bf16 v[236:251], a[200:203], v[32:35], v[236:251]
  ds_write_b128 v5, v[64:67] offset:128
  v_perm_b32 v48, v51, v50, s53
  v_mfma_f32_32x32x16_bf16 v[60:75], a[216:219], v[24:27], 0
  v_and_b32 v50, 0xffff0000, v51
  v_mfma_f32_32x32x16_bf16 v[60:75], a[220:223], v[28:31], v[60:75]
  ds_read_b128 a[0:3], v6 offset:0
  ds_read_b128 a[4:7], v6 offset:1024
  ds_read_b128 a[8:11], v6 offset:2048
  v_sub_f32 v49, v51, v50
  v_mfma_f32_32x32x16_bf16 v[60:75], a[224:227], v[32:35], v[60:75]
  ds_read_b128 a[12:15], v6 offset:3072
  v_mfma_f32_32x32x8_bf16 v[172:187], v[10:11], v[48:49], v[172:187]
  ds_read_b128 a[16:19], v6 offset:4096
  ds_read_b128 a[20:23], v6 offset:5120
  v_mfma_f32_32x32x8_bf16 v[188:203], v[10:11], v[48:49], v[188:203]
  s_nop 8
  v_exp_f32 v172, v172
  v_exp_f32 v173, v173
  s_waitcnt lgkmcnt(5)
  buffer_store_dwordx4 a[0:3], v7, s[12:15], s44 offen offset:0 sc1
  v_cvt_pk_bf16_f32 v172, v172, v173
  v_exp_f32 v174, v174
  v_exp_f32 v175, v175
  v_exp_f32 v176, v176
  v_exp_f32 v177, v177
  v_exp_f32 v178, v178
  v_exp_f32 v179, v179
  v_cvt_pk_bf16_f32 v173, v174, v175
  v_cvt_pk_bf16_f32 v174, v176, v177
  v_cvt_pk_bf16_f32 v175, v178, v179
  v_exp_f32 v180, v180
  v_mfma_f32_32x32x16_bf16 v[204:219], v[140:143], v[172:175], 0
  ds_read_b128 v[172:175], v3 offset:12928
  v_exp_f32 v181, v181
  v_exp_f32 v182, v182
  v_exp_f32 v183, v183
  v_exp_f32 v184, v184
  v_exp_f32 v185, v185
  v_exp_f32 v186, v186
  v_exp_f32 v187, v187
  v_cvt_pk_bf16_f32 v176, v180, v181
  v_cvt_pk_bf16_f32 v177, v182, v183
  v_cvt_pk_bf16_f32 v178, v184, v185
  v_cvt_pk_bf16_f32 v179, v186, v187
  v_exp_f32 v188, v188
  v_mfma_f32_32x32x16_bf16 v[204:219], v[144:147], v[176:179], v[204:219]
  ds_read_b128 v[176:179], v3 offset:12800
  v_exp_f32 v189, v189
  v_exp_f32 v190, v190
  v_exp_f32 v191, v191
  v_exp_f32 v192, v192
  v_exp_f32 v193, v193
  v_exp_f32 v194, v194
  v_exp_f32 v195, v195
  v_cvt_pk_bf16_f32 v180, v188, v189
  v_cvt_pk_bf16_f32 v181, v190, v191
  v_cvt_pk_bf16_f32 v182, v192, v193
  v_cvt_pk_bf16_f32 v183, v194, v195
  v_exp_f32 v196, v196
  v_mfma_f32_32x32x16_bf16 v[204:219], v[148:151], v[180:183], v[204:219]
  s_waitcnt lgkmcnt(1)
  buffer_store_dwordx4 a[4:7], v8, s[12:15], s44 offen offset:1024 sc1
  ds_read_b128 v[180:183], v3 offset:12672
  ds_read_b128 v[188:191], v2 offset:12416
  ds_read_b128 v[192:195], v2 offset:12288
  v_exp_f32 v197, v197
  v_exp_f32 v198, v198
  v_exp_f32 v199, v199
  v_exp_f32 v200, v200
  v_exp_f32 v201, v201
  v_exp_f32 v202, v202
  v_exp_f32 v203, v203
  v_cvt_pk_bf16_f32 v184, v196, v197
  v_cvt_pk_bf16_f32 v185, v198, v199
  v_cvt_pk_bf16_f32 v186, v200, v201
  v_cvt_pk_bf16_f32 v187, v202, v203
  ds_read_b128 v[196:199], v2 offset:12160
  ds_read_b128 v[200:203], v2 offset:12032
  v_mfma_f32_32x32x16_bf16 v[204:219], v[152:155], v[184:187], v[204:219]
  ds_read_b128 v[184:187], v3 offset:12544
  s_nop 10
  v_rcp_f32 v209, v208
  s_nop 0
  v_mul_f32 v212, v212, v209
  v_mul_f32 v213, v213, v209
  v_mul_f32 v214, v214, v209
  v_cvt_pk_bf16_f32 v48, v212, v213
  v_mul_f32 v215, v215, v209
  v_mul_f32 v216, v216, v209
  v_cvt_pk_bf16_f32 v49, v214, v215
  v_mul_f32 v217, v217, v209
  v_mul_f32 v218, v218, v209
  v_mul_f32 v219, v219, v209
  v_mul_f32 v204, v204, v209
  v_mul_f32 v205, v205, v209
  v_mul_f32 v206, v206, v209
  v_mul_f32 v207, v207, v209
  v_cvt_pk_bf16_f32 v50, v216, v217
  s_waitcnt lgkmcnt(1)
  v_mfma_f32_32x32x16_bf16 v[188:203], v[102:105], v[54:57], v[188:203]
  buffer_store_dwordx4 a[8:11], v9, s[12:15], s44 offen offset:2048 sc1
  s_waitcnt lgkmcnt(0)
  v_mfma_f32_32x32x16_bf16 v[172:187], v[96:99], v[54:57], v[172:187]
  v_cvt_pk_bf16_f32 v51, v218, v219
  v_cvt_pk_bf16_f32 v52, v204, v205
  v_cvt_pk_bf16_f32 v53, v206, v207
  v_mfma_f32_32x32x16_bf16 v[220:235], a[180:183], v[48:51], v[220:235]
  v_mfma_f32_32x32x16_bf16 v[236:251], a[204:207], v[48:51], v[236:251]
  v_mfma_f32_32x32x8_bf16 v[188:203], v[106:107], v[58:59], v[188:203]
  v_mfma_f32_32x32x16_bf16 v[60:75], a[228:231], v[48:51], v[60:75]
  v_mfma_f32_32x32x8_bf16 v[172:187], v[100:101], v[58:59], v[172:187]
  s_nop 8
  v_max3_f32 v57, v188, v189, v190
  v_max3_f32 v57, v57, v191, v192
  v_max3_f32 v57, v57, v193, v194
  v_max3_f32 v57, v57, v195, v196
  v_max3_f32 v57, v57, v197, v198
  v_max3_f32 v57, v57, v199, v200
  v_max3_f32 v57, v57, v201, v202
  buffer_store_dwordx4 a[12:15], v7, s[12:15], s45 offen offset:0 sc1
  v_max3_f32 v56, v172, v173, v174
  v_max3_f32 v56, v56, v175, v176
  v_max3_f32 v56, v56, v177, v178
  v_max3_f32 v56, v56, v179, v180
  v_max3_f32 v56, v56, v181, v182
  v_max3_f32 v56, v56, v183, v184
  v_max3_f32 v56, v56, v185, v186
  v_max3_f32 v56, v56, v187, v203
  v_max_f32 v56, v56, v57
  s_nop 1
  v_permlane32_swap_b32 v56, v57
  v_max_f32 v56, v56, v57
  v_and_b32 v57, 0xffff0000, v56
  v_sub_f32 v57, v56, v57
  v_perm_b32 v54, v57, v56, s53
  v_and_b32 v56, 0xffff0000, v57
  v_sub_f32 v55, v57, v56
  s_nop 1
  v_mfma_f32_32x32x8_bf16 v[172:187], v[10:11], v[54:55], v[172:187]
  v_mfma_f32_32x32x8_bf16 v[188:203], v[10:11], v[54:55], v[188:203]
  s_nop 10
  v_exp_f32 v172, v172
  v_exp_f32 v173, v173
  v_exp_f32 v174, v174
  v_cvt_pk_bf16_f32 v172, v172, v173
  v_exp_f32 v175, v175
  v_exp_f32 v176, v176
  v_exp_f32 v177, v177
  v_exp_f32 v178, v178
  v_exp_f32 v179, v179
  v_cvt_pk_bf16_f32 v173, v174, v175
  v_cvt_pk_bf16_f32 v174, v176, v177
  v_cvt_pk_bf16_f32 v175, v178, v179
  v_exp_f32 v180, v180
  v_mfma_f32_32x32x16_bf16 v[204:219], v[156:159], v[172:175], 0
  buffer_store_dwordx4 a[16:19], v8, s[12:15], s45 offen offset:1024 sc1
  v_exp_f32 v181, v181
  v_exp_f32 v182, v182
  v_exp_f32 v183, v183
  v_exp_f32 v184, v184
  v_exp_f32 v185, v185
  v_exp_f32 v186, v186
  v_exp_f32 v187, v187
  v_cvt_pk_bf16_f32 v176, v180, v181
  v_cvt_pk_bf16_f32 v177, v182, v183
  v_cvt_pk_bf16_f32 v178, v184, v185
  v_cvt_pk_bf16_f32 v179, v186, v187
  v_exp_f32 v188, v188
  v_mfma_f32_32x32x16_bf16 v[204:219], v[160:163], v[176:179], v[204:219]
  v_exp_f32 v189, v189
  v_exp_f32 v190, v190
  v_exp_f32 v191, v191
  v_exp_f32 v192, v192
  v_exp_f32 v193, v193
  v_exp_f32 v194, v194
  v_exp_f32 v195, v195
  v_cvt_pk_bf16_f32 v180, v188, v189
  v_cvt_pk_bf16_f32 v181, v190, v191
  v_cvt_pk_bf16_f32 v182, v192, v193
  v_cvt_pk_bf16_f32 v183, v194, v195
  v_exp_f32 v196, v196
  v_mfma_f32_32x32x16_bf16 v[204:219], v[164:167], v[180:183], v[204:219]
  v_exp_f32 v197, v197
  v_exp_f32 v198, v198
  v_exp_f32 v199, v199
  v_exp_f32 v200, v200
  v_exp_f32 v201, v201
  v_exp_f32 v202, v202
  v_exp_f32 v203, v203
  v_cvt_pk_bf16_f32 v184, v196, v197
  v_cvt_pk_bf16_f32 v185, v198, v199
  v_cvt_pk_bf16_f32 v186, v200, v201
  v_cvt_pk_bf16_f32 v187, v202, v203
  buffer_store_dwordx4 a[20:23], v9, s[12:15], s45 offen offset:2048 sc1
  s_nop 0
  v_mfma_f32_32x32x16_bf16 v[204:219], v[168:171], v[184:187], v[204:219]
  s_nop 11
  v_rcp_f32 v205, v204
  s_nop 0
  v_mul_f32 v208, v208, v205
  v_mul_f32 v209, v209, v205
  v_mul_f32 v210, v210, v205
  v_cvt_pk_bf16_f32 v54, v208, v209
  v_mul_f32 v211, v211, v205
  v_mul_f32 v212, v212, v205
  v_cvt_pk_bf16_f32 v55, v210, v211
  v_mul_f32 v213, v213, v205
  v_mul_f32 v214, v214, v205
  v_mfma_f32_32x32x16_bf16 v[220:235], a[184:187], v[52:55], v[220:235]
  v_mul_f32 v215, v215, v205
  v_mul_f32 v216, v216, v205
  v_mul_f32 v217, v217, v205
  v_mul_f32 v218, v218, v205
  v_mul_f32 v219, v219, v205
  v_cvt_pk_bf16_f32 v56, v212, v213
  v_mfma_f32_32x32x16_bf16 v[236:251], a[208:211], v[52:55], v[236:251]
  v_cvt_pk_bf16_f32 v57, v214, v215
  v_cvt_pk_bf16_f32 v58, v216, v217
  v_cvt_pk_bf16_f32 v59, v218, v219
  v_mfma_f32_32x32x16_bf16 v[60:75], a[232:235], v[52:55], v[60:75]
  v_mfma_f32_32x32x16_bf16 v[220:235], a[188:191], v[56:59], v[220:235]
  v_mfma_f32_32x32x16_bf16 v[236:251], a[212:215], v[56:59], v[236:251]
  v_mfma_f32_32x32x16_bf16 v[60:75], a[236:239], v[56:59], v[60:75]
  s_nop 7
  v_cvt_pk_bf16_f32 v220, v220, v221
  v_cvt_pk_bf16_f32 v221, v222, v223
  v_cvt_pk_bf16_f32 v222, v224, v225
  v_cvt_pk_bf16_f32 v223, v226, v227
  v_cvt_pk_bf16_f32 v224, v228, v229
  ds_write_b128 v4, v[220:223] offset:6144
  v_cvt_pk_bf16_f32 v225, v230, v231
  v_cvt_pk_bf16_f32 v226, v232, v233
  v_cvt_pk_bf16_f32 v227, v234, v235
  v_cvt_pk_bf16_f32 v236, v236, v237
  v_cvt_pk_bf16_f32 v237, v238, v239
  v_cvt_pk_bf16_f32 v238, v240, v241
  v_cvt_pk_bf16_f32 v239, v242, v243
  v_cvt_pk_bf16_f32 v240, v244, v245
  v_cvt_pk_bf16_f32 v241, v246, v247
  v_cvt_pk_bf16_f32 v242, v248, v249
  v_cvt_pk_bf16_f32 v243, v250, v251
  v_cvt_pk_bf16_f32 v60, v60, v61
  v_cvt_pk_bf16_f32 v61, v62, v63
  v_cvt_pk_bf16_f32 v62, v64, v65
  v_cvt_pk_bf16_f32 v63, v66, v67
  v_cvt_pk_bf16_f32 v64, v68, v69
  v_cvt_pk_bf16_f32 v65, v70, v71
  v_cvt_pk_bf16_f32 v66, v72, v73
  v_cvt_pk_bf16_f32 v67, v74, v75
  ds_write_b128 v5, v[224:227] offset:6144
  ds_write_b128 v4, v[236:239] offset:6208
  ds_write_b128 v5, v[240:243] offset:6208
  ds_write_b128 v4, v[60:63] offset:6272
  ds_write_b128 v5, v[64:67] offset:6272
  ds_read_b128 a[24:27], v6 offset:6144
  ds_read_b128 a[28:31], v6 offset:7168
  ds_read_b128 a[32:35], v6 offset:8192
  ds_read_b128 a[36:39], v6 offset:9216
  ds_read_b128 a[40:43], v6 offset:10240
  ds_read_b128 a[44:47], v6 offset:11264
  s_waitcnt lgkmcnt(5)
  buffer_store_dwordx4 a[24:27], v7, s[12:15], s46 offen offset:0 sc1
  s_waitcnt lgkmcnt(4)
  buffer_store_dwordx4 a[28:31], v8, s[12:15], s46 offen offset:1024 sc1
  s_waitcnt lgkmcnt(3)
  buffer_store_dwordx4 a[32:35], v9, s[12:15], s46 offen offset:2048 sc1
  s_waitcnt lgkmcnt(1)
  buffer_store_dwordx4 a[36:39], v7, s[12:15], s47 offen offset:0 sc1
  buffer_store_dwordx4 a[40:43], v8, s[12:15], s47 offen offset:1024 sc1
  s_waitcnt lgkmcnt(0)
  buffer_store_dwordx4 a[44:47], v9, s[12:15], s47 offen offset:2048 sc1
  s_endpgm
.section .rodata,"a"
.p2align 6
.amdhsa_kernel standalone__window_attn_swin__vision_kernel
  .amdhsa_next_free_vgpr 512
  .amdhsa_next_free_sgpr 102
  .amdhsa_accum_offset 256
  .amdhsa_group_segment_fixed_size 0
  .amdhsa_kernarg_size 72
  .amdhsa_user_sgpr_count 2
  .amdhsa_user_sgpr_kernarg_segment_ptr 1
  .amdhsa_system_sgpr_workgroup_id_x 1
.end_amdhsa_kernel
```
